```python
import torch

def _softmax(x, axis=-1):
    return torch.softmax(x, dim=axis)

def _gelu(x):
    return torch.nn.functional.gelu(x, approximate='tanh')

def _silu(x):
    return torch.nn.functional.silu(x)

def _sigmoid(x):
    return torch.sigmoid(x)

def _layernorm(x, axis=-1, eps=1e-05):
    m = x.mean(dim=axis, keepdim=True)
    v = x.var(dim=axis, keepdim=True, unbiased=False)
    return (x - m) / torch.sqrt(v + eps)

def _scatter_add(tgt, idx, src, axis=0):
    return tgt.clone().index_add_(axis, idx, src)

def _segment_sum(src, seg, n):
    out = torch.zeros((n,) + src.shape[1:], dtype=src.dtype)
    return out.index_add_(0, seg, src)

def _pad(x, pw):
    flat = tuple((v for pair in reversed(pw) for v in pair))
    return torch.nn.functional.pad(x, flat)
kernel_name = 'sequential_preLN__mha_block__mixer_gmlp__prompt'

def setup_inputs():

    _w = lambda a: (lambda t: t.to(torch.bfloat16) if t.is_floating_point() else t)(torch.as_tensor(a))

    def _A_setup():
        B, S, D, H = (1, 2048, 576, 32)
        return {'x': _w((lambda *s: torch.randn(*s, dtype=torch.bfloat16) * 0.05)(B, S, D)), 'wqkv': _w((lambda *s: torch.randn(*s, dtype=torch.bfloat16) * 0.05)(D, 3 * D)), 'wo': _w((lambda *s: torch.randn(*s, dtype=torch.bfloat16) * 0.05)(D, D))}
    _A_in = _A_setup()

    def _B_setup():
        B, S, D, F = (1, 2048, 576, 4608)
        Fh = F // 2
        return {'x': _w((lambda *s: torch.randn(*s, dtype=torch.bfloat16) * 0.05)(B, S, D)), 'w_in': _w((lambda *s: torch.randn(*s, dtype=torch.bfloat16) * 0.8)(D, 2 * Fh)), 'w_sp': _w(0.01 * (lambda *s: torch.randn(*s, dtype=torch.bfloat16) * 0.8)(S, S)), 'b_sp': _w(1.0 + 0.01 * (lambda *s: torch.randn(*s, dtype=torch.bfloat16) * 0.05)(S)), 'w_out': _w((lambda *s: torch.randn(*s, dtype=torch.bfloat16) * 0.05)(Fh, D))}
    _B_in = _B_setup()
    return {'A_x': _A_in['x'], 'A_wqkv': _A_in['wqkv'], 'A_wo': _A_in['wo'], 'B_x': _B_in['x'], 'B_w_in': _B_in['w_in'], 'B_w_sp': _B_in['w_sp'], 'B_b_sp': _B_in['b_sp'], 'B_w_out': _B_in['w_out']}

def reference(A_x, A_wqkv, A_wo, B_x, B_w_in, B_w_sp, B_b_sp, B_w_out):

    def _A_ref(x, wqkv, wo):
        B, S, D = x.shape
        H = 32
        Dh = D // H
        qkv = (lambda x, *d: x.permute(*d))((x @ wqkv).reshape(B, S, 3, H, Dh), 2, 0, 3, 1, 4)
        q, k, v = (qkv[0], qkv[1], qkv[2])
        scores = torch.einsum('bhqd,bhkd->bhqk', q, k) * Dh ** (-0.5)
        p = _softmax(scores, axis=-1)
        o = torch.einsum('bhqk,bhkd->bhqd', p, v)
        return (lambda x, *d: x.permute(*d))(o, 0, 2, 1, 3).reshape(B, S, D) @ wo

    def _B_ref(x, w_in, w_sp, b_sp, w_out):
        B, S, D = x.shape
        F = w_in.shape[-1]
        Fh = F // 2
        z = _gelu(torch.einsum('bsd,df->bsf', x, w_in))
        z1 = z[..., :Fh].clone()
        z2 = _layernorm(z[..., Fh:], axis=-1)
        g = torch.einsum('ts,bsf->btf', w_sp, z2) + b_sp[None, :, None]
        return torch.einsum('bsf,fd->bsd', z1 * g, w_out)
    x = A_x
    h = x + _A_ref(_layernorm(x, axis=-1), A_wqkv, A_wo)
    h2 = h + _B_ref(_layernorm(h, axis=-1), B_w_in, B_w_sp, B_b_sp, B_w_out)
    return h2
```

```asm
; @launch grid=(256,1,1) block=(256,1,1) lds=163840
.amdgcn_target "amdgcn-amd-amdhsa--gfx950"
.text
.globl sequential_preLN__mha_block__mixer_gmlp__prompt_kernel
.p2align 12
.type sequential_preLN__mha_block__mixer_gmlp__prompt_kernel,@function
sequential_preLN__mha_block__mixer_gmlp__prompt_kernel:
L_entry:
  s_cmp_ge_u32 s2, 256
  s_cbranch_scc1 L_k1_end
  v_lshrrev_b32 v1, 6, v0
  s_nop 0
  v_readfirstlane_b32 s12, v1
  v_and_b32 v1, 63, v0
  v_and_b32 v2, 15, v0
  v_bfe_u32 v3, v0, 4, 2
  s_load_dwordx4 s[4:7], s[0:1], 0
  s_load_dwordx2 s[8:9], s[0:1], 80
  s_load_dwordx2 s[100:101], s[0:1], 72
  s_load_dwordx2 s[64:65], s[0:1], 32
  s_load_dwordx2 s[56:57], s[0:1], 16
  s_getpc_b64 s[44:45]
L_pc_1:
  s_add_u32 s44, s44, L_k1_pf0-L_pc_1
  s_addc_u32 s45, s45, 0
  s_lshr_b32 s46, s2, 3
  s_lshl_b32 s46, s46, 8
  v_and_b32 v236, 63, v0
  v_lshlrev_b32 v236, 13, v236
  v_lshrrev_b32_e64 v237, 6, v0
  v_lshl_add_u32 v236, v237, 6, v236
  v_add_u32_e64 v236, s46, v236
  v_mov_b32 v237, L_k2_end-L_k1_pf0-4
  v_cmp_gt_u32 vcc, v237, v236
  s_and_saveexec_b64 s[46:47], vcc
  global_load_dword v237, v236, s[44:45]
  s_mov_b64 exec, -1
L_k1_pf0:
  s_cmp_lt_u32 s2, 224
  s_cbranch_scc1 L_k1_main
  s_load_dwordx2 s[20:21], s[0:1], 56
  s_sub_u32 s13, s2, 224
  v_lshlrev_b32 v4, 4, v1
  v_mov_b32 v8, -1
  v_mov_b32 v9, -1
  v_mov_b32 v10, -1
  v_mov_b32_e64 v11, -1
  s_lshl_b32 s59, s13, 2
  s_add_u32 s59, s59, s12
  s_mul_i32 s59, s59, 5120
  s_add_u32 s60, s59, 4096
  s_waitcnt lgkmcnt(0)
  s_add_u32 s96, s8, 60817408
  s_addc_u32 s97, s9, 0
  s_mov_b32 s98, 327680
  s_mov_b32 s99, 0x00020000
  buffer_store_dwordx4 v[8:11], v4, s[96:99], s59 offen offset:0 sc0 sc1
  buffer_store_dwordx4 v[8:11], v4, s[96:99], s59 offen offset:1024 sc0 sc1
  buffer_store_dwordx4 v[8:11], v4, s[96:99], s59 offen offset:2048 sc0 sc1
  buffer_store_dwordx4 v[8:11], v4, s[96:99], s59 offen offset:3072 sc0 sc1
  buffer_store_dwordx4 v[8:11], v4, s[96:99], s60 offen offset:0 sc0 sc1
  s_branch L_k1_colsum
L_k1_main:
  s_and_b32 s13, s2, 7
  s_lshr_b32 s14, s2, 3
  s_lshr_b32 s48, s13, 1
  s_lshl_b32 s10, s48, 2
  s_and_b32 s15, s14, 3
  s_add_u32 s10, s10, s15
  s_and_b32 s49, s13, 1
  s_lshr_b32 s50, s14, 2
  s_lshl_b32 s11, s50, 1
  s_add_u32 s11, s11, s49
  s_add_u32 s49, s49, s15
  s_lshl_b32 s49, s49, 1
  s_lshr_b32 s15, s15, 1
  s_add_u32 s50, s50, s49
  s_add_u32 s48, s48, s15
  s_add_u32 s50, s50, s48
  s_sub_u32 s51, s50, 9
  s_cmp_ge_u32 s50, 9
  s_cselect_b32 s50, s51, s50
  s_sub_u32 s51, s50, 9
  s_cmp_ge_u32 s50, 9
  s_cselect_b32 s50, s51, s50
  s_lshr_b32 s28, s12, 1
  s_and_b32 s29, s12, 1
  v_lshrrev_b32 v16, 3, v1
  v_and_b32 v17, 7, v1
  v_xor_b32 v17, v17, v16
  v_mul_u32_u24 v4, 1152, v16
  v_lshl_add_u32 v4, v17, 4, v4
  v_bfe_u32 v16, v1, 1, 3
  v_xor_b32 v16, v16, v3
  v_and_b32 v17, 1, v1
  v_lshl_or_b32 v16, v16, 1, v17
  v_mul_u32_u24 v28, 3456, v3
  v_lshlrev_b32_e64 v16, 4, v16
  v_xor_b32 v17, 128, v16
  v_add_u32 v29, v28, v17
  v_add_u32 v28, v28, v16
  v_add_u32 v5, 8192, v4
  v_add_u32 v6, 16384, v4
  v_add_u32 v7, 24576, v4
  v_add_u32 v31, 79872, v29
  v_add_u32 v30, 53248, v28
  v_add_u32 v29, 26624, v29
  s_lshl_b32 s31, s10, 263
  s_lshl_b32 s15, s12, 5
  s_add_u32 s31, s31, s15
  s_mul_i32 s31, s31, 1152
  s_lshl_b32 s32, s28, 261
  s_lshl_b32 s15, s29, 2
  s_add_u32 s32, s32, s15
  s_mul_i32 s32, s32, 3456
  s_lshl_b32 s15, s11, 8
  s_add_u32 s32, s32, s15
  s_lshl_b32 s33, s12, 12
  s_add_u32 s34, s33, 16384
  s_mul_i32 s52, s10, 9
  s_mul_i32 s53, s11, 9
  s_add_u32 s48, s52, s50
  s_add_u32 s49, s53, s50
  s_waitcnt lgkmcnt(0)
  s_mov_b32 s16, s4
  s_mov_b32 s17, s5
  s_mov_b32 s18, 2359296
  s_mov_b32 s19, 0x00020000
  s_mov_b32 s20, s6
  s_mov_b32 s21, s7
  s_mov_b32 s22, 1990656
  s_mov_b32 s23, 0x00020000
  s_lshl_b32 s51, s50, 263
  s_add_u32 m0, s33, 0
  s_add_u32 s51, s51, s31
  buffer_load_dwordx4 v4, s[16:19], s51 offen offset:0 lds
  buffer_load_dwordx4 v5, s[16:19], s51 offen offset:1024 lds
  buffer_load_dwordx4 v6, s[16:19], s51 offen offset:2048 lds
  buffer_load_dwordx4 v7, s[16:19], s51 offen offset:3072 lds
  s_mul_i32 s51, s50, 221184
  s_add_u32 m0, s34, 0
  s_add_u32 s51, s51, s32
  buffer_load_dwordx4 v28, s[20:23], s51 offen offset:0 lds
  buffer_load_dwordx4 v29, s[20:23], s51 offen offset:1024 lds
  buffer_load_dwordx4 v30, s[20:23], s51 offen offset:2048 lds
  buffer_load_dwordx4 v31, s[20:23], s51 offen offset:3072 lds
  s_add_u32 s24, s8, 0
  s_addc_u32 s25, s9, 0
  s_mov_b32 s26, 7077888
  s_mov_b32 s27, 0x00020000
  s_add_u32 s96, s8, 60817408
  s_addc_u32 s97, s9, 0
  s_mov_b32 s98, 327680
  s_mov_b32 s99, 0x00020000
  s_lshl_b32 s58, s11, 4
  s_add_u32 s58, s58, s10
  s_lshl_b32 s59, s58, 5
  s_add_u32 s59, s59, 4096
  v_lshlrev_b32 v247, 24, v0
  v_add_u32 v239, s59, v247
  s_and_b32 s59, s58, 7
  s_lshr_b32 s58, s58, 3
  s_lshl_b32 s58, s58, 4
  s_add_u32 s58, s58, s59
  s_lshl_b32 s58, s58, 2
  v_lshrrev_b32 v244, 3, v0
  v_lshlrev_b32 v244, 24, v244
  v_and_b32 v246, 7, v0
  v_mul_u32_u24 v246, 2048, v246
  v_add3_u32 v244, s58, v244, v246
  v_and_b32 v246, 15, v0
  v_mul_u32_u24 v246, 16, v246
  v_mov_b32 v240, 1
  v_mov_b32 v241, 1
  v_mov_b32 v242, 1
  v_mov_b32 v243, 1
  s_mov_b32 s66, 5308416
  s_mov_b32 s67, 0x00020000
  s_sub_u32 s59, s2, 40
  s_max_i32 s60, s59, 0
  s_mul_i32 s57, s60, 911
  s_lshr_b32 s57, s57, 16
  s_mul_i32 s61, s57, 72
  s_sub_u32 s60, s60, s61
  s_cmp_lt_i32 s59, 0
  s_cselect_b32 s59, 0x40000000, 0
  s_lshl_b32 s60, s60, 2
  s_add_u32 s60, s60, s12
  s_mul_i32 s61, s57, 1769472
  s_lshl_b32 s3, s60, 261
  s_add_u32 s61, s61, s3
  s_add_u32 s61, s61, s59
  s_mul_i32 s3, s12, 73696
  s_add_u32 s61, s61, s3
  v_lshrrev_b32 v248, 3, v1
  v_mul_u32_u24 v248, 9216, v248
  v_and_b32_e64 v252, 7, v1
  v_lshl_add_u32 v248, v252, 4, v248
  v_add_u32_e64 v248, s61, v248
  s_mul_i32 s61, s57, 18432
  s_lshl_b32 s3, s60, 6
  s_add_u32 s61, s61, s3
  s_add_u32 s61, s61, s59
  v_lshrrev_b32 v250, 4, v1
  v_lshlrev_b32_e64 v250, 28, v250
  v_lshl_add_u32 v250, v1, 2, v250
  v_add_u32_e64 v250, s61, v250
  s_cmp_lt_u32 s60, 144
  s_cselect_b32 s61, 952320, 0
  s_cselect_b32 s3, 0, 144
  s_max_u32 s61, s61, 786432
  s_sub_u32 s60, s60, s3
  s_add_u32 s61, s61, s59
  s_mul_i32 s57, s57, 18432
  s_add_u32 s61, s61, s57
  s_mul_i32 s3, s60, 21846
  s_lshr_b32 s3, s3, 16
  s_mul_i32 s57, s3, 3
  s_sub_u32 s60, s60, s57
  s_lshl_b32 s60, s60, 10
  s_add_u32 s61, s61, s60
  s_mul_i32 s57, s3, 21846
  s_lshr_b32 s57, s57, 272
  s_mul_i32 s3, s3, 55296
  s_mul_i32 s57, s57, 165888
  s_add_u32 s61, s61, s3
  s_add_u32 s61, s61, s57
  v_lshlrev_b32 v249, 4, v1
  v_add_u32 v249, s61, v249
  v_and_b32 v16, 7, v2
  v_xor_b32 v16, v16, v3
  v_lshlrev_b32_e64 v16, 4, v16
  v_lshl_add_u32 v16, v2, 7, v16
  s_lshl_b32 s15, s28, 269
  s_lshl_b32 s35, s29, 12
  s_add_u32 s36, s15, s35
  s_xor_b32 s37, s36, 4096
  v_xor_b32 v17, 0, v16
  v_add_u32 v8, s36, v17
  v_add_u32 v12, 0x10000, v8
  v_add_u32 v164, 0x20000, v8
  v_xor_b32 v17, 64, v16
  v_add_u32 v9, s36, v17
  v_add_u32 v13, 0x10000, v9
  v_add_u32 v165, 0x20000, v9
  v_xor_b32 v17, 0, v16
  v_add_u32 v10, s37, v17
  v_add_u32 v14, 0x10000, v10
  v_add_u32 v166, 0x20000, v10
  v_xor_b32 v17, 64, v16
  v_add_u32 v11, s37, v17
  v_add_u32 v15, 0x10000, v11
  v_add_u32 v167, 0x20000, v11
  v_lshrrev_b32 v16, 2, v1
  v_and_b32 v17, 7, v16
  v_lshlrev_b32 v16, 8, v16
  v_and_b32 v18, 3, v1
  v_lshl_add_u32 v16, v18, 3, v16
  v_add_u32 v16, 16384, v16
  s_lshl_b32 s15, s29, 2
  s_lshl_b32 s35, s28, 1
  s_add_u32 s38, s15, s35
  s_xor_b32 s15, s38, 0
  v_xor_b32_e64 v18, s15, v17
  v_lshl_add_u32 v20, v18, 5, v16
  v_add_u32 v24, 0x10000, v20
  v_add_u32 v168, 0x20000, v20
  s_xor_b32 s15, s38, 1
  v_xor_b32 v18, s15, v17
  v_lshl_add_u32 v21, v18, 5, v16
  v_add_u32 v25, 0x10000, v21
  v_add_u32 v169, 0x20000, v21
  s_xor_b32 s15, s38, 2
  v_xor_b32 v18, s15, v17
  v_lshl_add_u32 v22, v18, 5, v16
  v_add_u32 v26, 0x10000, v22
  v_add_u32 v170, 0x20000, v22
  s_xor_b32 s15, s38, 3
  v_xor_b32 v18, s15, v17
  v_lshl_add_u32 v23, v18, 5, v16
  v_add_u32 v27, 0x10000, v23
  v_add_u32 v171, 0x20000, v23
  v_mov_b32 v160, 0x3f803f80
  v_mov_b32 v161, 0x3f803f80
  v_mov_b32 v162, 0x3f803f80
  v_mov_b32 v163, 0x3f803f80
  s_add_u32 s50, s50, 1
  s_cmp_eq_u32 s50, 9
  s_cselect_b32 s50, 0, s50
  s_lshl_b32 s51, s50, 7
  s_add_u32 m0, s33, 32768
  s_add_u32 s51, s51, s31
  buffer_load_dwordx4 v4, s[16:19], s51 offen offset:0 lds
  buffer_load_dwordx4 v5, s[16:19], s51 offen offset:1024 lds
  buffer_load_dwordx4 v6, s[16:19], s51 offen offset:2048 lds
  buffer_load_dwordx4 v7, s[16:19], s51 offen offset:3072 lds
  s_mul_i32 s51, s50, 221184
  s_add_u32 m0, s34, 32768
  s_add_u32 s51, s51, s32
  buffer_load_dwordx4 v28, s[20:23], s51 offen offset:0 lds
  buffer_load_dwordx4 v29, s[20:23], s51 offen offset:1024 lds
  buffer_load_dwordx4 v30, s[20:23], s51 offen offset:2048 lds
  buffer_load_dwordx4 v31, s[20:23], s51 offen offset:3072 lds
  s_lshl_b32 s39, s11, 7
  s_lshl_b32 s15, s29, 6
  s_add_u32 s39, s39, s15
  v_add_u32 v16, s39, v2
  v_lshlrev_b32 v16, 6, v16
  v_and_b32 v17, 1, v3
  v_lshl_add_u32 v16, v17, 5, v16
  v_lshrrev_b32_e64 v17, 1, v3
  v_lshl_add_u32 v16, v17, 4, v16
  s_lshl_b32 s15, s10, 1
  s_add_u32 s15, s15, s28
  s_mul_i32 s15, s15, 221184
  s_cmp_ge_u32 s39, 1728
  s_cselect_b32 s15, 0x40000000, s15
  s_xor_b32 s36, s35, 0
  s_lshl_b32 s36, s36, 10
  s_add_u32 s36, s36, s15
  v_add_u32 v172, s36, v16
  s_xor_b32 s36, s35, 1
  s_lshl_b32 s36, s36, 10
  s_add_u32 s36, s36, s15
  v_add_u32 v173, s36, v16
  s_xor_b32 s36, s35, 2
  s_lshl_b32 s36, s36, 10
  s_add_u32 s36, s36, s15
  v_add_u32 v174, s36, v16
  s_xor_b32 s36, s35, 3
  s_lshl_b32 s36, s36, 10
  s_add_u32 s36, s36, s15
  v_add_u32_e64 v175, s36, v16
  s_mul_i32 s36, s29, 110592
  s_sub_u32 s37, 110592, s36
  s_lshl_b32 s48, s48, 2
  s_add_u32 s48, s48, s12
  s_lshl_b32 s48, s48, 264
  s_add_u32 s48, s48, 98304
  s_lshl_b32 s49, s49, 2
  s_lshr_b32 s15, s38, 1
  s_add_u32 s49, s49, s15
  s_lshl_b32 s49, s49, 7
  s_add_u32 s49, s49, 245760
  v_lshrrev_b32 v16, 2, v2
  v_xor_b32 v16, v16, v3
  v_lshlrev_b32_e64 v16, 28, v16
  v_lshl_add_u32 v180, v2, 3, v16
  v_lshlrev_b32_e64 v16, 28, v3
  v_lshl_add_u32 v181, v2, 2, v16
  v_and_b32_e64 v16, 3, v2
  v_cmp_eq_u32 s[42:43], 1, v16
  v_cmp_eq_u32 s[44:45], 2, v16
  v_cmp_eq_u32 s[46:47], 3, v16
  s_lshl_b32 s52, s52, 2
  s_add_u32 s52, s52, s12
  s_lshl_b32 s52, s52, 264
  s_add_u32 s52, s52, 98304
  s_add_u32 s54, s52, 4096
  s_lshl_b32 s53, s53, 2
  s_add_u32 s53, s53, s12
  s_lshl_b32 s53, s53, 263
  s_add_u32 s53, s53, 245760
  v_lshrrev_b32 v17, 5, v1
  v_and_b32 v16, 31, v1
  v_lshlrev_b32_e64 v16, 2, v16
  v_lshl_add_u32 v194, v17, 9, v16
  v_lshlrev_b32_e64 v192, 1, v194
  v_lshl_add_u32 v195, v17, 28, v16
  v_add_u32 v195, 4096, v195
  v_lshlrev_b32_e64 v193, 1, v195
  v_lshl_add_u32 v16, v17, 10, v16
  s_lshl_b32 s15, s12, 263
  s_add_u32 s15, s15, 131072
  v_add_u32_e64 v16, s15, v16
  v_mov_b32 v253, 0x3eae1a93
  v_cmp_eq_u32_e64 vcc, 0, v17
  v_cndmask_b32 v253, v253, 1.0, vcc
  s_cmp_lt_u32 s39, 576
  s_cselect_b32 s35, 1024, 0
  s_add_u32 s15, s15, s35
  v_lshl_add_u32 v17, v3, 4, s15
  v_xor_b32 v19, 128, v17
  s_lshl_b32 s15, s38, 6
  s_add_u32 s15, s15, 133120
  v_lshl_add_u32 v18, v2, 2, s15
  v_xor_b32 v238, 128, v18
  s_mov_b64 exec, 0
  s_bitcmp1_b32 s12, 1
  s_cbranch_scc1 L_wh_0
  s_bitcmp1_b32 s12, 0
  s_cbranch_scc1 L_pg_1
  s_branch L_pg_0
L_wh_0:
  s_bitcmp1_b32 s12, 0
  s_cbranch_scc1 L_pg_3
  s_branch L_pg_2
L_wr_0:
  s_mov_b64 exec, -1
  s_waitcnt vmcnt(8)
  s_barrier
  ds_read_b128 v[32:35], v8 offset:0
  ds_read_b64_tr_b16 v[64:65], v20 offset:0
  ds_read_b64_tr_b16 v[66:67], v20 offset:4096
  ds_read_b128 v[36:39], v8 offset:2048
  ds_read_b128 v[40:43], v10 offset:0
  ds_read_b128 v[44:47], v10 offset:2048
  ds_read_b64_tr_b16 v[68:69], v21 offset:0
  ds_read_b64_tr_b16 v[70:71], v21 offset:4096
  ds_read_b64_tr_b16 v[72:73], v22 offset:0
  ds_read_b64_tr_b16 v[74:75], v22 offset:4096
  ds_read_b64_tr_b16 v[76:77], v23 offset:0
  ds_read_b64_tr_b16 v[78:79], v23 offset:4096
  global_load_dword v245, v246, s[100:101] sc0 sc1
  s_waitcnt lgkmcnt(9)
  v_mfma_f32_16x16x32_bf16 v[96:99], v[32:35], v[64:67], 0
  ds_read_b128 v[48:51], v9 offset:0
  s_waitcnt lgkmcnt(9)
  v_mfma_f32_16x16x32_bf16 v[112:115], v[36:39], v[64:67], 0
  ds_read_b64_tr_b16 v[80:81], v20 offset:8192
  s_add_u32 s50, s50, 1
  s_cmp_eq_u32 s50, 9
  s_cselect_b32 s50, 0, s50
  s_lshl_b32 s51, s50, 7
  s_add_u32 m0, s33, 65536
  s_add_u32 s51, s51, s31
  buffer_load_dwordx4 v4, s[16:19], s51 offen offset:0 lds
  s_waitcnt lgkmcnt(9)
  v_mfma_f32_16x16x32_bf16 v[128:131], v[40:43], v[64:67], 0
  ds_read_b64_tr_b16 v[82:83], v20 offset:12288
  s_waitcnt lgkmcnt(9)
  v_mfma_f32_16x16x32_bf16 v[144:147], v[44:47], v[64:67], 0
  ds_read_b128 v[52:55], v9 offset:2048
  buffer_load_dwordx4 v5, s[16:19], s51 offen offset:1024 lds
  s_waitcnt lgkmcnt(8)
  v_mfma_f32_16x16x32_bf16 v[100:103], v[32:35], v[68:71], 0
  ds_read_b64_tr_b16 v[84:85], v21 offset:8192
  v_mfma_f32_16x16x32_bf16 v[116:119], v[36:39], v[68:71], 0
  ds_read_b64_tr_b16 v[86:87], v21 offset:12288
  buffer_load_dwordx4 v6, s[16:19], s51 offen offset:2048 lds
  v_mfma_f32_16x16x32_bf16 v[132:135], v[40:43], v[68:71], 0
  ds_read_b128 v[56:59], v11 offset:0
  v_mfma_f32_16x16x32_bf16 v[148:151], v[44:47], v[68:71], 0
  ds_read_b128 v[60:63], v11 offset:2048
  buffer_load_dwordx4 v7, s[16:19], s51 offen offset:3072 lds
  s_waitcnt lgkmcnt(10)
  v_mfma_f32_16x16x32_bf16 v[104:107], v[32:35], v[72:75], 0
  ds_read_b64_tr_b16 v[88:89], v22 offset:8192
  v_mfma_f32_16x16x32_bf16 v[120:123], v[36:39], v[72:75], 0
  ds_read_b64_tr_b16 v[90:91], v22 offset:12288
  s_mul_i32 s51, s50, 221184
  s_add_u32 m0, s34, 65536
  s_add_u32 s51, s51, s32
  buffer_load_dwordx4 v28, s[20:23], s51 offen offset:0 lds
  v_mfma_f32_16x16x32_bf16 v[136:139], v[40:43], v[72:75], 0
  ds_read_b64_tr_b16 v[92:93], v23 offset:8192
  v_mfma_f32_16x16x32_bf16 v[152:155], v[44:47], v[72:75], 0
  ds_read_b64_tr_b16 v[94:95], v23 offset:12288
  buffer_load_dwordx4 v29, s[20:23], s51 offen offset:1024 lds
  s_waitcnt lgkmcnt(12)
  v_mfma_f32_16x16x32_bf16 v[108:111], v[32:35], v[76:79], 0
  v_mfma_f32_16x16x32_bf16 v[124:127], v[36:39], v[76:79], 0
  buffer_load_dwordx4 v30, s[20:23], s51 offen offset:2048 lds
  v_mfma_f32_16x16x32_bf16 v[140:143], v[40:43], v[76:79], 0
  v_mfma_f32_16x16x32_bf16 v[156:159], v[44:47], v[76:79], 0
  buffer_load_dwordx4 v31, s[20:23], s51 offen offset:3072 lds
  v_mfma_f32_16x16x32_bf16 v[212:215], v[32:35], v[160:163], 0
  v_mfma_f32_16x16x32_bf16 v[220:223], v[32:35], v[32:35], 0
  v_mfma_f32_16x16x32_bf16 v[228:231], v[160:163], v[64:67], 0
  v_mfma_f32_16x16x32_bf16 v[216:219], v[36:39], v[160:163], 0
  v_mfma_f32_16x16x32_bf16 v[224:227], v[36:39], v[36:39], 0
  v_mfma_f32_16x16x32_bf16 v[232:235], v[160:163], v[68:71], 0
  s_waitcnt vmcnt(9)
  s_barrier
  s_waitcnt lgkmcnt(9)
  v_mfma_f32_16x16x32_bf16 v[212:215], v[48:51], v[160:163], v[212:215]
  ds_read_b128 v[32:35], v8 offset:32768
  v_mfma_f32_16x16x32_bf16 v[220:223], v[48:51], v[48:51], v[220:223]
  ds_read_b64_tr_b16 v[64:65], v20 offset:32768
  v_mfma_f32_16x16x32_bf16 v[228:231], v[160:163], v[80:83], v[228:231]
  ds_read_b64_tr_b16 v[66:67], v20 offset:36864
  s_waitcnt lgkmcnt(11)
  v_mfma_f32_16x16x32_bf16 v[216:219], v[52:55], v[160:163], v[216:219]
  ds_read_b128 v[36:39], v8 offset:34816
  v_mfma_f32_16x16x32_bf16 v[224:227], v[52:55], v[52:55], v[224:227]
  ds_read_b128 v[40:43], v10 offset:32768
  s_waitcnt lgkmcnt(11)
  v_mfma_f32_16x16x32_bf16 v[232:235], v[160:163], v[84:87], v[232:235]
  ds_read_b128 v[44:47], v10 offset:34816
  v_mfma_f32_16x16x32_bf16 v[96:99], v[48:51], v[80:83], v[96:99]
  ds_read_b64_tr_b16 v[68:69], v21 offset:32768
  v_mfma_f32_16x16x32_bf16 v[112:115], v[52:55], v[80:83], v[112:115]
  ds_read_b64_tr_b16 v[70:71], v21 offset:36864
  s_waitcnt lgkmcnt(13)
  v_mfma_f32_16x16x32_bf16 v[128:131], v[56:59], v[80:83], v[128:131]
  ds_read_b64_tr_b16 v[72:73], v22 offset:32768
  s_waitcnt lgkmcnt(13)
  v_mfma_f32_16x16x32_bf16 v[144:147], v[60:63], v[80:83], v[144:147]
  ds_read_b64_tr_b16 v[74:75], v22 offset:36864
  v_cndmask_b32 v212, v212, v213, s[42:43]
  v_mfma_f32_16x16x32_bf16 v[100:103], v[48:51], v[84:87], v[100:103]
  ds_read_b64_tr_b16 v[76:77], v23 offset:32768
  v_cndmask_b32 v220, v220, v221, s[42:43]
  v_mfma_f32_16x16x32_bf16 v[116:119], v[52:55], v[84:87], v[116:119]
  ds_read_b64_tr_b16 v[78:79], v23 offset:36864
  v_cndmask_b32 v212, v212, v214, s[44:45]
  v_mfma_f32_16x16x32_bf16 v[132:135], v[56:59], v[84:87], v[132:135]
  s_add_u32 s50, s50, 1
  s_cmp_eq_u32 s50, 9
  s_cselect_b32 s50, 0, s50
  s_lshl_b32 s51, s50, 7
  s_add_u32 m0, s33, 98304
  s_add_u32 s51, s51, s31
  buffer_load_dwordx4 v4, s[16:19], s51 offen offset:0 lds
  v_mfma_f32_16x16x32_bf16 v[148:151], v[60:63], v[84:87], v[148:151]
  v_cndmask_b32 v220, v220, v222, s[44:45]
  v_cndmask_b32 v212, v212, v215, s[46:47]
  s_waitcnt lgkmcnt(14)
  v_mfma_f32_16x16x32_bf16 v[104:107], v[48:51], v[88:91], v[104:107]
  buffer_load_dwordx4 v5, s[16:19], s51 offen offset:1024 lds
  v_mfma_f32_16x16x32_bf16 v[120:123], v[52:55], v[88:91], v[120:123]
  v_cndmask_b32 v213, v220, v223, s[46:47]
  v_cndmask_b32 v216, v216, v217, s[42:43]
  v_mfma_f32_16x16x32_bf16 v[136:139], v[56:59], v[88:91], v[136:139]
  buffer_load_dwordx4 v6, s[16:19], s51 offen offset:2048 lds
  v_mfma_f32_16x16x32_bf16 v[152:155], v[60:63], v[88:91], v[152:155]
  v_cndmask_b32 v224, v224, v225, s[42:43]
  v_cndmask_b32 v216, v216, v218, s[44:45]
  s_waitcnt lgkmcnt(12)
  v_mfma_f32_16x16x32_bf16 v[108:111], v[48:51], v[92:95], v[108:111]
  buffer_load_dwordx4 v7, s[16:19], s51 offen offset:3072 lds
  v_mfma_f32_16x16x32_bf16 v[124:127], v[52:55], v[92:95], v[124:127]
  v_cndmask_b32 v224, v224, v226, s[44:45]
  v_cndmask_b32 v216, v216, v219, s[46:47]
  v_mfma_f32_16x16x32_bf16 v[140:143], v[56:59], v[92:95], v[140:143]
  v_cndmask_b32 v217, v224, v227, s[46:47]
  v_mfma_f32_16x16x32_bf16 v[156:159], v[60:63], v[92:95], v[156:159]
  s_waitcnt vmcnt(12)
  s_mov_b32 s55, 0
L_d1_chk:
  v_cmp_ne_u32 vcc, 1, v245
  s_cmp_eq_u64 vcc, 0
  s_cbranch_scc1 L_d1_go
  s_add_u32 s55, s55, 1
  s_cmp_lt_u32 s55, 0x40000
  s_cbranch_scc0 L_d1_go
  global_load_dword v245, v246, s[100:101] sc0 sc1
  s_waitcnt vmcnt(0)
  s_branch L_d1_chk
L_d1_go:
  buffer_store_dwordx2 v[212:213], v180, s[96:99], s48 offen offset:0 sc0 sc1
  buffer_store_dword v228, v181, s[96:99], s49 offen offset:0 sc0 sc1
  buffer_store_dwordx2 v[216:217], v180, s[96:99], s48 offen offset:128 sc0 sc1
  buffer_store_dword v232, v181, s[96:99], s49 offen offset:64 sc0 sc1
  s_waitcnt lgkmcnt(6)
  v_mfma_f32_16x16x32_bf16 v[96:99], v[32:35], v[64:67], v[96:99]
  ds_read_b128 v[48:51], v9 offset:32768
  v_mfma_f32_16x16x32_bf16 v[112:115], v[36:39], v[64:67], v[112:115]
  ds_read_b64_tr_b16 v[80:81], v20 offset:40960
  v_mfma_f32_16x16x32_bf16 v[128:131], v[40:43], v[64:67], v[128:131]
  ds_read_b64_tr_b16 v[82:83], v20 offset:45056
  v_mfma_f32_16x16x32_bf16 v[144:147], v[44:47], v[64:67], v[144:147]
  ds_read_b128 v[52:55], v9 offset:34816
  s_waitcnt lgkmcnt(8)
  v_mfma_f32_16x16x32_bf16 v[100:103], v[32:35], v[68:71], v[100:103]
  ds_read_b128 v[56:59], v11 offset:32768
  v_mfma_f32_16x16x32_bf16 v[116:119], v[36:39], v[68:71], v[116:119]
  ds_read_b128 v[60:63], v11 offset:34816
  v_mfma_f32_16x16x32_bf16 v[132:135], v[40:43], v[68:71], v[132:135]
  ds_read_b64_tr_b16 v[84:85], v21 offset:40960
  v_mfma_f32_16x16x32_bf16 v[148:151], v[44:47], v[68:71], v[148:151]
  ds_read_b64_tr_b16 v[86:87], v21 offset:45056
  s_waitcnt lgkmcnt(10)
  v_mfma_f32_16x16x32_bf16 v[104:107], v[32:35], v[72:75], v[104:107]
  ds_read_b64_tr_b16 v[88:89], v22 offset:40960
  v_mfma_f32_16x16x32_bf16 v[120:123], v[36:39], v[72:75], v[120:123]
  ds_read_b64_tr_b16 v[90:91], v22 offset:45056
  v_mfma_f32_16x16x32_bf16 v[136:139], v[40:43], v[72:75], v[136:139]
  ds_read_b64_tr_b16 v[92:93], v23 offset:40960
  v_mfma_f32_16x16x32_bf16 v[152:155], v[44:47], v[72:75], v[152:155]
  ds_read_b64_tr_b16 v[94:95], v23 offset:45056
  s_waitcnt lgkmcnt(12)
  v_mfma_f32_16x16x32_bf16 v[108:111], v[32:35], v[76:79], v[108:111]
  s_mul_i32 s51, s50, 221184
  s_add_u32 m0, s34, 98304
  s_add_u32 s51, s51, s32
  buffer_load_dwordx4 v28, s[20:23], s51 offen offset:0 lds
  v_mfma_f32_16x16x32_bf16 v[124:127], v[36:39], v[76:79], v[124:127]
  buffer_load_dwordx4 v29, s[20:23], s51 offen offset:1024 lds
  v_mfma_f32_16x16x32_bf16 v[140:143], v[40:43], v[76:79], v[140:143]
  buffer_load_dwordx4 v30, s[20:23], s51 offen offset:2048 lds
  v_mfma_f32_16x16x32_bf16 v[156:159], v[44:47], v[76:79], v[156:159]
  buffer_load_dwordx4 v31, s[20:23], s51 offen offset:3072 lds
  s_waitcnt vmcnt(12)
  s_barrier
  s_waitcnt lgkmcnt(6)
  v_mfma_f32_16x16x32_bf16 v[96:99], v[48:51], v[80:83], v[96:99]
  ds_read_b128 v[32:35], v12 offset:0
  v_mfma_f32_16x16x32_bf16 v[112:115], v[52:55], v[80:83], v[112:115]
  ds_read_b64_tr_b16 v[64:65], v24 offset:0
  v_mfma_f32_16x16x32_bf16 v[128:131], v[56:59], v[80:83], v[128:131]
  ds_read_b64_tr_b16 v[66:67], v24 offset:4096
  v_mfma_f32_16x16x32_bf16 v[144:147], v[60:63], v[80:83], v[144:147]
  ds_read_b128 v[36:39], v12 offset:2048
  s_waitcnt lgkmcnt(8)
  v_mfma_f32_16x16x32_bf16 v[100:103], v[48:51], v[84:87], v[100:103]
  ds_read_b128 v[40:43], v14 offset:0
  v_mfma_f32_16x16x32_bf16 v[116:119], v[52:55], v[84:87], v[116:119]
  ds_read_b128 v[44:47], v14 offset:2048
  v_mfma_f32_16x16x32_bf16 v[132:135], v[56:59], v[84:87], v[132:135]
  ds_read_b64_tr_b16 v[68:69], v25 offset:0
  v_mfma_f32_16x16x32_bf16 v[148:151], v[60:63], v[84:87], v[148:151]
  ds_read_b64_tr_b16 v[70:71], v25 offset:4096
  s_waitcnt lgkmcnt(10)
  v_mfma_f32_16x16x32_bf16 v[104:107], v[48:51], v[88:91], v[104:107]
  ds_read_b64_tr_b16 v[72:73], v26 offset:0
  v_mfma_f32_16x16x32_bf16 v[120:123], v[52:55], v[88:91], v[120:123]
  ds_read_b64_tr_b16 v[74:75], v26 offset:4096
  v_mfma_f32_16x16x32_bf16 v[136:139], v[56:59], v[88:91], v[136:139]
  ds_read_b64_tr_b16 v[76:77], v27 offset:0
  v_mfma_f32_16x16x32_bf16 v[152:155], v[60:63], v[88:91], v[152:155]
  ds_read_b64_tr_b16 v[78:79], v27 offset:4096
  s_waitcnt lgkmcnt(12)
  v_mfma_f32_16x16x32_bf16 v[108:111], v[48:51], v[92:95], v[108:111]
  s_add_u32 s50, s50, 1
  s_cmp_eq_u32 s50, 9
  s_cselect_b32 s50, 0, s50
  s_lshl_b32 s51, s50, 263
  s_add_u32 m0, s33, 131072
  s_add_u32 s51, s51, s31
  buffer_load_dwordx4 v4, s[16:19], s51 offen offset:0 lds
  v_mfma_f32_16x16x32_bf16 v[124:127], v[52:55], v[92:95], v[124:127]
  buffer_load_dwordx4 v5, s[16:19], s51 offen offset:1024 lds
  v_mfma_f32_16x16x32_bf16 v[140:143], v[56:59], v[92:95], v[140:143]
  buffer_load_dwordx4 v6, s[16:19], s51 offen offset:2048 lds
  v_mfma_f32_16x16x32_bf16 v[156:159], v[60:63], v[92:95], v[156:159]
  buffer_load_dwordx4 v7, s[16:19], s51 offen offset:3072 lds
  s_waitcnt lgkmcnt(6)
  v_mfma_f32_16x16x32_bf16 v[96:99], v[32:35], v[64:67], v[96:99]
  ds_read_b128 v[48:51], v13 offset:0
  v_mfma_f32_16x16x32_bf16 v[112:115], v[36:39], v[64:67], v[112:115]
  ds_read_b64_tr_b16 v[80:81], v24 offset:8192
  v_mfma_f32_16x16x32_bf16 v[128:131], v[40:43], v[64:67], v[128:131]
  ds_read_b64_tr_b16 v[82:83], v24 offset:12288
  v_mfma_f32_16x16x32_bf16 v[144:147], v[44:47], v[64:67], v[144:147]
  ds_read_b128 v[52:55], v13 offset:2048
  s_waitcnt lgkmcnt(8)
  v_mfma_f32_16x16x32_bf16 v[100:103], v[32:35], v[68:71], v[100:103]
  ds_read_b128 v[56:59], v15 offset:0
  v_mfma_f32_16x16x32_bf16 v[116:119], v[36:39], v[68:71], v[116:119]
  ds_read_b128 v[60:63], v15 offset:2048
  v_mfma_f32_16x16x32_bf16 v[132:135], v[40:43], v[68:71], v[132:135]
  ds_read_b64_tr_b16 v[84:85], v25 offset:8192
  v_mfma_f32_16x16x32_bf16 v[148:151], v[44:47], v[68:71], v[148:151]
  ds_read_b64_tr_b16 v[86:87], v25 offset:12288
  s_waitcnt lgkmcnt(10)
  v_mfma_f32_16x16x32_bf16 v[104:107], v[32:35], v[72:75], v[104:107]
  ds_read_b64_tr_b16 v[88:89], v26 offset:8192
  v_mfma_f32_16x16x32_bf16 v[120:123], v[36:39], v[72:75], v[120:123]
  ds_read_b64_tr_b16 v[90:91], v26 offset:12288
  v_mfma_f32_16x16x32_bf16 v[136:139], v[40:43], v[72:75], v[136:139]
  ds_read_b64_tr_b16 v[92:93], v27 offset:8192
  v_mfma_f32_16x16x32_bf16 v[152:155], v[44:47], v[72:75], v[152:155]
  s_nop 0
L_pg_0:
  s_cbranch_execz L_wr_0
  ds_read_b64_tr_b16 v[94:95], v27 offset:12288
  s_waitcnt lgkmcnt(12)
  v_mfma_f32_16x16x32_bf16 v[108:111], v[32:35], v[76:79], v[108:111]
  s_mul_i32 s51, s50, 221184
  s_add_u32 m0, s34, 131072
  s_add_u32 s51, s51, s32
  buffer_load_dwordx4 v28, s[20:23], s51 offen offset:0 lds
  v_mfma_f32_16x16x32_bf16 v[124:127], v[36:39], v[76:79], v[124:127]
  buffer_load_dwordx4 v29, s[20:23], s51 offen offset:1024 lds
  v_mfma_f32_16x16x32_bf16 v[140:143], v[40:43], v[76:79], v[140:143]
  buffer_load_dwordx4 v30, s[20:23], s51 offen offset:2048 lds
  v_mfma_f32_16x16x32_bf16 v[156:159], v[44:47], v[76:79], v[156:159]
  buffer_load_dwordx4 v31, s[20:23], s51 offen offset:3072 lds
  s_waitcnt vmcnt(8)
  s_barrier
  s_waitcnt lgkmcnt(6)
  v_mfma_f32_16x16x32_bf16 v[96:99], v[48:51], v[80:83], v[96:99]
  ds_read_b128 v[32:35], v12 offset:32768
  v_mfma_f32_16x16x32_bf16 v[112:115], v[52:55], v[80:83], v[112:115]
  ds_read_b64_tr_b16 v[64:65], v24 offset:32768
  v_mfma_f32_16x16x32_bf16 v[128:131], v[56:59], v[80:83], v[128:131]
  ds_read_b64_tr_b16 v[66:67], v24 offset:36864
  v_mfma_f32_16x16x32_bf16 v[144:147], v[60:63], v[80:83], v[144:147]
  ds_read_b128 v[36:39], v12 offset:34816
  s_waitcnt lgkmcnt(8)
  v_mfma_f32_16x16x32_bf16 v[100:103], v[48:51], v[84:87], v[100:103]
  ds_read_b128 v[40:43], v14 offset:32768
  v_mfma_f32_16x16x32_bf16 v[116:119], v[52:55], v[84:87], v[116:119]
  ds_read_b128 v[44:47], v14 offset:34816
  v_mfma_f32_16x16x32_bf16 v[132:135], v[56:59], v[84:87], v[132:135]
  ds_read_b64_tr_b16 v[68:69], v25 offset:32768
  v_mfma_f32_16x16x32_bf16 v[148:151], v[60:63], v[84:87], v[148:151]
  ds_read_b64_tr_b16 v[70:71], v25 offset:36864
  s_waitcnt lgkmcnt(10)
  v_mfma_f32_16x16x32_bf16 v[104:107], v[48:51], v[88:91], v[104:107]
  ds_read_b64_tr_b16 v[72:73], v26 offset:32768
  v_mfma_f32_16x16x32_bf16 v[120:123], v[52:55], v[88:91], v[120:123]
  ds_read_b64_tr_b16 v[74:75], v26 offset:36864
  v_mfma_f32_16x16x32_bf16 v[136:139], v[56:59], v[88:91], v[136:139]
  ds_read_b64_tr_b16 v[76:77], v27 offset:32768
  v_mfma_f32_16x16x32_bf16 v[152:155], v[60:63], v[88:91], v[152:155]
  ds_read_b64_tr_b16 v[78:79], v27 offset:36864
  s_waitcnt lgkmcnt(12)
  v_mfma_f32_16x16x32_bf16 v[108:111], v[48:51], v[92:95], v[108:111]
  s_add_u32 s50, s50, 1
  s_cmp_eq_u32 s50, 9
  s_cselect_b32 s50, 0, s50
  s_lshl_b32 s51, s50, 7
  s_add_u32 m0, s33, 0
  s_add_u32 s51, s51, s31
  buffer_load_dwordx4 v4, s[16:19], s51 offen offset:0 lds
  v_mfma_f32_16x16x32_bf16 v[124:127], v[52:55], v[92:95], v[124:127]
  buffer_load_dwordx4 v5, s[16:19], s51 offen offset:1024 lds
  v_mfma_f32_16x16x32_bf16 v[140:143], v[56:59], v[92:95], v[140:143]
  buffer_load_dwordx4 v6, s[16:19], s51 offen offset:2048 lds
  v_mfma_f32_16x16x32_bf16 v[156:159], v[60:63], v[92:95], v[156:159]
  buffer_load_dwordx4 v7, s[16:19], s51 offen offset:3072 lds
  s_waitcnt lgkmcnt(6)
  v_mfma_f32_16x16x32_bf16 v[96:99], v[32:35], v[64:67], v[96:99]
  ds_read_b128 v[48:51], v13 offset:32768
  v_mfma_f32_16x16x32_bf16 v[112:115], v[36:39], v[64:67], v[112:115]
  ds_read_b64_tr_b16 v[80:81], v24 offset:40960
  v_mfma_f32_16x16x32_bf16 v[128:131], v[40:43], v[64:67], v[128:131]
  ds_read_b64_tr_b16 v[82:83], v24 offset:45056
  v_mfma_f32_16x16x32_bf16 v[144:147], v[44:47], v[64:67], v[144:147]
  ds_read_b128 v[52:55], v13 offset:34816
  s_waitcnt lgkmcnt(8)
  v_mfma_f32_16x16x32_bf16 v[100:103], v[32:35], v[68:71], v[100:103]
  ds_read_b128 v[56:59], v15 offset:32768
  v_mfma_f32_16x16x32_bf16 v[116:119], v[36:39], v[68:71], v[116:119]
  ds_read_b128 v[60:63], v15 offset:34816
  v_mfma_f32_16x16x32_bf16 v[132:135], v[40:43], v[68:71], v[132:135]
  ds_read_b64_tr_b16 v[84:85], v25 offset:40960
  v_mfma_f32_16x16x32_bf16 v[148:151], v[44:47], v[68:71], v[148:151]
  ds_read_b64_tr_b16 v[86:87], v25 offset:45056
  s_waitcnt lgkmcnt(10)
  v_mfma_f32_16x16x32_bf16 v[104:107], v[32:35], v[72:75], v[104:107]
  ds_read_b64_tr_b16 v[88:89], v26 offset:40960
  v_mfma_f32_16x16x32_bf16 v[120:123], v[36:39], v[72:75], v[120:123]
  ds_read_b64_tr_b16 v[90:91], v26 offset:45056
  v_mfma_f32_16x16x32_bf16 v[136:139], v[40:43], v[72:75], v[136:139]
  ds_read_b64_tr_b16 v[92:93], v27 offset:40960
  v_mfma_f32_16x16x32_bf16 v[152:155], v[44:47], v[72:75], v[152:155]
  ds_read_b64_tr_b16 v[94:95], v27 offset:45056
  s_waitcnt lgkmcnt(12)
  v_mfma_f32_16x16x32_bf16 v[108:111], v[32:35], v[76:79], v[108:111]
  s_mul_i32 s51, s50, 221184
  s_add_u32 m0, s34, 0
  s_add_u32 s51, s51, s32
  buffer_load_dwordx4 v28, s[20:23], s51 offen offset:0 lds
  v_mfma_f32_16x16x32_bf16 v[124:127], v[36:39], v[76:79], v[124:127]
  buffer_load_dwordx4 v29, s[20:23], s51 offen offset:1024 lds
  v_mfma_f32_16x16x32_bf16 v[140:143], v[40:43], v[76:79], v[140:143]
  buffer_load_dwordx4 v30, s[20:23], s51 offen offset:2048 lds
  v_mfma_f32_16x16x32_bf16 v[156:159], v[44:47], v[76:79], v[156:159]
  buffer_load_dwordx4 v31, s[20:23], s51 offen offset:3072 lds
  s_waitcnt vmcnt(8)
  s_barrier
  s_waitcnt lgkmcnt(6)
  v_mfma_f32_16x16x32_bf16 v[96:99], v[48:51], v[80:83], v[96:99]
  ds_read_b128 v[32:35], v164 offset:0
  v_mfma_f32_16x16x32_bf16 v[112:115], v[52:55], v[80:83], v[112:115]
  ds_read_b64_tr_b16 v[64:65], v168 offset:0
  v_mfma_f32_16x16x32_bf16 v[128:131], v[56:59], v[80:83], v[128:131]
  ds_read_b64_tr_b16 v[66:67], v168 offset:4096
  v_mfma_f32_16x16x32_bf16 v[144:147], v[60:63], v[80:83], v[144:147]
  ds_read_b128 v[36:39], v164 offset:2048
  s_waitcnt lgkmcnt(8)
  v_mfma_f32_16x16x32_bf16 v[100:103], v[48:51], v[84:87], v[100:103]
  ds_read_b128 v[40:43], v166 offset:0
  v_mfma_f32_16x16x32_bf16 v[116:119], v[52:55], v[84:87], v[116:119]
  ds_read_b128 v[44:47], v166 offset:2048
  v_mfma_f32_16x16x32_bf16 v[132:135], v[56:59], v[84:87], v[132:135]
  ds_read_b64_tr_b16 v[68:69], v169 offset:0
  v_mfma_f32_16x16x32_bf16 v[148:151], v[60:63], v[84:87], v[148:151]
  ds_read_b64_tr_b16 v[70:71], v169 offset:4096
  s_waitcnt lgkmcnt(10)
  v_mfma_f32_16x16x32_bf16 v[104:107], v[48:51], v[88:91], v[104:107]
  ds_read_b64_tr_b16 v[72:73], v170 offset:0
  v_mfma_f32_16x16x32_bf16 v[120:123], v[52:55], v[88:91], v[120:123]
  ds_read_b64_tr_b16 v[74:75], v170 offset:4096
  v_mfma_f32_16x16x32_bf16 v[136:139], v[56:59], v[88:91], v[136:139]
  ds_read_b64_tr_b16 v[76:77], v171 offset:0
  v_mfma_f32_16x16x32_bf16 v[152:155], v[60:63], v[88:91], v[152:155]
  ds_read_b64_tr_b16 v[78:79], v171 offset:4096
  s_waitcnt lgkmcnt(12)
  v_mfma_f32_16x16x32_bf16 v[108:111], v[48:51], v[92:95], v[108:111]
  s_add_u32 s50, s50, 1
  s_cmp_eq_u32 s50, 9
  s_cselect_b32 s50, 0, s50
  s_lshl_b32 s51, s50, 7
  s_add_u32 m0, s33, 32768
  s_add_u32 s51, s51, s31
  buffer_load_dwordx4 v4, s[16:19], s51 offen offset:0 lds
  v_mfma_f32_16x16x32_bf16 v[124:127], v[52:55], v[92:95], v[124:127]
  buffer_load_dwordx4 v5, s[16:19], s51 offen offset:1024 lds
  v_mfma_f32_16x16x32_bf16 v[140:143], v[56:59], v[92:95], v[140:143]
  buffer_load_dwordx4 v6, s[16:19], s51 offen offset:2048 lds
  v_mfma_f32_16x16x32_bf16 v[156:159], v[60:63], v[92:95], v[156:159]
  buffer_load_dwordx4 v7, s[16:19], s51 offen offset:3072 lds
  s_waitcnt lgkmcnt(6)
  v_mfma_f32_16x16x32_bf16 v[96:99], v[32:35], v[64:67], v[96:99]
  ds_read_b128 v[48:51], v165 offset:0
  v_mfma_f32_16x16x32_bf16 v[112:115], v[36:39], v[64:67], v[112:115]
  ds_read_b64_tr_b16 v[80:81], v168 offset:8192
  v_mfma_f32_16x16x32_bf16 v[128:131], v[40:43], v[64:67], v[128:131]
  ds_read_b64_tr_b16 v[82:83], v168 offset:12288
  v_mfma_f32_16x16x32_bf16 v[144:147], v[44:47], v[64:67], v[144:147]
  ds_read_b128 v[52:55], v165 offset:2048
  s_waitcnt lgkmcnt(8)
  v_mfma_f32_16x16x32_bf16 v[100:103], v[32:35], v[68:71], v[100:103]
  ds_read_b128 v[56:59], v167 offset:0
  v_mfma_f32_16x16x32_bf16 v[116:119], v[36:39], v[68:71], v[116:119]
  ds_read_b128 v[60:63], v167 offset:2048
  v_mfma_f32_16x16x32_bf16 v[132:135], v[40:43], v[68:71], v[132:135]
  ds_read_b64_tr_b16 v[84:85], v169 offset:8192
  v_mfma_f32_16x16x32_bf16 v[148:151], v[44:47], v[68:71], v[148:151]
  ds_read_b64_tr_b16 v[86:87], v169 offset:12288
  s_waitcnt lgkmcnt(10)
  v_mfma_f32_16x16x32_bf16 v[104:107], v[32:35], v[72:75], v[104:107]
  ds_read_b64_tr_b16 v[88:89], v170 offset:8192
  v_mfma_f32_16x16x32_bf16 v[120:123], v[36:39], v[72:75], v[120:123]
  ds_read_b64_tr_b16 v[90:91], v170 offset:12288
  v_mfma_f32_16x16x32_bf16 v[136:139], v[40:43], v[72:75], v[136:139]
  ds_read_b64_tr_b16 v[92:93], v171 offset:8192
  v_mfma_f32_16x16x32_bf16 v[152:155], v[44:47], v[72:75], v[152:155]
  ds_read_b64_tr_b16 v[94:95], v171 offset:12288
  s_waitcnt lgkmcnt(12)
  v_mfma_f32_16x16x32_bf16 v[108:111], v[32:35], v[76:79], v[108:111]
  s_mul_i32 s51, s50, 221184
  s_add_u32 m0, s34, 32768
  s_add_u32 s51, s51, s32
  buffer_load_dwordx4 v28, s[20:23], s51 offen offset:0 lds
  v_mfma_f32_16x16x32_bf16 v[124:127], v[36:39], v[76:79], v[124:127]
  buffer_load_dwordx4 v29, s[20:23], s51 offen offset:1024 lds
  v_mfma_f32_16x16x32_bf16 v[140:143], v[40:43], v[76:79], v[140:143]
  buffer_load_dwordx4 v30, s[20:23], s51 offen offset:2048 lds
  v_mfma_f32_16x16x32_bf16 v[156:159], v[44:47], v[76:79], v[156:159]
  buffer_load_dwordx4 v31, s[20:23], s51 offen offset:3072 lds
  s_waitcnt vmcnt(8)
  s_barrier
  s_waitcnt lgkmcnt(6)
  v_mfma_f32_16x16x32_bf16 v[96:99], v[48:51], v[80:83], v[96:99]
  ds_read_b128 v[32:35], v8 offset:0
  v_mfma_f32_16x16x32_bf16 v[112:115], v[52:55], v[80:83], v[112:115]
  ds_read_b64_tr_b16 v[64:65], v20 offset:0
  v_mfma_f32_16x16x32_bf16 v[128:131], v[56:59], v[80:83], v[128:131]
  ds_read_b64_tr_b16 v[66:67], v20 offset:4096
  v_mfma_f32_16x16x32_bf16 v[144:147], v[60:63], v[80:83], v[144:147]
  ds_read_b128 v[36:39], v8 offset:2048
  s_add_u32 s50, s50, 1
  s_cmp_eq_u32 s50, 9
  s_cselect_b32 s50, 0, s50
  s_lshl_b32 s51, s50, 7
  s_add_u32 m0, s33, 65536
  s_add_u32 s51, s51, s31
  buffer_load_dwordx4 v4, s[16:19], s51 offen offset:0 lds
  s_waitcnt lgkmcnt(8)
  v_mfma_f32_16x16x32_bf16 v[100:103], v[48:51], v[84:87], v[100:103]
  ds_read_b128 v[40:43], v10 offset:0
  v_mfma_f32_16x16x32_bf16 v[116:119], v[52:55], v[84:87], v[116:119]
  ds_read_b128 v[44:47], v10 offset:2048
  buffer_load_dwordx4 v5, s[16:19], s51 offen offset:1024 lds
  v_mfma_f32_16x16x32_bf16 v[132:135], v[56:59], v[84:87], v[132:135]
  ds_read_b64_tr_b16 v[68:69], v21 offset:0
  v_mfma_f32_16x16x32_bf16 v[148:151], v[60:63], v[84:87], v[148:151]
  ds_read_b64_tr_b16 v[70:71], v21 offset:4096
  buffer_load_dwordx4 v6, s[16:19], s51 offen offset:2048 lds
  s_waitcnt lgkmcnt(10)
  v_mfma_f32_16x16x32_bf16 v[104:107], v[48:51], v[88:91], v[104:107]
  ds_read_b64_tr_b16 v[72:73], v22 offset:0
  v_mfma_f32_16x16x32_bf16 v[120:123], v[52:55], v[88:91], v[120:123]
  ds_read_b64_tr_b16 v[74:75], v22 offset:4096
  buffer_load_dwordx4 v7, s[16:19], s51 offen offset:3072 lds
  v_mfma_f32_16x16x32_bf16 v[136:139], v[56:59], v[88:91], v[136:139]
  ds_read_b64_tr_b16 v[76:77], v23 offset:0
  v_mfma_f32_16x16x32_bf16 v[152:155], v[60:63], v[88:91], v[152:155]
  ds_read_b64_tr_b16 v[78:79], v23 offset:4096
  s_mul_i32 s51, s50, 221184
  s_add_u32 m0, s34, 65536
  s_add_u32 s51, s51, s32
  buffer_load_dwordx4 v28, s[20:23], s51 offen offset:0 lds
  s_waitcnt lgkmcnt(12)
  v_mfma_f32_16x16x32_bf16 v[108:111], v[48:51], v[92:95], v[108:111]
  buffer_load_dwordx4 v29, s[20:23], s51 offen offset:1024 lds
  v_mfma_f32_16x16x32_bf16 v[124:127], v[52:55], v[92:95], v[124:127]
  buffer_load_dwordx4 v30, s[20:23], s51 offen offset:2048 lds
  v_mfma_f32_16x16x32_bf16 v[140:143], v[56:59], v[92:95], v[140:143]
  buffer_load_dwordx4 v31, s[20:23], s51 offen offset:3072 lds
  v_mfma_f32_16x16x32_bf16 v[156:159], v[60:63], v[92:95], v[156:159]
  buffer_load_dwordx2 v[212:213], v192, s[96:99], s52 offen offset:0 sc0 sc1
  s_waitcnt lgkmcnt(6)
  v_mfma_f32_16x16x32_bf16 v[96:99], v[32:35], v[64:67], v[96:99]
  ds_read_b128 v[48:51], v9 offset:0
  v_mfma_f32_16x16x32_bf16 v[112:115], v[36:39], v[64:67], v[112:115]
  ds_read_b64_tr_b16 v[80:81], v20 offset:8192
  v_mfma_f32_16x16x32_bf16 v[128:131], v[40:43], v[64:67], v[128:131]
  ds_read_b64_tr_b16 v[82:83], v20 offset:12288
  v_mfma_f32_16x16x32_bf16 v[144:147], v[44:47], v[64:67], v[144:147]
  ds_read_b128 v[52:55], v9 offset:2048
  buffer_load_dword v222, v194, s[96:99], s53 offen offset:0 sc0 sc1
  s_waitcnt lgkmcnt(8)
  v_mfma_f32_16x16x32_bf16 v[100:103], v[32:35], v[68:71], v[100:103]
  ds_read_b128 v[56:59], v11 offset:0
  v_mfma_f32_16x16x32_bf16 v[116:119], v[36:39], v[68:71], v[116:119]
  ds_read_b128 v[60:63], v11 offset:2048
  buffer_load_dwordx2 v[214:215], v192, s[96:99], s52 offen offset:2048 sc0 sc1
  v_mfma_f32_16x16x32_bf16 v[132:135], v[40:43], v[68:71], v[132:135]
  ds_read_b64_tr_b16 v[84:85], v21 offset:8192
  v_mfma_f32_16x16x32_bf16 v[148:151], v[44:47], v[68:71], v[148:151]
  ds_read_b64_tr_b16 v[86:87], v21 offset:12288
  buffer_load_dword v223, v194, s[96:99], s53 offen offset:1024 sc0 sc1
  s_waitcnt lgkmcnt(10)
  v_mfma_f32_16x16x32_bf16 v[104:107], v[32:35], v[72:75], v[104:107]
  ds_read_b64_tr_b16 v[88:89], v22 offset:8192
  v_mfma_f32_16x16x32_bf16 v[120:123], v[36:39], v[72:75], v[120:123]
  ds_read_b64_tr_b16 v[90:91], v22 offset:12288
  buffer_load_dwordx2 v[216:217], v192, s[96:99], s54 offen offset:0 sc0 sc1
  v_mfma_f32_16x16x32_bf16 v[136:139], v[40:43], v[72:75], v[136:139]
  ds_read_b64_tr_b16 v[92:93], v23 offset:8192
  v_mfma_f32_16x16x32_bf16 v[152:155], v[44:47], v[72:75], v[152:155]
  ds_read_b64_tr_b16 v[94:95], v23 offset:12288
  buffer_load_dword v224, v194, s[96:99], s53 offen offset:2048 sc0 sc1
  s_waitcnt lgkmcnt(12)
  v_mfma_f32_16x16x32_bf16 v[108:111], v[32:35], v[76:79], v[108:111]
  buffer_load_dwordx2 v[218:219], v192, s[96:99], s54 offen offset:2048 sc0 sc1
  v_mfma_f32_16x16x32_bf16 v[124:127], v[36:39], v[76:79], v[124:127]
  buffer_load_dword v225, v194, s[96:99], s53 offen offset:3072 sc0 sc1
  v_mfma_f32_16x16x32_bf16 v[140:143], v[40:43], v[76:79], v[140:143]
  buffer_load_dwordx2 v[220:221], v193, s[96:99], s52 offen offset:0 sc0 sc1
  v_mfma_f32_16x16x32_bf16 v[156:159], v[44:47], v[76:79], v[156:159]
  buffer_load_dword v226, v195, s[96:99], s53 offen offset:0 sc0 sc1
  s_waitcnt vmcnt(18)
  s_barrier
  s_waitcnt lgkmcnt(6)
  v_mfma_f32_16x16x32_bf16 v[96:99], v[48:51], v[80:83], v[96:99]
  ds_read_b128 v[32:35], v8 offset:32768
  v_mfma_f32_16x16x32_bf16 v[112:115], v[52:55], v[80:83], v[112:115]
  ds_read_b64_tr_b16 v[64:65], v20 offset:32768
  v_mfma_f32_16x16x32_bf16 v[128:131], v[56:59], v[80:83], v[128:131]
  ds_read_b64_tr_b16 v[66:67], v20 offset:36864
  v_mfma_f32_16x16x32_bf16 v[144:147], v[60:63], v[80:83], v[144:147]
  ds_read_b128 v[36:39], v8 offset:34816
  s_waitcnt lgkmcnt(8)
  v_mfma_f32_16x16x32_bf16 v[100:103], v[48:51], v[84:87], v[100:103]
  ds_read_b128 v[40:43], v10 offset:32768
  v_mfma_f32_16x16x32_bf16 v[116:119], v[52:55], v[84:87], v[116:119]
  ds_read_b128 v[44:47], v10 offset:34816
  v_mfma_f32_16x16x32_bf16 v[132:135], v[56:59], v[84:87], v[132:135]
  ds_read_b64_tr_b16 v[68:69], v21 offset:32768
  v_mfma_f32_16x16x32_bf16 v[148:151], v[60:63], v[84:87], v[148:151]
  ds_read_b64_tr_b16 v[70:71], v21 offset:36864
  s_waitcnt lgkmcnt(10)
  v_mfma_f32_16x16x32_bf16 v[104:107], v[48:51], v[88:91], v[104:107]
  ds_read_b64_tr_b16 v[72:73], v22 offset:32768
  v_mfma_f32_16x16x32_bf16 v[120:123], v[52:55], v[88:91], v[120:123]
  ds_read_b64_tr_b16 v[74:75], v22 offset:36864
  v_mfma_f32_16x16x32_bf16 v[136:139], v[56:59], v[88:91], v[136:139]
  ds_read_b64_tr_b16 v[76:77], v23 offset:32768
  v_mfma_f32_16x16x32_bf16 v[152:155], v[60:63], v[88:91], v[152:155]
  ds_read_b64_tr_b16 v[78:79], v23 offset:36864
  s_waitcnt lgkmcnt(12)
  v_mfma_f32_16x16x32_bf16 v[108:111], v[48:51], v[92:95], v[108:111]
  s_add_u32 s50, s50, 1
  s_cmp_eq_u32 s50, 9
  s_cselect_b32 s50, 0, s50
  s_lshl_b32 s51, s50, 7
  s_add_u32 m0, s33, 98304
  s_add_u32 s51, s51, s31
  buffer_load_dwordx4 v4, s[16:19], s51 offen offset:0 lds
  v_mfma_f32_16x16x32_bf16 v[124:127], v[52:55], v[92:95], v[124:127]
  buffer_load_dwordx4 v5, s[16:19], s51 offen offset:1024 lds
  v_mfma_f32_16x16x32_bf16 v[140:143], v[56:59], v[92:95], v[140:143]
  buffer_load_dwordx4 v6, s[16:19], s51 offen offset:2048 lds
  v_mfma_f32_16x16x32_bf16 v[156:159], v[60:63], v[92:95], v[156:159]
  buffer_load_dwordx4 v7, s[16:19], s51 offen offset:3072 lds
  s_waitcnt lgkmcnt(6)
  v_mfma_f32_16x16x32_bf16 v[96:99], v[32:35], v[64:67], v[96:99]
  ds_read_b128 v[48:51], v9 offset:32768
  v_mfma_f32_16x16x32_bf16 v[112:115], v[36:39], v[64:67], v[112:115]
  ds_read_b64_tr_b16 v[80:81], v20 offset:40960
  v_mfma_f32_16x16x32_bf16 v[128:131], v[40:43], v[64:67], v[128:131]
  ds_read_b64_tr_b16 v[82:83], v20 offset:45056
  v_mfma_f32_16x16x32_bf16 v[144:147], v[44:47], v[64:67], v[144:147]
  ds_read_b128 v[52:55], v9 offset:34816
  s_waitcnt lgkmcnt(8)
  v_mfma_f32_16x16x32_bf16 v[100:103], v[32:35], v[68:71], v[100:103]
  ds_read_b128 v[56:59], v11 offset:32768
  v_mfma_f32_16x16x32_bf16 v[116:119], v[36:39], v[68:71], v[116:119]
  ds_read_b128 v[60:63], v11 offset:34816
  v_mfma_f32_16x16x32_bf16 v[132:135], v[40:43], v[68:71], v[132:135]
  ds_read_b64_tr_b16 v[84:85], v21 offset:40960
  v_mfma_f32_16x16x32_bf16 v[148:151], v[44:47], v[68:71], v[148:151]
  ds_read_b64_tr_b16 v[86:87], v21 offset:45056
  s_waitcnt lgkmcnt(10)
  v_mfma_f32_16x16x32_bf16 v[104:107], v[32:35], v[72:75], v[104:107]
  ds_read_b64_tr_b16 v[88:89], v22 offset:40960
  v_mfma_f32_16x16x32_bf16 v[120:123], v[36:39], v[72:75], v[120:123]
  ds_read_b64_tr_b16 v[90:91], v22 offset:45056
  v_mfma_f32_16x16x32_bf16 v[136:139], v[40:43], v[72:75], v[136:139]
  ds_read_b64_tr_b16 v[92:93], v23 offset:40960
  v_mfma_f32_16x16x32_bf16 v[152:155], v[44:47], v[72:75], v[152:155]
  ds_read_b64_tr_b16 v[94:95], v23 offset:45056
  s_waitcnt lgkmcnt(12)
  v_mfma_f32_16x16x32_bf16 v[108:111], v[32:35], v[76:79], v[108:111]
  s_mul_i32 s51, s50, 221184
  s_add_u32 m0, s34, 98304
  s_add_u32 s51, s51, s32
  buffer_load_dwordx4 v28, s[20:23], s51 offen offset:0 lds
  v_mfma_f32_16x16x32_bf16 v[124:127], v[36:39], v[76:79], v[124:127]
  buffer_load_dwordx4 v29, s[20:23], s51 offen offset:1024 lds
  v_mfma_f32_16x16x32_bf16 v[140:143], v[40:43], v[76:79], v[140:143]
  buffer_load_dwordx4 v30, s[20:23], s51 offen offset:2048 lds
  v_mfma_f32_16x16x32_bf16 v[156:159], v[44:47], v[76:79], v[156:159]
  buffer_load_dwordx4 v31, s[20:23], s51 offen offset:3072 lds
  s_waitcnt vmcnt(18)
  s_barrier
  s_waitcnt lgkmcnt(6)
  v_mfma_f32_16x16x32_bf16 v[96:99], v[48:51], v[80:83], v[96:99]
  ds_read_b128 v[32:35], v12 offset:0
  v_mfma_f32_16x16x32_bf16 v[112:115], v[52:55], v[80:83], v[112:115]
  ds_read_b64_tr_b16 v[64:65], v24 offset:0
  v_mfma_f32_16x16x32_bf16 v[128:131], v[56:59], v[80:83], v[128:131]
  ds_read_b64_tr_b16 v[66:67], v24 offset:4096
  v_mfma_f32_16x16x32_bf16 v[144:147], v[60:63], v[80:83], v[144:147]
  ds_read_b128 v[36:39], v12 offset:2048
  s_waitcnt lgkmcnt(8)
  v_mfma_f32_16x16x32_bf16 v[100:103], v[48:51], v[84:87], v[100:103]
  ds_read_b128 v[40:43], v14 offset:0
  v_mfma_f32_16x16x32_bf16 v[116:119], v[52:55], v[84:87], v[116:119]
  ds_read_b128 v[44:47], v14 offset:2048
  v_mfma_f32_16x16x32_bf16 v[132:135], v[56:59], v[84:87], v[132:135]
  ds_read_b64_tr_b16 v[68:69], v25 offset:0
  v_mfma_f32_16x16x32_bf16 v[148:151], v[60:63], v[84:87], v[148:151]
  ds_read_b64_tr_b16 v[70:71], v25 offset:4096
  s_waitcnt lgkmcnt(10)
  v_mfma_f32_16x16x32_bf16 v[104:107], v[48:51], v[88:91], v[104:107]
  ds_read_b64_tr_b16 v[72:73], v26 offset:0
  v_mfma_f32_16x16x32_bf16 v[120:123], v[52:55], v[88:91], v[120:123]
  ds_read_b64_tr_b16 v[74:75], v26 offset:4096
  v_mfma_f32_16x16x32_bf16 v[136:139], v[56:59], v[88:91], v[136:139]
  ds_read_b64_tr_b16 v[76:77], v27 offset:0
  v_mfma_f32_16x16x32_bf16 v[152:155], v[60:63], v[88:91], v[152:155]
  ds_read_b64_tr_b16 v[78:79], v27 offset:4096
  s_waitcnt lgkmcnt(12)
  v_mfma_f32_16x16x32_bf16 v[108:111], v[48:51], v[92:95], v[108:111]
  v_mfma_f32_16x16x32_bf16 v[124:127], v[52:55], v[92:95], v[124:127]
  v_mfma_f32_16x16x32_bf16 v[140:143], v[56:59], v[92:95], v[140:143]
  v_mfma_f32_16x16x32_bf16 v[156:159], v[60:63], v[92:95], v[156:159]
  s_waitcnt lgkmcnt(6)
  v_mfma_f32_16x16x32_bf16 v[96:99], v[32:35], v[64:67], v[96:99]
  ds_read_b128 v[48:51], v13 offset:0
  s_waitcnt vmcnt(8)
  v_mfma_f32_16x16x32_bf16 v[112:115], v[36:39], v[64:67], v[112:115]
  ds_read_b64_tr_b16 v[80:81], v24 offset:8192
  v_add_f32_e64 v212, v212, v214
  v_mfma_f32_16x16x32_bf16 v[128:131], v[40:43], v[64:67], v[128:131]
  ds_read_b64_tr_b16 v[82:83], v24 offset:12288
  v_add_f32_e64 v213, v213, v215
  v_mfma_f32_16x16x32_bf16 v[144:147], v[44:47], v[64:67], v[144:147]
  ds_read_b128 v[52:55], v13 offset:2048
  v_add_f32 v222, v222, v223
  s_waitcnt lgkmcnt(8)
  v_mfma_f32_16x16x32_bf16 v[100:103], v[32:35], v[68:71], v[100:103]
  ds_read_b128 v[56:59], v15 offset:0
  v_add_f32_e64 v216, v216, v218
  v_mfma_f32_16x16x32_bf16 v[116:119], v[36:39], v[68:71], v[116:119]
  ds_read_b128 v[60:63], v15 offset:2048
  v_add_f32_e64 v217, v217, v219
  v_mfma_f32_16x16x32_bf16 v[132:135], v[40:43], v[68:71], v[132:135]
  ds_read_b64_tr_b16 v[84:85], v25 offset:8192
  v_add_f32_e64 v224, v224, v225
  v_mfma_f32_16x16x32_bf16 v[148:151], v[44:47], v[68:71], v[148:151]
  ds_read_b64_tr_b16 v[86:87], v25 offset:12288
  v_add_f32 v212, v212, v220
  s_waitcnt lgkmcnt(10)
  v_mfma_f32_16x16x32_bf16 v[104:107], v[32:35], v[72:75], v[104:107]
  ds_read_b64_tr_b16 v[88:89], v26 offset:8192
  v_add_f32_e64 v213, v213, v221
  v_mfma_f32_16x16x32_bf16 v[120:123], v[36:39], v[72:75], v[120:123]
  ds_read_b64_tr_b16 v[90:91], v26 offset:12288
  v_add_f32_e64 v222, v222, v226
  v_mfma_f32_16x16x32_bf16 v[136:139], v[40:43], v[72:75], v[136:139]
  ds_read_b64_tr_b16 v[92:93], v27 offset:8192
  v_add_f32_e64 v212, v212, v216
  v_mfma_f32_16x16x32_bf16 v[152:155], v[44:47], v[72:75], v[152:155]
  ds_read_b64_tr_b16 v[94:95], v27 offset:12288
  v_add_f32 v213, v213, v217
  s_waitcnt lgkmcnt(12)
  v_mfma_f32_16x16x32_bf16 v[108:111], v[32:35], v[76:79], v[108:111]
  v_add_f32 v222, v222, v224
  v_mov_b32 v214, v212
  v_mfma_f32_16x16x32_bf16 v[124:127], v[36:39], v[76:79], v[124:127]
  v_mov_b32 v215, v213
  v_mov_b32 v223, v222
  v_mfma_f32_16x16x32_bf16 v[140:143], v[40:43], v[76:79], v[140:143]
  s_nop 0
  v_permlane32_swap_b32 v212, v214
  v_mfma_f32_16x16x32_bf16 v[156:159], v[44:47], v[76:79], v[156:159]
  v_permlane32_swap_b32 v213, v215
  v_permlane32_swap_b32 v222, v223
  s_waitcnt vmcnt(0)
  s_barrier
  s_waitcnt lgkmcnt(6)
  v_mfma_f32_16x16x32_bf16 v[96:99], v[48:51], v[80:83], v[96:99]
  ds_read_b128 v[32:35], v12 offset:32768
  s_nop 0
  v_mfma_f32_16x16x32_bf16 v[112:115], v[52:55], v[80:83], v[112:115]
  ds_read_b64_tr_b16 v[64:65], v24 offset:32768
  v_add_f32_e64 v212, v212, v214
  v_mfma_f32_16x16x32_bf16 v[128:131], v[56:59], v[80:83], v[128:131]
  ds_read_b64_tr_b16 v[66:67], v24 offset:36864
  v_add_f32_e64 v213, v213, v215
  v_mfma_f32_16x16x32_bf16 v[144:147], v[60:63], v[80:83], v[144:147]
  ds_read_b128 v[36:39], v12 offset:34816
  v_add_f32 v222, v222, v223
  s_waitcnt lgkmcnt(8)
  v_mfma_f32_16x16x32_bf16 v[100:103], v[48:51], v[84:87], v[100:103]
  ds_read_b128 v[40:43], v14 offset:32768
  v_add_f32_e64 v214, v212, v213
  v_mfma_f32_16x16x32_bf16 v[116:119], v[52:55], v[84:87], v[116:119]
  ds_read_b128 v[44:47], v14 offset:34816
  v_cmp_u_f32_e64 vcc, v214, v222
  s_cmp_eq_u64 vcc, 0
  s_cbranch_scc0 L_k1_sre
L_k1_sok:
  v_mfma_f32_16x16x32_bf16 v[132:135], v[56:59], v[84:87], v[132:135]
  ds_read_b64_tr_b16 v[68:69], v25 offset:32768
  v_mul_f32 v212, 0x3ae38e39, v212
  v_mfma_f32_16x16x32_bf16 v[148:151], v[60:63], v[84:87], v[148:151]
  ds_read_b64_tr_b16 v[70:71], v25 offset:36864
  v_mul_f32 v213, 0x3ae38e39, v213
  s_waitcnt lgkmcnt(10)
  v_mfma_f32_16x16x32_bf16 v[104:107], v[48:51], v[88:91], v[104:107]
  ds_read_b64_tr_b16 v[72:73], v26 offset:32768
  v_fma_f32 v213, -v212, v212, v213
  v_mfma_f32_16x16x32_bf16 v[120:123], v[52:55], v[88:91], v[120:123]
  ds_read_b64_tr_b16 v[74:75], v26 offset:36864
  v_max_f32 v213, 0, v213
  v_mfma_f32_16x16x32_bf16 v[136:139], v[56:59], v[88:91], v[136:139]
  ds_read_b64_tr_b16 v[76:77], v27 offset:32768
  v_cvt_pk_bf16_f32 v212, v212, v212
  v_mfma_f32_16x16x32_bf16 v[152:155], v[60:63], v[88:91], v[152:155]
  ds_read_b64_tr_b16 v[78:79], v27 offset:36864
  v_lshlrev_b32 v212, 16, v212
  s_waitcnt lgkmcnt(12)
  v_mfma_f32_16x16x32_bf16 v[108:111], v[48:51], v[92:95], v[108:111]
  v_cvt_pk_bf16_f32 v213, v213, v213
  v_lshlrev_b32_e64 v213, 16, v213
  v_mfma_f32_16x16x32_bf16 v[124:127], v[52:55], v[92:95], v[124:127]
  v_add_f32 v213, 0x3727c5ac, v213
  v_cvt_pk_bf16_f32 v213, v213, v213
  v_mfma_f32_16x16x32_bf16 v[140:143], v[56:59], v[92:95], v[140:143]
  v_lshlrev_b32 v213, 16, v213
  v_sqrt_f32 v213, v213
  v_mfma_f32_16x16x32_bf16 v[156:159], v[60:63], v[92:95], v[156:159]
  s_nop 0
  v_cvt_pk_bf16_f32 v213, v213, v213
  s_waitcnt lgkmcnt(6)
  v_mfma_f32_16x16x32_bf16 v[96:99], v[32:35], v[64:67], v[96:99]
  ds_read_b128 v[48:51], v13 offset:32768
  v_lshlrev_b32_e64 v213, 16, v213
  v_mfma_f32_16x16x32_bf16 v[112:115], v[36:39], v[64:67], v[112:115]
  ds_read_b64_tr_b16 v[80:81], v24 offset:40960
  v_rcp_f32 v213, v213
  v_mfma_f32_16x16x32_bf16 v[128:131], v[40:43], v[64:67], v[128:131]
  ds_read_b64_tr_b16 v[82:83], v24 offset:45056
  s_nop 0
  v_mfma_f32_16x16x32_bf16 v[144:147], v[44:47], v[64:67], v[144:147]
  ds_read_b128 v[52:55], v13 offset:34816
  v_mul_f32 v212, v212, v213
  s_waitcnt lgkmcnt(8)
  v_mfma_f32_16x16x32_bf16 v[100:103], v[32:35], v[68:71], v[100:103]
  ds_read_b128 v[56:59], v15 offset:32768
  v_sub_f32_e64 v212, 0, v212
  v_mfma_f32_16x16x32_bf16 v[116:119], v[36:39], v[68:71], v[116:119]
  ds_read_b128 v[60:63], v15 offset:34816
  v_mul_f32_e64 v212, v212, v253
  v_mfma_f32_16x16x32_bf16 v[132:135], v[40:43], v[68:71], v[132:135]
  ds_read_b64_tr_b16 v[84:85], v25 offset:40960
  v_mul_f32 v213, v213, v253
  v_mfma_f32_16x16x32_bf16 v[148:151], v[44:47], v[68:71], v[148:151]
  ds_read_b64_tr_b16 v[86:87], v25 offset:45056
  ds_write2_b32 v16, v213, v212 offset1:128
  s_waitcnt lgkmcnt(11)
  v_mfma_f32_16x16x32_bf16 v[104:107], v[32:35], v[72:75], v[104:107]
  ds_read_b64_tr_b16 v[88:89], v26 offset:40960
  ds_write_b32 v16, v222 offset:2048
  v_mfma_f32_16x16x32_bf16 v[120:123], v[36:39], v[72:75], v[120:123]
  ds_read_b64_tr_b16 v[90:91], v26 offset:45056
  v_mfma_f32_16x16x32_bf16 v[136:139], v[40:43], v[72:75], v[136:139]
  ds_read_b64_tr_b16 v[92:93], v27 offset:40960
  v_mfma_f32_16x16x32_bf16 v[152:155], v[44:47], v[72:75], v[152:155]
  ds_read_b64_tr_b16 v[94:95], v27 offset:45056
  s_waitcnt lgkmcnt(14)
  v_mfma_f32_16x16x32_bf16 v[108:111], v[32:35], v[76:79], v[108:111]
  v_mfma_f32_16x16x32_bf16 v[124:127], v[36:39], v[76:79], v[124:127]
  v_mfma_f32_16x16x32_bf16 v[140:143], v[40:43], v[76:79], v[140:143]
  v_mfma_f32_16x16x32_bf16 v[156:159], v[44:47], v[76:79], v[156:159]
  s_waitcnt lgkmcnt(3)
  s_barrier
  v_mfma_f32_16x16x32_bf16 v[96:99], v[48:51], v[80:83], v[96:99]
  ds_read_b128 v[176:179], v17 offset:0
  v_mfma_f32_16x16x32_bf16 v[112:115], v[52:55], v[80:83], v[112:115]
  ds_read_b128 v[192:195], v17 offset:512
  v_mfma_f32_16x16x32_bf16 v[128:131], v[56:59], v[80:83], v[128:131]
  ds_read_b32 v208, v18 offset:0
  v_mfma_f32_16x16x32_bf16 v[144:147], v[60:63], v[80:83], v[144:147]
  ds_read_b128 v[180:183], v17 offset:64
  v_mfma_f32_16x16x32_bf16 v[100:103], v[48:51], v[84:87], v[100:103]
  ds_read_b128 v[196:199], v17 offset:576
  v_mfma_f32_16x16x32_bf16 v[116:119], v[52:55], v[84:87], v[116:119]
  ds_read_b32 v209, v18 offset:64
  v_mfma_f32_16x16x32_bf16 v[132:135], v[56:59], v[84:87], v[132:135]
  ds_read_b128 v[184:187], v19 offset:0
  v_mfma_f32_16x16x32_bf16 v[148:151], v[60:63], v[84:87], v[148:151]
  ds_read_b128 v[200:203], v19 offset:512
  s_waitcnt lgkmcnt(10)
  v_mfma_f32_16x16x32_bf16 v[104:107], v[48:51], v[88:91], v[104:107]
  ds_read_b32 v210, v238 offset:0
  v_mfma_f32_16x16x32_bf16 v[120:123], v[52:55], v[88:91], v[120:123]
  ds_read_b128 v[188:191], v19 offset:64
  v_mfma_f32_16x16x32_bf16 v[136:139], v[56:59], v[88:91], v[136:139]
  ds_read_b128 v[204:207], v19 offset:576
  v_mfma_f32_16x16x32_bf16 v[152:155], v[60:63], v[88:91], v[152:155]
  ds_read_b32 v211, v238 offset:64
  s_waitcnt lgkmcnt(12)
  v_mfma_f32_16x16x32_bf16 v[108:111], v[48:51], v[92:95], v[108:111]
  v_mfma_f32_16x16x32_bf16 v[124:127], v[52:55], v[92:95], v[124:127]
  v_mfma_f32_16x16x32_bf16 v[140:143], v[56:59], v[92:95], v[140:143]
  v_mfma_f32_16x16x32_bf16 v[156:159], v[60:63], v[92:95], v[156:159]
  s_nop 0
L_pg_1:
  s_cbranch_execz L_wr_0
  s_waitcnt lgkmcnt(0)
  v_pk_mul_f32 v[32:33], v[192:193], v[208:209] op_sel:[0,0] op_sel_hi:[1,0]
  v_pk_mul_f32 v[34:35], v[194:195], v[208:209] op_sel:[0,0] op_sel_hi:[1,0]
  v_pk_fma_f32 v[96:97], v[96:97], v[176:177], v[32:33]
  v_pk_fma_f32 v[98:99], v[98:99], v[178:179], v[34:35]
  v_cvt_pk_bf16_f32 v64, v96, v97
  v_cvt_pk_bf16_f32 v65, v98, v99
  v_pk_mul_f32 v[40:41], v[196:197], v[208:209] op_sel:[0,0] op_sel_hi:[1,0]
  v_pk_mul_f32 v[42:43], v[198:199], v[208:209] op_sel:[0,0] op_sel_hi:[1,0]
  v_pk_fma_f32 v[112:113], v[112:113], v[180:181], v[40:41]
  v_pk_fma_f32 v[114:115], v[114:115], v[182:183], v[42:43]
  v_cvt_pk_bf16_f32 v66, v112, v113
  v_cvt_pk_bf16_f32 v67, v114, v115
  v_pk_mul_f32 v[32:33], v[200:201], v[208:209] op_sel:[0,0] op_sel_hi:[1,0]
  v_pk_mul_f32 v[34:35], v[202:203], v[208:209] op_sel:[0,0] op_sel_hi:[1,0]
  v_pk_fma_f32 v[128:129], v[128:129], v[184:185], v[32:33]
  v_pk_fma_f32 v[130:131], v[130:131], v[186:187], v[34:35]
  v_permlane16_swap_b32 v64, v66
  v_permlane16_swap_b32 v65, v67
  v_cvt_pk_bf16_f32 v68, v128, v129
  v_cvt_pk_bf16_f32 v69, v130, v131
  v_pk_mul_f32 v[40:41], v[204:205], v[208:209] op_sel:[0,0] op_sel_hi:[1,0]
  v_pk_mul_f32 v[42:43], v[206:207], v[208:209] op_sel:[0,0] op_sel_hi:[1,0]
  v_pk_fma_f32 v[144:145], v[144:145], v[188:189], v[40:41]
  v_pk_fma_f32 v[146:147], v[146:147], v[190:191], v[42:43]
  buffer_store_dwordx4 v[64:67], v172, s[24:27], s36 offen sc0 sc1
  v_cvt_pk_bf16_f32 v70, v144, v145
  v_cvt_pk_bf16_f32 v71, v146, v147
  v_pk_mul_f32 v[32:33], v[192:193], v[208:209] op_sel:[0,1] op_sel_hi:[1,1]
  v_pk_mul_f32 v[34:35], v[194:195], v[208:209] op_sel:[0,1] op_sel_hi:[1,1]
  v_pk_fma_f32 v[100:101], v[100:101], v[176:177], v[32:33]
  v_pk_fma_f32 v[102:103], v[102:103], v[178:179], v[34:35]
  v_permlane16_swap_b32 v68, v70
  v_permlane16_swap_b32 v69, v71
  v_cvt_pk_bf16_f32 v72, v100, v101
  v_cvt_pk_bf16_f32 v73, v102, v103
  v_pk_mul_f32 v[40:41], v[196:197], v[208:209] op_sel:[0,1] op_sel_hi:[1,1]
  v_pk_mul_f32 v[42:43], v[198:199], v[208:209] op_sel:[0,1] op_sel_hi:[1,1]
  v_pk_fma_f32 v[116:117], v[116:117], v[180:181], v[40:41]
  v_pk_fma_f32 v[118:119], v[118:119], v[182:183], v[42:43]
  buffer_store_dwordx4 v[68:71], v172, s[24:27], s37 offen sc0 sc1
  v_cvt_pk_bf16_f32 v74, v116, v117
  v_cvt_pk_bf16_f32 v75, v118, v119
  v_pk_mul_f32 v[32:33], v[200:201], v[208:209] op_sel:[0,1] op_sel_hi:[1,1]
  v_pk_mul_f32 v[34:35], v[202:203], v[208:209] op_sel:[0,1] op_sel_hi:[1,1]
  v_pk_fma_f32 v[132:133], v[132:133], v[184:185], v[32:33]
  v_pk_fma_f32 v[134:135], v[134:135], v[186:187], v[34:35]
  v_permlane16_swap_b32 v72, v74
  v_permlane16_swap_b32 v73, v75
  v_cvt_pk_bf16_f32 v76, v132, v133
  v_cvt_pk_bf16_f32 v77, v134, v135
  v_pk_mul_f32 v[40:41], v[204:205], v[208:209] op_sel:[0,1] op_sel_hi:[1,1]
  v_pk_mul_f32 v[42:43], v[206:207], v[208:209] op_sel:[0,1] op_sel_hi:[1,1]
  v_pk_fma_f32 v[148:149], v[148:149], v[188:189], v[40:41]
  v_pk_fma_f32 v[150:151], v[150:151], v[190:191], v[42:43]
  buffer_store_dwordx4 v[72:75], v173, s[24:27], s36 offen sc0 sc1
  v_cvt_pk_bf16_f32 v78, v148, v149
  v_cvt_pk_bf16_f32 v79, v150, v151
  v_pk_mul_f32 v[32:33], v[192:193], v[210:211] op_sel:[0,0] op_sel_hi:[1,0]
  v_pk_mul_f32 v[34:35], v[194:195], v[210:211] op_sel:[0,0] op_sel_hi:[1,0]
  v_pk_fma_f32 v[104:105], v[104:105], v[176:177], v[32:33]
  v_pk_fma_f32 v[106:107], v[106:107], v[178:179], v[34:35]
  v_permlane16_swap_b32 v76, v78
  v_permlane16_swap_b32 v77, v79
  v_cvt_pk_bf16_f32 v212, v104, v105
  v_cvt_pk_bf16_f32 v213, v106, v107
  v_pk_mul_f32 v[40:41], v[196:197], v[210:211] op_sel:[0,0] op_sel_hi:[1,0]
  v_pk_mul_f32 v[42:43], v[198:199], v[210:211] op_sel:[0,0] op_sel_hi:[1,0]
  v_pk_fma_f32 v[120:121], v[120:121], v[180:181], v[40:41]
  v_pk_fma_f32 v[122:123], v[122:123], v[182:183], v[42:43]
  buffer_store_dwordx4 v[76:79], v173, s[24:27], s37 offen sc0 sc1
  v_cvt_pk_bf16_f32 v214, v120, v121
  v_cvt_pk_bf16_f32 v215, v122, v123
  v_pk_mul_f32 v[32:33], v[200:201], v[210:211] op_sel:[0,0] op_sel_hi:[1,0]
  v_pk_mul_f32 v[34:35], v[202:203], v[210:211] op_sel:[0,0] op_sel_hi:[1,0]
  v_pk_fma_f32 v[136:137], v[136:137], v[184:185], v[32:33]
  v_pk_fma_f32 v[138:139], v[138:139], v[186:187], v[34:35]
  v_permlane16_swap_b32 v212, v214
  v_permlane16_swap_b32 v213, v215
  v_cvt_pk_bf16_f32 v216, v136, v137
  v_cvt_pk_bf16_f32 v217, v138, v139
  v_pk_mul_f32 v[40:41], v[204:205], v[210:211] op_sel:[0,0] op_sel_hi:[1,0]
  v_pk_mul_f32 v[42:43], v[206:207], v[210:211] op_sel:[0,0] op_sel_hi:[1,0]
  v_pk_fma_f32 v[152:153], v[152:153], v[188:189], v[40:41]
  v_pk_fma_f32 v[154:155], v[154:155], v[190:191], v[42:43]
  buffer_store_dwordx4 v[212:215], v174, s[24:27], s36 offen sc0 sc1
  v_cvt_pk_bf16_f32 v218, v152, v153
  v_cvt_pk_bf16_f32 v219, v154, v155
  v_pk_mul_f32 v[32:33], v[192:193], v[210:211] op_sel:[0,1] op_sel_hi:[1,1]
  v_pk_mul_f32 v[34:35], v[194:195], v[210:211] op_sel:[0,1] op_sel_hi:[1,1]
  v_pk_fma_f32 v[108:109], v[108:109], v[176:177], v[32:33]
  v_pk_fma_f32 v[110:111], v[110:111], v[178:179], v[34:35]
  v_permlane16_swap_b32 v216, v218
  v_permlane16_swap_b32 v217, v219
  v_cvt_pk_bf16_f32 v220, v108, v109
  v_cvt_pk_bf16_f32 v221, v110, v111
  v_pk_mul_f32 v[40:41], v[196:197], v[210:211] op_sel:[0,1] op_sel_hi:[1,1]
  v_pk_mul_f32 v[42:43], v[198:199], v[210:211] op_sel:[0,1] op_sel_hi:[1,1]
  v_pk_fma_f32 v[124:125], v[124:125], v[180:181], v[40:41]
  v_pk_fma_f32 v[126:127], v[126:127], v[182:183], v[42:43]
  buffer_store_dwordx4 v[216:219], v174, s[24:27], s37 offen sc0 sc1
  v_cvt_pk_bf16_f32 v222, v124, v125
  v_cvt_pk_bf16_f32 v223, v126, v127
  v_pk_mul_f32 v[32:33], v[200:201], v[210:211] op_sel:[0,1] op_sel_hi:[1,1]
  v_pk_mul_f32 v[34:35], v[202:203], v[210:211] op_sel:[0,1] op_sel_hi:[1,1]
  v_pk_fma_f32 v[140:141], v[140:141], v[184:185], v[32:33]
  v_pk_fma_f32 v[142:143], v[142:143], v[186:187], v[34:35]
  v_permlane16_swap_b32 v220, v222
  v_permlane16_swap_b32 v221, v223
  v_cvt_pk_bf16_f32 v224, v140, v141
  v_cvt_pk_bf16_f32 v225, v142, v143
  v_pk_mul_f32 v[40:41], v[204:205], v[210:211] op_sel:[0,1] op_sel_hi:[1,1]
  v_pk_mul_f32 v[42:43], v[206:207], v[210:211] op_sel:[0,1] op_sel_hi:[1,1]
  v_pk_fma_f32 v[156:157], v[156:157], v[188:189], v[40:41]
  v_pk_fma_f32 v[158:159], v[158:159], v[190:191], v[42:43]
  buffer_store_dwordx4 v[220:223], v175, s[24:27], s36 offen sc0 sc1
  v_cvt_pk_bf16_f32 v226, v156, v157
  v_cvt_pk_bf16_f32 v227, v158, v159
  s_nop 1
  v_permlane16_swap_b32 v224, v226
  v_permlane16_swap_b32 v225, v227
  s_nop 1
  buffer_store_dwordx4 v[224:227], v175, s[24:27], s37 offen sc0 sc1
  s_waitcnt vmcnt(0)
  s_barrier
  buffer_store_dword v240, v244, s[96:99], 0 offen sc0 sc1
  s_branch L_k2_start
L_k1_colsum:
  s_mov_b32 s58, s2
  s_lshl_b32 s59, s58, 261
  s_add_u32 s59, s59, 4096
  v_lshlrev_b32 v247, 24, v0
  v_add_u32 v239, s59, v247
  s_and_b32 s59, s58, 7
  s_lshr_b32 s58, s58, 3
  s_lshl_b32 s58, s58, 4
  s_add_u32 s58, s58, s59
  s_lshl_b32 s58, s58, 2
  v_lshrrev_b32 v244, 3, v0
  v_lshlrev_b32 v244, 24, v244
  v_and_b32 v246, 7, v0
  v_mul_u32_u24 v246, 2048, v246
  v_add3_u32 v244, s58, v244, v246
  v_and_b32 v246, 15, v0
  v_mul_u32_u24 v246, 16, v246
  v_mov_b32 v240, 1
  v_mov_b32 v241, 1
  v_mov_b32 v242, 1
  v_mov_b32 v243, 1
  s_mov_b32 s68, s100
  s_mov_b32 s69, s101
  s_mov_b32 s70, 256
  s_mov_b32 s71, 0x00020000
  s_mul_i32 s59, s13, 16
  v_add_u32 v247, s59, v247
  s_waitcnt vmcnt(0)
  s_barrier
  buffer_store_dword v240, v247, s[68:71], 0 offen sc0 sc1
  s_mov_b32 s4, s56
  s_mov_b32 s5, s57
  s_mov_b32 s6, 663552
  s_mov_b32 s7, 0x00020000
  s_mov_b32 s22, 2654208
  s_mov_b32 s23, 0x00020000
  s_mov_b32 s66, 5308416
  s_mov_b32 s67, 0x00020000
  s_add_u32 s24, s8, 40108032
  s_addc_u32 s25, s9, 0
  s_mov_b32 s26, 9609216
  s_mov_b32 s27, 0x00020000
  s_lshl_b32 s34, s13, 258
  s_add_u32 s34, s34, s12
  s_sub_u32 s62, 127, s34
  s_cmp_lt_u32 s62, 68
  s_cselect_b32 s63, s62, 1000
  s_mul_i32 s35, s12, 40960
  v_lshrrev_b32_e64 v20, 3, v1
  v_bfe_u32 v21, v20, 2, 1
  v_xor_b32 v21, v21, v20
  v_and_b32 v21, 3, v21
  v_lshlrev_b32_e64 v21, 5, v21
  v_and_b32 v22, 127, v4
  v_xor_b32_e64 v21, v21, v22
  v_mul_u32_u24 v9, 1152, v20
  v_lshl_add_u32 v8, v9, 3, v21
  v_add_u32 v9, v9, v21
  v_lshrrev_b32 v22, 5, v1
  v_mul_u32_u24 v22, 72, v22
  v_bfe_u32 v23, v1, 4, 1
  v_mad_u32_u24 v22, v23, 18, v22
  v_bfe_u32 v23, v1, 3, 1
  v_add_u32_e64 v22, v22, v23
  v_mul_u32_u24 v22, 1152, v22
  v_add_u32 v10, v22, v21
  v_lshrrev_b32 v20, 2, v1
  v_bfe_u32 v21, v20, 2, 1
  v_xor_b32 v21, v21, v20
  v_and_b32 v21, 3, v21
  v_lshlrev_b32_e64 v20, 7, v20
  v_lshl_add_u32 v20, v21, 5, v20
  v_and_b32_e64 v21, 3, v1
  v_lshl_add_u32 v20, v21, 3, v20
  v_add_u32 v12, s35, v20
  v_xor_b32 v13, 32, v12
  v_xor_b32_e64 v14, 64, v12
  v_xor_b32 v15, 96, v12
  v_mov_b32 v16, 0x3f803f80
  v_mov_b32 v17, 0x3f803f80
  v_mov_b32 v18, 0x3f803f80
  v_mov_b32 v19, 0x3f803f80
  v_cmp_eq_u32 s[28:29], 1, v3
  v_cmp_eq_u32 s[30:31], 2, v3
  v_cmp_eq_u32 s[32:33], 3, v3
  v_lshlrev_b32 v11, 2, v1
  s_add_u32 s40, s34, 0
  s_mul_i32 s41, s40, 7282
  s_lshr_b32 s41, s41, 16
  s_mul_i32 s42, s41, 9
  s_sub_u32 s42, s40, s42
  s_mul_i32 s36, s41, 36
  s_mul_i32 s36, s36, 1152
  s_lshl_b32 s42, s42, 263
  s_add_u32 s36, s36, s42
  s_add_u32 m0, s35, 0
  buffer_load_dwordx4 v9, s[4:7], s36 offen offset:0 lds
  s_add_u32 s37, s36, 19712
  buffer_load_dwordx4 v9, s[4:7], s37 offen offset:1024 lds
  s_add_u32 s37, s36, 7168
  buffer_load_dwordx4 v9, s[4:7], s37 offen offset:2048 lds
  s_add_u32 s37, s36, 26880
  buffer_load_dwordx4 v9, s[4:7], s37 offen offset:3072 lds
  s_add_u32 s40, s34, 128
  s_mul_i32 s41, s40, 7282
  s_lshr_b32 s41, s41, 16
  s_mul_i32 s42, s41, 9
  s_sub_u32 s42, s40, s42
  s_mul_i32 s36, s41, 36
  s_mul_i32 s43, s41, 288
  s_sub_u32 s43, s43, 4592
  s_cmp_lt_u32 s41, 16
  s_cselect_b32 s36, s36, s43
  s_cselect_b64 vcc, -1, 0
  v_cndmask_b32 v10, v10, v9, vcc
  s_mov_b32 s37, 144
  s_cselect_b32 s37, 18, s37
  s_cselect_b32 s38, 8, 36
  s_mov_b32 s39, 180
  s_cselect_b32 s39, 26, s39
  s_mul_i32 s36, s36, 1152
  s_lshl_b32 s42, s42, 7
  s_add_u32 s36, s36, s42
  s_mul_i32 s37, s37, 1152
  s_sub_u32 s37, s37, 1024
  s_add_u32 s37, s37, s36
  s_mul_i32 s38, s38, 1152
  s_sub_u32 s38, s38, 2048
  s_add_u32 s38, s38, s36
  s_mul_i32 s39, s39, 1152
  s_sub_u32 s39, s39, 3072
  s_add_u32 s39, s39, s36
  s_add_u32 m0, s35, 4096
  buffer_load_dwordx4 v10, s[4:7], s36 offen offset:0 lds
  buffer_load_dwordx4 v10, s[4:7], s37 offen offset:1024 lds
  buffer_load_dwordx4 v10, s[4:7], s38 offen offset:2048 lds
  buffer_load_dwordx4 v10, s[4:7], s39 offen offset:3072 lds
  s_add_u32 s40, s62, 0
  s_mul_i32 s41, s40, 7282
  s_lshr_b32 s41, s41, 16
  s_mul_i32 s42, s41, 9
  s_sub_u32 s42, s40, s42
  s_mul_i32 s40, s41, 3641
  s_lshr_b32 s40, s40, 272
  s_mul_i32 s43, s40, 18
  s_sub_u32 s41, s41, s43
  s_lshr_b32 s36, s41, 2
  s_mul_i32 s36, s36, 144
  s_and_b32 s43, s41, 3
  s_lshl_b32 s45, s43, 5
  s_add_u32 s36, s36, s45
  s_mul_i32 s43, s43, 288
  s_add_u32 s43, s43, 128
  s_cmp_lt_u32 s41, 16
  s_cselect_b32 s36, s36, s43
  s_mov_b32 s37, 8192
  s_mov_b32 s38, 144
  s_cselect_b32 s38, 16, s38
  s_mov_b32 s39, 152
  s_cselect_b32 s39, 24, s39
  s_mul_i32 s40, s40, 576
  s_add_u32 s36, s36, s40
  s_mul_i32 s36, s36, 9
  s_add_u32 s36, s36, s42
  s_lshl_b32 s36, s36, 263
  s_add_u32 s37, s37, s36
  s_mul_i32 s38, s38, 1152
  s_sub_u32 s38, s38, 2048
  s_add_u32 s38, s38, s36
  s_mul_i32 s39, s39, 1152
  s_sub_u32 s39, s39, 3072
  s_add_u32 s39, s39, s36
  s_add_u32 m0, s35, 8192
  buffer_load_dwordx4 v9, s[20:23], s36 offen offset:0 lds
  buffer_load_dwordx4 v9, s[20:23], s37 offen offset:1024 lds
  buffer_load_dwordx4 v9, s[20:23], s38 offen offset:2048 lds
  buffer_load_dwordx4 v9, s[20:23], s39 offen offset:3072 lds
  s_add_u32 s40, s62, 128
  s_mul_i32 s41, s40, 7282
  s_lshr_b32 s41, s41, 272
  s_mul_i32 s42, s41, 9
  s_sub_u32 s42, s40, s42
  s_mul_i32 s40, s41, 3641
  s_lshr_b32 s40, s40, 272
  s_mul_i32 s43, s40, 18
  s_sub_u32 s41, s41, s43
  s_lshr_b32 s36, s41, 2
  s_mul_i32 s36, s36, 144
  s_and_b32 s43, s41, 3
  s_lshl_b32 s45, s43, 5
  s_add_u32 s36, s36, s45
  s_mul_i32 s43, s43, 288
  s_add_u32 s43, s43, 128
  s_cmp_lt_u32 s41, 16
  s_cselect_b32 s36, s36, s43
  s_mov_b32 s37, 8192
  s_mov_b32 s38, 144
  s_cselect_b32 s38, 16, s38
  s_mov_b32 s39, 152
  s_cselect_b32 s39, 24, s39
  s_mul_i32 s40, s40, 576
  s_add_u32 s36, s36, s40
  s_mul_i32 s36, s36, 9
  s_add_u32 s36, s36, s42
  s_lshl_b32 s36, s36, 263
  s_add_u32 s37, s37, s36
  s_mul_i32 s38, s38, 1152
  s_sub_u32 s38, s38, 2048
  s_add_u32 s38, s38, s36
  s_mul_i32 s39, s39, 1152
  s_sub_u32 s39, s39, 3072
  s_add_u32 s39, s39, s36
  s_add_u32 m0, s35, 12288
  buffer_load_dwordx4 v9, s[20:23], s36 offen offset:0 lds
  buffer_load_dwordx4 v9, s[20:23], s37 offen offset:1024 lds
  buffer_load_dwordx4 v9, s[20:23], s38 offen offset:2048 lds
  buffer_load_dwordx4 v9, s[20:23], s39 offen offset:3072 lds
  s_add_u32 s40, s62, 256
  s_mul_i32 s41, s40, 7282
  s_lshr_b32 s41, s41, 272
  s_mul_i32 s42, s41, 9
  s_sub_u32 s42, s40, s42
  s_mul_i32 s40, s41, 3641
  s_lshr_b32 s40, s40, 272
  s_mul_i32 s43, s40, 18
  s_sub_u32 s41, s41, s43
  s_lshr_b32 s36, s41, 2
  s_mul_i32 s36, s36, 144
  s_and_b32 s43, s41, 3
  s_lshl_b32 s45, s43, 5
  s_add_u32 s36, s36, s45
  s_mul_i32 s43, s43, 288
  s_add_u32 s43, s43, 128
  s_cmp_lt_u32 s41, 16
  s_cselect_b32 s36, s36, s43
  s_mov_b32 s37, 8192
  s_mov_b32 s38, 144
  s_cselect_b32 s38, 16, s38
  s_mov_b32 s39, 152
  s_cselect_b32 s39, 24, s39
  s_mul_i32 s40, s40, 576
  s_add_u32 s36, s36, s40
  s_mul_i32 s36, s36, 9
  s_add_u32 s36, s36, s42
  s_lshl_b32 s36, s36, 263
  s_add_u32 s37, s37, s36
  s_mul_i32 s38, s38, 1152
  s_sub_u32 s38, s38, 2048
  s_add_u32 s38, s38, s36
  s_mul_i32 s39, s39, 1152
  s_sub_u32 s39, s39, 3072
  s_add_u32 s39, s39, s36
  s_add_u32 m0, s35, 16384
  buffer_load_dwordx4 v9, s[20:23], s36 offen offset:0 lds
  buffer_load_dwordx4 v9, s[20:23], s37 offen offset:1024 lds
  buffer_load_dwordx4 v9, s[20:23], s38 offen offset:2048 lds
  buffer_load_dwordx4 v9, s[20:23], s39 offen offset:3072 lds
  s_add_u32 s40, s62, 384
  s_mul_i32 s41, s40, 7282
  s_lshr_b32 s41, s41, 272
  s_mul_i32 s42, s41, 9
  s_sub_u32 s42, s40, s42
  s_mul_i32 s40, s41, 3641
  s_lshr_b32 s40, s40, 272
  s_mul_i32 s43, s40, 18
  s_sub_u32 s41, s41, s43
  s_lshr_b32 s36, s41, 2
  s_mul_i32 s36, s36, 144
  s_and_b32 s43, s41, 3
  s_lshl_b32 s45, s43, 5
  s_add_u32 s36, s36, s45
  s_mul_i32 s43, s43, 288
  s_add_u32 s43, s43, 128
  s_cmp_lt_u32 s41, 16
  s_cselect_b32 s36, s36, s43
  s_mov_b32 s37, 8192
  s_mov_b32 s38, 144
  s_cselect_b32 s38, 16, s38
  s_mov_b32 s39, 152
  s_cselect_b32 s39, 24, s39
  s_mul_i32 s40, s40, 576
  s_add_u32 s36, s36, s40
  s_mul_i32 s36, s36, 9
  s_add_u32 s36, s36, s42
  s_lshl_b32 s36, s36, 263
  s_add_u32 s37, s37, s36
  s_mul_i32 s38, s38, 1152
  s_sub_u32 s38, s38, 2048
  s_add_u32 s38, s38, s36
  s_mul_i32 s39, s39, 1152
  s_sub_u32 s39, s39, 3072
  s_add_u32 s39, s39, s36
  s_add_u32 m0, s35, 20480
  buffer_load_dwordx4 v9, s[20:23], s36 offen offset:0 lds
  buffer_load_dwordx4 v9, s[20:23], s37 offen offset:1024 lds
  buffer_load_dwordx4 v9, s[20:23], s38 offen offset:2048 lds
  buffer_load_dwordx4 v9, s[20:23], s39 offen offset:3072 lds
  s_add_u32 s40, s63, 512
  s_mul_i32 s41, s40, 7282
  s_lshr_b32 s41, s41, 272
  s_mul_i32 s42, s41, 9
  s_sub_u32 s42, s40, s42
  s_mul_i32 s40, s41, 3641
  s_lshr_b32 s40, s40, 272
  s_mul_i32 s43, s40, 18
  s_sub_u32 s41, s41, s43
  s_lshr_b32 s36, s41, 2
  s_mul_i32 s36, s36, 144
  s_and_b32 s43, s41, 3
  s_lshl_b32 s45, s43, 5
  s_add_u32 s36, s36, s45
  s_mul_i32 s43, s43, 288
  s_add_u32 s43, s43, 128
  s_cmp_lt_u32 s41, 16
  s_cselect_b32 s36, s36, s43
  s_mov_b32 s37, 8192
  s_mov_b32 s38, 144
  s_cselect_b32 s38, 16, s38
  s_mov_b32 s39, 152
  s_cselect_b32 s39, 24, s39
  s_mul_i32 s40, s40, 576
  s_add_u32 s36, s36, s40
  s_mul_i32 s36, s36, 9
  s_add_u32 s36, s36, s42
  s_lshl_b32 s36, s36, 7
  s_add_u32 s37, s37, s36
  s_mul_i32 s38, s38, 1152
  s_sub_u32 s38, s38, 2048
  s_add_u32 s38, s38, s36
  s_mul_i32 s39, s39, 1152
  s_sub_u32 s39, s39, 3072
  s_add_u32 s39, s39, s36
  s_add_u32 m0, s35, 24576
  buffer_load_dwordx4 v9, s[20:23], s36 offen offset:0 lds
  buffer_load_dwordx4 v9, s[20:23], s37 offen offset:1024 lds
  buffer_load_dwordx4 v9, s[20:23], s38 offen offset:2048 lds
  buffer_load_dwordx4 v9, s[20:23], s39 offen offset:3072 lds
  s_waitcnt vmcnt(24)
  ds_read_b64_tr_b16 v[32:33], v12 offset:0
  ds_read_b64_tr_b16 v[34:35], v12 offset:2048
  ds_read_b64_tr_b16 v[36:37], v13 offset:0
  ds_read_b64_tr_b16 v[38:39], v13 offset:2048
  ds_read_b64_tr_b16 v[40:41], v14 offset:0
  ds_read_b64_tr_b16 v[42:43], v14 offset:2048
  ds_read_b64_tr_b16 v[44:45], v15 offset:0
  ds_read_b64_tr_b16 v[46:47], v15 offset:2048
  s_add_u32 s40, s63, 580
  s_mul_i32 s41, s40, 7282
  s_lshr_b32 s41, s41, 272
  s_mul_i32 s42, s41, 9
  s_sub_u32 s42, s40, s42
  s_mul_i32 s40, s41, 3641
  s_lshr_b32 s40, s40, 272
  s_mul_i32 s43, s40, 18
  s_sub_u32 s41, s41, s43
  s_lshr_b32 s36, s41, 2
  s_mul_i32 s36, s36, 144
  s_and_b32 s43, s41, 3
  s_lshl_b32 s45, s43, 5
  s_add_u32 s36, s36, s45
  s_mul_i32 s43, s43, 288
  s_add_u32 s43, s43, 128
  s_cmp_lt_u32 s41, 16
  s_cselect_b32 s36, s36, s43
  s_mov_b32 s37, 8192
  s_mov_b32 s38, 144
  s_cselect_b32 s38, 16, s38
  s_mov_b32 s39, 152
  s_cselect_b32 s39, 24, s39
  s_mul_i32 s40, s40, 576
  s_add_u32 s36, s36, s40
  s_mul_i32 s36, s36, 9
  s_add_u32 s36, s36, s42
  s_lshl_b32 s36, s36, 263
  s_add_u32 s37, s37, s36
  s_mul_i32 s38, s38, 1152
  s_sub_u32 s38, s38, 2048
  s_add_u32 s38, s38, s36
  s_mul_i32 s39, s39, 1152
  s_sub_u32 s39, s39, 3072
  s_add_u32 s39, s39, s36
  s_add_u32 m0, s35, 28672
  buffer_load_dwordx4 v9, s[20:23], s36 offen offset:0 lds
  buffer_load_dwordx4 v9, s[20:23], s37 offen offset:1024 lds
  buffer_load_dwordx4 v9, s[20:23], s38 offen offset:2048 lds
  buffer_load_dwordx4 v9, s[20:23], s39 offen offset:3072 lds
  s_lshl_b32 s48, s34, 12
  s_add_u32 s48, s48, 8945664
  s_waitcnt lgkmcnt(6)
  buffer_store_dwordx4 v[32:35], v4, s[24:27], s48 offen offset:0 sc0 sc1
  s_waitcnt lgkmcnt(4)
  buffer_store_dwordx4 v[36:39], v4, s[24:27], s48 offen offset:1024 sc0 sc1
  s_waitcnt lgkmcnt(2)
  buffer_store_dwordx4 v[40:43], v4, s[24:27], s48 offen offset:2048 sc0 sc1
  s_waitcnt lgkmcnt(0)
  buffer_store_dwordx4 v[44:47], v4, s[24:27], s48 offen offset:3072 sc0 sc1
  s_waitcnt vmcnt(28)
  ds_read_b64_tr_b16 v[48:49], v12 offset:4096
  ds_read_b64_tr_b16 v[50:51], v12 offset:6144
  ds_read_b64_tr_b16 v[52:53], v13 offset:4096
  ds_read_b64_tr_b16 v[54:55], v13 offset:6144
  ds_read_b64_tr_b16 v[56:57], v14 offset:4096
  ds_read_b64_tr_b16 v[58:59], v14 offset:6144
  ds_read_b64_tr_b16 v[60:61], v15 offset:4096
  ds_read_b64_tr_b16 v[62:63], v15 offset:6144
  s_lshl_b32 s48, s34, 12
  s_add_u32 s48, s48, 9469952
  global_load_dword v245, v246, s[100:101] sc0 sc1
  s_waitcnt lgkmcnt(6)
  buffer_store_dwordx4 v[48:51], v4, s[24:27], s48 offen offset:0 sc0 sc1
  s_waitcnt lgkmcnt(4)
  buffer_store_dwordx4 v[52:55], v4, s[24:27], s48 offen offset:1024 sc0 sc1
  s_waitcnt lgkmcnt(2)
  buffer_store_dwordx4 v[56:59], v4, s[24:27], s48 offen offset:2048 sc0 sc1
  s_waitcnt lgkmcnt(0)
  buffer_store_dwordx4 v[60:63], v4, s[24:27], s48 offen offset:3072 sc0 sc1
  s_waitcnt vmcnt(29)
  ds_read_b64_tr_b16 v[32:33], v12 offset:8192
  ds_read_b64_tr_b16 v[34:35], v12 offset:10240
  ds_read_b64_tr_b16 v[36:37], v13 offset:8192
  ds_read_b64_tr_b16 v[38:39], v13 offset:10240
  ds_read_b64_tr_b16 v[40:41], v14 offset:8192
  ds_read_b64_tr_b16 v[42:43], v14 offset:10240
  ds_read_b64_tr_b16 v[44:45], v15 offset:8192
  ds_read_b64_tr_b16 v[46:47], v15 offset:10240
  s_add_u32 s52, s62, 0
  s_mul_i32 s53, s52, 7282
  s_lshr_b32 s53, s53, 16
  s_mul_i32 s54, s53, 9
  s_sub_u32 s54, s52, s54
  s_mul_i32 s52, s53, 3641
  s_lshr_b32 s52, s52, 272
  s_mul_i32 s55, s52, 18
  s_sub_u32 s53, s53, s55
  s_mul_i32 s55, s52, 72
  s_add_u32 s53, s53, s55
  s_mul_i32 s53, s53, 9
  s_add_u32 s53, s53, 6144
  s_lshl_b32 s54, s54, 258
  s_mul_i32 s55, s54, 7282
  s_lshr_b32 s55, s55, 272
  s_mul_i32 s55, s55, 153
  s_add_u32 s55, s55, s54
  s_add_u32 s55, s55, s53
  s_lshl_b32 s48, s55, 10
  s_add_u32 s54, s54, 1
  s_mul_i32 s55, s54, 7282
  s_lshr_b32 s55, s55, 272
  s_mul_i32 s55, s55, 153
  s_add_u32 s55, s55, s54
  s_add_u32 s55, s55, s53
  s_lshl_b32 s49, s55, 10
  s_add_u32 s54, s54, 1
  s_mul_i32 s55, s54, 7282
  s_lshr_b32 s55, s55, 272
  s_mul_i32 s55, s55, 153
  s_add_u32 s55, s55, s54
  s_add_u32 s55, s55, s53
  s_lshl_b32 s50, s55, 10
  s_add_u32 s54, s54, 1
  s_mul_i32 s55, s54, 7282
  s_lshr_b32 s55, s55, 272
  s_mul_i32 s55, s55, 153
  s_add_u32 s55, s55, s54
  s_add_u32 s55, s55, s53
  s_lshl_b32 s51, s55, 10
  s_waitcnt lgkmcnt(6)
  buffer_store_dwordx4 v[32:35], v4, s[24:27], s48 offen offset:0 sc0 sc1
  s_waitcnt lgkmcnt(4)
  buffer_store_dwordx4 v[36:39], v4, s[24:27], s49 offen offset:0 sc0 sc1
  s_waitcnt lgkmcnt(2)
  buffer_store_dwordx4 v[40:43], v4, s[24:27], s50 offen offset:0 sc0 sc1
  s_waitcnt lgkmcnt(0)
  buffer_store_dwordx4 v[44:47], v4, s[24:27], s51 offen offset:0 sc0 sc1
  s_waitcnt vmcnt(29)
  ds_read_b64_tr_b16 v[48:49], v12 offset:12288
  ds_read_b64_tr_b16 v[50:51], v12 offset:14336
  ds_read_b64_tr_b16 v[52:53], v13 offset:12288
  ds_read_b64_tr_b16 v[54:55], v13 offset:14336
  ds_read_b64_tr_b16 v[56:57], v14 offset:12288
  ds_read_b64_tr_b16 v[58:59], v14 offset:14336
  ds_read_b64_tr_b16 v[60:61], v15 offset:12288
  ds_read_b64_tr_b16 v[62:63], v15 offset:14336
  s_add_u32 s52, s62, 128
  s_mul_i32 s53, s52, 7282
  s_lshr_b32 s53, s53, 272
  s_mul_i32 s54, s53, 9
  s_sub_u32 s54, s52, s54
  s_mul_i32 s52, s53, 3641
  s_lshr_b32 s52, s52, 272
  s_mul_i32 s55, s52, 18
  s_sub_u32 s53, s53, s55
  s_mul_i32 s55, s52, 72
  s_add_u32 s53, s53, s55
  s_mul_i32 s53, s53, 9
  s_add_u32 s53, s53, 6144
  s_lshl_b32 s54, s54, 258
  s_mul_i32 s55, s54, 7282
  s_lshr_b32 s55, s55, 272
  s_mul_i32 s55, s55, 153
  s_add_u32 s55, s55, s54
  s_add_u32 s55, s55, s53
L_pg_2:
  s_cbranch_execz L_wr_0
  s_lshl_b32 s48, s55, 266
  s_add_u32 s54, s54, 1
  s_mul_i32 s55, s54, 7282
  s_lshr_b32 s55, s55, 272
  s_mul_i32 s55, s55, 153
  s_add_u32 s55, s55, s54
  s_add_u32 s55, s55, s53
  s_lshl_b32 s49, s55, 10
  s_add_u32 s54, s54, 1
  s_mul_i32 s55, s54, 7282
  s_lshr_b32 s55, s55, 272
  s_mul_i32 s55, s55, 153
  s_add_u32 s55, s55, s54
  s_add_u32 s55, s55, s53
  s_lshl_b32 s50, s55, 10
  s_add_u32 s54, s54, 1
  s_mul_i32 s55, s54, 7282
  s_lshr_b32 s55, s55, 272
  s_mul_i32 s55, s55, 153
  s_add_u32 s55, s55, s54
  s_add_u32 s55, s55, s53
  s_lshl_b32 s51, s55, 10
  s_waitcnt lgkmcnt(6)
  buffer_store_dwordx4 v[48:51], v4, s[24:27], s48 offen offset:0 sc0 sc1
  s_waitcnt lgkmcnt(4)
  buffer_store_dwordx4 v[52:55], v4, s[24:27], s49 offen offset:0 sc0 sc1
  s_waitcnt lgkmcnt(2)
  buffer_store_dwordx4 v[56:59], v4, s[24:27], s50 offen offset:0 sc0 sc1
  s_waitcnt lgkmcnt(0)
  buffer_store_dwordx4 v[60:63], v4, s[24:27], s51 offen offset:0 sc0 sc1
  s_waitcnt vmcnt(29)
  ds_read_b64_tr_b16 v[32:33], v12 offset:16384
  ds_read_b64_tr_b16 v[34:35], v12 offset:18432
  ds_read_b64_tr_b16 v[36:37], v13 offset:16384
  ds_read_b64_tr_b16 v[38:39], v13 offset:18432
  ds_read_b64_tr_b16 v[40:41], v14 offset:16384
  ds_read_b64_tr_b16 v[42:43], v14 offset:18432
  ds_read_b64_tr_b16 v[44:45], v15 offset:16384
  ds_read_b64_tr_b16 v[46:47], v15 offset:18432
  s_add_u32 s52, s62, 256
  s_mul_i32 s53, s52, 7282
  s_lshr_b32 s53, s53, 272
  s_mul_i32 s54, s53, 9
  s_sub_u32 s54, s52, s54
  s_mul_i32 s52, s53, 3641
  s_lshr_b32 s52, s52, 272
  s_mul_i32 s55, s52, 18
  s_sub_u32 s53, s53, s55
  s_mul_i32 s55, s52, 72
  s_add_u32 s53, s53, s55
  s_mul_i32 s53, s53, 9
  s_add_u32 s53, s53, 6144
  s_lshl_b32 s54, s54, 258
  s_mul_i32 s55, s54, 7282
  s_lshr_b32 s55, s55, 272
  s_mul_i32 s55, s55, 153
  s_add_u32 s55, s55, s54
  s_add_u32 s55, s55, s53
  s_lshl_b32 s48, s55, 10
  s_add_u32 s54, s54, 1
  s_mul_i32 s55, s54, 7282
  s_lshr_b32 s55, s55, 272
  s_mul_i32 s55, s55, 153
  s_add_u32 s55, s55, s54
  s_add_u32 s55, s55, s53
  s_lshl_b32 s49, s55, 10
  s_add_u32 s54, s54, 1
  s_mul_i32 s55, s54, 7282
  s_lshr_b32 s55, s55, 272
  s_mul_i32 s55, s55, 153
  s_add_u32 s55, s55, s54
  s_add_u32 s55, s55, s53
  s_lshl_b32 s50, s55, 10
  s_add_u32 s54, s54, 1
  s_mul_i32 s55, s54, 7282
  s_lshr_b32 s55, s55, 272
  s_mul_i32 s55, s55, 153
  s_add_u32 s55, s55, s54
  s_add_u32 s55, s55, s53
  s_lshl_b32 s51, s55, 10
  s_waitcnt vmcnt(8)
  s_mov_b32 s61, 0
L_d1h_chk:
  v_cmp_ne_u32 vcc, 1, v245
  s_cmp_eq_u64 vcc, 0
  s_cbranch_scc1 L_d1h_go
  s_add_u32 s61, s61, 1
  s_cmp_lt_u32 s61, 0x40000
  s_cbranch_scc0 L_d1h_go
  global_load_dword v245, v246, s[100:101] sc0 sc1
  s_waitcnt vmcnt(0)
  s_branch L_d1h_chk
L_d1h_go:
  s_barrier
  buffer_store_dword v240, v244, s[96:99], 0 offen sc0 sc1
  s_waitcnt lgkmcnt(6)
  buffer_store_dwordx4 v[32:35], v4, s[24:27], s48 offen offset:0 sc0 sc1
  s_waitcnt lgkmcnt(4)
  buffer_store_dwordx4 v[36:39], v4, s[24:27], s49 offen offset:0 sc0 sc1
  s_waitcnt lgkmcnt(2)
  buffer_store_dwordx4 v[40:43], v4, s[24:27], s50 offen offset:0 sc0 sc1
  s_waitcnt lgkmcnt(0)
  buffer_store_dwordx4 v[44:47], v4, s[24:27], s51 offen offset:0 sc0 sc1
  s_waitcnt vmcnt(30)
  ds_read_b64_tr_b16 v[48:49], v12 offset:20480
  ds_read_b64_tr_b16 v[50:51], v12 offset:22528
  ds_read_b64_tr_b16 v[52:53], v13 offset:20480
  ds_read_b64_tr_b16 v[54:55], v13 offset:22528
  ds_read_b64_tr_b16 v[56:57], v14 offset:20480
  ds_read_b64_tr_b16 v[58:59], v14 offset:22528
  ds_read_b64_tr_b16 v[60:61], v15 offset:20480
  ds_read_b64_tr_b16 v[62:63], v15 offset:22528
  s_add_u32 s52, s62, 384
  s_mul_i32 s53, s52, 7282
  s_lshr_b32 s53, s53, 272
  s_mul_i32 s54, s53, 9
  s_sub_u32 s54, s52, s54
  s_mul_i32 s52, s53, 3641
  s_lshr_b32 s52, s52, 272
  s_mul_i32 s55, s52, 18
  s_sub_u32 s53, s53, s55
  s_mul_i32 s55, s52, 72
  s_add_u32 s53, s53, s55
  s_mul_i32 s53, s53, 9
  s_add_u32 s53, s53, 6144
  s_lshl_b32 s54, s54, 258
  s_mul_i32 s55, s54, 7282
  s_lshr_b32 s55, s55, 272
  s_mul_i32 s55, s55, 153
  s_add_u32 s55, s55, s54
  s_add_u32 s55, s55, s53
  s_lshl_b32 s48, s55, 10
  s_add_u32 s54, s54, 1
  s_mul_i32 s55, s54, 7282
  s_lshr_b32 s55, s55, 272
  s_mul_i32 s55, s55, 153
  s_add_u32 s55, s55, s54
  s_add_u32 s55, s55, s53
  s_lshl_b32 s49, s55, 10
  s_add_u32 s54, s54, 1
  s_mul_i32 s55, s54, 7282
  s_lshr_b32 s55, s55, 272
  s_mul_i32 s55, s55, 153
  s_add_u32 s55, s55, s54
  s_add_u32 s55, s55, s53
  s_lshl_b32 s50, s55, 10
  s_add_u32 s54, s54, 1
  s_mul_i32 s55, s54, 7282
  s_lshr_b32 s55, s55, 272
  s_mul_i32 s55, s55, 153
  s_add_u32 s55, s55, s54
  s_add_u32 s55, s55, s53
  s_lshl_b32 s51, s55, 10
  s_waitcnt lgkmcnt(6)
  buffer_store_dwordx4 v[48:51], v4, s[24:27], s48 offen offset:0 sc0 sc1
  s_waitcnt lgkmcnt(4)
  buffer_store_dwordx4 v[52:55], v4, s[24:27], s49 offen offset:0 sc0 sc1
  s_waitcnt lgkmcnt(2)
  buffer_store_dwordx4 v[56:59], v4, s[24:27], s50 offen offset:0 sc0 sc1
  s_waitcnt lgkmcnt(0)
  buffer_store_dwordx4 v[60:63], v4, s[24:27], s51 offen offset:0 sc0 sc1
  s_waitcnt vmcnt(30)
  ds_read_b64_tr_b16 v[32:33], v12 offset:24576
  ds_read_b64_tr_b16 v[34:35], v12 offset:26624
  ds_read_b64_tr_b16 v[36:37], v13 offset:24576
  ds_read_b64_tr_b16 v[38:39], v13 offset:26624
  ds_read_b64_tr_b16 v[40:41], v14 offset:24576
  ds_read_b64_tr_b16 v[42:43], v14 offset:26624
  ds_read_b64_tr_b16 v[44:45], v15 offset:24576
  ds_read_b64_tr_b16 v[46:47], v15 offset:26624
  s_add_u32 s52, s63, 512
  s_mul_i32 s53, s52, 7282
  s_lshr_b32 s53, s53, 272
  s_mul_i32 s54, s53, 9
  s_sub_u32 s54, s52, s54
  s_mul_i32 s52, s53, 3641
  s_lshr_b32 s52, s52, 272
  s_mul_i32 s55, s52, 18
  s_sub_u32 s53, s53, s55
  s_mul_i32 s55, s52, 72
  s_add_u32 s53, s53, s55
  s_mul_i32 s53, s53, 9
  s_add_u32 s53, s53, 6144
  s_cmp_lt_u32 s52, 4
  s_cselect_b32 s53, s53, 0x100000
  s_lshl_b32 s54, s54, 2
  s_mul_i32 s55, s54, 7282
  s_lshr_b32 s55, s55, 272
  s_mul_i32 s55, s55, 153
  s_add_u32 s55, s55, s54
  s_add_u32 s55, s55, s53
  s_lshl_b32 s48, s55, 10
  s_add_u32 s54, s54, 1
  s_mul_i32 s55, s54, 7282
  s_lshr_b32 s55, s55, 272
  s_mul_i32 s55, s55, 153
  s_add_u32 s55, s55, s54
  s_add_u32 s55, s55, s53
  s_lshl_b32 s49, s55, 10
  s_add_u32 s54, s54, 1
  s_mul_i32 s55, s54, 7282
  s_lshr_b32 s55, s55, 272
  s_mul_i32 s55, s55, 153
  s_add_u32 s55, s55, s54
  s_add_u32 s55, s55, s53
  s_lshl_b32 s50, s55, 10
  s_add_u32 s54, s54, 1
  s_mul_i32 s55, s54, 7282
  s_lshr_b32 s55, s55, 272
  s_mul_i32 s55, s55, 153
  s_add_u32 s55, s55, s54
  s_add_u32 s55, s55, s53
  s_lshl_b32 s51, s55, 10
  s_waitcnt lgkmcnt(6)
  buffer_store_dwordx4 v[32:35], v4, s[24:27], s48 offen offset:0 sc0 sc1
  s_waitcnt lgkmcnt(4)
  buffer_store_dwordx4 v[36:39], v4, s[24:27], s49 offen offset:0 sc0 sc1
  s_waitcnt lgkmcnt(2)
  buffer_store_dwordx4 v[40:43], v4, s[24:27], s50 offen offset:0 sc0 sc1
  s_waitcnt lgkmcnt(0)
  buffer_store_dwordx4 v[44:47], v4, s[24:27], s51 offen offset:0 sc0 sc1
  s_waitcnt vmcnt(30)
  ds_read_b64_tr_b16 v[48:49], v12 offset:28672
  ds_read_b64_tr_b16 v[50:51], v12 offset:30720
  ds_read_b64_tr_b16 v[52:53], v13 offset:28672
  ds_read_b64_tr_b16 v[54:55], v13 offset:30720
  ds_read_b64_tr_b16 v[56:57], v14 offset:28672
  ds_read_b64_tr_b16 v[58:59], v14 offset:30720
  ds_read_b64_tr_b16 v[60:61], v15 offset:28672
  ds_read_b64_tr_b16 v[62:63], v15 offset:30720
  s_add_u32 s52, s63, 580
  s_mul_i32 s53, s52, 7282
  s_lshr_b32 s53, s53, 272
  s_mul_i32 s54, s53, 9
  s_sub_u32 s54, s52, s54
  s_mul_i32 s52, s53, 3641
  s_lshr_b32 s52, s52, 272
  s_mul_i32 s55, s52, 18
  s_sub_u32 s53, s53, s55
  s_mul_i32 s55, s52, 72
  s_add_u32 s53, s53, s55
  s_mul_i32 s53, s53, 9
  s_add_u32 s53, s53, 6144
  s_cmp_lt_u32 s52, 4
  s_cselect_b32 s53, s53, 0x100000
  s_lshl_b32 s54, s54, 2
  s_mul_i32 s55, s54, 7282
  s_lshr_b32 s55, s55, 272
  s_mul_i32 s55, s55, 153
  s_add_u32 s55, s55, s54
  s_add_u32 s55, s55, s53
  s_lshl_b32 s48, s55, 10
  s_add_u32 s54, s54, 1
  s_mul_i32 s55, s54, 7282
  s_lshr_b32 s55, s55, 272
  s_mul_i32 s55, s55, 153
  s_add_u32 s55, s55, s54
  s_add_u32 s55, s55, s53
  s_lshl_b32 s49, s55, 10
  s_add_u32 s54, s54, 1
  s_mul_i32 s55, s54, 7282
  s_lshr_b32 s55, s55, 272
  s_mul_i32 s55, s55, 153
  s_add_u32 s55, s55, s54
  s_add_u32 s55, s55, s53
  s_lshl_b32 s50, s55, 10
  s_add_u32 s54, s54, 1
  s_mul_i32 s55, s54, 7282
  s_lshr_b32 s55, s55, 272
  s_mul_i32 s55, s55, 153
  s_add_u32 s55, s55, s54
  s_add_u32 s55, s55, s53
  s_lshl_b32 s51, s55, 266
  s_waitcnt lgkmcnt(6)
  buffer_store_dwordx4 v[48:51], v4, s[24:27], s48 offen offset:0 sc0 sc1
  s_waitcnt lgkmcnt(4)
  buffer_store_dwordx4 v[52:55], v4, s[24:27], s49 offen offset:0 sc0 sc1
  s_waitcnt lgkmcnt(2)
  buffer_store_dwordx4 v[56:59], v4, s[24:27], s50 offen offset:0 sc0 sc1
  s_waitcnt lgkmcnt(0)
  buffer_store_dwordx4 v[60:63], v4, s[24:27], s51 offen offset:0 sc0 sc1
  s_mov_b32 s66, 5308416
  s_mov_b32 s67, 0x00020000
  s_sub_u32 s59, s2, 40
  s_max_i32 s60, s59, 0
  s_mul_i32 s57, s60, 911
  s_lshr_b32 s57, s57, 16
  s_mul_i32 s61, s57, 72
  s_sub_u32 s60, s60, s61
  s_cmp_lt_i32 s59, 0
  s_cselect_b32 s59, 0x40000000, 0
  s_lshl_b32 s60, s60, 2
  s_add_u32 s60, s60, s12
  s_mul_i32 s61, s57, 1769472
  s_lshl_b32 s3, s60, 261
  s_add_u32 s61, s61, s3
  s_add_u32 s61, s61, s59
  s_mul_i32 s3, s12, 73696
  s_add_u32 s61, s61, s3
  v_lshrrev_b32 v248, 3, v1
  v_mul_u32_u24 v248, 9216, v248
  v_and_b32_e64 v252, 7, v1
  v_lshl_add_u32 v248, v252, 4, v248
  v_add_u32_e64 v248, s61, v248
  s_mul_i32 s61, s57, 18432
  s_lshl_b32 s3, s60, 6
  s_add_u32 s61, s61, s3
  s_add_u32 s61, s61, s59
  v_lshrrev_b32 v250, 4, v1
  v_lshlrev_b32_e64 v250, 28, v250
  v_lshl_add_u32 v250, v1, 2, v250
  v_add_u32_e64 v250, s61, v250
  s_cmp_lt_u32 s60, 144
  s_cselect_b32 s61, 952320, 0
  s_cselect_b32 s3, 0, 144
  s_max_u32 s61, s61, 786432
  s_sub_u32 s60, s60, s3
  s_add_u32 s61, s61, s59
  s_mul_i32 s57, s57, 18432
  s_add_u32 s61, s61, s57
  s_mul_i32 s3, s60, 21846
  s_lshr_b32 s3, s3, 16
  s_mul_i32 s57, s3, 3
  s_sub_u32 s60, s60, s57
  s_lshl_b32 s60, s60, 10
  s_add_u32 s61, s61, s60
  s_mul_i32 s57, s3, 21846
  s_lshr_b32 s57, s57, 272
  s_mul_i32 s3, s3, 55296
  s_mul_i32 s57, s57, 165888
  s_add_u32 s61, s61, s3
  s_add_u32 s61, s61, s57
  v_lshlrev_b32_e64 v249, 4, v1
  v_add_u32 v249, s61, v249
  s_barrier
  s_branch L_k2_start
L_k1_end:
  s_endpgm
L_k2_start:
  s_nop 0
L_pg_3:
  s_cbranch_execz L_wr_0
  s_load_dwordx2 s[60:61], s[0:1], 0
  s_load_dwordx4 s[64:67], s[0:1], 32
  s_and_b32 s13, s2, 7
  s_lshr_b32 s14, s2, 3
  s_lshl_b32 s10, s13, 2
  s_and_b32 s15, s14, 3
  s_add_u32 s10, s10, s15
  s_lshr_b32 s11, s14, 2
  s_mul_i32 s28, s10, 18
  v_lshlrev_b32 v2, 4, v1
  v_and_b32 v3, 31, v1
  v_lshrrev_b32 v4, 5, v1
  s_lshl_b32 s30, s11, 8
  s_lshl_b32 s31, s12, 6
  s_add_u32 s30, s30, s31
  v_cmp_eq_u32 s[68:69], 0, v4
  s_mul_i32 s29, s12, 9
  s_mul_i32 s32, s29, 4160
  s_mul_i32 s33, s29, 4112
  s_add_u32 s33, s33, 9280
  s_add_u32 s34, s29, 558
  s_cmp_lt_u32 s12, 2
  s_cselect_b32 s32, s32, s33
  s_cselect_b32 s29, s29, s34
  s_mov_b32 s33, 4048
  s_cselect_b32 s33, 4096, s33
  s_add_u32 s29, s29, s28
  s_add_u32 s29, s29, 576
  v_mov_b32 v232, s29
  v_mov_b32 v233, s28
  v_cndmask_b32 v232, v233, v232, s[68:69]
  v_cndmask_b32 v233, 17, 8, s[68:69]
  v_bfe_u32 v234, v1, 4, 1
  v_mad_u32_u24 v232, v233, v234, v232
  v_lshrrev_b32 v232, 7, v232
  s_lshr_b32 s34, s30, 7
  v_mov_b32 v233, s34
  v_and_b32 v234, 15, v1
  v_cndmask_b32 v233, v233, v234, s[68:69]
  v_lshl_add_u32 v232, v232, 4, v233
  s_lshl_b32 s34, s12, 259
  s_add_u32 s34, s34, 168
  v_add_u32 v233, s34, v1
  v_cmp_gt_u32 vcc, 56, v1
  v_cndmask_b32 v233, v233, v232, vcc
  v_and_b32 v234, 7, v233
  v_lshrrev_b32 v232, 3, v233
  v_lshlrev_b32 v232, 6, v232
  v_lshl_add_u32 v232, v234, 2, v232
  s_lshr_b32 s34, s2, 0
  s_and_b32 s34, s34, 7
  s_mul_i32 s34, s34, 2048
  v_add_u32 v232, s34, v232
  s_lshl_b32 s29, s29, 6
  v_add_u32 v5, s30, v3
  s_lshr_b32 s31, s30, 5
  s_mul_i32 s31, s31, 110592
  v_lshl_add_u32 v6, v3, 1, s31
  v_lshrrev_b32_e64 v7, 2, v1
  v_mul_u32_u24 v7, 110528, v7
  v_add_u32_e64 v235, v7, v2
  v_lshl_add_u32 v7, v4, 9, v6
  s_lshl_b32 s31, s28, 262
  s_add_u32 s16, s8, 0
  s_addc_u32 s17, s9, 0
  s_mov_b32 s18, 7077888
  s_mov_b32 s19, 0x00020000
  s_add_u32 s37, s32, s33
  s_add_u32 s38, s37, s33
  s_add_u32 s39, s38, s33
  s_add_u32 s40, s39, s33
  s_add_u32 s41, s40, s33
  s_add_u32 s42, s41, s33
  s_add_u32 s43, s42, s33
  s_add_u32 s44, s43, s33
  s_add_u32 s45, s29, 1768448
  s_add_u32 s46, s29, 3536896
  s_add_u32 s47, s29, 5305344
  s_add_u32 s24, s8, 7077888
  s_addc_u32 s25, s9, 0
  s_mov_b32 s26, 2359296
  s_mov_b32 s27, 0x00020000
  v_and_b32 v8, 15, v1
  v_lshrrev_b32 v9, 4, v1
  v_lshlrev_b32 v136, 12, v8
  v_lshl_add_u32 v136, v9, 3, v136
  s_lshl_b32 s76, s2, 2
  s_add_u32 s76, s76, s12
  s_lshr_b32 s77, s76, 260
  s_lshl_b32 s77, s77, 17
  s_and_b32 s78, s76, 15
  s_lshl_b32 s78, s78, 8
  s_add_u32 s77, s77, s78
  s_add_u32 s78, s77, 65536
  v_bfe_u32 v10, v1, 2, 3
  v_and_b32 v11, 3, v1
  v_lshlrev_b32 v10, 7, v10
  v_lshl_add_u32 v10, v11, 3, v10
  s_lshl_b32 s35, s12, 5
  v_add_u32 v10, s35, v10
  v_mul_u32_u24 v252, 37440, v4
  v_add_u32_e64 v252, v252, v10
  v_mul_u32_u24 v253, 37008, v4
  v_add_u32 v10, 83296, v10
  v_add_u32 v253, v253, v10
  s_and_b32 s84, s2, 7
  s_lshr_b32 s85, s2, 3
  s_and_b32 s86, s84, 1
  s_lshl_b32 s86, s86, 3
  s_and_b32 s20, s85, 7
  s_add_u32 s20, s20, s86
  s_lshr_b32 s86, s84, 1
  s_lshl_b32 s86, s86, 2
  s_lshr_b32 s21, s85, 3
  s_add_u32 s21, s21, s86
  s_and_b32 s53, s21, 7
  s_lshr_b32 s84, s53, 1
  s_mul_i32 s52, s84, 9
  s_and_b32 s85, s53, 1
  s_mul_i32 s86, s85, 5
  s_add_u32 s52, s52, s86
  s_lshr_b32 s86, s21, 3
  s_lshl_b32 s86, s86, 2
  s_lshl_b32 s53, s20, 3
  s_add_u32 s53, s53, s86
  s_add_u32 s53, s53, s12
  s_mul_i32 s53, s53, 18432
  s_lshl_b32 s84, s52, 5
  s_add_u32 s53, s53, s84
  s_mul_i32 s84, s12, 36
  s_add_u32 s52, s52, s84
  s_lshl_b32 s52, s52, 266
  s_add_u32 s52, s52, 8945664
  s_lshr_b32 s54, s12, 257
  s_mul_i32 s54, s54, 7
  s_add_u32 s54, s54, s12
  s_mul_i32 s54, s54, 4112
  s_add_u32 s54, s54, 112080
  v_add_u32_e64 v10, 0, v1
  v_mul_u32_u24 v11, 205, v10
  v_lshrrev_b32_e64 v11, 11, v11
  v_mul_u32_u24 v11, 992, v11
  v_add_u32 v138, v2, v11
  v_add_u32 v10, 64, v1
  v_mul_u32_u24 v11, 205, v10
  v_lshrrev_b32_e64 v11, 11, v11
  v_mul_u32_u24 v11, 992, v11
  v_add_u32_e64 v139, v2, v11
  v_add_u32 v10, 128, v1
  v_mul_u32_u24 v11, 205, v10
  v_lshrrev_b32_e64 v11, 11, v11
  v_mul_u32_u24 v11, 992, v11
  v_add_u32_e64 v31, v2, v11
  s_mov_b32 s80, 294848
  s_mov_b32 s81, 589696
  s_mov_b32 s82, 884544
  s_mov_b32 s83, 1179392
  s_mov_b32 s84, 1474240
  s_mov_b32 s85, 36864
  s_movk_i32 s86, 6144
  s_movk_i32 s87, 12288
  s_lshl_b32 s79, s2, 262
  s_add_u32 s79, s79, 81920
  v_mov_b32_e64 v238, 0x40000000
  v_bfe_u32 v8, v1, 2, 2
  v_and_b32_e64 v9, 1, v1
  v_bfe_u32 v10, v1, 1, 1
  v_lshl_or_b32 v9, v9, 1, v10
  v_bfe_u32 v10, v1, 4, 1
  v_lshl_add_u32 v9, v10, 2, v9
  v_lshlrev_b32_e64 v9, 3, v9
  v_lshl_add_u32 v10, v4, 3, v8
  v_mul_u32_u24 v10, 4160, v10
  v_add_u32_e64 v140, v10, v9
  v_lshl_or_b32 v8, v4, 1, v8
  v_add_u32_e64 v10, 16, v8
  v_mul_u32_u24 v10, 4160, v10
  v_add_u32 v141, v10, v9
  v_mov_b32 v8, 4
  v_subrev_u32_e64 v9, 20, v3
  v_cmp_gt_u32 vcc, 8, v9
  s_nop 1
  v_cndmask_b32 v8, v8, 0, vcc
  v_cmp_gt_u32 vcc, 18, v3
  s_nop 1
  v_cndmask_b32_e64 v8, v8, v3, vcc
  v_mul_u32_u24 v8, 4112, v8
  v_add_u32 v8, 83296, v8
  v_mov_b32 v9, 74880
  v_cmp_eq_u32 vcc, 18, v3
  s_nop 1
  v_cndmask_b32_e64 v8, v8, v9, vcc
  v_mov_b32 v9, 0x100000
  v_cmp_lt_u32 vcc, 18, v3
  s_nop 1
  v_cndmask_b32_e64 v8, v8, v9, vcc
  v_lshl_add_u32 v142, v4, 4, v8
  s_lshl_b32 s35, s2, 8
  v_add_u32 v30, s35, v0
  v_lshlrev_b32 v30, 4, v30
  v_mov_b32 v224, -1
  v_mov_b32 v225, -1
  v_mov_b32 v226, -1
  v_mov_b32 v227, -1
  s_add_u32 s72, s8, 50331648
  s_addc_u32 s73, s9, 0
  s_mov_b32 s74, 10027008
  s_mov_b32 s75, 0x00020000
  s_add_u32 s56, s8, 11796480
  s_addc_u32 s57, s9, 0
  s_mov_b32 s58, 8388608
  s_mov_b32 s59, 0x00020000
  s_lshl_b32 s70, s76, 13
  s_add_u32 s71, s70, 4096
  s_lshr_b32 s35, s2, 3
  s_lshl_b32 s35, s35, 2
  s_add_u32 s35, s35, s12
  s_lshr_b32 s35, s35, 1
  s_lshl_b32 s35, s35, 262
  s_add_u32 s35, s35, 2560
  v_mov_b32_e64 v230, s35
  s_getpc_b64 s[22:23]
L_k2_pc:
  s_add_u32 s22, s22, L_kb_start-L_k2_pc
  s_addc_u32 s23, s23, 0
  s_lshl_b32 s15, s14, 2
  s_add_u32 s15, s15, s12
  v_lshlrev_b32 v228, 7, v1
  v_add_lshl_u32 v228, s15, v228, 6
  v_min_u32 v228, L_kb_end-L_kb_start-4, v228
  s_waitcnt lgkmcnt(0)
  s_mov_b32 s48, s66
  s_mov_b32 s49, s67
  s_mov_b32 s50, 8388608
  s_mov_b32 s51, 0x00020000
  s_mov_b32 s66, 5308416
  s_mov_b32 s67, 0x00020000
  s_mov_b32 s4, s60
  s_mov_b32 s5, s61
  s_mov_b32 s6, 2359296
  s_mov_b32 s7, 0x00020000
  s_add_u32 s60, s8, 40108032
  s_addc_u32 s61, s9, 0
  s_mov_b32 s62, 9609216
  s_mov_b32 s63, 0x00020000
  v_mov_b32 v236, 157440
  v_mov_b32 v237, 0
  buffer_load_dword v144, v232, s[96:99], 0 offen sc0 sc1
  v_lshrrev_b32_e64 v28, 4, v5
  v_mul_u32_u24 v28, 18432, v28
  v_and_b32_e64 v12, 15, v5
  v_lshl_add_u32 v29, v12, 4, v28
  v_lshl_add_u32 v29, v4, 8, v29
  v_lshl_add_u32 v28, v12, 2, v28
  v_mov_b32 v12, 0x7f000000
  v_cndmask_b32 v28, v12, v28, s[68:69]
  s_lshl_b32 s35, s10, 9
  v_add_u32 v29, s35, v29
  s_lshl_b32 s35, s10, 262
  s_add_u32 s35, s35, 16384
  v_add_u32_e64 v28, s35, v28
  v_mov_b32 v12, 0x3f803f80
  v_mov_b32 v13, v12
  v_mov_b32 v14, v12
  v_mov_b32 v15, v12
  v_lshlrev_b32 v10, 4, v0
  v_add_u32 v10, 74880, v10
  ds_write_b128 v10, v[12:15]
  ds_write_b128 v10, v[12:15] offset:4096
  v_and_b32 v10, 7, v0
  v_lshlrev_b32 v10, 4, v10
  v_add_u32 v10, 83072, v10
  ds_write_b128 v10, v[12:15]
  s_lshl_b32 s35, s11, 2
  s_add_u32 s35, s35, s12
  s_lshl_b32 s35, s35, 5
  s_add_u32 s35, s35, s10
  s_lshl_b32 s35, s35, 262
  s_add_u32 s35, s35, 16384
  v_lshrrev_b32 v244, 2, v1
  v_lshlrev_b32 v244, 24, v244
  v_lshl_add_u32 v244, v1, 4, v244
  v_add_u32_e64 v244, s35, v244
  v_accvgpr_write_b32 a28, v12
  v_accvgpr_write_b32 a29, v12
  v_accvgpr_write_b32 a30, v12
  v_accvgpr_write_b32 a31, v12
  ds_write2_b32 v236, v237, v237 offset1:1
  v_lshlrev_b32_e64 v246, 6, v0
  v_add_u32 v246, 81920, v246
  v_mov_b32 v104, 0
  v_mov_b32 v105, 0
  v_mov_b32 v106, 0
  v_mov_b32 v107, 0
  v_mov_b32 v108, 0
  v_mov_b32 v109, 0
  v_mov_b32 v110, 0
  v_mov_b32 v111, 0
  v_mov_b32 v112, 0
  v_mov_b32 v113, 0
  v_mov_b32 v114, 0
  v_mov_b32 v115, 0
  v_mov_b32 v116, 0
  v_mov_b32 v117, 0
  v_mov_b32 v118, 0
  v_mov_b32 v119, 0
  v_mov_b32 v120, 0
  v_mov_b32 v121, 0
  v_mov_b32 v122, 0
  v_mov_b32 v123, 0
  v_mov_b32 v124, 0
  v_mov_b32 v125, 0
  v_mov_b32 v126, 0
  v_mov_b32 v127, 0
  v_mov_b32 v128, 0
  v_mov_b32 v129, 0
  v_mov_b32 v130, 0
  v_mov_b32 v131, 0
  v_mov_b32 v132, 0
  v_mov_b32 v133, 0
  v_mov_b32 v134, 0
  v_mov_b32 v135, 0
  v_mov_b32 v68, 0
  v_mov_b32 v60, 0
  v_mov_b32 v69, 0
  v_mov_b32 v61, 0
  v_mov_b32 v70, 0
  v_mov_b32 v62, 0
  v_mov_b32 v71, 0
  v_mov_b32 v63, 0
  s_mov_b32 m0, s32
  s_mov_b32 s34, 0
L_f1_chk:
  s_waitcnt vmcnt(0)
  v_cmp_ne_u32 vcc, 1, v144
  s_cmp_eq_u64 vcc, 0
  s_cbranch_scc1 L_f1_go
  buffer_load_dword v144, v232, s[96:99], 0 offen sc0 sc1
  s_add_u32 s34, s34, 1
  s_cmp_lt_u32 s34, 0x10000
  s_cbranch_scc1 L_f1_chk
L_f1_go:
  s_add_u32 s35, s31, 110592
  buffer_load_ushort v16, v7, s[16:19], s31 offen offset:0
  buffer_load_ushort v20, v7, s[16:19], s35 offen offset:0
  buffer_load_ushort v17, v7, s[16:19], s31 offen offset:128
  buffer_load_ushort v21, v7, s[16:19], s35 offen offset:128
  buffer_load_ushort v18, v7, s[16:19], s31 offen offset:256
  buffer_load_ushort v22, v7, s[16:19], s35 offen offset:256
  buffer_load_ushort v19, v7, s[16:19], s31 offen offset:384
  buffer_load_ushort v23, v7, s[16:19], s35 offen offset:384
  buffer_load_ushort v24, v6, s[16:19], s31 offen offset:1024
  buffer_load_ushort v26, v6, s[16:19], s35 offen offset:1024
  buffer_load_dwordx4 v235, s[16:19], s29 offen offset:0 lds
  s_mov_b32 m0, s38
  s_nop 0
  buffer_load_dwordx4 v235, s[16:19], s29 offen offset:128 lds
  s_mov_b32 m0, s40
  s_nop 0
  buffer_load_dwordx4 v235, s[16:19], s29 offen offset:256 lds
  s_nop 0
  s_nop 0
  s_mov_b32 m0, s42
  s_nop 0
  buffer_load_dwordx4 v235, s[16:19], s29 offen offset:384 lds
  s_mov_b32 m0, s44
  s_nop 0
  buffer_load_dwordx4 v235, s[16:19], s29 offen offset:512 lds
  s_mov_b32 m0, s37
  s_nop 0
  buffer_load_ushort v72, v7, s[16:19], s31 offen offset:64
  buffer_load_ushort v88, v7, s[16:19], s35 offen offset:64
  buffer_load_ushort v73, v7, s[16:19], s31 offen offset:192
  buffer_load_ushort v89, v7, s[16:19], s35 offen offset:192
  buffer_load_ushort v74, v7, s[16:19], s31 offen offset:320
  buffer_load_ushort v90, v7, s[16:19], s35 offen offset:320
  buffer_load_ushort v75, v7, s[16:19], s31 offen offset:448
  buffer_load_ushort v91, v7, s[16:19], s35 offen offset:448
  buffer_load_ushort v76, v6, s[16:19], s31 offen offset:1088
  buffer_load_ushort v92, v6, s[16:19], s35 offen offset:1088
  buffer_load_dwordx4 v235, s[16:19], s29 offen offset:64 lds
  s_mov_b32 m0, s39
  s_nop 0
  buffer_load_dwordx4 v235, s[16:19], s29 offen offset:192 lds
  s_mov_b32 m0, s41
  s_nop 0
  buffer_load_dwordx4 v235, s[16:19], s29 offen offset:320 lds
  s_mov_b32 m0, s43
  s_nop 0
  buffer_load_dwordx4 v235, s[16:19], s29 offen offset:448 lds
  s_mov_b64 exec, 0
  s_bitcmp1_b32 s12, 1
  s_cbranch_scc1 L_wh_1
  s_bitcmp1_b32 s12, 0
  s_cbranch_scc1 L_pg_6
  s_branch L_pg_5
L_wh_1:
  s_bitcmp1_b32 s12, 0
  s_cbranch_scc1 L_pg_8
  s_branch L_pg_7
L_wr_1:
  s_mov_b64 exec, -1
  s_waitcnt vmcnt(4)
  s_nop 0
  v_lshl_or_b32 v16, v72, 16, v16
  v_lshl_or_b32 v17, v73, 16, v17
  v_lshl_or_b32 v18, v74, 16, v18
  v_lshl_or_b32 v19, v75, 16, v19
  v_lshl_or_b32 v24, v76, 16, v24
  v_cndmask_b32 v24, 0, v24, s[68:69]
  v_lshl_or_b32 v20, v88, 16, v20
  v_lshl_or_b32 v21, v89, 16, v21
  v_lshl_or_b32 v22, v90, 16, v22
  v_lshl_or_b32 v23, v91, 16, v23
  v_lshl_or_b32 v26, v92, 16, v26
  v_cndmask_b32 v26, 0, v26, s[68:69]
  s_mov_b32 s30, 1
  s_mov_b32 s31, 0
  s_waitcnt vmcnt(0)
  s_waitcnt lgkmcnt(0)
  s_barrier
  s_nop 0
  ds_read_b64_tr_b16 v[32:33], v140 offset:0
  ds_read_b64_tr_b16 v[34:35], v140 offset:16640
  ds_read_b64_tr_b16 v[40:41], v141 offset:0
  ds_read_b64_tr_b16 v[36:37], v140 offset:64
  ds_read_b64_tr_b16 v[38:39], v140 offset:16704
  ds_read_b64_tr_b16 v[42:43], v141 offset:64
  ds_read_b128 v[48:51], v142 offset:0
  ds_read_b128 v[52:55], v142 offset:32
  s_waitcnt lgkmcnt(6)
  v_mfma_f32_32x32x16_bf16 v[72:87], v[32:35], v[16:19], 0
  v_mfma_f32_32x32x16_bf16 v[88:103], v[32:35], v[20:23], 0
  s_nop 11
  v_max3_f32 v10, v72, v73, v74
  v_cvt_pk_bf16_f32 v10, -v10, 0
  v_cndmask_b32 v25, 0, v10, s[68:69]
  v_max3_f32 v10, v88, v89, v90
  v_cvt_pk_bf16_f32 v10, -v10, 0
  v_cndmask_b32 v27, 0, v10, s[68:69]
  s_waitcnt lgkmcnt(5)
  v_mfma_f32_32x32x8bf16_1k v[72:87], v[40:41], v[24:25], v[72:87]
  s_nop 15
  s_mov_b32 m0, s32
  v_mfma_f32_32x32x16_bf16 v[88:103], v[32:35], v[20:23], 0
  buffer_load_dwordx4 v235, s[16:19], s45 offen offset:1024 lds
  buffer_load_dwordx4 v235, s[16:19], s46 offen offset:2048 lds
  buffer_store_dwordx4 v[224:227], v29, s[24:27], 0 offen sc0 sc1
  v_exp_f32 v72, v72
  v_exp_f32 v73, v73
  v_exp_f32 v74, v74
  v_exp_f32_e64 v75, v75
  v_cvt_pk_bf16_f32 v64, v72, v73
  v_cvt_pk_bf16_f32 v65, v74, v75
  v_mfma_f32_32x32x16_bf16 v[120:135], v[60:63], v[68:71], v[120:135]
  ds_read_b64_tr_b16 v[32:33], v140 offset:128
  v_exp_f32 v76, v76
  v_exp_f32 v77, v77
  v_exp_f32 v78, v78
  v_exp_f32 v79, v79
  v_cvt_pk_bf16_f32 v66, v76, v77
  v_cvt_pk_bf16_f32 v67, v78, v79
  v_mfma_f32_32x32x8bf16_1k v[88:103], v[40:41], v[26:27], v[88:103]
  s_waitcnt lgkmcnt(1)
  ds_read_b64_tr_b16 v[34:35], v140 offset:16768
  v_exp_f32 v80, v80
  v_exp_f32 v81, v81
  v_exp_f32 v82, v82
  v_exp_f32_e64 v83, v83
  v_cvt_pk_bf16_f32 v68, v80, v81
  v_cvt_pk_bf16_f32 v69, v82, v83
  v_mfma_f32_32x32x16_bf16 v[104:119], v[48:51], v[64:67], v[104:119]
  ds_read_b64_tr_b16 v[40:41], v141 offset:128
  v_exp_f32 v84, v84
  v_exp_f32 v85, v85
  v_exp_f32 v86, v86
  v_exp_f32 v87, v87
  v_cvt_pk_bf16_f32 v70, v84, v85
  v_cvt_pk_bf16_f32 v71, v86, v87
  v_mfma_f32_32x32x16_bf16 v[72:87], v[36:39], v[16:19], 0
  ds_read_b128 v[56:59], v142 offset:64
  v_exp_f32 v88, v88
  v_exp_f32 v89, v89
  v_exp_f32 v90, v90
  v_exp_f32 v91, v91
  v_cvt_pk_bf16_f32 v64, v88, v89
  v_cvt_pk_bf16_f32 v65, v90, v91
  v_mfma_f32_32x32x16_bf16 v[104:119], v[52:55], v[68:71], v[104:119]
  ds_read_b128 v[60:63], v142 offset:96
  v_exp_f32 v92, v92
  v_exp_f32 v93, v93
  v_exp_f32 v94, v94
  v_exp_f32 v95, v95
  v_cvt_pk_bf16_f32 v66, v92, v93
  v_cvt_pk_bf16_f32 v67, v94, v95
  v_mfma_f32_32x32x8bf16_1k v[72:87], v[42:43], v[24:25], v[72:87]
  v_exp_f32 v96, v96
  v_exp_f32 v97, v97
  v_exp_f32 v98, v98
  v_exp_f32 v99, v99
  v_cvt_pk_bf16_f32 v68, v96, v97
  v_cvt_pk_bf16_f32 v69, v98, v99
  v_mfma_f32_32x32x16_bf16 v[120:135], v[48:51], v[64:67], v[120:135]
  v_exp_f32 v100, v100
  v_exp_f32 v101, v101
  v_exp_f32 v102, v102
  v_exp_f32 v103, v103
  v_cvt_pk_bf16_f32 v70, v100, v101
  v_cvt_pk_bf16_f32 v71, v102, v103
  v_mfma_f32_32x32x16_bf16 v[88:103], v[36:39], v[20:23], 0
  v_exp_f32 v72, v72
  v_exp_f32 v73, v73
  v_exp_f32_e64 v74, v74
  v_exp_f32 v75, v75
  v_cvt_pk_bf16_f32 v64, v72, v73
  v_cvt_pk_bf16_f32 v65, v74, v75
  s_mov_b32 m0, s38
  v_mfma_f32_32x32x16_bf16 v[120:135], v[52:55], v[68:71], v[120:135]
  buffer_load_dwordx4 v235, s[16:19], s45 offen offset:1152 lds
  buffer_load_dwordx4 v235, s[16:19], s46 offen offset:2176 lds
  buffer_store_dword v224, v28, s[24:27], 0 offen sc0 sc1
  ds_read_b64_tr_b16 v[36:37], v140 offset:192
  v_exp_f32 v76, v76
  v_exp_f32 v77, v77
  v_exp_f32 v78, v78
  v_exp_f32 v79, v79
  v_cvt_pk_bf16_f32 v66, v76, v77
  v_cvt_pk_bf16_f32 v67, v78, v79
  v_mfma_f32_32x32x8bf16_1k v[88:103], v[42:43], v[26:27], v[88:103]
  s_waitcnt lgkmcnt(1)
  ds_read_b64_tr_b16 v[38:39], v140 offset:16832
  v_exp_f32 v80, v80
  v_exp_f32 v81, v81
  v_exp_f32 v82, v82
  v_exp_f32_e64 v83, v83
  v_cvt_pk_bf16_f32 v68, v80, v81
  v_cvt_pk_bf16_f32 v69, v82, v83
  v_mfma_f32_32x32x16_bf16 v[104:119], v[56:59], v[64:67], v[104:119]
  ds_read_b64_tr_b16 v[42:43], v141 offset:192
  v_exp_f32 v84, v84
  v_exp_f32 v85, v85
  v_exp_f32 v86, v86
  v_exp_f32 v87, v87
  v_cvt_pk_bf16_f32 v70, v84, v85
  v_cvt_pk_bf16_f32 v71, v86, v87
  v_mfma_f32_32x32x16_bf16 v[72:87], v[32:35], v[16:19], 0
  ds_read_b128 v[48:51], v142 offset:128
  v_exp_f32 v88, v88
  v_exp_f32 v89, v89
  v_exp_f32 v90, v90
  v_exp_f32 v91, v91
  v_cvt_pk_bf16_f32 v64, v88, v89
  v_cvt_pk_bf16_f32 v65, v90, v91
  v_mfma_f32_32x32x16_bf16 v[104:119], v[60:63], v[68:71], v[104:119]
  ds_read_b128 v[52:55], v142 offset:160
  v_exp_f32 v92, v92
  v_exp_f32 v93, v93
  v_exp_f32 v94, v94
  v_exp_f32 v95, v95
  v_cvt_pk_bf16_f32 v66, v92, v93
  v_cvt_pk_bf16_f32 v67, v94, v95
  v_mfma_f32_32x32x8bf16_1k v[72:87], v[40:41], v[24:25], v[72:87]
  v_exp_f32 v96, v96
  v_exp_f32 v97, v97
  v_exp_f32 v98, v98
  v_exp_f32 v99, v99
  v_cvt_pk_bf16_f32 v68, v96, v97
  v_cvt_pk_bf16_f32 v69, v98, v99
  v_mfma_f32_32x32x16_bf16 v[120:135], v[56:59], v[64:67], v[120:135]
  v_exp_f32 v100, v100
  v_exp_f32 v101, v101
  v_exp_f32 v102, v102
  v_exp_f32 v103, v103
  v_cvt_pk_bf16_f32 v70, v100, v101
  v_cvt_pk_bf16_f32 v71, v102, v103
  v_mfma_f32_32x32x16_bf16 v[88:103], v[32:35], v[20:23], 0
  v_exp_f32 v72, v72
  v_exp_f32 v73, v73
  v_exp_f32 v74, v74
  v_exp_f32 v75, v75
  v_cvt_pk_bf16_f32 v64, v72, v73
  v_cvt_pk_bf16_f32 v65, v74, v75
  v_mfma_f32_32x32x16_bf16 v[120:135], v[60:63], v[68:71], v[120:135]
  ds_read_b64_tr_b16 v[32:33], v140 offset:256
  v_exp_f32 v76, v76
  v_exp_f32 v77, v77
  v_exp_f32 v78, v78
  v_exp_f32 v79, v79
  v_cvt_pk_bf16_f32 v66, v76, v77
  v_cvt_pk_bf16_f32 v67, v78, v79
  v_mfma_f32_32x32x8bf16_1k v[88:103], v[40:41], v[26:27], v[88:103]
  s_waitcnt lgkmcnt(1)
  ds_read_b64_tr_b16 v[34:35], v140 offset:16896
  v_exp_f32 v80, v80
  v_exp_f32 v81, v81
  v_exp_f32 v82, v82
  v_exp_f32 v83, v83
  v_cvt_pk_bf16_f32 v68, v80, v81
  v_cvt_pk_bf16_f32 v69, v82, v83
  s_mov_b32 m0, s40
  v_mfma_f32_32x32x16_bf16 v[104:119], v[48:51], v[64:67], v[104:119]
  buffer_load_dwordx4 v235, s[16:19], s45 offen offset:1280 lds
  buffer_load_dwordx4 v235, s[16:19], s46 offen offset:2304 lds
  buffer_store_dwordx4 v[224:227], v29, s[24:27], s85 offen sc0 sc1
  ds_read_b64_tr_b16 v[40:41], v141 offset:256
  v_exp_f32 v84, v84
  v_exp_f32 v85, v85
  v_exp_f32 v86, v86
  v_exp_f32 v87, v87
  v_cvt_pk_bf16_f32 v70, v84, v85
  v_cvt_pk_bf16_f32 v71, v86, v87
  v_mfma_f32_32x32x16_bf16 v[72:87], v[36:39], v[16:19], 0
  ds_read_b128 v[56:59], v142 offset:192
  v_exp_f32 v88, v88
  v_exp_f32 v89, v89
  v_exp_f32 v90, v90
  v_exp_f32 v91, v91
  v_cvt_pk_bf16_f32 v64, v88, v89
  v_cvt_pk_bf16_f32 v65, v90, v91
  v_mfma_f32_32x32x16_bf16 v[104:119], v[52:55], v[68:71], v[104:119]
  ds_read_b128 v[60:63], v142 offset:224
  v_exp_f32 v92, v92
  v_exp_f32 v93, v93
  v_exp_f32 v94, v94
  v_exp_f32 v95, v95
  v_cvt_pk_bf16_f32 v66, v92, v93
  v_cvt_pk_bf16_f32 v67, v94, v95
  v_mfma_f32_32x32x8bf16_1k v[72:87], v[42:43], v[24:25], v[72:87]
  v_exp_f32 v96, v96
  v_exp_f32 v97, v97
  v_exp_f32 v98, v98
  v_exp_f32 v99, v99
  v_cvt_pk_bf16_f32 v68, v96, v97
  v_cvt_pk_bf16_f32 v69, v98, v99
  v_mfma_f32_32x32x16_bf16 v[120:135], v[48:51], v[64:67], v[120:135]
  v_exp_f32 v100, v100
  v_exp_f32 v101, v101
  v_exp_f32 v102, v102
  v_exp_f32 v103, v103
  v_cvt_pk_bf16_f32 v70, v100, v101
  v_cvt_pk_bf16_f32 v71, v102, v103
  v_mfma_f32_32x32x16_bf16 v[88:103], v[36:39], v[20:23], 0
  v_exp_f32 v72, v72
  v_exp_f32 v73, v73
  v_exp_f32 v74, v74
  v_exp_f32 v75, v75
  v_cvt_pk_bf16_f32 v64, v72, v73
  v_cvt_pk_bf16_f32 v65, v74, v75
  v_mfma_f32_32x32x16_bf16 v[120:135], v[52:55], v[68:71], v[120:135]
  s_mov_b32 m0, s42
  ds_read_b64_tr_b16 v[36:37], v140 offset:320
  v_exp_f32 v76, v76
  v_exp_f32 v77, v77
  v_exp_f32 v78, v78
  v_exp_f32_e64 v79, v79
  v_cvt_pk_bf16_f32 v66, v76, v77
  v_cvt_pk_bf16_f32 v67, v78, v79
  v_mfma_f32_32x32x8bf16_1k v[88:103], v[42:43], v[26:27], v[88:103]
  s_waitcnt lgkmcnt(1)
  ds_read_b64_tr_b16 v[38:39], v140 offset:16960
  v_exp_f32 v80, v80
  v_exp_f32 v81, v81
  v_exp_f32 v82, v82
  v_exp_f32 v83, v83
  v_cvt_pk_bf16_f32 v68, v80, v81
  v_cvt_pk_bf16_f32 v69, v82, v83
  s_getpc_b64 s[94:95]
  v_mfma_f32_32x32x16_bf16 v[104:119], v[56:59], v[64:67], v[104:119]
  buffer_load_dwordx4 v235, s[16:19], s45 offen offset:1408 lds
  buffer_load_dwordx4 v235, s[16:19], s46 offen offset:2432 lds
  global_load_dword v231, v230, s[94:95]
  buffer_store_dword v224, v28, s[24:27], s85 offen sc0 sc1
  ds_read_b64_tr_b16 v[42:43], v141 offset:320
  v_exp_f32 v84, v84
  v_exp_f32 v85, v85
  v_exp_f32 v86, v86
  v_exp_f32 v87, v87
  v_cvt_pk_bf16_f32 v70, v84, v85
  v_cvt_pk_bf16_f32 v71, v86, v87
  v_mfma_f32_32x32x16_bf16 v[72:87], v[32:35], v[16:19], 0
  ds_read_b128 v[48:51], v142 offset:256
  v_exp_f32 v88, v88
  v_exp_f32 v89, v89
  v_exp_f32 v90, v90
  v_exp_f32 v91, v91
  v_cvt_pk_bf16_f32 v64, v88, v89
  v_cvt_pk_bf16_f32 v65, v90, v91
  v_mfma_f32_32x32x16_bf16 v[104:119], v[60:63], v[68:71], v[104:119]
  ds_read_b128 v[52:55], v142 offset:288
  v_exp_f32 v92, v92
  v_exp_f32 v93, v93
  v_exp_f32 v94, v94
  v_exp_f32 v95, v95
  v_cvt_pk_bf16_f32 v66, v92, v93
  v_cvt_pk_bf16_f32 v67, v94, v95
  v_mfma_f32_32x32x8bf16_1k v[72:87], v[40:41], v[24:25], v[72:87]
  v_exp_f32 v96, v96
  v_exp_f32 v97, v97
  v_exp_f32 v98, v98
  v_exp_f32 v99, v99
  v_cvt_pk_bf16_f32 v68, v96, v97
  v_cvt_pk_bf16_f32 v69, v98, v99
  v_mfma_f32_32x32x16_bf16 v[120:135], v[56:59], v[64:67], v[120:135]
  v_exp_f32 v100, v100
  v_exp_f32 v101, v101
  v_exp_f32 v102, v102
  v_exp_f32 v103, v103
  v_cvt_pk_bf16_f32 v70, v100, v101
  v_cvt_pk_bf16_f32 v71, v102, v103
  v_mfma_f32_32x32x16_bf16 v[88:103], v[32:35], v[20:23], 0
  v_exp_f32 v72, v72
  v_exp_f32 v73, v73
  v_exp_f32 v74, v74
  v_exp_f32 v75, v75
  v_cvt_pk_bf16_f32 v64, v72, v73
  v_cvt_pk_bf16_f32 v65, v74, v75
  v_mfma_f32_32x32x16_bf16 v[120:135], v[60:63], v[68:71], v[120:135]
  ds_read_b64_tr_b16 v[32:33], v140 offset:384
  v_exp_f32 v76, v76
  v_exp_f32 v77, v77
  v_exp_f32 v78, v78
  v_exp_f32 v79, v79
  v_cvt_pk_bf16_f32 v66, v76, v77
  v_cvt_pk_bf16_f32 v67, v78, v79
  v_mfma_f32_32x32x8bf16_1k v[88:103], v[40:41], v[26:27], v[88:103]
  s_waitcnt lgkmcnt(1)
  ds_read_b64_tr_b16 v[34:35], v140 offset:17024
  v_exp_f32 v80, v80
  v_exp_f32 v81, v81
  v_exp_f32 v82, v82
  v_exp_f32_e64 v83, v83
  v_cvt_pk_bf16_f32 v68, v80, v81
  v_cvt_pk_bf16_f32 v69, v82, v83
  v_mfma_f32_32x32x16_bf16 v[104:119], v[48:51], v[64:67], v[104:119]
  ds_read_b64_tr_b16 v[40:41], v141 offset:384
  v_exp_f32 v84, v84
  v_exp_f32 v85, v85
  v_exp_f32_e64 v86, v86
  v_exp_f32 v87, v87
  v_cvt_pk_bf16_f32 v70, v84, v85
  v_cvt_pk_bf16_f32 v71, v86, v87
  s_mov_b32 m0, s44
  v_mfma_f32_32x32x16_bf16 v[72:87], v[36:39], v[16:19], 0
  buffer_load_dwordx4 v235, s[16:19], s45 offen offset:1536 lds
  buffer_load_dwordx4 v235, s[16:19], s46 offen offset:2560 lds
  buffer_store_dwordx4 v[224:227], v30, s[72:75], 0 offen sc0 sc1
  ds_read_b128 v[56:59], v142 offset:320
  v_exp_f32 v88, v88
  v_exp_f32 v89, v89
  v_exp_f32 v90, v90
  v_exp_f32 v91, v91
  v_cvt_pk_bf16_f32 v64, v88, v89
  v_cvt_pk_bf16_f32 v65, v90, v91
  v_mfma_f32_32x32x16_bf16 v[104:119], v[52:55], v[68:71], v[104:119]
  ds_read_b128 v[60:63], v142 offset:352
  v_exp_f32 v92, v92
  v_exp_f32 v93, v93
  v_exp_f32 v94, v94
  v_exp_f32 v95, v95
  v_cvt_pk_bf16_f32 v66, v92, v93
  v_cvt_pk_bf16_f32 v67, v94, v95
  v_mfma_f32_32x32x8bf16_1k v[72:87], v[42:43], v[24:25], v[72:87]
  v_exp_f32 v96, v96
  v_exp_f32 v97, v97
  v_exp_f32 v98, v98
  v_exp_f32 v99, v99
  v_cvt_pk_bf16_f32 v68, v96, v97
  v_cvt_pk_bf16_f32 v69, v98, v99
  v_mfma_f32_32x32x16_bf16 v[120:135], v[48:51], v[64:67], v[120:135]
  v_exp_f32 v100, v100
  v_exp_f32 v101, v101
  v_exp_f32 v102, v102
  v_exp_f32 v103, v103
  v_cvt_pk_bf16_f32 v70, v100, v101
  v_cvt_pk_bf16_f32 v71, v102, v103
  v_mfma_f32_32x32x16_bf16 v[88:103], v[36:39], v[20:23], 0
  v_exp_f32 v72, v72
  v_exp_f32 v73, v73
  v_exp_f32 v74, v74
  v_exp_f32 v75, v75
  v_cvt_pk_bf16_f32 v64, v72, v73
  v_cvt_pk_bf16_f32 v65, v74, v75
  v_mfma_f32_32x32x16_bf16 v[120:135], v[52:55], v[68:71], v[120:135]
  ds_read_b64_tr_b16 v[36:37], v140 offset:448
  v_exp_f32 v76, v76
  v_exp_f32 v77, v77
  v_exp_f32 v78, v78
  v_exp_f32 v79, v79
  v_cvt_pk_bf16_f32 v66, v76, v77
  v_cvt_pk_bf16_f32 v67, v78, v79
  v_mfma_f32_32x32x8bf16_1k v[88:103], v[42:43], v[26:27], v[88:103]
  s_waitcnt lgkmcnt(1)
  ds_read_b64_tr_b16 v[38:39], v140 offset:17088
  v_exp_f32 v80, v80
  v_exp_f32 v81, v81
  v_exp_f32 v82, v82
  v_exp_f32_e64 v83, v83
  v_cvt_pk_bf16_f32 v68, v80, v81
  v_cvt_pk_bf16_f32 v69, v82, v83
  v_mfma_f32_32x32x16_bf16 v[104:119], v[56:59], v[64:67], v[104:119]
  ds_read_b64_tr_b16 v[42:43], v141 offset:448
  v_exp_f32 v84, v84
  v_exp_f32 v85, v85
  v_exp_f32 v86, v86
  v_exp_f32 v87, v87
  v_cvt_pk_bf16_f32 v70, v84, v85
  v_cvt_pk_bf16_f32 v71, v86, v87
  v_mfma_f32_32x32x16_bf16 v[72:87], v[32:35], v[16:19], 0
  s_mov_b32 m0, s37
  ds_read_b128 v[48:51], v142 offset:384
  v_exp_f32 v88, v88
  v_exp_f32 v89, v89
  v_exp_f32 v90, v90
  v_exp_f32_e64 v91, v91
  v_cvt_pk_bf16_f32 v64, v88, v89
  v_cvt_pk_bf16_f32 v65, v90, v91
  s_mov_b32 s35, 1048576
  v_mfma_f32_32x32x16_bf16 v[104:119], v[60:63], v[68:71], v[104:119]
  buffer_load_dwordx4 v235, s[16:19], s45 offen offset:1088 lds
  buffer_load_dwordx4 v235, s[16:19], s46 offen offset:2112 lds
  buffer_store_dwordx4 v[224:227], v30, s[72:75], s35 offen sc0 sc1
  ds_read_b128 v[52:55], v142 offset:416
  v_exp_f32 v92, v92
  v_exp_f32 v93, v93
  v_exp_f32 v94, v94
  v_exp_f32 v95, v95
  v_cvt_pk_bf16_f32 v66, v92, v93
  v_cvt_pk_bf16_f32 v67, v94, v95
  v_mfma_f32_32x32x8bf16_1k v[72:87], v[40:41], v[24:25], v[72:87]
  v_exp_f32 v96, v96
  v_exp_f32 v97, v97
  v_exp_f32 v98, v98
  v_exp_f32 v99, v99
  v_cvt_pk_bf16_f32 v68, v96, v97
  v_cvt_pk_bf16_f32 v69, v98, v99
  v_mfma_f32_32x32x16_bf16 v[120:135], v[56:59], v[64:67], v[120:135]
  v_exp_f32 v100, v100
  v_exp_f32 v101, v101
  v_exp_f32 v102, v102
  v_exp_f32 v103, v103
  v_cvt_pk_bf16_f32 v70, v100, v101
  v_cvt_pk_bf16_f32 v71, v102, v103
  v_mfma_f32_32x32x16_bf16 v[88:103], v[32:35], v[20:23], 0
  v_exp_f32 v72, v72
  v_exp_f32 v73, v73
  v_exp_f32 v74, v74
  v_exp_f32 v75, v75
  v_cvt_pk_bf16_f32 v64, v72, v73
  v_cvt_pk_bf16_f32 v65, v74, v75
  v_mfma_f32_32x32x16_bf16 v[120:135], v[60:63], v[68:71], v[120:135]
  ds_read_b64_tr_b16 v[32:33], v140 offset:512
  v_exp_f32 v76, v76
  v_exp_f32 v77, v77
  v_exp_f32 v78, v78
  v_exp_f32 v79, v79
  v_cvt_pk_bf16_f32 v66, v76, v77
  v_cvt_pk_bf16_f32 v67, v78, v79
  v_mfma_f32_32x32x8bf16_1k v[88:103], v[40:41], v[26:27], v[88:103]
  s_waitcnt lgkmcnt(1)
  ds_read_b64_tr_b16 v[34:35], v140 offset:17152
  v_exp_f32 v80, v80
  v_exp_f32 v81, v81
  v_exp_f32 v82, v82
  v_exp_f32_e64 v83, v83
  v_cvt_pk_bf16_f32 v68, v80, v81
  v_cvt_pk_bf16_f32 v69, v82, v83
  v_mfma_f32_32x32x16_bf16 v[104:119], v[48:51], v[64:67], v[104:119]
  ds_read_b64_tr_b16 v[40:41], v141 offset:512
  v_exp_f32 v84, v84
  v_exp_f32 v85, v85
  v_exp_f32 v86, v86
  v_exp_f32 v87, v87
  v_cvt_pk_bf16_f32 v70, v84, v85
  v_cvt_pk_bf16_f32 v71, v86, v87
  v_mfma_f32_32x32x16_bf16 v[72:87], v[36:39], v[16:19], 0
  ds_read_b128 v[56:59], v142 offset:448
  v_exp_f32 v88, v88
  v_exp_f32 v89, v89
  v_exp_f32 v90, v90
  v_exp_f32 v91, v91
  v_cvt_pk_bf16_f32 v64, v88, v89
  v_cvt_pk_bf16_f32 v65, v90, v91
  v_mfma_f32_32x32x16_bf16 v[104:119], v[52:55], v[68:71], v[104:119]
  s_mov_b32 m0, s39
  ds_read_b128 v[60:63], v142 offset:480
  v_exp_f32 v92, v92
  v_exp_f32 v93, v93
  v_exp_f32 v94, v94
  v_exp_f32_e64 v95, v95
  v_cvt_pk_bf16_f32 v66, v92, v93
  v_cvt_pk_bf16_f32 v67, v94, v95
  s_mov_b32 s35, 2097152
  v_mfma_f32_32x32x8bf16_1k v[72:87], v[42:43], v[24:25], v[72:87]
  buffer_load_dwordx4 v235, s[16:19], s45 offen offset:1216 lds
  buffer_load_dwordx4 v235, s[16:19], s46 offen offset:2240 lds
  buffer_store_dwordx4 v[224:227], v30, s[72:75], s35 offen sc0 sc1
  v_exp_f32 v96, v96
  v_exp_f32 v97, v97
  v_exp_f32 v98, v98
  v_exp_f32 v99, v99
  v_cvt_pk_bf16_f32 v68, v96, v97
  v_cvt_pk_bf16_f32 v69, v98, v99
  v_mfma_f32_32x32x16_bf16 v[120:135], v[48:51], v[64:67], v[120:135]
  v_exp_f32 v100, v100
  v_exp_f32 v101, v101
  v_exp_f32 v102, v102
  v_exp_f32 v103, v103
  v_cvt_pk_bf16_f32 v70, v100, v101
  v_cvt_pk_bf16_f32 v71, v102, v103
  v_mfma_f32_32x32x16_bf16 v[88:103], v[36:39], v[20:23], 0
  v_exp_f32 v72, v72
  v_exp_f32 v73, v73
  v_exp_f32 v74, v74
  v_exp_f32 v75, v75
  v_cvt_pk_bf16_f32 v64, v72, v73
  v_cvt_pk_bf16_f32 v65, v74, v75
  v_mfma_f32_32x32x16_bf16 v[120:135], v[52:55], v[68:71], v[120:135]
  ds_read_b64_tr_b16 v[36:37], v140 offset:576
  v_exp_f32 v76, v76
  v_exp_f32 v77, v77
  v_exp_f32 v78, v78
  v_exp_f32 v79, v79
  v_cvt_pk_bf16_f32 v66, v76, v77
  v_cvt_pk_bf16_f32 v67, v78, v79
  v_mfma_f32_32x32x8bf16_1k v[88:103], v[42:43], v[26:27], v[88:103]
  s_waitcnt lgkmcnt(1)
  ds_read_b64_tr_b16 v[38:39], v140 offset:17216
  v_exp_f32 v80, v80
  v_exp_f32 v81, v81
  v_exp_f32 v82, v82
  v_exp_f32_e64 v83, v83
  v_cvt_pk_bf16_f32 v68, v80, v81
  v_cvt_pk_bf16_f32 v69, v82, v83
  v_mfma_f32_32x32x16_bf16 v[104:119], v[56:59], v[64:67], v[104:119]
  ds_read_b64_tr_b16 v[42:43], v141 offset:576
  v_exp_f32 v84, v84
  v_exp_f32 v85, v85
  v_exp_f32 v86, v86
  v_exp_f32 v87, v87
  v_cvt_pk_bf16_f32 v70, v84, v85
  v_cvt_pk_bf16_f32 v71, v86, v87
  v_mfma_f32_32x32x16_bf16 v[72:87], v[32:35], v[16:19], 0
  ds_read_b128 v[48:51], v142 offset:512
  v_exp_f32 v88, v88
  v_exp_f32 v89, v89
  v_exp_f32 v90, v90
  v_exp_f32 v91, v91
  v_cvt_pk_bf16_f32 v64, v88, v89
  v_cvt_pk_bf16_f32 v65, v90, v91
  v_mfma_f32_32x32x16_bf16 v[104:119], v[60:63], v[68:71], v[104:119]
  ds_read_b128 v[52:55], v142 offset:544
  v_exp_f32 v92, v92
  v_exp_f32 v93, v93
  v_exp_f32 v94, v94
  v_exp_f32 v95, v95
  v_cvt_pk_bf16_f32 v66, v92, v93
  v_cvt_pk_bf16_f32 v67, v94, v95
  v_mfma_f32_32x32x8bf16_1k v[72:87], v[40:41], v[24:25], v[72:87]
  s_mov_b32 m0, s41
  v_exp_f32 v96, v96
  v_exp_f32 v97, v97
  v_exp_f32 v98, v98
  v_exp_f32_e64 v99, v99
  v_cvt_pk_bf16_f32 v68, v96, v97
  v_cvt_pk_bf16_f32 v69, v98, v99
  s_mov_b32 s35, 3145728
  v_mfma_f32_32x32x16_bf16 v[120:135], v[56:59], v[64:67], v[120:135]
  buffer_load_dwordx4 v235, s[16:19], s45 offen offset:1344 lds
  buffer_load_dwordx4 v235, s[16:19], s46 offen offset:2368 lds
  buffer_store_dwordx4 v[224:227], v30, s[72:75], s35 offen sc0 sc1
  v_exp_f32 v100, v100
  v_exp_f32 v101, v101
  v_exp_f32 v102, v102
  v_exp_f32 v103, v103
  v_cvt_pk_bf16_f32 v70, v100, v101
  v_cvt_pk_bf16_f32 v71, v102, v103
  v_mfma_f32_32x32x16_bf16 v[88:103], v[32:35], v[20:23], 0
  v_exp_f32 v72, v72
  v_exp_f32 v73, v73
  v_exp_f32 v74, v74
  v_exp_f32 v75, v75
  v_cvt_pk_bf16_f32 v64, v72, v73
  v_cvt_pk_bf16_f32 v65, v74, v75
  v_mfma_f32_32x32x16_bf16 v[120:135], v[60:63], v[68:71], v[120:135]
  ds_read_b64_tr_b16 v[32:33], v140 offset:640
  v_exp_f32 v76, v76
  v_exp_f32 v77, v77
  v_exp_f32 v78, v78
  v_exp_f32 v79, v79
  v_cvt_pk_bf16_f32 v66, v76, v77
  v_cvt_pk_bf16_f32 v67, v78, v79
  v_mfma_f32_32x32x8bf16_1k v[88:103], v[40:41], v[26:27], v[88:103]
  s_waitcnt lgkmcnt(1)
  ds_read_b64_tr_b16 v[34:35], v140 offset:17280
  v_exp_f32 v80, v80
  v_exp_f32 v81, v81
  v_exp_f32 v82, v82
  v_exp_f32_e64 v83, v83
  v_cvt_pk_bf16_f32 v68, v80, v81
  v_cvt_pk_bf16_f32 v69, v82, v83
  v_mfma_f32_32x32x16_bf16 v[104:119], v[48:51], v[64:67], v[104:119]
  ds_read_b64_tr_b16 v[40:41], v141 offset:640
  v_exp_f32 v84, v84
  v_exp_f32 v85, v85
  v_exp_f32 v86, v86
  v_exp_f32 v87, v87
  v_cvt_pk_bf16_f32 v70, v84, v85
  v_cvt_pk_bf16_f32 v71, v86, v87
  v_mfma_f32_32x32x16_bf16 v[72:87], v[36:39], v[16:19], 0
  ds_read_b128 v[56:59], v142 offset:576
  v_exp_f32 v88, v88
  v_exp_f32 v89, v89
  v_exp_f32 v90, v90
  v_exp_f32 v91, v91
  v_cvt_pk_bf16_f32 v64, v88, v89
  v_cvt_pk_bf16_f32 v65, v90, v91
  v_mfma_f32_32x32x16_bf16 v[104:119], v[52:55], v[68:71], v[104:119]
  ds_read_b128 v[60:63], v142 offset:608
  v_exp_f32 v92, v92
  v_exp_f32 v93, v93
  v_exp_f32 v94, v94
  v_exp_f32 v95, v95
  v_cvt_pk_bf16_f32 v66, v92, v93
  v_cvt_pk_bf16_f32 v67, v94, v95
  v_mfma_f32_32x32x8bf16_1k v[72:87], v[42:43], v[24:25], v[72:87]
  v_exp_f32 v96, v96
  v_exp_f32 v97, v97
  v_exp_f32 v98, v98
  v_exp_f32 v99, v99
  v_cvt_pk_bf16_f32 v68, v96, v97
  v_cvt_pk_bf16_f32 v69, v98, v99
  v_mfma_f32_32x32x16_bf16 v[120:135], v[48:51], v[64:67], v[120:135]
  s_mov_b32 m0, s43
L_pg_5:
  s_cbranch_execz L_pg_9
  v_exp_f32_e64 v100, v100
  v_exp_f32 v101, v101
  v_exp_f32 v102, v102
  v_exp_f32_e64 v103, v103
  v_cvt_pk_bf16_f32 v70, v100, v101
  v_cvt_pk_bf16_f32 v71, v102, v103
  s_mov_b32 s35, 4194304
  v_mfma_f32_32x32x16_bf16 v[88:103], v[36:39], v[20:23], 0
  buffer_load_dwordx4 v235, s[16:19], s45 offen offset:1472 lds
  buffer_load_dwordx4 v235, s[16:19], s46 offen offset:2496 lds
  buffer_store_dwordx4 v[224:227], v30, s[72:75], s35 offen sc0 sc1
  v_exp_f32 v72, v72
  v_exp_f32 v73, v73
  v_exp_f32 v74, v74
  v_exp_f32 v75, v75
  v_cvt_pk_bf16_f32 v64, v72, v73
  v_cvt_pk_bf16_f32 v65, v74, v75
  v_mfma_f32_32x32x16_bf16 v[120:135], v[52:55], v[68:71], v[120:135]
  ds_read_b64_tr_b16 v[36:37], v140 offset:704
  v_exp_f32 v76, v76
  v_exp_f32 v77, v77
  v_exp_f32 v78, v78
  v_exp_f32 v79, v79
  v_cvt_pk_bf16_f32 v66, v76, v77
  v_cvt_pk_bf16_f32 v67, v78, v79
  v_mfma_f32_32x32x8bf16_1k v[88:103], v[42:43], v[26:27], v[88:103]
  s_waitcnt lgkmcnt(1)
  ds_read_b64_tr_b16 v[38:39], v140 offset:17344
  v_exp_f32 v80, v80
  v_exp_f32 v81, v81
  v_exp_f32 v82, v82
  v_exp_f32_e64 v83, v83
  v_cvt_pk_bf16_f32 v68, v80, v81
  v_cvt_pk_bf16_f32 v69, v82, v83
  v_mfma_f32_32x32x16_bf16 v[104:119], v[56:59], v[64:67], v[104:119]
  ds_read_b64_tr_b16 v[42:43], v141 offset:704
  v_exp_f32 v84, v84
  v_exp_f32 v85, v85
  v_exp_f32 v86, v86
  v_exp_f32 v87, v87
  v_cvt_pk_bf16_f32 v70, v84, v85
  v_cvt_pk_bf16_f32 v71, v86, v87
  v_mfma_f32_32x32x16_bf16 v[72:87], v[32:35], v[16:19], 0
  ds_read_b128 v[48:51], v142 offset:640
  v_exp_f32 v88, v88
  v_exp_f32 v89, v89
  v_exp_f32 v90, v90
  v_exp_f32 v91, v91
  v_cvt_pk_bf16_f32 v64, v88, v89
  v_cvt_pk_bf16_f32 v65, v90, v91
  v_mfma_f32_32x32x16_bf16 v[104:119], v[60:63], v[68:71], v[104:119]
  ds_read_b128 v[52:55], v142 offset:672
  v_exp_f32 v92, v92
  v_exp_f32 v93, v93
  v_exp_f32 v94, v94
  v_exp_f32 v95, v95
  v_cvt_pk_bf16_f32 v66, v92, v93
  v_cvt_pk_bf16_f32 v67, v94, v95
  v_mfma_f32_32x32x8bf16_1k v[72:87], v[40:41], v[24:25], v[72:87]
  v_exp_f32 v96, v96
  v_exp_f32 v97, v97
  v_exp_f32 v98, v98
  v_exp_f32 v99, v99
  v_cvt_pk_bf16_f32 v68, v96, v97
  v_cvt_pk_bf16_f32 v69, v98, v99
  v_mfma_f32_32x32x16_bf16 v[120:135], v[56:59], v[64:67], v[120:135]
  v_exp_f32 v100, v100
  v_exp_f32 v101, v101
  v_exp_f32 v102, v102
  v_exp_f32 v103, v103
  v_cvt_pk_bf16_f32 v70, v100, v101
  v_cvt_pk_bf16_f32 v71, v102, v103
  v_mfma_f32_32x32x16_bf16 v[88:103], v[32:35], v[20:23], 0
  v_exp_f32 v72, v72
  v_exp_f32 v73, v73
  v_exp_f32 v74, v74
  v_exp_f32 v75, v75
  v_cvt_pk_bf16_f32 v64, v72, v73
  v_cvt_pk_bf16_f32 v65, v74, v75
  v_mfma_f32_32x32x16_bf16 v[120:135], v[60:63], v[68:71], v[120:135]
  ds_read_b64_tr_b16 v[32:33], v140 offset:768
  v_exp_f32 v76, v76
  v_exp_f32 v77, v77
  v_exp_f32 v78, v78
  v_exp_f32 v79, v79
  v_cvt_pk_bf16_f32 v66, v76, v77
  v_cvt_pk_bf16_f32 v67, v78, v79
  v_mfma_f32_32x32x8bf16_1k v[88:103], v[40:41], v[26:27], v[88:103]
  s_waitcnt lgkmcnt(1)
  ds_read_b64_tr_b16 v[34:35], v140 offset:17408
  v_exp_f32 v80, v80
  v_exp_f32 v81, v81
  v_exp_f32 v82, v82
  v_exp_f32_e64 v83, v83
  v_cvt_pk_bf16_f32 v68, v80, v81
  v_cvt_pk_bf16_f32 v69, v82, v83
  v_mfma_f32_32x32x16_bf16 v[104:119], v[48:51], v[64:67], v[104:119]
  s_getpc_b64 s[94:95]
  ds_read_b64_tr_b16 v[40:41], v141 offset:768
  v_exp_f32 v84, v84
  v_exp_f32 v85, v85
  v_exp_f32 v86, v86
  v_exp_f32_e64 v87, v87
  v_cvt_pk_bf16_f32 v70, v84, v85
  v_cvt_pk_bf16_f32 v71, v86, v87
  s_mov_b32 s35, 5242880
  v_mfma_f32_32x32x16_bf16 v[72:87], v[36:39], v[16:19], 0
  buffer_load_dwordx2 v[144:145], v136, s[48:51], s77 offen offset:0
  global_load_dword v231, v230, s[94:95]
  buffer_store_dwordx4 v[224:227], v30, s[72:75], s35 offen sc0 sc1
  ds_read_b128 v[56:59], v142 offset:704
  v_exp_f32 v88, v88
  v_exp_f32 v89, v89
  v_exp_f32 v90, v90
  v_exp_f32 v91, v91
  v_cvt_pk_bf16_f32 v64, v88, v89
  v_cvt_pk_bf16_f32 v65, v90, v91
  v_mfma_f32_32x32x16_bf16 v[104:119], v[52:55], v[68:71], v[104:119]
  ds_read_b128 v[60:63], v142 offset:736
  v_exp_f32 v92, v92
  v_exp_f32 v93, v93
  v_exp_f32 v94, v94
  v_exp_f32 v95, v95
  v_cvt_pk_bf16_f32 v66, v92, v93
  v_cvt_pk_bf16_f32 v67, v94, v95
  v_mfma_f32_32x32x8bf16_1k v[72:87], v[42:43], v[24:25], v[72:87]
  v_exp_f32 v96, v96
  v_exp_f32 v97, v97
  v_exp_f32 v98, v98
  v_exp_f32 v99, v99
  v_cvt_pk_bf16_f32 v68, v96, v97
  v_cvt_pk_bf16_f32 v69, v98, v99
  v_mfma_f32_32x32x16_bf16 v[120:135], v[48:51], v[64:67], v[120:135]
  v_exp_f32 v100, v100
  v_exp_f32 v101, v101
  v_exp_f32 v102, v102
  v_exp_f32 v103, v103
  v_cvt_pk_bf16_f32 v70, v100, v101
  v_cvt_pk_bf16_f32 v71, v102, v103
  v_mfma_f32_32x32x16_bf16 v[88:103], v[36:39], v[20:23], 0
  v_exp_f32 v72, v72
  v_exp_f32 v73, v73
  v_exp_f32 v74, v74
  v_exp_f32 v75, v75
  v_cvt_pk_bf16_f32 v64, v72, v73
  v_cvt_pk_bf16_f32 v65, v74, v75
  v_mfma_f32_32x32x16_bf16 v[120:135], v[52:55], v[68:71], v[120:135]
  ds_read_b64_tr_b16 v[36:37], v140 offset:832
  v_exp_f32 v76, v76
  v_exp_f32 v77, v77
  v_exp_f32 v78, v78
  v_exp_f32 v79, v79
  v_cvt_pk_bf16_f32 v66, v76, v77
  v_cvt_pk_bf16_f32 v67, v78, v79
  v_mfma_f32_32x32x8bf16_1k v[88:103], v[42:43], v[26:27], v[88:103]
  s_waitcnt lgkmcnt(1)
  ds_read_b64_tr_b16 v[38:39], v140 offset:17472
  v_exp_f32 v80, v80
  v_exp_f32 v81, v81
  v_exp_f32 v82, v82
  v_exp_f32_e64 v83, v83
  v_cvt_pk_bf16_f32 v68, v80, v81
  v_cvt_pk_bf16_f32 v69, v82, v83
  v_mfma_f32_32x32x16_bf16 v[104:119], v[56:59], v[64:67], v[104:119]
  ds_read_b64_tr_b16 v[42:43], v141 offset:832
  v_exp_f32 v84, v84
  v_exp_f32 v85, v85
  v_exp_f32 v86, v86
  v_exp_f32 v87, v87
  v_cvt_pk_bf16_f32 v70, v84, v85
  v_cvt_pk_bf16_f32 v71, v86, v87
  v_mfma_f32_32x32x16_bf16 v[72:87], v[32:35], v[16:19], 0
  ds_read_b128 v[48:51], v142 offset:768
  v_exp_f32 v88, v88
  v_exp_f32 v89, v89
  v_exp_f32 v90, v90
  v_exp_f32 v91, v91
  v_cvt_pk_bf16_f32 v64, v88, v89
  v_cvt_pk_bf16_f32 v65, v90, v91
  v_mfma_f32_32x32x16_bf16 v[104:119], v[60:63], v[68:71], v[104:119]
  ds_read_b128 v[52:55], v142 offset:800
  v_exp_f32 v92, v92
  v_exp_f32 v93, v93
  v_exp_f32 v94, v94
  v_exp_f32 v95, v95
  v_cvt_pk_bf16_f32 v66, v92, v93
  v_cvt_pk_bf16_f32 v67, v94, v95
  v_mfma_f32_32x32x8bf16_1k v[72:87], v[40:41], v[24:25], v[72:87]
  v_exp_f32 v96, v96
  v_exp_f32 v97, v97
  v_exp_f32 v98, v98
  v_exp_f32 v99, v99
  v_cvt_pk_bf16_f32 v68, v96, v97
  v_cvt_pk_bf16_f32 v69, v98, v99
  v_mfma_f32_32x32x16_bf16 v[120:135], v[56:59], v[64:67], v[120:135]
  v_exp_f32 v100, v100
  v_exp_f32 v101, v101
  v_exp_f32 v102, v102
  v_exp_f32 v103, v103
  v_cvt_pk_bf16_f32 v70, v100, v101
  v_cvt_pk_bf16_f32 v71, v102, v103
  v_mfma_f32_32x32x16_bf16 v[88:103], v[32:35], v[20:23], 0
  v_exp_f32 v72, v72
  v_exp_f32 v73, v73
  v_exp_f32 v74, v74
  v_exp_f32 v75, v75
  v_cvt_pk_bf16_f32 v64, v72, v73
  v_cvt_pk_bf16_f32 v65, v74, v75
  v_mfma_f32_32x32x16_bf16 v[120:135], v[60:63], v[68:71], v[120:135]
  ds_read_b64_tr_b16 v[32:33], v140 offset:896
  v_exp_f32 v76, v76
  v_exp_f32 v77, v77
  v_exp_f32 v78, v78
  v_exp_f32 v79, v79
  v_cvt_pk_bf16_f32 v66, v76, v77
  v_cvt_pk_bf16_f32 v67, v78, v79
  v_mfma_f32_32x32x8bf16_1k v[88:103], v[40:41], v[26:27], v[88:103]
  s_waitcnt lgkmcnt(1)
  ds_read_b64_tr_b16 v[34:35], v140 offset:17536
  v_exp_f32 v80, v80
  v_exp_f32 v81, v81
  v_exp_f32 v82, v82
  v_exp_f32_e64 v83, v83
  v_cvt_pk_bf16_f32 v68, v80, v81
  v_cvt_pk_bf16_f32 v69, v82, v83
  v_mfma_f32_32x32x16_bf16 v[104:119], v[48:51], v[64:67], v[104:119]
  ds_read_b64_tr_b16 v[40:41], v141 offset:896
  v_exp_f32 v84, v84
  v_exp_f32 v85, v85
  v_exp_f32 v86, v86
  v_exp_f32 v87, v87
  v_cvt_pk_bf16_f32 v70, v84, v85
  v_cvt_pk_bf16_f32 v71, v86, v87
  v_mfma_f32_32x32x16_bf16 v[72:87], v[36:39], v[16:19], 0
  ds_read_b128 v[56:59], v142 offset:832
  v_exp_f32 v88, v88
  v_exp_f32 v89, v89
  v_exp_f32 v90, v90
  v_exp_f32 v91, v91
  v_cvt_pk_bf16_f32 v64, v88, v89
  v_cvt_pk_bf16_f32 v65, v90, v91
  v_mfma_f32_32x32x16_bf16 v[104:119], v[52:55], v[68:71], v[104:119]
  ds_read_b128 v[60:63], v142 offset:864
  v_exp_f32 v92, v92
  v_exp_f32 v93, v93
  v_exp_f32 v94, v94
  v_exp_f32 v95, v95
  v_cvt_pk_bf16_f32 v66, v92, v93
  v_cvt_pk_bf16_f32 v67, v94, v95
  v_mfma_f32_32x32x8bf16_1k v[72:87], v[42:43], v[24:25], v[72:87]
  v_exp_f32 v96, v96
  v_exp_f32 v97, v97
  v_exp_f32 v98, v98
  v_exp_f32 v99, v99
  v_cvt_pk_bf16_f32 v68, v96, v97
  v_cvt_pk_bf16_f32 v69, v98, v99
  v_mfma_f32_32x32x16_bf16 v[120:135], v[48:51], v[64:67], v[120:135]
  v_exp_f32 v100, v100
  v_exp_f32 v101, v101
  v_exp_f32 v102, v102
  v_exp_f32 v103, v103
  v_cvt_pk_bf16_f32 v70, v100, v101
  v_cvt_pk_bf16_f32 v71, v102, v103
  s_mov_b32 s35, 6291456
  v_mfma_f32_32x32x16_bf16 v[88:103], v[36:39], v[20:23], 0
  buffer_load_dwordx2 v[148:149], v136, s[48:51], s78 offen offset:0
  buffer_store_dwordx4 v[224:227], v30, s[72:75], s35 offen sc0 sc1
  v_exp_f32 v72, v72
  v_exp_f32 v73, v73
  v_exp_f32 v74, v74
  v_exp_f32 v75, v75
  v_cvt_pk_bf16_f32 v64, v72, v73
  v_cvt_pk_bf16_f32 v65, v74, v75
  v_mfma_f32_32x32x16_bf16 v[120:135], v[52:55], v[68:71], v[120:135]
  ds_read_b64_tr_b16 v[36:37], v140 offset:960
  v_exp_f32 v76, v76
  v_exp_f32 v77, v77
  v_exp_f32 v78, v78
  v_exp_f32 v79, v79
  v_cvt_pk_bf16_f32 v66, v76, v77
  v_cvt_pk_bf16_f32 v67, v78, v79
  v_mfma_f32_32x32x8bf16_1k v[88:103], v[42:43], v[26:27], v[88:103]
  s_waitcnt lgkmcnt(1)
  ds_read_b64_tr_b16 v[38:39], v140 offset:17600
  v_exp_f32 v80, v80
  v_exp_f32 v81, v81
  v_exp_f32 v82, v82
  v_exp_f32_e64 v83, v83
  v_cvt_pk_bf16_f32 v68, v80, v81
  v_cvt_pk_bf16_f32 v69, v82, v83
  v_mfma_f32_32x32x16_bf16 v[104:119], v[56:59], v[64:67], v[104:119]
  ds_read_b64_tr_b16 v[42:43], v141 offset:960
  v_exp_f32 v84, v84
  v_exp_f32 v85, v85
  v_exp_f32 v86, v86
  v_exp_f32 v87, v87
  v_cvt_pk_bf16_f32 v70, v84, v85
  v_cvt_pk_bf16_f32 v71, v86, v87
  v_mfma_f32_32x32x16_bf16 v[72:87], v[32:35], v[16:19], 0
  ds_read_b128 v[48:51], v142 offset:896
  v_exp_f32 v88, v88
  v_exp_f32 v89, v89
  v_exp_f32 v90, v90
  v_exp_f32 v91, v91
  v_cvt_pk_bf16_f32 v64, v88, v89
  v_cvt_pk_bf16_f32 v65, v90, v91
  v_mfma_f32_32x32x16_bf16 v[104:119], v[60:63], v[68:71], v[104:119]
  ds_read_b128 v[52:55], v142 offset:928
  v_exp_f32 v92, v92
  v_exp_f32 v93, v93
  v_exp_f32 v94, v94
  v_exp_f32 v95, v95
  v_cvt_pk_bf16_f32 v66, v92, v93
  v_cvt_pk_bf16_f32 v67, v94, v95
  v_mfma_f32_32x32x8bf16_1k v[72:87], v[40:41], v[24:25], v[72:87]
  v_exp_f32 v96, v96
  v_exp_f32 v97, v97
  v_exp_f32 v98, v98
  v_exp_f32 v99, v99
  v_cvt_pk_bf16_f32 v68, v96, v97
  v_cvt_pk_bf16_f32 v69, v98, v99
  v_mfma_f32_32x32x16_bf16 v[120:135], v[56:59], v[64:67], v[120:135]
  s_waitcnt vmcnt(6)
  v_exp_f32 v100, v100
  v_exp_f32 v101, v101
  v_exp_f32 v102, v102
  v_exp_f32_e64 v103, v103
  v_cvt_pk_bf16_f32 v70, v100, v101
  v_cvt_pk_bf16_f32 v71, v102, v103
  v_mfma_f32_32x32x16_bf16 v[88:103], v[32:35], v[20:23], 0
  s_barrier
  v_exp_f32 v72, v72
  v_exp_f32 v73, v73
  v_exp_f32 v74, v74
  v_exp_f32_e64 v75, v75
  v_cvt_pk_bf16_f32 v64, v72, v73
  v_cvt_pk_bf16_f32 v65, v74, v75
  v_mfma_f32_32x32x16_bf16 v[120:135], v[60:63], v[68:71], v[120:135]
  ds_read_b64_tr_b16 v[32:33], v140 offset:1024
  v_exp_f32 v76, v76
  v_exp_f32 v77, v77
  v_exp_f32 v78, v78
  v_exp_f32 v79, v79
  v_cvt_pk_bf16_f32 v66, v76, v77
  v_cvt_pk_bf16_f32 v67, v78, v79
  v_mfma_f32_32x32x8bf16_1k v[88:103], v[40:41], v[26:27], v[88:103]
  s_waitcnt lgkmcnt(1)
  ds_read_b64_tr_b16 v[34:35], v140 offset:17664
  v_exp_f32 v80, v80
  v_exp_f32 v81, v81
  v_exp_f32 v82, v82
  v_exp_f32_e64 v83, v83
  v_cvt_pk_bf16_f32 v68, v80, v81
  v_cvt_pk_bf16_f32 v69, v82, v83
  v_mfma_f32_32x32x16_bf16 v[104:119], v[48:51], v[64:67], v[104:119]
  ds_read_b64_tr_b16 v[40:41], v141 offset:1024
  v_exp_f32 v84, v84
  v_exp_f32 v85, v85
  v_exp_f32 v86, v86
  v_exp_f32 v87, v87
  v_cvt_pk_bf16_f32 v70, v84, v85
  v_cvt_pk_bf16_f32 v71, v86, v87
  v_mfma_f32_32x32x16_bf16 v[72:87], v[36:39], v[16:19], 0
  ds_read_b128 v[56:59], v142 offset:960
  v_exp_f32 v88, v88
  v_exp_f32 v89, v89
  v_exp_f32 v90, v90
  v_exp_f32 v91, v91
  v_cvt_pk_bf16_f32 v64, v88, v89
  v_cvt_pk_bf16_f32 v65, v90, v91
  v_mfma_f32_32x32x16_bf16 v[104:119], v[52:55], v[68:71], v[104:119]
  ds_read_b128 v[60:63], v142 offset:992
  v_exp_f32 v92, v92
  v_exp_f32 v93, v93
  v_exp_f32 v94, v94
  v_exp_f32 v95, v95
  v_cvt_pk_bf16_f32 v66, v92, v93
  v_cvt_pk_bf16_f32 v67, v94, v95
  v_mfma_f32_32x32x8bf16_1k v[72:87], v[42:43], v[24:25], v[72:87]
  v_exp_f32 v96, v96
  v_exp_f32 v97, v97
  v_exp_f32 v98, v98
  v_exp_f32 v99, v99
  v_cvt_pk_bf16_f32 v68, v96, v97
  v_cvt_pk_bf16_f32 v69, v98, v99
  v_mfma_f32_32x32x16_bf16 v[120:135], v[48:51], v[64:67], v[120:135]
  v_exp_f32 v100, v100
  v_exp_f32 v101, v101
  v_exp_f32 v102, v102
  v_exp_f32 v103, v103
  v_cvt_pk_bf16_f32 v70, v100, v101
  v_cvt_pk_bf16_f32 v71, v102, v103
  v_mfma_f32_32x32x16_bf16 v[88:103], v[36:39], v[20:23], 0
  v_exp_f32 v72, v72
  v_exp_f32 v73, v73
  v_exp_f32 v74, v74
  v_exp_f32 v75, v75
  v_cvt_pk_bf16_f32 v64, v72, v73
  v_cvt_pk_bf16_f32 v65, v74, v75
  v_mfma_f32_32x32x16_bf16 v[120:135], v[52:55], v[68:71], v[120:135]
  ds_read_b64_tr_b16 v[36:37], v140 offset:1088
  v_exp_f32 v76, v76
  v_exp_f32 v77, v77
  v_exp_f32 v78, v78
  v_exp_f32 v79, v79
  v_cvt_pk_bf16_f32 v66, v76, v77
  v_cvt_pk_bf16_f32 v67, v78, v79
  v_mfma_f32_32x32x8bf16_1k v[88:103], v[42:43], v[26:27], v[88:103]
  s_waitcnt lgkmcnt(1)
  ds_read_b64_tr_b16 v[38:39], v140 offset:17728
  v_exp_f32 v80, v80
  v_exp_f32 v81, v81
  v_exp_f32 v82, v82
  v_exp_f32_e64 v83, v83
  v_cvt_pk_bf16_f32 v68, v80, v81
  v_cvt_pk_bf16_f32 v69, v82, v83
  v_mfma_f32_32x32x16_bf16 v[104:119], v[56:59], v[64:67], v[104:119]
  s_barrier
  ds_read_b64_tr_b16 v[42:43], v141 offset:1088
  v_exp_f32 v84, v84
  v_exp_f32 v85, v85
  v_exp_f32 v86, v86
  v_exp_f32_e64 v87, v87
  v_cvt_pk_bf16_f32 v70, v84, v85
  v_cvt_pk_bf16_f32 v71, v86, v87
  v_mfma_f32_32x32x16_bf16 v[72:87], v[32:35], v[16:19], 0
  ds_read_b128 v[48:51], v142 offset:1024
  v_exp_f32 v88, v88
  v_exp_f32 v89, v89
  v_exp_f32 v90, v90
  v_exp_f32 v91, v91
  v_cvt_pk_bf16_f32 v64, v88, v89
  v_cvt_pk_bf16_f32 v65, v90, v91
  v_mfma_f32_32x32x16_bf16 v[104:119], v[60:63], v[68:71], v[104:119]
  ds_read_b128 v[52:55], v142 offset:1056
  v_exp_f32 v92, v92
  v_exp_f32 v93, v93
  v_exp_f32 v94, v94
  v_exp_f32 v95, v95
  v_cvt_pk_bf16_f32 v66, v92, v93
  v_cvt_pk_bf16_f32 v67, v94, v95
  v_mfma_f32_32x32x8bf16_1k v[72:87], v[40:41], v[24:25], v[72:87]
  v_exp_f32 v96, v96
  v_exp_f32 v97, v97
  v_exp_f32 v98, v98
  v_exp_f32 v99, v99
  v_cvt_pk_bf16_f32 v68, v96, v97
  v_cvt_pk_bf16_f32 v69, v98, v99
  v_mfma_f32_32x32x16_bf16 v[120:135], v[56:59], v[64:67], v[120:135]
  s_mov_b32 m0, s32
  v_exp_f32 v100, v100
  v_exp_f32 v101, v101
  v_exp_f32 v102, v102
  v_exp_f32_e64 v103, v103
  v_cvt_pk_bf16_f32 v70, v100, v101
  v_cvt_pk_bf16_f32 v71, v102, v103
  s_mov_b32 s35, 7340032
  v_mfma_f32_32x32x16_bf16 v[88:103], v[32:35], v[20:23], 0
  buffer_load_dwordx4 v235, s[16:19], s47 offen offset:3072 lds
  buffer_load_dwordx4 v248, s[64:67], 0 offen offset:0 lds
  buffer_store_dwordx4 v[224:227], v30, s[72:75], s35 offen sc0 sc1
  v_exp_f32 v72, v72
  v_exp_f32 v73, v73
  v_exp_f32 v74, v74
  v_exp_f32 v75, v75
  v_cvt_pk_bf16_f32 v64, v72, v73
  v_cvt_pk_bf16_f32 v65, v74, v75
  v_mfma_f32_32x32x16_bf16 v[120:135], v[60:63], v[68:71], v[120:135]
  ds_read_b64_tr_b16 v[32:33], v140 offset:1152
  v_exp_f32 v76, v76
  v_exp_f32 v77, v77
  v_exp_f32 v78, v78
  v_exp_f32 v79, v79
  v_cvt_pk_bf16_f32 v66, v76, v77
  v_cvt_pk_bf16_f32 v67, v78, v79
  v_mfma_f32_32x32x8bf16_1k v[88:103], v[40:41], v[26:27], v[88:103]
  s_waitcnt lgkmcnt(1)
  ds_read_b64_tr_b16 v[34:35], v140 offset:17792
  v_exp_f32 v80, v80
  v_exp_f32 v81, v81
  v_exp_f32 v82, v82
  v_exp_f32_e64 v83, v83
  v_cvt_pk_bf16_f32 v68, v80, v81
  v_cvt_pk_bf16_f32 v69, v82, v83
  v_mfma_f32_32x32x16_bf16 v[104:119], v[48:51], v[64:67], v[104:119]
  ds_read_b64_tr_b16 v[40:41], v141 offset:1152
  v_exp_f32 v84, v84
  v_exp_f32 v85, v85
  v_exp_f32 v86, v86
  v_exp_f32 v87, v87
  v_cvt_pk_bf16_f32 v70, v84, v85
  v_cvt_pk_bf16_f32 v71, v86, v87
  v_mfma_f32_32x32x16_bf16 v[72:87], v[36:39], v[16:19], 0
  ds_read_b128 v[56:59], v142 offset:1088
  v_exp_f32 v88, v88
  v_exp_f32 v89, v89
  v_exp_f32 v90, v90
  v_exp_f32 v91, v91
  v_cvt_pk_bf16_f32 v64, v88, v89
  v_cvt_pk_bf16_f32 v65, v90, v91
  v_mfma_f32_32x32x16_bf16 v[104:119], v[52:55], v[68:71], v[104:119]
  ds_read_b128 v[60:63], v142 offset:1120
  v_exp_f32 v92, v92
  v_exp_f32 v93, v93
  v_exp_f32 v94, v94
  v_exp_f32 v95, v95
  v_cvt_pk_bf16_f32 v66, v92, v93
  v_cvt_pk_bf16_f32 v67, v94, v95
  v_mfma_f32_32x32x8bf16_1k v[72:87], v[42:43], v[24:25], v[72:87]
  v_exp_f32 v96, v96
  v_exp_f32 v97, v97
  v_exp_f32 v98, v98
  v_exp_f32 v99, v99
  v_cvt_pk_bf16_f32 v68, v96, v97
  v_cvt_pk_bf16_f32 v69, v98, v99
  v_mfma_f32_32x32x16_bf16 v[120:135], v[48:51], v[64:67], v[120:135]
  v_exp_f32 v100, v100
  v_exp_f32 v101, v101
  v_exp_f32 v102, v102
  v_exp_f32 v103, v103
  v_cvt_pk_bf16_f32 v70, v100, v101
  v_cvt_pk_bf16_f32 v71, v102, v103
  v_mfma_f32_32x32x16_bf16 v[88:103], v[36:39], v[20:23], 0
  v_exp_f32 v72, v72
  v_exp_f32 v73, v73
  v_exp_f32 v74, v74
  v_exp_f32 v75, v75
  v_cvt_pk_bf16_f32 v64, v72, v73
  v_cvt_pk_bf16_f32 v65, v74, v75
  v_mfma_f32_32x32x16_bf16 v[120:135], v[52:55], v[68:71], v[120:135]
  ds_read_b64_tr_b16 v[36:37], v140 offset:1216
  v_exp_f32 v76, v76
  v_exp_f32 v77, v77
  v_exp_f32 v78, v78
  v_exp_f32 v79, v79
  v_cvt_pk_bf16_f32 v66, v76, v77
  v_cvt_pk_bf16_f32 v67, v78, v79
  v_mfma_f32_32x32x8bf16_1k v[88:103], v[42:43], v[26:27], v[88:103]
  s_waitcnt lgkmcnt(1)
  ds_read_b64_tr_b16 v[38:39], v140 offset:17856
  v_exp_f32 v80, v80
  v_exp_f32 v81, v81
  v_exp_f32 v82, v82
  v_exp_f32_e64 v83, v83
  v_cvt_pk_bf16_f32 v68, v80, v81
  v_cvt_pk_bf16_f32 v69, v82, v83
  v_mfma_f32_32x32x16_bf16 v[104:119], v[56:59], v[64:67], v[104:119]
  ds_read_b64_tr_b16 v[42:43], v141 offset:1216
  v_exp_f32 v84, v84
  v_exp_f32 v85, v85
  v_exp_f32 v86, v86
  v_exp_f32 v87, v87
  v_cvt_pk_bf16_f32 v70, v84, v85
  v_cvt_pk_bf16_f32 v71, v86, v87
  v_mfma_f32_32x32x16_bf16 v[72:87], v[32:35], v[16:19], 0
  ds_read_b128 v[48:51], v142 offset:1152
  v_exp_f32 v88, v88
  v_exp_f32 v89, v89
  v_exp_f32 v90, v90
  v_exp_f32 v91, v91
  v_cvt_pk_bf16_f32 v64, v88, v89
  v_cvt_pk_bf16_f32 v65, v90, v91
  v_mfma_f32_32x32x16_bf16 v[104:119], v[60:63], v[68:71], v[104:119]
  ds_read_b128 v[52:55], v142 offset:1184
  v_exp_f32 v92, v92
  v_exp_f32 v93, v93
  v_exp_f32 v94, v94
  v_exp_f32 v95, v95
  v_cvt_pk_bf16_f32 v66, v92, v93
  v_cvt_pk_bf16_f32 v67, v94, v95
  v_mfma_f32_32x32x8bf16_1k v[72:87], v[40:41], v[24:25], v[72:87]
  s_mov_b32 m0, s37
  v_exp_f32 v96, v96
  v_exp_f32 v97, v97
  v_exp_f32 v98, v98
  v_exp_f32_e64 v99, v99
  v_cvt_pk_bf16_f32 v68, v96, v97
  v_cvt_pk_bf16_f32 v69, v98, v99
  v_mfma_f32_32x32x16_bf16 v[120:135], v[56:59], v[64:67], v[120:135]
  s_getpc_b64 s[94:95]
  v_exp_f32 v100, v100
  v_exp_f32 v101, v101
  v_exp_f32 v102, v102
  v_exp_f32_e64 v103, v103
  v_cvt_pk_bf16_f32 v70, v100, v101
  v_cvt_pk_bf16_f32 v71, v102, v103
  s_mov_b32 s35, 8388608
  v_mfma_f32_32x32x16_bf16 v[88:103], v[32:35], v[20:23], 0
  buffer_load_dwordx4 v235, s[16:19], s47 offen offset:3136 lds
  buffer_load_dwordx4 v248, s[64:67], s80 offen offset:64 lds
  global_load_dword v231, v230, s[94:95]
  buffer_store_dwordx4 v[224:227], v30, s[72:75], s35 offen sc0 sc1
  v_exp_f32 v72, v72
  v_exp_f32 v73, v73
  v_exp_f32 v74, v74
  v_exp_f32 v75, v75
  v_cvt_pk_bf16_f32 v64, v72, v73
  v_cvt_pk_bf16_f32 v65, v74, v75
  v_mfma_f32_32x32x16_bf16 v[120:135], v[60:63], v[68:71], v[120:135]
  ds_read_b64_tr_b16 v[32:33], v140 offset:1280
  v_exp_f32 v76, v76
  v_exp_f32 v77, v77
  v_exp_f32 v78, v78
  v_exp_f32 v79, v79
  v_cvt_pk_bf16_f32 v66, v76, v77
  v_cvt_pk_bf16_f32 v67, v78, v79
  v_mfma_f32_32x32x8bf16_1k v[88:103], v[40:41], v[26:27], v[88:103]
  s_waitcnt lgkmcnt(1)
  ds_read_b64_tr_b16 v[34:35], v140 offset:17920
  v_exp_f32 v80, v80
  v_exp_f32 v81, v81
  v_exp_f32 v82, v82
  v_exp_f32_e64 v83, v83
  v_cvt_pk_bf16_f32 v68, v80, v81
  v_cvt_pk_bf16_f32 v69, v82, v83
  v_mfma_f32_32x32x16_bf16 v[104:119], v[48:51], v[64:67], v[104:119]
  ds_read_b64_tr_b16 v[40:41], v141 offset:1280
  v_exp_f32 v84, v84
  v_exp_f32 v85, v85
  v_exp_f32 v86, v86
  v_exp_f32 v87, v87
  v_cvt_pk_bf16_f32 v70, v84, v85
  v_cvt_pk_bf16_f32 v71, v86, v87
  v_mfma_f32_32x32x16_bf16 v[72:87], v[36:39], v[16:19], 0
  ds_read_b128 v[56:59], v142 offset:1216
  v_exp_f32 v88, v88
  v_exp_f32 v89, v89
  v_exp_f32 v90, v90
  v_exp_f32 v91, v91
  v_cvt_pk_bf16_f32 v64, v88, v89
  v_cvt_pk_bf16_f32 v65, v90, v91
  v_mfma_f32_32x32x16_bf16 v[104:119], v[52:55], v[68:71], v[104:119]
  ds_read_b128 v[60:63], v142 offset:1248
  v_exp_f32 v92, v92
  v_exp_f32 v93, v93
  v_exp_f32 v94, v94
  v_exp_f32 v95, v95
  v_cvt_pk_bf16_f32 v66, v92, v93
  v_cvt_pk_bf16_f32 v67, v94, v95
  v_mfma_f32_32x32x8bf16_1k v[72:87], v[42:43], v[24:25], v[72:87]
  v_exp_f32 v96, v96
  v_exp_f32 v97, v97
  v_exp_f32 v98, v98
  v_exp_f32 v99, v99
  v_cvt_pk_bf16_f32 v68, v96, v97
  v_cvt_pk_bf16_f32 v69, v98, v99
  v_mfma_f32_32x32x16_bf16 v[120:135], v[48:51], v[64:67], v[120:135]
  v_exp_f32 v100, v100
  v_exp_f32 v101, v101
  v_exp_f32 v102, v102
  v_exp_f32 v103, v103
  v_cvt_pk_bf16_f32 v70, v100, v101
  v_cvt_pk_bf16_f32 v71, v102, v103
  v_mfma_f32_32x32x16_bf16 v[88:103], v[36:39], v[20:23], 0
  v_exp_f32 v72, v72
  v_exp_f32 v73, v73
  v_exp_f32 v74, v74
  v_exp_f32 v75, v75
  v_cvt_pk_bf16_f32 v64, v72, v73
  v_cvt_pk_bf16_f32 v65, v74, v75
  v_mfma_f32_32x32x16_bf16 v[120:135], v[52:55], v[68:71], v[120:135]
  ds_read_b64_tr_b16 v[36:37], v140 offset:1344
  v_exp_f32 v76, v76
  v_exp_f32 v77, v77
  v_exp_f32 v78, v78
  v_exp_f32 v79, v79
  v_cvt_pk_bf16_f32 v66, v76, v77
  v_cvt_pk_bf16_f32 v67, v78, v79
  v_mfma_f32_32x32x8bf16_1k v[88:103], v[42:43], v[26:27], v[88:103]
  s_waitcnt lgkmcnt(1)
  ds_read_b64_tr_b16 v[38:39], v140 offset:17984
  v_exp_f32 v80, v80
  v_exp_f32 v81, v81
  v_exp_f32 v82, v82
  v_exp_f32_e64 v83, v83
  v_cvt_pk_bf16_f32 v68, v80, v81
  v_cvt_pk_bf16_f32 v69, v82, v83
  v_mfma_f32_32x32x16_bf16 v[104:119], v[56:59], v[64:67], v[104:119]
  ds_read_b64_tr_b16 v[42:43], v141 offset:1344
L_pg_6:
  s_cbranch_execz L_pg_10
  v_exp_f32_e64 v84, v84
  v_exp_f32 v85, v85
  v_exp_f32 v86, v86
  v_exp_f32 v87, v87
  v_cvt_pk_bf16_f32 v70, v84, v85
  v_cvt_pk_bf16_f32 v71, v86, v87
  v_mfma_f32_32x32x16_bf16 v[72:87], v[32:35], v[16:19], 0
  ds_read_b128 v[48:51], v142 offset:1280
  v_exp_f32 v88, v88
  v_exp_f32 v89, v89
  v_exp_f32 v90, v90
  v_exp_f32 v91, v91
  v_cvt_pk_bf16_f32 v64, v88, v89
  v_cvt_pk_bf16_f32 v65, v90, v91
  v_mfma_f32_32x32x16_bf16 v[104:119], v[60:63], v[68:71], v[104:119]
  ds_read_b128 v[52:55], v142 offset:1312
  v_exp_f32 v92, v92
  v_exp_f32 v93, v93
  v_exp_f32 v94, v94
  v_exp_f32 v95, v95
  v_cvt_pk_bf16_f32 v66, v92, v93
  v_cvt_pk_bf16_f32 v67, v94, v95
  v_mfma_f32_32x32x8bf16_1k v[72:87], v[40:41], v[24:25], v[72:87]
  v_exp_f32 v96, v96
  v_exp_f32 v97, v97
  v_exp_f32 v98, v98
  v_exp_f32 v99, v99
  v_cvt_pk_bf16_f32 v68, v96, v97
  v_cvt_pk_bf16_f32 v69, v98, v99
  v_mfma_f32_32x32x16_bf16 v[120:135], v[56:59], v[64:67], v[120:135]
  s_mov_b32 m0, s38
  v_exp_f32 v100, v100
  v_exp_f32 v101, v101
  v_exp_f32 v102, v102
  v_exp_f32_e64 v103, v103
  v_cvt_pk_bf16_f32 v70, v100, v101
  v_cvt_pk_bf16_f32 v71, v102, v103
  s_mov_b32 s35, 9437184
  v_mfma_f32_32x32x16_bf16 v[88:103], v[32:35], v[20:23], 0
  buffer_load_dwordx4 v235, s[16:19], s47 offen offset:3200 lds
  buffer_load_dwordx4 v248, s[64:67], s81 offen offset:128 lds
  buffer_store_dwordx4 v[224:227], v30, s[72:75], s35 offen sc0 sc1
  v_exp_f32 v72, v72
  v_exp_f32 v73, v73
  v_exp_f32 v74, v74
  v_exp_f32 v75, v75
  v_cvt_pk_bf16_f32 v64, v72, v73
  v_cvt_pk_bf16_f32 v65, v74, v75
  v_mfma_f32_32x32x16_bf16 v[120:135], v[60:63], v[68:71], v[120:135]
  ds_read_b64_tr_b16 v[32:33], v140 offset:1408
  v_exp_f32 v76, v76
  v_exp_f32 v77, v77
  v_exp_f32 v78, v78
  v_exp_f32 v79, v79
  v_cvt_pk_bf16_f32 v66, v76, v77
  v_cvt_pk_bf16_f32 v67, v78, v79
  v_mfma_f32_32x32x8bf16_1k v[88:103], v[40:41], v[26:27], v[88:103]
  s_waitcnt lgkmcnt(1)
  ds_read_b64_tr_b16 v[34:35], v140 offset:18048
  v_exp_f32 v80, v80
  v_exp_f32 v81, v81
  v_exp_f32 v82, v82
  v_exp_f32_e64 v83, v83
  v_cvt_pk_bf16_f32 v68, v80, v81
  v_cvt_pk_bf16_f32 v69, v82, v83
  v_mfma_f32_32x32x16_bf16 v[104:119], v[48:51], v[64:67], v[104:119]
  ds_read_b64_tr_b16 v[40:41], v141 offset:1408
  v_exp_f32 v84, v84
  v_exp_f32 v85, v85
  v_exp_f32 v86, v86
  v_exp_f32 v87, v87
  v_cvt_pk_bf16_f32 v70, v84, v85
  v_cvt_pk_bf16_f32 v71, v86, v87
  v_mfma_f32_32x32x16_bf16 v[72:87], v[36:39], v[16:19], 0
  ds_read_b128 v[56:59], v142 offset:1344
  v_exp_f32 v88, v88
  v_exp_f32 v89, v89
  v_exp_f32 v90, v90
  v_exp_f32 v91, v91
  v_cvt_pk_bf16_f32 v64, v88, v89
  v_cvt_pk_bf16_f32 v65, v90, v91
  v_mfma_f32_32x32x16_bf16 v[104:119], v[52:55], v[68:71], v[104:119]
  ds_read_b128 v[60:63], v142 offset:1376
  v_exp_f32 v92, v92
  v_exp_f32 v93, v93
  v_exp_f32 v94, v94
  v_exp_f32 v95, v95
  v_cvt_pk_bf16_f32 v66, v92, v93
  v_cvt_pk_bf16_f32 v67, v94, v95
  v_mfma_f32_32x32x8bf16_1k v[72:87], v[42:43], v[24:25], v[72:87]
  v_exp_f32 v96, v96
  v_exp_f32 v97, v97
  v_exp_f32 v98, v98
  v_exp_f32 v99, v99
  v_cvt_pk_bf16_f32 v68, v96, v97
  v_cvt_pk_bf16_f32 v69, v98, v99
  v_mfma_f32_32x32x16_bf16 v[120:135], v[48:51], v[64:67], v[120:135]
  v_exp_f32 v100, v100
  v_exp_f32 v101, v101
  v_exp_f32 v102, v102
  v_exp_f32 v103, v103
  v_cvt_pk_bf16_f32 v70, v100, v101
  v_cvt_pk_bf16_f32 v71, v102, v103
  v_mfma_f32_32x32x16_bf16 v[88:103], v[36:39], v[20:23], 0
  v_exp_f32 v72, v72
  v_exp_f32 v73, v73
  v_exp_f32 v74, v74
  v_exp_f32 v75, v75
  v_cvt_pk_bf16_f32 v64, v72, v73
  v_cvt_pk_bf16_f32 v65, v74, v75
  v_mfma_f32_32x32x16_bf16 v[120:135], v[52:55], v[68:71], v[120:135]
  ds_read_b64_tr_b16 v[36:37], v140 offset:1472
  v_exp_f32 v76, v76
  v_exp_f32 v77, v77
  v_exp_f32 v78, v78
  v_exp_f32 v79, v79
  v_cvt_pk_bf16_f32 v66, v76, v77
  v_cvt_pk_bf16_f32 v67, v78, v79
  v_mfma_f32_32x32x8bf16_1k v[88:103], v[42:43], v[26:27], v[88:103]
  s_waitcnt lgkmcnt(1)
  ds_read_b64_tr_b16 v[38:39], v140 offset:18112
  v_exp_f32 v80, v80
  v_exp_f32 v81, v81
  v_exp_f32 v82, v82
  v_exp_f32_e64 v83, v83
  v_cvt_pk_bf16_f32 v68, v80, v81
  v_cvt_pk_bf16_f32 v69, v82, v83
  v_mfma_f32_32x32x16_bf16 v[104:119], v[56:59], v[64:67], v[104:119]
  ds_read_b64_tr_b16 v[42:43], v141 offset:1472
  v_exp_f32 v84, v84
  v_exp_f32 v85, v85
  v_exp_f32 v86, v86
  v_exp_f32 v87, v87
  v_cvt_pk_bf16_f32 v70, v84, v85
  v_cvt_pk_bf16_f32 v71, v86, v87
  v_mfma_f32_32x32x16_bf16 v[72:87], v[32:35], v[16:19], 0
  ds_read_b128 v[48:51], v142 offset:1408
  v_exp_f32 v88, v88
  v_exp_f32 v89, v89
  v_exp_f32 v90, v90
  v_exp_f32 v91, v91
  v_cvt_pk_bf16_f32 v64, v88, v89
  v_cvt_pk_bf16_f32 v65, v90, v91
  v_mfma_f32_32x32x16_bf16 v[104:119], v[60:63], v[68:71], v[104:119]
  ds_read_b128 v[52:55], v142 offset:1440
  v_exp_f32 v92, v92
  v_exp_f32 v93, v93
  v_exp_f32 v94, v94
  v_exp_f32 v95, v95
  v_cvt_pk_bf16_f32 v66, v92, v93
  v_cvt_pk_bf16_f32 v67, v94, v95
  v_mfma_f32_32x32x8bf16_1k v[72:87], v[40:41], v[24:25], v[72:87]
  v_exp_f32 v96, v96
  v_exp_f32 v97, v97
  v_exp_f32 v98, v98
  v_exp_f32 v99, v99
  v_cvt_pk_bf16_f32 v68, v96, v97
  v_cvt_pk_bf16_f32 v69, v98, v99
  v_mfma_f32_32x32x16_bf16 v[120:135], v[56:59], v[64:67], v[120:135]
  v_exp_f32 v100, v100
  v_exp_f32 v101, v101
  v_exp_f32_e64 v102, v102
  v_exp_f32 v103, v103
  v_cvt_pk_bf16_f32 v70, v100, v101
  v_cvt_pk_bf16_f32 v71, v102, v103
  s_mov_b32 m0, s39
  v_mfma_f32_32x32x16_bf16 v[88:103], v[32:35], v[20:23], 0
  buffer_load_dwordx4 v235, s[16:19], s47 offen offset:3264 lds
  buffer_load_dwordx4 v248, s[64:67], s82 offen offset:192 lds
  v_exp_f32 v72, v72
  v_exp_f32 v73, v73
  v_exp_f32 v74, v74
  v_exp_f32 v75, v75
  v_cvt_pk_bf16_f32 v64, v72, v73
  v_cvt_pk_bf16_f32 v65, v74, v75
  v_mfma_f32_32x32x16_bf16 v[120:135], v[60:63], v[68:71], v[120:135]
  ds_read_b64_tr_b16 v[32:33], v140 offset:1536
  v_exp_f32 v76, v76
  v_exp_f32 v77, v77
  v_exp_f32 v78, v78
  v_exp_f32 v79, v79
  v_cvt_pk_bf16_f32 v66, v76, v77
  v_cvt_pk_bf16_f32 v67, v78, v79
  v_mfma_f32_32x32x8bf16_1k v[88:103], v[40:41], v[26:27], v[88:103]
  s_waitcnt lgkmcnt(1)
  ds_read_b64_tr_b16 v[34:35], v140 offset:18176
  v_exp_f32 v80, v80
  v_exp_f32 v81, v81
  v_exp_f32 v82, v82
  v_exp_f32_e64 v83, v83
  v_cvt_pk_bf16_f32 v68, v80, v81
  v_cvt_pk_bf16_f32 v69, v82, v83
  v_mfma_f32_32x32x16_bf16 v[104:119], v[48:51], v[64:67], v[104:119]
  ds_read_b64_tr_b16 v[40:41], v141 offset:1536
  v_exp_f32 v84, v84
  v_exp_f32 v85, v85
  v_exp_f32 v86, v86
  v_exp_f32 v87, v87
  v_cvt_pk_bf16_f32 v70, v84, v85
  v_cvt_pk_bf16_f32 v71, v86, v87
  v_mfma_f32_32x32x16_bf16 v[72:87], v[36:39], v[16:19], 0
  ds_read_b128 v[56:59], v142 offset:1472
  v_exp_f32 v88, v88
  v_exp_f32 v89, v89
  v_exp_f32 v90, v90
  v_exp_f32 v91, v91
  v_cvt_pk_bf16_f32 v64, v88, v89
  v_cvt_pk_bf16_f32 v65, v90, v91
  v_mfma_f32_32x32x16_bf16 v[104:119], v[52:55], v[68:71], v[104:119]
  ds_read_b128 v[60:63], v142 offset:1504
  v_exp_f32 v92, v92
  v_exp_f32 v93, v93
  v_exp_f32 v94, v94
  v_exp_f32 v95, v95
  v_cvt_pk_bf16_f32 v66, v92, v93
  v_cvt_pk_bf16_f32 v67, v94, v95
  v_mfma_f32_32x32x8bf16_1k v[72:87], v[42:43], v[24:25], v[72:87]
  v_exp_f32 v96, v96
  v_exp_f32 v97, v97
  v_exp_f32 v98, v98
  v_exp_f32 v99, v99
  v_cvt_pk_bf16_f32 v68, v96, v97
  v_cvt_pk_bf16_f32 v69, v98, v99
  v_mfma_f32_32x32x16_bf16 v[120:135], v[48:51], v[64:67], v[120:135]
  v_exp_f32 v100, v100
  v_exp_f32 v101, v101
  v_exp_f32 v102, v102
  v_exp_f32 v103, v103
  v_cvt_pk_bf16_f32 v70, v100, v101
  v_cvt_pk_bf16_f32 v71, v102, v103
  v_mfma_f32_32x32x16_bf16 v[88:103], v[36:39], v[20:23], 0
  v_exp_f32 v72, v72
  v_exp_f32 v73, v73
  v_exp_f32 v74, v74
  v_exp_f32 v75, v75
  v_cvt_pk_bf16_f32 v64, v72, v73
  v_cvt_pk_bf16_f32 v65, v74, v75
  v_mfma_f32_32x32x16_bf16 v[120:135], v[52:55], v[68:71], v[120:135]
  ds_read_b64_tr_b16 v[36:37], v140 offset:1600
  v_exp_f32 v76, v76
  v_exp_f32 v77, v77
  v_exp_f32 v78, v78
  v_exp_f32 v79, v79
  v_cvt_pk_bf16_f32 v66, v76, v77
  v_cvt_pk_bf16_f32 v67, v78, v79
  v_mfma_f32_32x32x8bf16_1k v[88:103], v[42:43], v[26:27], v[88:103]
  s_waitcnt lgkmcnt(1)
  ds_read_b64_tr_b16 v[38:39], v140 offset:18240
  v_exp_f32 v80, v80
  v_exp_f32 v81, v81
  v_exp_f32 v82, v82
  v_exp_f32_e64 v83, v83
  v_cvt_pk_bf16_f32 v68, v80, v81
  v_cvt_pk_bf16_f32 v69, v82, v83
  v_mfma_f32_32x32x16_bf16 v[104:119], v[56:59], v[64:67], v[104:119]
  ds_read_b64_tr_b16 v[42:43], v141 offset:1600
  v_exp_f32 v84, v84
  v_exp_f32 v85, v85
  v_exp_f32 v86, v86
  v_exp_f32 v87, v87
  v_cvt_pk_bf16_f32 v70, v84, v85
  v_cvt_pk_bf16_f32 v71, v86, v87
  v_mfma_f32_32x32x16_bf16 v[72:87], v[32:35], v[16:19], 0
  ds_read_b128 v[48:51], v142 offset:1536
  v_exp_f32 v88, v88
  v_exp_f32 v89, v89
  v_exp_f32 v90, v90
  v_exp_f32 v91, v91
  v_cvt_pk_bf16_f32 v64, v88, v89
  v_cvt_pk_bf16_f32 v65, v90, v91
  v_mfma_f32_32x32x16_bf16 v[104:119], v[60:63], v[68:71], v[104:119]
  ds_read_b128 v[52:55], v142 offset:1568
  v_exp_f32 v92, v92
  v_exp_f32 v93, v93
  v_exp_f32 v94, v94
  v_exp_f32 v95, v95
  v_cvt_pk_bf16_f32 v66, v92, v93
  v_cvt_pk_bf16_f32 v67, v94, v95
  v_mfma_f32_32x32x8bf16_1k v[72:87], v[40:41], v[24:25], v[72:87]
  v_exp_f32 v96, v96
  v_exp_f32 v97, v97
  v_exp_f32 v98, v98
  v_exp_f32 v99, v99
  v_cvt_pk_bf16_f32 v68, v96, v97
  v_cvt_pk_bf16_f32 v69, v98, v99
  v_mfma_f32_32x32x16_bf16 v[120:135], v[56:59], v[64:67], v[120:135]
  v_exp_f32 v100, v100
  v_exp_f32 v101, v101
  v_exp_f32_e64 v102, v102
  v_exp_f32 v103, v103
  v_cvt_pk_bf16_f32 v70, v100, v101
  v_cvt_pk_bf16_f32 v71, v102, v103
  s_mov_b32 m0, s40
  v_mfma_f32_32x32x16_bf16 v[88:103], v[32:35], v[20:23], 0
  buffer_load_dwordx4 v235, s[16:19], s47 offen offset:3328 lds
  buffer_load_dwordx4 v248, s[64:67], s83 offen offset:256 lds
  v_exp_f32 v72, v72
  v_exp_f32 v73, v73
  v_exp_f32 v74, v74
  v_exp_f32 v75, v75
  v_cvt_pk_bf16_f32 v64, v72, v73
  v_cvt_pk_bf16_f32 v65, v74, v75
  v_mfma_f32_32x32x16_bf16 v[120:135], v[60:63], v[68:71], v[120:135]
  ds_read_b64_tr_b16 v[32:33], v140 offset:1664
  v_exp_f32 v76, v76
  v_exp_f32 v77, v77
  v_exp_f32 v78, v78
  v_exp_f32 v79, v79
  v_cvt_pk_bf16_f32 v66, v76, v77
  v_cvt_pk_bf16_f32 v67, v78, v79
  v_mfma_f32_32x32x8bf16_1k v[88:103], v[40:41], v[26:27], v[88:103]
  s_waitcnt lgkmcnt(1)
  ds_read_b64_tr_b16 v[34:35], v140 offset:18304
  v_exp_f32 v80, v80
  v_exp_f32 v81, v81
  v_exp_f32 v82, v82
  v_exp_f32_e64 v83, v83
  v_cvt_pk_bf16_f32 v68, v80, v81
  v_cvt_pk_bf16_f32 v69, v82, v83
  v_mfma_f32_32x32x16_bf16 v[104:119], v[48:51], v[64:67], v[104:119]
  ds_read_b64_tr_b16 v[40:41], v141 offset:1664
  v_exp_f32 v84, v84
  v_exp_f32 v85, v85
  v_exp_f32 v86, v86
  v_exp_f32 v87, v87
  v_cvt_pk_bf16_f32 v70, v84, v85
  v_cvt_pk_bf16_f32 v71, v86, v87
  v_mfma_f32_32x32x16_bf16 v[72:87], v[36:39], v[16:19], 0
  ds_read_b128 v[56:59], v142 offset:1600
  v_exp_f32 v88, v88
  v_exp_f32 v89, v89
  v_exp_f32 v90, v90
  v_exp_f32 v91, v91
  v_cvt_pk_bf16_f32 v64, v88, v89
  v_cvt_pk_bf16_f32 v65, v90, v91
  v_mfma_f32_32x32x16_bf16 v[104:119], v[52:55], v[68:71], v[104:119]
  ds_read_b128 v[60:63], v142 offset:1632
  v_exp_f32 v92, v92
  v_exp_f32 v93, v93
  v_exp_f32 v94, v94
  v_exp_f32 v95, v95
  v_cvt_pk_bf16_f32 v66, v92, v93
  v_cvt_pk_bf16_f32 v67, v94, v95
  v_mfma_f32_32x32x8bf16_1k v[72:87], v[42:43], v[24:25], v[72:87]
  v_exp_f32 v96, v96
  v_exp_f32 v97, v97
  v_exp_f32 v98, v98
  v_exp_f32 v99, v99
  v_cvt_pk_bf16_f32 v68, v96, v97
  v_cvt_pk_bf16_f32 v69, v98, v99
  v_mfma_f32_32x32x16_bf16 v[120:135], v[48:51], v[64:67], v[120:135]
  v_exp_f32 v100, v100
  v_exp_f32 v101, v101
  v_exp_f32 v102, v102
  v_exp_f32 v103, v103
  v_cvt_pk_bf16_f32 v70, v100, v101
  v_cvt_pk_bf16_f32 v71, v102, v103
  v_mfma_f32_32x32x16_bf16 v[88:103], v[36:39], v[20:23], 0
  v_exp_f32 v72, v72
  v_exp_f32 v73, v73
  v_exp_f32 v74, v74
  v_exp_f32 v75, v75
  v_cvt_pk_bf16_f32 v64, v72, v73
  v_cvt_pk_bf16_f32 v65, v74, v75
  v_mfma_f32_32x32x16_bf16 v[120:135], v[52:55], v[68:71], v[120:135]
  ds_read_b64_tr_b16 v[36:37], v140 offset:1728
  v_exp_f32 v76, v76
  v_exp_f32 v77, v77
  v_exp_f32 v78, v78
  v_exp_f32 v79, v79
  v_cvt_pk_bf16_f32 v66, v76, v77
  v_cvt_pk_bf16_f32 v67, v78, v79
  v_mfma_f32_32x32x8bf16_1k v[88:103], v[42:43], v[26:27], v[88:103]
  s_waitcnt lgkmcnt(1)
  ds_read_b64_tr_b16 v[38:39], v140 offset:18368
  v_exp_f32 v80, v80
  v_exp_f32 v81, v81
  v_exp_f32 v82, v82
  v_exp_f32_e64 v83, v83
  v_cvt_pk_bf16_f32 v68, v80, v81
  v_cvt_pk_bf16_f32 v69, v82, v83
  v_mfma_f32_32x32x16_bf16 v[104:119], v[56:59], v[64:67], v[104:119]
  ds_read_b64_tr_b16 v[42:43], v141 offset:1728
  v_exp_f32 v84, v84
  v_exp_f32 v85, v85
  v_exp_f32 v86, v86
  v_exp_f32 v87, v87
  v_cvt_pk_bf16_f32 v70, v84, v85
  v_cvt_pk_bf16_f32 v71, v86, v87
  v_mfma_f32_32x32x16_bf16 v[72:87], v[32:35], v[16:19], 0
  ds_read_b128 v[48:51], v142 offset:1664
  v_exp_f32 v88, v88
  v_exp_f32 v89, v89
  v_exp_f32 v90, v90
  v_exp_f32 v91, v91
  v_cvt_pk_bf16_f32 v64, v88, v89
  v_cvt_pk_bf16_f32 v65, v90, v91
  v_mfma_f32_32x32x16_bf16 v[104:119], v[60:63], v[68:71], v[104:119]
  ds_read_b128 v[52:55], v142 offset:1696
  v_exp_f32 v92, v92
  v_exp_f32 v93, v93
  v_exp_f32 v94, v94
  v_exp_f32 v95, v95
  v_cvt_pk_bf16_f32 v66, v92, v93
  v_cvt_pk_bf16_f32 v67, v94, v95
  v_mfma_f32_32x32x8bf16_1k v[72:87], v[40:41], v[24:25], v[72:87]
  v_exp_f32 v96, v96
  v_exp_f32 v97, v97
  v_exp_f32 v98, v98
  v_exp_f32 v99, v99
  v_cvt_pk_bf16_f32 v68, v96, v97
  v_cvt_pk_bf16_f32 v69, v98, v99
  v_mfma_f32_32x32x16_bf16 v[120:135], v[56:59], v[64:67], v[120:135]
  s_mov_b32 m0, s41
  v_exp_f32 v100, v100
  v_exp_f32 v101, v101
  v_exp_f32 v102, v102
  v_exp_f32 v103, v103
  v_cvt_pk_bf16_f32 v70, v100, v101
  v_cvt_pk_bf16_f32 v71, v102, v103
  s_getpc_b64 s[94:95]
  v_mfma_f32_32x32x16_bf16 v[88:103], v[32:35], v[20:23], 0
  buffer_load_dwordx4 v235, s[16:19], s47 offen offset:3392 lds
  buffer_load_dwordx4 v248, s[64:67], s84 offen offset:320 lds
  global_load_dword v231, v230, s[94:95]
  v_exp_f32 v72, v72
  v_exp_f32 v73, v73
  v_exp_f32 v74, v74
  v_exp_f32 v75, v75
  v_cvt_pk_bf16_f32 v64, v72, v73
  v_cvt_pk_bf16_f32 v65, v74, v75
  v_mfma_f32_32x32x16_bf16 v[120:135], v[60:63], v[68:71], v[120:135]
  ds_read_b64_tr_b16 v[32:33], v140 offset:1792
  v_exp_f32 v76, v76
  v_exp_f32 v77, v77
  v_exp_f32 v78, v78
  v_exp_f32 v79, v79
  v_cvt_pk_bf16_f32 v66, v76, v77
  v_cvt_pk_bf16_f32 v67, v78, v79
  v_mfma_f32_32x32x8bf16_1k v[88:103], v[40:41], v[26:27], v[88:103]
  s_waitcnt lgkmcnt(1)
  ds_read_b64_tr_b16 v[34:35], v140 offset:18432
  v_exp_f32 v80, v80
  v_exp_f32 v81, v81
  v_exp_f32 v82, v82
  v_exp_f32_e64 v83, v83
  v_cvt_pk_bf16_f32 v68, v80, v81
  v_cvt_pk_bf16_f32 v69, v82, v83
  v_mfma_f32_32x32x16_bf16 v[104:119], v[48:51], v[64:67], v[104:119]
  ds_read_b64_tr_b16 v[40:41], v141 offset:1792
  v_exp_f32 v84, v84
  v_exp_f32 v85, v85
  v_exp_f32 v86, v86
  v_exp_f32 v87, v87
  v_cvt_pk_bf16_f32 v70, v84, v85
  v_cvt_pk_bf16_f32 v71, v86, v87
  v_mfma_f32_32x32x16_bf16 v[72:87], v[36:39], v[16:19], 0
  ds_read_b128 v[56:59], v142 offset:1728
  v_exp_f32 v88, v88
  v_exp_f32 v89, v89
  v_exp_f32 v90, v90
  v_exp_f32 v91, v91
  v_cvt_pk_bf16_f32 v64, v88, v89
  v_cvt_pk_bf16_f32 v65, v90, v91
  v_mfma_f32_32x32x16_bf16 v[104:119], v[52:55], v[68:71], v[104:119]
  ds_read_b128 v[60:63], v142 offset:1760
  v_exp_f32 v92, v92
  v_exp_f32 v93, v93
  v_exp_f32 v94, v94
  v_exp_f32 v95, v95
  v_cvt_pk_bf16_f32 v66, v92, v93
  v_cvt_pk_bf16_f32 v67, v94, v95
  v_mfma_f32_32x32x8bf16_1k v[72:87], v[42:43], v[24:25], v[72:87]
  v_exp_f32 v96, v96
  v_exp_f32 v97, v97
  v_exp_f32 v98, v98
  v_exp_f32 v99, v99
  v_cvt_pk_bf16_f32 v68, v96, v97
  v_cvt_pk_bf16_f32 v69, v98, v99
  v_mfma_f32_32x32x16_bf16 v[120:135], v[48:51], v[64:67], v[120:135]
  v_exp_f32 v100, v100
  v_exp_f32 v101, v101
  v_exp_f32 v102, v102
  v_exp_f32 v103, v103
  v_cvt_pk_bf16_f32 v70, v100, v101
  v_cvt_pk_bf16_f32 v71, v102, v103
  v_mfma_f32_32x32x16_bf16 v[88:103], v[36:39], v[20:23], 0
  v_exp_f32 v72, v72
  v_exp_f32 v73, v73
  v_exp_f32 v74, v74
  v_exp_f32 v75, v75
  v_cvt_pk_bf16_f32 v64, v72, v73
  v_cvt_pk_bf16_f32 v65, v74, v75
  v_mfma_f32_32x32x16_bf16 v[120:135], v[52:55], v[68:71], v[120:135]
  ds_read_b64_tr_b16 v[36:37], v140 offset:1856
  v_exp_f32 v76, v76
  v_exp_f32 v77, v77
  v_exp_f32 v78, v78
  v_exp_f32 v79, v79
  v_cvt_pk_bf16_f32 v66, v76, v77
  v_cvt_pk_bf16_f32 v67, v78, v79
  v_mfma_f32_32x32x8bf16_1k v[88:103], v[42:43], v[26:27], v[88:103]
  s_waitcnt lgkmcnt(1)
  ds_read_b64_tr_b16 v[38:39], v140 offset:18496
  v_exp_f32 v80, v80
  v_exp_f32 v81, v81
  v_exp_f32 v82, v82
  v_exp_f32_e64 v83, v83
  v_cvt_pk_bf16_f32 v68, v80, v81
  v_cvt_pk_bf16_f32 v69, v82, v83
  v_mfma_f32_32x32x16_bf16 v[104:119], v[56:59], v[64:67], v[104:119]
  ds_read_b64_tr_b16 v[42:43], v141 offset:1856
  v_exp_f32 v84, v84
  v_exp_f32 v85, v85
  v_exp_f32 v86, v86
  v_exp_f32 v87, v87
  v_cvt_pk_bf16_f32 v70, v84, v85
  v_cvt_pk_bf16_f32 v71, v86, v87
  v_mfma_f32_32x32x16_bf16 v[72:87], v[32:35], v[16:19], 0
  ds_read_b128 v[48:51], v142 offset:1792
  v_exp_f32 v88, v88
  v_exp_f32 v89, v89
  v_exp_f32 v90, v90
  v_exp_f32 v91, v91
  v_cvt_pk_bf16_f32 v64, v88, v89
  v_cvt_pk_bf16_f32 v65, v90, v91
  v_mfma_f32_32x32x16_bf16 v[104:119], v[60:63], v[68:71], v[104:119]
  ds_read_b128 v[52:55], v142 offset:1824
  v_exp_f32 v92, v92
  v_exp_f32 v93, v93
  v_exp_f32 v94, v94
  v_exp_f32 v95, v95
  v_cvt_pk_bf16_f32 v66, v92, v93
  v_cvt_pk_bf16_f32 v67, v94, v95
  v_mfma_f32_32x32x8bf16_1k v[72:87], v[40:41], v[24:25], v[72:87]
  v_exp_f32 v96, v96
  v_exp_f32 v97, v97
  v_exp_f32 v98, v98
  v_exp_f32 v99, v99
  v_cvt_pk_bf16_f32 v68, v96, v97
  v_cvt_pk_bf16_f32 v69, v98, v99
  v_mfma_f32_32x32x16_bf16 v[120:135], v[56:59], v[64:67], v[120:135]
  v_exp_f32 v100, v100
  v_exp_f32 v101, v101
  v_exp_f32_e64 v102, v102
  v_exp_f32 v103, v103
  v_cvt_pk_bf16_f32 v70, v100, v101
  v_cvt_pk_bf16_f32 v71, v102, v103
  s_mov_b32 m0, s42
  v_mfma_f32_32x32x16_bf16 v[88:103], v[32:35], v[20:23], 0
  buffer_load_dwordx4 v235, s[16:19], s47 offen offset:3456 lds
  buffer_load_dwordx2 v[160:161], v136, s[48:51], s77 offen offset:128
  v_exp_f32 v72, v72
  v_exp_f32 v73, v73
  v_exp_f32 v74, v74
  v_exp_f32 v75, v75
  v_cvt_pk_bf16_f32 v64, v72, v73
  v_cvt_pk_bf16_f32 v65, v74, v75
  v_mfma_f32_32x32x16_bf16 v[120:135], v[60:63], v[68:71], v[120:135]
  ds_read_b64_tr_b16 v[32:33], v140 offset:1920
  v_exp_f32 v76, v76
  v_exp_f32 v77, v77
  v_exp_f32 v78, v78
  v_exp_f32 v79, v79
  v_cvt_pk_bf16_f32 v66, v76, v77
  v_cvt_pk_bf16_f32 v67, v78, v79
  v_mfma_f32_32x32x8bf16_1k v[88:103], v[40:41], v[26:27], v[88:103]
  s_waitcnt lgkmcnt(1)
  ds_read_b64_tr_b16 v[34:35], v140 offset:18560
  v_exp_f32 v80, v80
  v_exp_f32 v81, v81
  v_exp_f32 v82, v82
  v_exp_f32_e64 v83, v83
  v_cvt_pk_bf16_f32 v68, v80, v81
  v_cvt_pk_bf16_f32 v69, v82, v83
  v_mfma_f32_32x32x16_bf16 v[104:119], v[48:51], v[64:67], v[104:119]
  ds_read_b64_tr_b16 v[40:41], v141 offset:1920
  v_exp_f32 v84, v84
  v_exp_f32 v85, v85
  v_exp_f32 v86, v86
  v_exp_f32 v87, v87
  v_cvt_pk_bf16_f32 v70, v84, v85
  v_cvt_pk_bf16_f32 v71, v86, v87
  v_mfma_f32_32x32x16_bf16 v[72:87], v[36:39], v[16:19], 0
  ds_read_b128 v[56:59], v142 offset:1856
  v_exp_f32 v88, v88
  v_exp_f32 v89, v89
  v_exp_f32 v90, v90
  v_exp_f32 v91, v91
  v_cvt_pk_bf16_f32 v64, v88, v89
  v_cvt_pk_bf16_f32 v65, v90, v91
  v_mfma_f32_32x32x16_bf16 v[104:119], v[52:55], v[68:71], v[104:119]
  ds_read_b128 v[60:63], v142 offset:1888
  v_exp_f32 v92, v92
  v_exp_f32 v93, v93
  v_exp_f32 v94, v94
  v_exp_f32 v95, v95
  v_cvt_pk_bf16_f32 v66, v92, v93
  v_cvt_pk_bf16_f32 v67, v94, v95
  v_mfma_f32_32x32x8bf16_1k v[72:87], v[42:43], v[24:25], v[72:87]
  v_exp_f32 v96, v96
  v_exp_f32 v97, v97
  v_exp_f32 v98, v98
  v_exp_f32 v99, v99
  v_cvt_pk_bf16_f32 v68, v96, v97
  v_cvt_pk_bf16_f32 v69, v98, v99
  v_mfma_f32_32x32x16_bf16 v[120:135], v[48:51], v[64:67], v[120:135]
  v_exp_f32 v100, v100
  v_exp_f32 v101, v101
  v_exp_f32 v102, v102
  v_exp_f32 v103, v103
  v_cvt_pk_bf16_f32 v70, v100, v101
  v_cvt_pk_bf16_f32 v71, v102, v103
  v_mfma_f32_32x32x16_bf16 v[88:103], v[36:39], v[20:23], 0
  v_exp_f32 v72, v72
  v_exp_f32 v73, v73
  v_exp_f32 v74, v74
  v_exp_f32 v75, v75
  v_cvt_pk_bf16_f32 v64, v72, v73
  v_cvt_pk_bf16_f32 v65, v74, v75
  v_mfma_f32_32x32x16_bf16 v[120:135], v[52:55], v[68:71], v[120:135]
  ds_read_b64_tr_b16 v[36:37], v140 offset:1984
  v_exp_f32 v76, v76
  v_exp_f32 v77, v77
  v_exp_f32 v78, v78
  v_exp_f32 v79, v79
  v_cvt_pk_bf16_f32 v66, v76, v77
  v_cvt_pk_bf16_f32 v67, v78, v79
  v_mfma_f32_32x32x8bf16_1k v[88:103], v[42:43], v[26:27], v[88:103]
  s_waitcnt lgkmcnt(1)
  ds_read_b64_tr_b16 v[38:39], v140 offset:18624
  v_exp_f32 v80, v80
  v_exp_f32 v81, v81
  v_exp_f32 v82, v82
  v_exp_f32_e64 v83, v83
  v_cvt_pk_bf16_f32 v68, v80, v81
  v_cvt_pk_bf16_f32 v69, v82, v83
  v_mfma_f32_32x32x16_bf16 v[104:119], v[56:59], v[64:67], v[104:119]
  ds_read_b64_tr_b16 v[42:43], v141 offset:1984
  v_exp_f32 v84, v84
  v_exp_f32 v85, v85
  v_exp_f32_e64 v86, v86
  v_exp_f32 v87, v87
  v_cvt_pk_bf16_f32 v70, v84, v85
  v_cvt_pk_bf16_f32 v71, v86, v87
  s_mov_b32 m0, s43
  v_mfma_f32_32x32x16_bf16 v[72:87], v[32:35], v[16:19], 0
  buffer_load_dwordx4 v235, s[16:19], s47 offen offset:3520 lds
  ds_read_b128 v[48:51], v142 offset:1920
  v_exp_f32 v88, v88
  v_exp_f32 v89, v89
  v_exp_f32 v90, v90
  v_exp_f32 v91, v91
  v_cvt_pk_bf16_f32 v64, v88, v89
  v_cvt_pk_bf16_f32 v65, v90, v91
  v_mfma_f32_32x32x16_bf16 v[104:119], v[60:63], v[68:71], v[104:119]
  ds_read_b128 v[52:55], v142 offset:1952
  v_exp_f32 v92, v92
  v_exp_f32 v93, v93
  v_exp_f32 v94, v94
  v_exp_f32 v95, v95
  v_cvt_pk_bf16_f32 v66, v92, v93
  v_cvt_pk_bf16_f32 v67, v94, v95
  v_mfma_f32_32x32x8bf16_1k v[72:87], v[40:41], v[24:25], v[72:87]
  v_exp_f32 v96, v96
  v_exp_f32 v97, v97
  v_exp_f32 v98, v98
  v_exp_f32 v99, v99
  v_cvt_pk_bf16_f32 v68, v96, v97
  v_cvt_pk_bf16_f32 v69, v98, v99
  v_mfma_f32_32x32x16_bf16 v[120:135], v[56:59], v[64:67], v[120:135]
  v_exp_f32 v100, v100
  v_exp_f32 v101, v101
  v_exp_f32 v102, v102
  v_exp_f32 v103, v103
  v_cvt_pk_bf16_f32 v70, v100, v101
  v_cvt_pk_bf16_f32 v71, v102, v103
  v_mfma_f32_32x32x16_bf16 v[88:103], v[32:35], v[20:23], 0
  v_exp_f32 v72, v72
  v_exp_f32 v73, v73
  v_exp_f32 v74, v74
  v_exp_f32 v75, v75
  v_cvt_pk_bf16_f32 v64, v72, v73
  v_cvt_pk_bf16_f32 v65, v74, v75
  v_mfma_f32_32x32x16_bf16 v[120:135], v[60:63], v[68:71], v[120:135]
  ds_read_b64_tr_b16 v[32:33], v140 offset:2048
L_pg_7:
  s_cbranch_execz L_wr_1
  v_exp_f32_e64 v76, v76
  v_exp_f32 v77, v77
  v_exp_f32 v78, v78
  v_exp_f32 v79, v79
  v_cvt_pk_bf16_f32 v66, v76, v77
  v_cvt_pk_bf16_f32 v67, v78, v79
  v_mfma_f32_32x32x8bf16_1k v[88:103], v[40:41], v[26:27], v[88:103]
  s_waitcnt lgkmcnt(1)
  ds_read_b64_tr_b16 v[34:35], v140 offset:18688
  v_exp_f32 v80, v80
  v_exp_f32 v81, v81
  v_exp_f32 v82, v82
  v_exp_f32_e64 v83, v83
  v_cvt_pk_bf16_f32 v68, v80, v81
  v_cvt_pk_bf16_f32 v69, v82, v83
  v_mfma_f32_32x32x16_bf16 v[104:119], v[48:51], v[64:67], v[104:119]
  ds_read_b64_tr_b16 v[40:41], v141 offset:2048
  v_exp_f32 v84, v84
  v_exp_f32 v85, v85
  v_exp_f32 v86, v86
  v_exp_f32 v87, v87
  v_cvt_pk_bf16_f32 v70, v84, v85
  v_cvt_pk_bf16_f32 v71, v86, v87
  v_mfma_f32_32x32x16_bf16 v[72:87], v[36:39], v[16:19], 0
  ds_read_b128 v[56:59], v142 offset:1984
  v_exp_f32 v88, v88
  v_exp_f32 v89, v89
  v_exp_f32 v90, v90
  v_exp_f32 v91, v91
  v_cvt_pk_bf16_f32 v64, v88, v89
  v_cvt_pk_bf16_f32 v65, v90, v91
  v_mfma_f32_32x32x16_bf16 v[104:119], v[52:55], v[68:71], v[104:119]
  ds_read_b128 v[60:63], v142 offset:2016
  v_exp_f32 v92, v92
  v_exp_f32 v93, v93
  v_exp_f32 v94, v94
  v_exp_f32 v95, v95
  v_cvt_pk_bf16_f32 v66, v92, v93
  v_cvt_pk_bf16_f32 v67, v94, v95
  v_mfma_f32_32x32x8bf16_1k v[72:87], v[42:43], v[24:25], v[72:87]
  v_exp_f32 v96, v96
  v_exp_f32 v97, v97
  v_exp_f32 v98, v98
  v_exp_f32 v99, v99
  v_cvt_pk_bf16_f32 v68, v96, v97
  v_cvt_pk_bf16_f32 v69, v98, v99
  v_mfma_f32_32x32x16_bf16 v[120:135], v[48:51], v[64:67], v[120:135]
  v_exp_f32 v100, v100
  v_exp_f32 v101, v101
  v_exp_f32_e64 v102, v102
  v_exp_f32 v103, v103
  v_cvt_pk_bf16_f32 v70, v100, v101
  v_cvt_pk_bf16_f32 v71, v102, v103
  s_mov_b32 m0, s44
  v_mfma_f32_32x32x16_bf16 v[88:103], v[36:39], v[20:23], 0
  buffer_load_dwordx4 v235, s[16:19], s47 offen offset:3584 lds
  buffer_load_dwordx2 v[164:165], v136, s[48:51], s78 offen offset:128
  v_exp_f32 v72, v72
  v_exp_f32 v73, v73
  v_exp_f32 v74, v74
  v_exp_f32 v75, v75
  v_cvt_pk_bf16_f32 v64, v72, v73
  v_cvt_pk_bf16_f32 v65, v74, v75
  v_mfma_f32_32x32x16_bf16 v[120:135], v[52:55], v[68:71], v[120:135]
  ds_read_b64_tr_b16 v[36:37], v140 offset:2112
  v_exp_f32 v76, v76
  v_exp_f32 v77, v77
  v_exp_f32 v78, v78
  v_exp_f32 v79, v79
  v_cvt_pk_bf16_f32 v66, v76, v77
  v_cvt_pk_bf16_f32 v67, v78, v79
  v_mfma_f32_32x32x8bf16_1k v[88:103], v[42:43], v[26:27], v[88:103]
  s_waitcnt lgkmcnt(1)
  ds_read_b64_tr_b16 v[38:39], v140 offset:18752
  v_exp_f32 v80, v80
  v_exp_f32 v81, v81
  v_exp_f32 v82, v82
  v_exp_f32_e64 v83, v83
  v_cvt_pk_bf16_f32 v68, v80, v81
  v_cvt_pk_bf16_f32 v69, v82, v83
  v_mfma_f32_32x32x16_bf16 v[104:119], v[56:59], v[64:67], v[104:119]
  ds_read_b64_tr_b16 v[42:43], v141 offset:2112
  v_exp_f32 v84, v84
  v_exp_f32 v85, v85
  v_exp_f32 v86, v86
  v_exp_f32 v87, v87
  v_cvt_pk_bf16_f32 v70, v84, v85
  v_cvt_pk_bf16_f32 v71, v86, v87
  v_mfma_f32_32x32x16_bf16 v[72:87], v[32:35], v[16:19], 0
  ds_read_b128 v[48:51], v142 offset:2048
  v_exp_f32 v88, v88
  v_exp_f32 v89, v89
  v_exp_f32 v90, v90
  v_exp_f32 v91, v91
  v_cvt_pk_bf16_f32 v64, v88, v89
  v_cvt_pk_bf16_f32 v65, v90, v91
  v_mfma_f32_32x32x16_bf16 v[104:119], v[60:63], v[68:71], v[104:119]
  ds_read_b128 v[52:55], v142 offset:2080
  v_exp_f32 v92, v92
  v_exp_f32 v93, v93
  v_exp_f32 v94, v94
  v_exp_f32 v95, v95
  v_cvt_pk_bf16_f32 v66, v92, v93
  v_cvt_pk_bf16_f32 v67, v94, v95
  v_mfma_f32_32x32x8bf16_1k v[72:87], v[40:41], v[24:25], v[72:87]
  v_exp_f32 v96, v96
  v_exp_f32 v97, v97
  v_exp_f32 v98, v98
  v_exp_f32 v99, v99
  v_cvt_pk_bf16_f32 v68, v96, v97
  v_cvt_pk_bf16_f32 v69, v98, v99
  v_mfma_f32_32x32x16_bf16 v[120:135], v[56:59], v[64:67], v[120:135]
  v_exp_f32 v100, v100
  v_exp_f32 v101, v101
  v_exp_f32 v102, v102
  v_exp_f32 v103, v103
  v_cvt_pk_bf16_f32 v70, v100, v101
  v_cvt_pk_bf16_f32 v71, v102, v103
  v_mfma_f32_32x32x16_bf16 v[88:103], v[32:35], v[20:23], 0
  v_exp_f32 v72, v72
  v_exp_f32 v73, v73
  v_exp_f32 v74, v74
  v_exp_f32 v75, v75
  v_cvt_pk_bf16_f32 v64, v72, v73
  v_cvt_pk_bf16_f32 v65, v74, v75
  v_mfma_f32_32x32x16_bf16 v[120:135], v[60:63], v[68:71], v[120:135]
  ds_read_b64_tr_b16 v[32:33], v140 offset:2176
  v_exp_f32 v76, v76
  v_exp_f32 v77, v77
  v_exp_f32 v78, v78
  v_exp_f32 v79, v79
  v_cvt_pk_bf16_f32 v66, v76, v77
  v_cvt_pk_bf16_f32 v67, v78, v79
  v_mfma_f32_32x32x8bf16_1k v[88:103], v[40:41], v[26:27], v[88:103]
  s_waitcnt lgkmcnt(1)
  ds_read_b64_tr_b16 v[34:35], v140 offset:18816
  v_exp_f32 v80, v80
  v_exp_f32 v81, v81
  v_exp_f32 v82, v82
  v_exp_f32_e64 v83, v83
  v_cvt_pk_bf16_f32 v68, v80, v81
  v_cvt_pk_bf16_f32 v69, v82, v83
  v_mfma_f32_32x32x16_bf16 v[104:119], v[48:51], v[64:67], v[104:119]
  ds_read_b64_tr_b16 v[40:41], v141 offset:2176
  v_exp_f32 v84, v84
  v_exp_f32 v85, v85
  v_exp_f32 v86, v86
  v_exp_f32 v87, v87
  v_cvt_pk_bf16_f32 v70, v84, v85
  v_cvt_pk_bf16_f32 v71, v86, v87
  v_mfma_f32_32x32x16_bf16 v[72:87], v[36:39], v[16:19], 0
  ds_read_b128 v[56:59], v142 offset:2112
  v_exp_f32 v88, v88
  v_exp_f32 v89, v89
  v_exp_f32 v90, v90
  v_exp_f32 v91, v91
  v_cvt_pk_bf16_f32 v64, v88, v89
  v_cvt_pk_bf16_f32 v65, v90, v91
  v_mfma_f32_32x32x16_bf16 v[104:119], v[52:55], v[68:71], v[104:119]
  ds_read_b128 v[60:63], v142 offset:2144
  v_exp_f32 v92, v92
  v_exp_f32 v93, v93
  v_exp_f32 v94, v94
  v_exp_f32 v95, v95
  v_cvt_pk_bf16_f32 v66, v92, v93
  v_cvt_pk_bf16_f32 v67, v94, v95
  v_mfma_f32_32x32x8bf16_1k v[72:87], v[42:43], v[24:25], v[72:87]
  v_exp_f32 v96, v96
  v_exp_f32 v97, v97
  v_exp_f32 v98, v98
  v_exp_f32 v99, v99
  v_cvt_pk_bf16_f32 v68, v96, v97
  v_cvt_pk_bf16_f32 v69, v98, v99
  v_mfma_f32_32x32x16_bf16 v[120:135], v[48:51], v[64:67], v[120:135]
  v_exp_f32 v100, v100
  v_exp_f32 v101, v101
  v_exp_f32 v102, v102
  v_exp_f32 v103, v103
  v_cvt_pk_bf16_f32 v70, v100, v101
  v_cvt_pk_bf16_f32 v71, v102, v103
  v_mfma_f32_32x32x16_bf16 v[88:103], v[36:39], v[20:23], 0
  buffer_load_dwordx2 v[146:147], v136, s[48:51], s77 offen offset:32
  buffer_load_dwordx2 v[152:153], v136, s[48:51], s77 offen offset:64
  buffer_load_dwordx2 v[154:155], v136, s[48:51], s77 offen offset:96
  v_exp_f32 v72, v72
  v_exp_f32 v73, v73
  v_exp_f32 v74, v74
  v_exp_f32 v75, v75
  v_cvt_pk_bf16_f32 v64, v72, v73
  v_cvt_pk_bf16_f32 v65, v74, v75
  v_mfma_f32_32x32x16_bf16 v[120:135], v[52:55], v[68:71], v[120:135]
  ds_read_b64_tr_b16 v[36:37], v140 offset:2240
  v_exp_f32 v76, v76
  v_exp_f32 v77, v77
  v_exp_f32 v78, v78
  v_exp_f32 v79, v79
  v_cvt_pk_bf16_f32 v66, v76, v77
  v_cvt_pk_bf16_f32 v67, v78, v79
  v_mfma_f32_32x32x8bf16_1k v[88:103], v[42:43], v[26:27], v[88:103]
  s_waitcnt lgkmcnt(1)
  ds_read_b64_tr_b16 v[38:39], v140 offset:18880
  v_exp_f32 v80, v80
  v_exp_f32 v81, v81
  v_exp_f32 v82, v82
  v_exp_f32_e64 v83, v83
  v_cvt_pk_bf16_f32 v68, v80, v81
  v_cvt_pk_bf16_f32 v69, v82, v83
  v_mfma_f32_32x32x16_bf16 v[104:119], v[56:59], v[64:67], v[104:119]
  ds_read_b64_tr_b16 v[42:43], v141 offset:2240
  v_exp_f32 v84, v84
  v_exp_f32 v85, v85
  v_exp_f32 v86, v86
  v_exp_f32 v87, v87
  v_cvt_pk_bf16_f32 v70, v84, v85
  v_cvt_pk_bf16_f32 v71, v86, v87
  v_mfma_f32_32x32x16_bf16 v[72:87], v[32:35], v[16:19], 0
  ds_read_b128 v[48:51], v142 offset:2176
  v_exp_f32 v88, v88
  v_exp_f32 v89, v89
  v_exp_f32 v90, v90
  v_exp_f32 v91, v91
  v_cvt_pk_bf16_f32 v64, v88, v89
  v_cvt_pk_bf16_f32 v65, v90, v91
  v_mfma_f32_32x32x16_bf16 v[104:119], v[60:63], v[68:71], v[104:119]
  ds_read_b128 v[52:55], v142 offset:2208
  v_exp_f32 v92, v92
  v_exp_f32 v93, v93
  v_exp_f32 v94, v94
  v_exp_f32 v95, v95
  v_cvt_pk_bf16_f32 v66, v92, v93
  v_cvt_pk_bf16_f32 v67, v94, v95
  v_mfma_f32_32x32x8bf16_1k v[72:87], v[40:41], v[24:25], v[72:87]
  v_exp_f32 v96, v96
  v_exp_f32 v97, v97
  v_exp_f32 v98, v98
  v_exp_f32 v99, v99
  v_cvt_pk_bf16_f32 v68, v96, v97
  v_cvt_pk_bf16_f32 v69, v98, v99
  v_mfma_f32_32x32x16_bf16 v[120:135], v[56:59], v[64:67], v[120:135]
  v_exp_f32 v100, v100
  v_exp_f32 v101, v101
  v_exp_f32 v102, v102
  v_exp_f32 v103, v103
  v_cvt_pk_bf16_f32 v70, v100, v101
  v_cvt_pk_bf16_f32 v71, v102, v103
  v_mfma_f32_32x32x16_bf16 v[88:103], v[32:35], v[20:23], 0
  v_exp_f32 v72, v72
  v_exp_f32 v73, v73
  v_exp_f32 v74, v74
  v_exp_f32 v75, v75
  v_cvt_pk_bf16_f32 v64, v72, v73
  v_cvt_pk_bf16_f32 v65, v74, v75
  v_mfma_f32_32x32x16_bf16 v[120:135], v[60:63], v[68:71], v[120:135]
  ds_read_b64_tr_b16 v[32:33], v140 offset:2304
  v_exp_f32 v76, v76
  v_exp_f32 v77, v77
  v_exp_f32 v78, v78
  v_exp_f32 v79, v79
  v_cvt_pk_bf16_f32 v66, v76, v77
  v_cvt_pk_bf16_f32 v67, v78, v79
  v_mfma_f32_32x32x8bf16_1k v[88:103], v[40:41], v[26:27], v[88:103]
  s_waitcnt lgkmcnt(1)
  ds_read_b64_tr_b16 v[34:35], v140 offset:18944
  v_exp_f32 v80, v80
  v_exp_f32 v81, v81
  v_exp_f32 v82, v82
  v_exp_f32_e64 v83, v83
  v_cvt_pk_bf16_f32 v68, v80, v81
  v_cvt_pk_bf16_f32 v69, v82, v83
  v_mfma_f32_32x32x16_bf16 v[104:119], v[48:51], v[64:67], v[104:119]
  ds_read_b64_tr_b16 v[40:41], v141 offset:2304
  v_exp_f32 v84, v84
  v_exp_f32 v85, v85
  v_exp_f32_e64 v86, v86
  v_exp_f32 v87, v87
  v_cvt_pk_bf16_f32 v70, v84, v85
  v_cvt_pk_bf16_f32 v71, v86, v87
  s_getpc_b64 s[94:95]
  v_mfma_f32_32x32x16_bf16 v[72:87], v[36:39], v[16:19], 0
  buffer_load_dwordx2 v[150:151], v136, s[48:51], s78 offen offset:32
  buffer_load_dwordx2 v[156:157], v136, s[48:51], s78 offen offset:64
  buffer_load_dwordx2 v[158:159], v136, s[48:51], s78 offen offset:96
  global_load_dword v231, v230, s[94:95]
  ds_read_b128 v[56:59], v142 offset:2240
  v_exp_f32 v88, v88
  v_exp_f32 v89, v89
  v_exp_f32 v90, v90
  v_exp_f32 v91, v91
  v_cvt_pk_bf16_f32 v64, v88, v89
  v_cvt_pk_bf16_f32 v65, v90, v91
  v_mfma_f32_32x32x16_bf16 v[104:119], v[52:55], v[68:71], v[104:119]
  ds_read_b128 v[60:63], v142 offset:2272
  v_exp_f32 v92, v92
  v_exp_f32 v93, v93
  v_exp_f32 v94, v94
  v_exp_f32 v95, v95
  v_cvt_pk_bf16_f32 v66, v92, v93
  v_cvt_pk_bf16_f32 v67, v94, v95
  v_mfma_f32_32x32x8bf16_1k v[72:87], v[42:43], v[24:25], v[72:87]
  v_exp_f32 v96, v96
  v_exp_f32 v97, v97
  v_exp_f32 v98, v98
  v_exp_f32 v99, v99
  v_cvt_pk_bf16_f32 v68, v96, v97
  v_cvt_pk_bf16_f32 v69, v98, v99
  v_mfma_f32_32x32x16_bf16 v[120:135], v[48:51], v[64:67], v[120:135]
  v_exp_f32 v100, v100
  v_exp_f32 v101, v101
  v_exp_f32 v102, v102
  v_exp_f32 v103, v103
  v_cvt_pk_bf16_f32 v70, v100, v101
  v_cvt_pk_bf16_f32 v71, v102, v103
  v_mfma_f32_32x32x16_bf16 v[88:103], v[36:39], v[20:23], 0
  v_exp_f32 v72, v72
  v_exp_f32 v73, v73
  v_exp_f32 v74, v74
  v_exp_f32 v75, v75
  v_cvt_pk_bf16_f32 v64, v72, v73
  v_cvt_pk_bf16_f32 v65, v74, v75
  v_mfma_f32_32x32x16_bf16 v[120:135], v[52:55], v[68:71], v[120:135]
  ds_read_b64_tr_b16 v[36:37], v140 offset:2368
  v_exp_f32 v76, v76
  v_exp_f32 v77, v77
  v_exp_f32 v78, v78
  v_exp_f32 v79, v79
  v_cvt_pk_bf16_f32 v66, v76, v77
  v_cvt_pk_bf16_f32 v67, v78, v79
  v_mfma_f32_32x32x8bf16_1k v[88:103], v[42:43], v[26:27], v[88:103]
  s_waitcnt lgkmcnt(1)
  ds_read_b64_tr_b16 v[38:39], v140 offset:19008
  v_exp_f32 v80, v80
  v_exp_f32 v81, v81
  v_exp_f32 v82, v82
  v_exp_f32_e64 v83, v83
  v_cvt_pk_bf16_f32 v68, v80, v81
  v_cvt_pk_bf16_f32 v69, v82, v83
  v_mfma_f32_32x32x16_bf16 v[104:119], v[56:59], v[64:67], v[104:119]
  ds_read_b64_tr_b16 v[42:43], v141 offset:2368
  v_exp_f32 v84, v84
  v_exp_f32 v85, v85
  v_exp_f32 v86, v86
  v_exp_f32 v87, v87
  v_cvt_pk_bf16_f32 v70, v84, v85
  v_cvt_pk_bf16_f32 v71, v86, v87
  v_mfma_f32_32x32x16_bf16 v[72:87], v[32:35], v[16:19], 0
  s_waitcnt vmcnt(8)
  ds_read_b128 v[48:51], v142 offset:2304
  v_exp_f32 v88, v88
  v_exp_f32 v89, v89
  v_exp_f32 v90, v90
  v_exp_f32_e64 v91, v91
  v_cvt_pk_bf16_f32 v64, v88, v89
  v_cvt_pk_bf16_f32 v65, v90, v91
  v_mfma_f32_32x32x16_bf16 v[104:119], v[60:63], v[68:71], v[104:119]
  s_barrier
  ds_read_b128 v[52:55], v142 offset:2336
  v_exp_f32 v92, v92
  v_exp_f32 v93, v93
  v_exp_f32 v94, v94
  v_exp_f32_e64 v95, v95
  v_cvt_pk_bf16_f32 v66, v92, v93
  v_cvt_pk_bf16_f32 v67, v94, v95
  v_mfma_f32_32x32x8bf16_1k v[72:87], v[40:41], v[24:25], v[72:87]
  ds_read_b64_tr_b16 a[0:1], v252 offset:0
  ds_read_b64_tr_b16 a[2:3], v253 offset:0
  v_exp_f32 v96, v96
  v_exp_f32 v97, v97
  v_exp_f32 v98, v98
  v_exp_f32 v99, v99
  v_cvt_pk_bf16_f32 v68, v96, v97
  v_cvt_pk_bf16_f32 v69, v98, v99
  v_mfma_f32_32x32x16_bf16 v[120:135], v[56:59], v[64:67], v[120:135]
  ds_read_b64_tr_b16 a[4:5], v252 offset:4160
  ds_read_b64_tr_b16 a[6:7], v253 offset:4112
  v_exp_f32 v100, v100
  v_exp_f32 v101, v101
  v_exp_f32 v102, v102
  v_exp_f32 v103, v103
  v_cvt_pk_bf16_f32 v70, v100, v101
  v_cvt_pk_bf16_f32 v71, v102, v103
  v_mfma_f32_32x32x16_bf16 v[88:103], v[32:35], v[20:23], 0
  ds_read_b64_tr_b16 a[8:9], v252 offset:8320
  ds_read_b64_tr_b16 a[10:11], v253 offset:8224
  v_exp_f32 v72, v72
  v_exp_f32 v73, v73
  v_exp_f32 v74, v74
  v_exp_f32 v75, v75
  v_cvt_pk_bf16_f32 v64, v72, v73
  v_cvt_pk_bf16_f32 v65, v74, v75
  v_mfma_f32_32x32x16_bf16 v[120:135], v[60:63], v[68:71], v[120:135]
  ds_read_b64_tr_b16 v[32:33], v140 offset:2432
  v_exp_f32 v76, v76
  v_exp_f32 v77, v77
  v_exp_f32 v78, v78
  v_exp_f32 v79, v79
  v_cvt_pk_bf16_f32 v66, v76, v77
  v_cvt_pk_bf16_f32 v67, v78, v79
  v_mfma_f32_32x32x8bf16_1k v[88:103], v[40:41], v[26:27], v[88:103]
  s_waitcnt lgkmcnt(1)
  ds_read_b64_tr_b16 v[34:35], v140 offset:19072
  v_exp_f32 v80, v80
  v_exp_f32 v81, v81
  v_exp_f32 v82, v82
  v_exp_f32_e64 v83, v83
  v_cvt_pk_bf16_f32 v68, v80, v81
  v_cvt_pk_bf16_f32 v69, v82, v83
  v_mfma_f32_32x32x16_bf16 v[104:119], v[48:51], v[64:67], v[104:119]
  ds_read_b64_tr_b16 v[40:41], v141 offset:2432
  v_exp_f32 v84, v84
  v_exp_f32 v85, v85
  v_exp_f32 v86, v86
  v_exp_f32 v87, v87
  v_cvt_pk_bf16_f32 v70, v84, v85
  v_cvt_pk_bf16_f32 v71, v86, v87
  v_mfma_f32_32x32x16_bf16 v[72:87], v[36:39], v[16:19], 0
  ds_read_b128 v[56:59], v142 offset:2368
  v_exp_f32 v88, v88
  v_exp_f32 v89, v89
  v_exp_f32 v90, v90
  v_exp_f32 v91, v91
  v_cvt_pk_bf16_f32 v64, v88, v89
  v_cvt_pk_bf16_f32 v65, v90, v91
  v_mfma_f32_32x32x16_bf16 v[104:119], v[52:55], v[68:71], v[104:119]
  ds_read_b128 v[60:63], v142 offset:2400
  v_exp_f32 v92, v92
  v_exp_f32 v93, v93
  v_exp_f32 v94, v94
  v_exp_f32 v95, v95
  v_cvt_pk_bf16_f32 v66, v92, v93
  v_cvt_pk_bf16_f32 v67, v94, v95
  v_mfma_f32_32x32x8bf16_1k v[72:87], v[42:43], v[24:25], v[72:87]
  ds_read_b64_tr_b16 a[12:13], v252 offset:12480
  ds_read_b64_tr_b16 a[14:15], v253 offset:12336
  v_exp_f32 v96, v96
  v_exp_f32 v97, v97
  v_exp_f32 v98, v98
  v_exp_f32 v99, v99
  v_cvt_pk_bf16_f32 v68, v96, v97
  v_cvt_pk_bf16_f32 v69, v98, v99
  v_mfma_f32_32x32x16_bf16 v[120:135], v[48:51], v[64:67], v[120:135]
  ds_read_b64_tr_b16 a[16:17], v252 offset:16640
  ds_read_b64_tr_b16 a[18:19], v253 offset:16448
  v_exp_f32 v100, v100
  v_exp_f32 v101, v101
  v_exp_f32 v102, v102
  v_exp_f32 v103, v103
  v_cvt_pk_bf16_f32 v70, v100, v101
  v_cvt_pk_bf16_f32 v71, v102, v103
  v_mfma_f32_32x32x16_bf16 v[88:103], v[36:39], v[20:23], 0
  s_waitcnt vmcnt(6)
  ds_read_b64_tr_b16 a[20:21], v252 offset:20800
  ds_read_b64_tr_b16 a[22:23], v253 offset:20560
  v_exp_f32 v72, v72
  v_exp_f32 v73, v73
  v_exp_f32 v74, v74
  v_exp_f32 v75, v75
  v_cvt_pk_bf16_f32 v64, v72, v73
  v_cvt_pk_bf16_f32 v65, v74, v75
  s_waitcnt vmcnt(4)
  v_mfma_f32_32x32x16_bf16 v[120:135], v[52:55], v[68:71], v[120:135]
  buffer_store_dwordx4 v[144:147], v2, s[56:59], s70 offen offset:0 sc0 sc1
  buffer_store_dwordx4 v[152:155], v2, s[56:59], s70 offen offset:2048 sc0 sc1
  ds_read_b64_tr_b16 v[36:37], v140 offset:2496
  v_exp_f32 v76, v76
  v_exp_f32 v77, v77
  v_exp_f32 v78, v78
  v_exp_f32 v79, v79
  v_cvt_pk_bf16_f32 v66, v76, v77
  v_cvt_pk_bf16_f32 v67, v78, v79
  v_mfma_f32_32x32x8bf16_1k v[88:103], v[42:43], v[26:27], v[88:103]
  s_waitcnt lgkmcnt(1)
  ds_read_b64_tr_b16 v[38:39], v140 offset:19136
  v_exp_f32 v80, v80
  v_exp_f32 v81, v81
  v_exp_f32 v82, v82
  v_exp_f32_e64 v83, v83
  v_cvt_pk_bf16_f32 v68, v80, v81
  v_cvt_pk_bf16_f32 v69, v82, v83
  v_mfma_f32_32x32x16_bf16 v[104:119], v[56:59], v[64:67], v[104:119]
  ds_read_b64_tr_b16 v[42:43], v141 offset:2496
  v_exp_f32 v84, v84
  v_exp_f32 v85, v85
  v_exp_f32 v86, v86
  v_exp_f32 v87, v87
  v_mfma_f32_16x16x32_bf16 a[24:27], a[28:31], a[0:3], 0
  v_cvt_pk_bf16_f32 v70, v84, v85
  v_cvt_pk_bf16_f32 v71, v86, v87
  v_mfma_f32_32x32x16_bf16 v[72:87], v[32:35], v[16:19], 0
  ds_read_b128 v[48:51], v142 offset:2432
  v_exp_f32 v88, v88
  v_exp_f32 v89, v89
  v_exp_f32 v90, v90
  v_exp_f32 v91, v91
  v_cvt_pk_bf16_f32 v64, v88, v89
  v_cvt_pk_bf16_f32 v65, v90, v91
  v_mfma_f32_32x32x16_bf16 v[104:119], v[60:63], v[68:71], v[104:119]
  ds_read_b128 v[52:55], v142 offset:2464
  v_exp_f32 v92, v92
  v_exp_f32 v93, v93
  v_exp_f32 v94, v94
  v_exp_f32 v95, v95
  v_mfma_f32_16x16x32_bf16 a[24:27], a[28:31], a[4:7], a[24:27]
  v_cvt_pk_bf16_f32 v66, v92, v93
  v_cvt_pk_bf16_f32 v67, v94, v95
  v_mfma_f32_32x32x8bf16_1k v[72:87], v[40:41], v[24:25], v[72:87]
  v_exp_f32 v96, v96
  v_exp_f32 v97, v97
  v_exp_f32 v98, v98
  v_exp_f32 v99, v99
  v_cvt_pk_bf16_f32 v68, v96, v97
  v_cvt_pk_bf16_f32 v69, v98, v99
  v_mfma_f32_32x32x16_bf16 v[120:135], v[56:59], v[64:67], v[120:135]
  v_exp_f32 v100, v100
  v_exp_f32 v101, v101
  v_exp_f32 v102, v102
  v_exp_f32 v103, v103
  v_mfma_f32_16x16x32_bf16 a[24:27], a[28:31], a[8:11], a[24:27]
  v_cvt_pk_bf16_f32 v70, v100, v101
  v_cvt_pk_bf16_f32 v71, v102, v103
  v_mfma_f32_32x32x16_bf16 v[88:103], v[32:35], v[20:23], 0
  buffer_load_dwordx2 v[162:163], v136, s[48:51], s77 offen offset:160
  buffer_load_dwordx2 v[168:169], v136, s[48:51], s77 offen offset:192
  buffer_load_dwordx2 v[170:171], v136, s[48:51], s77 offen offset:224
  buffer_store_dwordx4 a[0:3], v249, s[60:63], 0 offen offset:0 sc0 sc1
  v_exp_f32 v72, v72
  v_exp_f32 v73, v73
  v_exp_f32 v74, v74
  v_exp_f32 v75, v75
  v_cvt_pk_bf16_f32 v64, v72, v73
  v_cvt_pk_bf16_f32 v65, v74, v75
  v_mfma_f32_32x32x16_bf16 v[120:135], v[60:63], v[68:71], v[120:135]
  ds_read_b64_tr_b16 v[32:33], v140 offset:2560
  v_exp_f32 v76, v76
  v_exp_f32 v77, v77
  v_exp_f32 v78, v78
  v_exp_f32 v79, v79
  v_mfma_f32_16x16x32_bf16 a[24:27], a[28:31], a[12:15], a[24:27]
  v_cvt_pk_bf16_f32 v66, v76, v77
  v_cvt_pk_bf16_f32 v67, v78, v79
  v_mfma_f32_32x32x8bf16_1k v[88:103], v[40:41], v[26:27], v[88:103]
  s_waitcnt lgkmcnt(1)
  ds_read_b64_tr_b16 v[34:35], v140 offset:19200
  v_exp_f32 v80, v80
  v_exp_f32 v81, v81
  v_exp_f32 v82, v82
  v_exp_f32_e64 v83, v83
  v_cvt_pk_bf16_f32 v68, v80, v81
  v_cvt_pk_bf16_f32 v69, v82, v83
  v_mfma_f32_32x32x16_bf16 v[104:119], v[48:51], v[64:67], v[104:119]
  buffer_store_dwordx4 a[12:15], v249, s[60:63], s86 offen offset:3072 sc0 sc1
  buffer_store_dwordx4 a[16:19], v249, s[60:63], s87 offen offset:0 sc0 sc1
  ds_read_b64_tr_b16 v[40:41], v141 offset:2560
  v_exp_f32 v84, v84
  v_exp_f32 v85, v85
  v_exp_f32 v86, v86
  v_exp_f32 v87, v87
  v_mfma_f32_16x16x32_bf16 a[24:27], a[28:31], a[16:19], a[24:27]
  v_cvt_pk_bf16_f32 v70, v84, v85
  v_cvt_pk_bf16_f32 v71, v86, v87
  v_mfma_f32_32x32x16_bf16 v[72:87], v[36:39], v[16:19], 0
  ds_read_b128 v[56:59], v142 offset:2496
  v_exp_f32 v88, v88
  v_exp_f32 v89, v89
  v_exp_f32 v90, v90
  v_exp_f32 v91, v91
  v_cvt_pk_bf16_f32 v64, v88, v89
  v_cvt_pk_bf16_f32 v65, v90, v91
  v_mfma_f32_32x32x16_bf16 v[104:119], v[52:55], v[68:71], v[104:119]
  ds_read_b128 v[60:63], v142 offset:2528
  v_exp_f32 v92, v92
  v_exp_f32 v93, v93
  v_exp_f32 v94, v94
  v_exp_f32 v95, v95
  v_mfma_f32_16x16x32_bf16 a[24:27], a[28:31], a[20:23], a[24:27]
  v_cvt_pk_bf16_f32 v66, v92, v93
  v_cvt_pk_bf16_f32 v67, v94, v95
  v_mfma_f32_32x32x8bf16_1k v[72:87], v[42:43], v[24:25], v[72:87]
  v_exp_f32 v96, v96
  v_exp_f32 v97, v97
  v_exp_f32 v98, v98
  v_exp_f32 v99, v99
  v_cvt_pk_bf16_f32 v68, v96, v97
  v_cvt_pk_bf16_f32 v69, v98, v99
  v_mfma_f32_32x32x16_bf16 v[120:135], v[48:51], v[64:67], v[120:135]
  v_exp_f32 v100, v100
  v_exp_f32 v101, v101
  v_exp_f32 v102, v102
  v_exp_f32 v103, v103
  v_cvt_pk_bf16_f32 v70, v100, v101
  v_cvt_pk_bf16_f32 v71, v102, v103
  v_mfma_f32_32x32x16_bf16 v[88:103], v[36:39], v[20:23], 0
  v_exp_f32 v72, v72
  v_exp_f32 v73, v73
  v_exp_f32_e64 v74, v74
  v_exp_f32 v75, v75
  v_cvt_pk_bf16_f32 v64, v72, v73
  v_cvt_pk_bf16_f32 v65, v74, v75
  s_waitcnt vmcnt(11)
  v_mfma_f32_32x32x16_bf16 v[120:135], v[52:55], v[68:71], v[120:135]
  buffer_store_dwordx4 a[20:23], v249, s[60:63], s87 offen offset:3072 sc0 sc1
  buffer_store_dwordx4 v[148:151], v2, s[56:59], s70 offen offset:1024 sc0 sc1
  ds_read_b64_tr_b16 v[36:37], v140 offset:2624
  v_exp_f32 v76, v76
  v_exp_f32 v77, v77
  v_exp_f32 v78, v78
  v_exp_f32 v79, v79
  v_cvt_pk_bf16_f32 v66, v76, v77
  v_cvt_pk_bf16_f32 v67, v78, v79
  v_mfma_f32_32x32x8bf16_1k v[88:103], v[42:43], v[26:27], v[88:103]
  s_waitcnt lgkmcnt(1)
  ds_read_b64_tr_b16 v[38:39], v140 offset:19264
  v_exp_f32 v80, v80
  v_exp_f32 v81, v81
  v_exp_f32 v82, v82
  v_exp_f32_e64 v83, v83
  v_cvt_pk_bf16_f32 v68, v80, v81
  v_cvt_pk_bf16_f32 v69, v82, v83
  v_mfma_f32_32x32x16_bf16 v[104:119], v[56:59], v[64:67], v[104:119]
  ds_read_b64_tr_b16 v[42:43], v141 offset:2624
  v_exp_f32 v84, v84
  v_exp_f32 v85, v85
  v_exp_f32 v86, v86
  v_exp_f32 v87, v87
  v_cvt_pk_bf16_f32 v70, v84, v85
  v_cvt_pk_bf16_f32 v71, v86, v87
  v_mfma_f32_32x32x16_bf16 v[72:87], v[32:35], v[16:19], 0
  ds_read_b128 v[48:51], v142 offset:2560
  v_exp_f32 v88, v88
  v_exp_f32 v89, v89
  v_exp_f32 v90, v90
  v_exp_f32 v91, v91
  v_cvt_pk_bf16_f32 v64, v88, v89
  v_cvt_pk_bf16_f32 v65, v90, v91
  v_mfma_f32_32x32x16_bf16 v[104:119], v[60:63], v[68:71], v[104:119]
  ds_read_b128 v[52:55], v142 offset:2592
  v_exp_f32 v92, v92
  v_exp_f32 v93, v93
  v_exp_f32 v94, v94
  v_exp_f32 v95, v95
  v_cvt_pk_bf16_f32 v66, v92, v93
  v_cvt_pk_bf16_f32 v67, v94, v95
  v_mfma_f32_32x32x8bf16_1k v[72:87], v[40:41], v[24:25], v[72:87]
  v_exp_f32 v96, v96
  v_exp_f32 v97, v97
  v_exp_f32 v98, v98
  v_exp_f32 v99, v99
  v_cvt_pk_bf16_f32 v68, v96, v97
  v_cvt_pk_bf16_f32 v69, v98, v99
  v_mfma_f32_32x32x16_bf16 v[120:135], v[56:59], v[64:67], v[120:135]
  v_exp_f32 v100, v100
  v_exp_f32 v101, v101
  v_exp_f32 v102, v102
  v_exp_f32 v103, v103
  v_cvt_pk_bf16_f32 v70, v100, v101
  v_cvt_pk_bf16_f32 v71, v102, v103
  v_mfma_f32_32x32x16_bf16 v[88:103], v[32:35], v[20:23], 0
  buffer_load_dwordx2 v[166:167], v136, s[48:51], s78 offen offset:160
  buffer_load_dwordx2 v[172:173], v136, s[48:51], s78 offen offset:192
  buffer_load_dwordx2 v[174:175], v136, s[48:51], s78 offen offset:224
  buffer_store_dwordx4 a[4:7], v249, s[60:63], 0 offen offset:3072 sc0 sc1
  v_exp_f32 v72, v72
  v_exp_f32 v73, v73
  v_exp_f32 v74, v74
  v_exp_f32 v75, v75
  v_cvt_pk_bf16_f32 v64, v72, v73
  v_cvt_pk_bf16_f32 v65, v74, v75
  v_mfma_f32_32x32x16_bf16 v[120:135], v[60:63], v[68:71], v[120:135]
  ds_read_b64_tr_b16 v[32:33], v140 offset:2688
  v_exp_f32 v76, v76
  v_exp_f32 v77, v77
L_pg_8:
  s_cbranch_execz L_wr_1
  v_exp_f32_e64 v78, v78
  v_exp_f32 v79, v79
  v_cvt_pk_bf16_f32 v66, v76, v77
  v_cvt_pk_bf16_f32 v67, v78, v79
  v_mfma_f32_32x32x8bf16_1k v[88:103], v[40:41], v[26:27], v[88:103]
  s_waitcnt lgkmcnt(1)
  ds_read_b64_tr_b16 v[34:35], v140 offset:19328
  v_exp_f32 v80, v80
  v_exp_f32 v81, v81
  v_exp_f32 v82, v82
  v_exp_f32 v83, v83
  v_cvt_pk_bf16_f32 v68, v80, v81
  v_cvt_pk_bf16_f32 v69, v82, v83
  s_waitcnt vmcnt(15)
  v_mfma_f32_32x32x16_bf16 v[104:119], v[48:51], v[64:67], v[104:119]
  buffer_store_dwordx4 v[156:159], v2, s[56:59], s70 offen offset:3072 sc0 sc1
  buffer_store_dword a24, v250, s[60:63], 0 offen sc0 sc1
  ds_read_b64_tr_b16 v[40:41], v141 offset:2688
  v_exp_f32 v84, v84
  v_exp_f32 v85, v85
  v_exp_f32 v86, v86
  v_exp_f32 v87, v87
  v_cvt_pk_bf16_f32 v70, v84, v85
  v_cvt_pk_bf16_f32 v71, v86, v87
  v_mfma_f32_32x32x16_bf16 v[72:87], v[36:39], v[16:19], 0
  ds_read_b128 v[56:59], v142 offset:2624
  v_exp_f32 v88, v88
  v_exp_f32 v89, v89
  v_exp_f32 v90, v90
  v_exp_f32 v91, v91
  v_cvt_pk_bf16_f32 v64, v88, v89
  v_cvt_pk_bf16_f32 v65, v90, v91
  v_mfma_f32_32x32x16_bf16 v[104:119], v[52:55], v[68:71], v[104:119]
  ds_read_b128 v[60:63], v142 offset:2656
  v_exp_f32 v92, v92
  v_exp_f32 v93, v93
  v_exp_f32 v94, v94
  v_exp_f32 v95, v95
  v_cvt_pk_bf16_f32 v66, v92, v93
  v_cvt_pk_bf16_f32 v67, v94, v95
  v_mfma_f32_32x32x8bf16_1k v[72:87], v[42:43], v[24:25], v[72:87]
  v_exp_f32 v96, v96
  v_exp_f32 v97, v97
  v_exp_f32 v98, v98
  v_exp_f32 v99, v99
  v_cvt_pk_bf16_f32 v68, v96, v97
  v_cvt_pk_bf16_f32 v69, v98, v99
  v_mfma_f32_32x32x16_bf16 v[120:135], v[48:51], v[64:67], v[120:135]
  v_exp_f32 v100, v100
  v_exp_f32 v101, v101
  v_exp_f32 v102, v102
  v_exp_f32 v103, v103
  v_cvt_pk_bf16_f32 v70, v100, v101
  v_cvt_pk_bf16_f32 v71, v102, v103
  v_mfma_f32_32x32x16_bf16 v[88:103], v[36:39], v[20:23], 0
  v_exp_f32 v72, v72
  v_exp_f32 v73, v73
  v_exp_f32 v74, v74
  v_exp_f32 v75, v75
  v_cvt_pk_bf16_f32 v64, v72, v73
  v_cvt_pk_bf16_f32 v65, v74, v75
  v_mfma_f32_32x32x16_bf16 v[120:135], v[52:55], v[68:71], v[120:135]
  ds_read_b64_tr_b16 v[36:37], v140 offset:2752
  v_exp_f32 v76, v76
  v_exp_f32 v77, v77
  v_exp_f32 v78, v78
  v_exp_f32 v79, v79
  v_cvt_pk_bf16_f32 v66, v76, v77
  v_cvt_pk_bf16_f32 v67, v78, v79
  v_mfma_f32_32x32x8bf16_1k v[88:103], v[42:43], v[26:27], v[88:103]
  s_waitcnt lgkmcnt(1)
  ds_read_b64_tr_b16 v[38:39], v140 offset:19392
  v_exp_f32 v80, v80
  v_exp_f32 v81, v81
  v_exp_f32 v82, v82
  v_exp_f32_e64 v83, v83
  v_cvt_pk_bf16_f32 v68, v80, v81
  v_cvt_pk_bf16_f32 v69, v82, v83
  v_mfma_f32_32x32x16_bf16 v[104:119], v[56:59], v[64:67], v[104:119]
  ds_read_b64_tr_b16 v[42:43], v141 offset:2752
  v_exp_f32 v84, v84
  v_exp_f32 v85, v85
  v_exp_f32 v86, v86
  v_exp_f32 v87, v87
  v_cvt_pk_bf16_f32 v70, v84, v85
  v_cvt_pk_bf16_f32 v71, v86, v87
  v_mfma_f32_32x32x16_bf16 v[72:87], v[32:35], v[16:19], 0
  ds_read_b128 v[48:51], v142 offset:2688
  v_exp_f32 v88, v88
  v_exp_f32 v89, v89
  v_exp_f32 v90, v90
  v_exp_f32 v91, v91
  v_cvt_pk_bf16_f32 v64, v88, v89
  v_cvt_pk_bf16_f32 v65, v90, v91
  v_mfma_f32_32x32x16_bf16 v[104:119], v[60:63], v[68:71], v[104:119]
  ds_read_b128 v[52:55], v142 offset:2720
  v_exp_f32 v92, v92
  v_exp_f32 v93, v93
  v_exp_f32 v94, v94
  v_exp_f32 v95, v95
  v_cvt_pk_bf16_f32 v66, v92, v93
  v_cvt_pk_bf16_f32 v67, v94, v95
  v_mfma_f32_32x32x8bf16_1k v[72:87], v[40:41], v[24:25], v[72:87]
  v_exp_f32 v96, v96
  v_exp_f32 v97, v97
  v_exp_f32 v98, v98
  v_exp_f32 v99, v99
  v_cvt_pk_bf16_f32 v68, v96, v97
  v_cvt_pk_bf16_f32 v69, v98, v99
  v_mfma_f32_32x32x16_bf16 v[120:135], v[56:59], v[64:67], v[120:135]
  v_exp_f32 v100, v100
  v_exp_f32 v101, v101
  v_exp_f32 v102, v102
  v_exp_f32 v103, v103
  v_cvt_pk_bf16_f32 v70, v100, v101
  v_cvt_pk_bf16_f32 v71, v102, v103
  v_mfma_f32_32x32x16_bf16 v[88:103], v[32:35], v[20:23], 0
  s_waitcnt vmcnt(13)
  v_exp_f32 v72, v72
  v_exp_f32 v73, v73
  v_exp_f32 v74, v74
  v_exp_f32 v75, v75
  v_cvt_pk_bf16_f32 v64, v72, v73
  v_cvt_pk_bf16_f32 v65, v74, v75
  s_waitcnt vmcnt(11)
  v_mfma_f32_32x32x16_bf16 v[120:135], v[60:63], v[68:71], v[120:135]
  buffer_store_dwordx4 v[160:163], v2, s[56:59], s71 offen offset:0 sc0 sc1
  buffer_store_dwordx4 v[168:171], v2, s[56:59], s71 offen offset:2048 sc0 sc1
  ds_read_b64_tr_b16 v[32:33], v140 offset:2816
  v_exp_f32 v76, v76
  v_exp_f32 v77, v77
  v_exp_f32 v78, v78
  v_exp_f32 v79, v79
  v_cvt_pk_bf16_f32 v66, v76, v77
  v_cvt_pk_bf16_f32 v67, v78, v79
  v_mfma_f32_32x32x8bf16_1k v[88:103], v[40:41], v[26:27], v[88:103]
  s_waitcnt lgkmcnt(1)
  ds_read_b64_tr_b16 v[34:35], v140 offset:19456
  v_exp_f32 v80, v80
  v_exp_f32 v81, v81
  v_exp_f32 v82, v82
  v_exp_f32_e64 v83, v83
  v_cvt_pk_bf16_f32 v68, v80, v81
  v_cvt_pk_bf16_f32 v69, v82, v83
  v_mfma_f32_32x32x16_bf16 v[104:119], v[48:51], v[64:67], v[104:119]
  ds_read_b64_tr_b16 v[40:41], v141 offset:2816
  v_exp_f32 v84, v84
  v_exp_f32 v85, v85
  v_exp_f32 v86, v86
  v_exp_f32 v87, v87
  v_cvt_pk_bf16_f32 v70, v84, v85
  v_cvt_pk_bf16_f32 v71, v86, v87
  v_mfma_f32_32x32x16_bf16 v[72:87], v[36:39], v[16:19], 0
  ds_read_b128 v[56:59], v142 offset:2752
  v_exp_f32 v88, v88
  v_exp_f32 v89, v89
  v_exp_f32 v90, v90
  v_exp_f32 v91, v91
  v_cvt_pk_bf16_f32 v64, v88, v89
  v_cvt_pk_bf16_f32 v65, v90, v91
  v_mfma_f32_32x32x16_bf16 v[104:119], v[52:55], v[68:71], v[104:119]
  ds_read_b128 v[60:63], v142 offset:2784
  v_exp_f32 v92, v92
  v_exp_f32 v93, v93
  v_exp_f32 v94, v94
  v_exp_f32 v95, v95
  v_cvt_pk_bf16_f32 v66, v92, v93
  v_cvt_pk_bf16_f32 v67, v94, v95
  v_mfma_f32_32x32x8bf16_1k v[72:87], v[42:43], v[24:25], v[72:87]
  v_exp_f32 v96, v96
  v_exp_f32 v97, v97
  v_exp_f32 v98, v98
  v_exp_f32 v99, v99
  v_cvt_pk_bf16_f32 v68, v96, v97
  v_cvt_pk_bf16_f32 v69, v98, v99
  v_mfma_f32_32x32x16_bf16 v[120:135], v[48:51], v[64:67], v[120:135]
  v_exp_f32 v100, v100
  v_exp_f32 v101, v101
  v_exp_f32 v102, v102
  v_exp_f32 v103, v103
  v_cvt_pk_bf16_f32 v70, v100, v101
  v_cvt_pk_bf16_f32 v71, v102, v103
  v_mfma_f32_32x32x16_bf16 v[88:103], v[36:39], v[20:23], 0
  v_exp_f32 v72, v72
  v_exp_f32 v73, v73
  v_exp_f32_e64 v74, v74
  v_exp_f32 v75, v75
  v_cvt_pk_bf16_f32 v64, v72, v73
  v_cvt_pk_bf16_f32 v65, v74, v75
  s_getpc_b64 s[94:95]
  v_mfma_f32_32x32x16_bf16 v[120:135], v[52:55], v[68:71], v[120:135]
  global_load_dword v231, v230, s[94:95]
  buffer_store_dwordx4 a[8:11], v249, s[60:63], s86 offen offset:0 sc0 sc1
  ds_read_b64_tr_b16 v[36:37], v140 offset:2880
  v_exp_f32 v76, v76
  v_exp_f32 v77, v77
  v_exp_f32 v78, v78
  v_exp_f32 v79, v79
  v_cvt_pk_bf16_f32 v66, v76, v77
  v_cvt_pk_bf16_f32 v67, v78, v79
  v_mfma_f32_32x32x8bf16_1k v[88:103], v[42:43], v[26:27], v[88:103]
  s_waitcnt lgkmcnt(1)
  ds_read_b64_tr_b16 v[38:39], v140 offset:19520
  v_exp_f32 v80, v80
  v_exp_f32 v81, v81
  v_exp_f32 v82, v82
  v_exp_f32_e64 v83, v83
  v_cvt_pk_bf16_f32 v68, v80, v81
  v_cvt_pk_bf16_f32 v69, v82, v83
  v_mfma_f32_32x32x16_bf16 v[104:119], v[56:59], v[64:67], v[104:119]
  ds_read_b64_tr_b16 v[42:43], v141 offset:2880
  v_exp_f32 v84, v84
  v_exp_f32 v85, v85
  v_exp_f32 v86, v86
  v_exp_f32 v87, v87
  v_cvt_pk_bf16_f32 v70, v84, v85
  v_cvt_pk_bf16_f32 v71, v86, v87
  v_mfma_f32_32x32x16_bf16 v[72:87], v[32:35], v[16:19], 0
  ds_read_b128 v[48:51], v142 offset:2816
  v_exp_f32 v88, v88
  v_exp_f32 v89, v89
  v_exp_f32 v90, v90
  v_exp_f32 v91, v91
  v_cvt_pk_bf16_f32 v64, v88, v89
  v_cvt_pk_bf16_f32 v65, v90, v91
  v_mfma_f32_32x32x16_bf16 v[104:119], v[60:63], v[68:71], v[104:119]
  ds_read_b128 v[52:55], v142 offset:2848
  v_exp_f32 v92, v92
  v_exp_f32 v93, v93
  v_exp_f32 v94, v94
  v_exp_f32 v95, v95
  v_cvt_pk_bf16_f32 v66, v92, v93
  v_cvt_pk_bf16_f32 v67, v94, v95
  v_mfma_f32_32x32x8bf16_1k v[72:87], v[40:41], v[24:25], v[72:87]
  v_exp_f32 v96, v96
  v_exp_f32 v97, v97
  v_exp_f32 v98, v98
  v_exp_f32 v99, v99
  v_cvt_pk_bf16_f32 v68, v96, v97
  v_cvt_pk_bf16_f32 v69, v98, v99
  v_mfma_f32_32x32x16_bf16 v[120:135], v[56:59], v[64:67], v[120:135]
  v_exp_f32 v100, v100
  v_exp_f32 v101, v101
  v_exp_f32 v102, v102
  v_exp_f32 v103, v103
  v_cvt_pk_bf16_f32 v70, v100, v101
  v_cvt_pk_bf16_f32 v71, v102, v103
  v_mfma_f32_32x32x16_bf16 v[88:103], v[32:35], v[20:23], 0
  s_waitcnt vmcnt(9)
  v_exp_f32 v72, v72
  v_exp_f32 v73, v73
  v_exp_f32 v74, v74
  v_exp_f32 v75, v75
  v_cvt_pk_bf16_f32 v64, v72, v73
  v_cvt_pk_bf16_f32 v65, v74, v75
  s_waitcnt vmcnt(7)
  v_mfma_f32_32x32x16_bf16 v[120:135], v[60:63], v[68:71], v[120:135]
  buffer_store_dwordx4 v[164:167], v2, s[56:59], s71 offen offset:1024 sc0 sc1
  buffer_store_dwordx4 v[172:175], v2, s[56:59], s71 offen offset:3072 sc0 sc1
  ds_read_b64_tr_b16 v[32:33], v140 offset:2944
  v_exp_f32 v76, v76
  v_exp_f32 v77, v77
  v_exp_f32 v78, v78
  v_exp_f32 v79, v79
  v_cvt_pk_bf16_f32 v66, v76, v77
  v_cvt_pk_bf16_f32 v67, v78, v79
  v_mfma_f32_32x32x8bf16_1k v[88:103], v[40:41], v[26:27], v[88:103]
  s_waitcnt lgkmcnt(1)
  ds_read_b64_tr_b16 v[34:35], v140 offset:19584
  v_exp_f32 v80, v80
  v_exp_f32 v81, v81
  v_exp_f32 v82, v82
  v_exp_f32_e64 v83, v83
  v_cvt_pk_bf16_f32 v68, v80, v81
  v_cvt_pk_bf16_f32 v69, v82, v83
  v_mfma_f32_32x32x16_bf16 v[104:119], v[48:51], v[64:67], v[104:119]
  ds_read_b64_tr_b16 v[40:41], v141 offset:2944
  v_exp_f32 v84, v84
  v_exp_f32 v85, v85
  v_exp_f32 v86, v86
  v_exp_f32 v87, v87
  v_cvt_pk_bf16_f32 v70, v84, v85
  v_cvt_pk_bf16_f32 v71, v86, v87
  v_mfma_f32_32x32x16_bf16 v[72:87], v[36:39], v[16:19], 0
  ds_read_b128 v[56:59], v142 offset:2880
  v_exp_f32 v88, v88
  v_exp_f32 v89, v89
  v_exp_f32 v90, v90
  v_exp_f32 v91, v91
  v_cvt_pk_bf16_f32 v64, v88, v89
  v_cvt_pk_bf16_f32 v65, v90, v91
  v_mfma_f32_32x32x16_bf16 v[104:119], v[52:55], v[68:71], v[104:119]
  ds_read_b128 v[60:63], v142 offset:2912
  v_exp_f32 v92, v92
  v_exp_f32 v93, v93
  v_exp_f32 v94, v94
  v_exp_f32 v95, v95
  v_cvt_pk_bf16_f32 v66, v92, v93
  v_cvt_pk_bf16_f32 v67, v94, v95
  v_mfma_f32_32x32x8bf16_1k v[72:87], v[42:43], v[24:25], v[72:87]
  v_exp_f32 v96, v96
  v_exp_f32 v97, v97
  v_exp_f32 v98, v98
  v_exp_f32 v99, v99
  v_cvt_pk_bf16_f32 v68, v96, v97
  v_cvt_pk_bf16_f32 v69, v98, v99
  v_mfma_f32_32x32x16_bf16 v[120:135], v[48:51], v[64:67], v[120:135]
  v_exp_f32 v100, v100
  v_exp_f32 v101, v101
  v_exp_f32 v102, v102
  v_exp_f32 v103, v103
  v_cvt_pk_bf16_f32 v70, v100, v101
  v_cvt_pk_bf16_f32 v71, v102, v103
  v_mfma_f32_32x32x16_bf16 v[88:103], v[36:39], v[20:23], 0
  v_exp_f32 v72, v72
  v_exp_f32 v73, v73
  v_exp_f32 v74, v74
  v_exp_f32 v75, v75
  v_cvt_pk_bf16_f32 v64, v72, v73
  v_cvt_pk_bf16_f32 v65, v74, v75
  v_mfma_f32_32x32x16_bf16 v[120:135], v[52:55], v[68:71], v[120:135]
  ds_read_b64_tr_b16 v[36:37], v140 offset:3008
  v_exp_f32 v76, v76
  v_exp_f32 v77, v77
  v_exp_f32 v78, v78
  v_exp_f32 v79, v79
  v_cvt_pk_bf16_f32 v66, v76, v77
  v_cvt_pk_bf16_f32 v67, v78, v79
  v_mfma_f32_32x32x8bf16_1k v[88:103], v[42:43], v[26:27], v[88:103]
  s_waitcnt lgkmcnt(1)
  ds_read_b64_tr_b16 v[38:39], v140 offset:19648
  v_exp_f32 v80, v80
  v_exp_f32 v81, v81
  v_exp_f32 v82, v82
  v_exp_f32_e64 v83, v83
  v_cvt_pk_bf16_f32 v68, v80, v81
  v_cvt_pk_bf16_f32 v69, v82, v83
  v_mfma_f32_32x32x16_bf16 v[104:119], v[56:59], v[64:67], v[104:119]
  ds_read_b64_tr_b16 v[42:43], v141 offset:3008
  v_exp_f32 v84, v84
  v_exp_f32 v85, v85
  v_exp_f32 v86, v86
  v_exp_f32 v87, v87
  v_cvt_pk_bf16_f32 v70, v84, v85
  v_cvt_pk_bf16_f32 v71, v86, v87
  v_mfma_f32_32x32x16_bf16 v[72:87], v[32:35], v[16:19], 0
  ds_read_b128 v[48:51], v142 offset:2944
  v_exp_f32 v88, v88
  v_exp_f32 v89, v89
  v_exp_f32 v90, v90
  v_exp_f32 v91, v91
  v_cvt_pk_bf16_f32 v64, v88, v89
  v_cvt_pk_bf16_f32 v65, v90, v91
  v_mfma_f32_32x32x16_bf16 v[104:119], v[60:63], v[68:71], v[104:119]
  ds_read_b128 v[52:55], v142 offset:2976
  v_exp_f32 v92, v92
  v_exp_f32 v93, v93
  v_exp_f32 v94, v94
  v_exp_f32 v95, v95
  v_cvt_pk_bf16_f32 v66, v92, v93
  v_cvt_pk_bf16_f32 v67, v94, v95
  v_mfma_f32_32x32x8bf16_1k v[72:87], v[40:41], v[24:25], v[72:87]
  v_exp_f32 v96, v96
  v_exp_f32 v97, v97
  v_exp_f32 v98, v98
  v_exp_f32 v99, v99
  v_cvt_pk_bf16_f32 v68, v96, v97
  v_cvt_pk_bf16_f32 v69, v98, v99
  v_mfma_f32_32x32x16_bf16 v[120:135], v[56:59], v[64:67], v[120:135]
  v_exp_f32 v100, v100
  v_exp_f32 v101, v101
  v_exp_f32 v102, v102
  v_exp_f32 v103, v103
  v_cvt_pk_bf16_f32 v70, v100, v101
  v_cvt_pk_bf16_f32 v71, v102, v103
  v_mfma_f32_32x32x16_bf16 v[88:103], v[32:35], v[20:23], 0
  v_exp_f32 v72, v72
  v_exp_f32 v73, v73
  v_exp_f32 v74, v74
  v_exp_f32 v75, v75
  v_cvt_pk_bf16_f32 v64, v72, v73
  v_cvt_pk_bf16_f32 v65, v74, v75
  v_mfma_f32_32x32x16_bf16 v[120:135], v[60:63], v[68:71], v[120:135]
  ds_read_b64_tr_b16 v[32:33], v140 offset:3072
  v_exp_f32 v76, v76
  v_exp_f32 v77, v77
  v_exp_f32 v78, v78
  v_exp_f32 v79, v79
  v_cvt_pk_bf16_f32 v66, v76, v77
  v_cvt_pk_bf16_f32 v67, v78, v79
  v_mfma_f32_32x32x8bf16_1k v[88:103], v[40:41], v[26:27], v[88:103]
  s_waitcnt lgkmcnt(1)
  ds_read_b64_tr_b16 v[34:35], v140 offset:19712
  v_exp_f32 v80, v80
  v_exp_f32 v81, v81
  v_exp_f32 v82, v82
  v_exp_f32_e64 v83, v83
  v_cvt_pk_bf16_f32 v68, v80, v81
  v_cvt_pk_bf16_f32 v69, v82, v83
  v_mfma_f32_32x32x16_bf16 v[104:119], v[48:51], v[64:67], v[104:119]
  ds_read_b64_tr_b16 v[40:41], v141 offset:3072
  v_exp_f32 v84, v84
  v_exp_f32 v85, v85
  v_exp_f32 v86, v86
  v_exp_f32 v87, v87
  v_cvt_pk_bf16_f32 v70, v84, v85
  v_cvt_pk_bf16_f32 v71, v86, v87
  v_mfma_f32_32x32x16_bf16 v[72:87], v[36:39], v[16:19], 0
  ds_read_b128 v[56:59], v142 offset:3008
  v_exp_f32 v88, v88
  v_exp_f32 v89, v89
  v_exp_f32 v90, v90
  v_exp_f32 v91, v91
  v_cvt_pk_bf16_f32 v64, v88, v89
  v_cvt_pk_bf16_f32 v65, v90, v91
  v_mfma_f32_32x32x16_bf16 v[104:119], v[52:55], v[68:71], v[104:119]
  ds_read_b128 v[60:63], v142 offset:3040
  v_exp_f32 v92, v92
  v_exp_f32 v93, v93
  v_exp_f32 v94, v94
  v_exp_f32 v95, v95
  v_cvt_pk_bf16_f32 v66, v92, v93
  v_cvt_pk_bf16_f32 v67, v94, v95
  v_mfma_f32_32x32x8bf16_1k v[72:87], v[42:43], v[24:25], v[72:87]
  v_exp_f32 v96, v96
  v_exp_f32 v97, v97
  v_exp_f32 v98, v98
  v_exp_f32 v99, v99
  v_cvt_pk_bf16_f32 v68, v96, v97
  v_cvt_pk_bf16_f32 v69, v98, v99
  v_mfma_f32_32x32x16_bf16 v[120:135], v[48:51], v[64:67], v[120:135]
  v_exp_f32 v100, v100
  v_exp_f32 v101, v101
  v_exp_f32 v102, v102
  v_exp_f32 v103, v103
  v_cvt_pk_bf16_f32 v70, v100, v101
  v_cvt_pk_bf16_f32 v71, v102, v103
  v_mfma_f32_32x32x16_bf16 v[88:103], v[36:39], v[20:23], 0
  v_exp_f32 v72, v72
  v_exp_f32 v73, v73
  v_exp_f32 v74, v74
  v_exp_f32 v75, v75
  v_cvt_pk_bf16_f32 v64, v72, v73
  v_cvt_pk_bf16_f32 v65, v74, v75
  v_mfma_f32_32x32x16_bf16 v[120:135], v[52:55], v[68:71], v[120:135]
  ds_read_b64_tr_b16 v[36:37], v140 offset:3136
  v_exp_f32 v76, v76
  v_exp_f32 v77, v77
  v_exp_f32 v78, v78
  v_exp_f32 v79, v79
  v_cvt_pk_bf16_f32 v66, v76, v77
  v_cvt_pk_bf16_f32 v67, v78, v79
  v_mfma_f32_32x32x8bf16_1k v[88:103], v[42:43], v[26:27], v[88:103]
  s_waitcnt lgkmcnt(1)
  ds_read_b64_tr_b16 v[38:39], v140 offset:19776
  v_exp_f32 v80, v80
  v_exp_f32 v81, v81
  v_exp_f32 v82, v82
  v_exp_f32_e64 v83, v83
  v_cvt_pk_bf16_f32 v68, v80, v81
  v_cvt_pk_bf16_f32 v69, v82, v83
  v_mfma_f32_32x32x16_bf16 v[104:119], v[56:59], v[64:67], v[104:119]
  s_barrier
  ds_read_b64_tr_b16 v[42:43], v141 offset:3136
  v_exp_f32 v84, v84
  v_exp_f32 v85, v85
  v_exp_f32 v86, v86
  v_exp_f32_e64 v87, v87
  v_cvt_pk_bf16_f32 v70, v84, v85
  v_cvt_pk_bf16_f32 v71, v86, v87
  v_mfma_f32_32x32x16_bf16 v[72:87], v[32:35], v[16:19], 0
  ds_read_b128 v[48:51], v142 offset:3072
  v_exp_f32 v88, v88
  v_exp_f32 v89, v89
  v_exp_f32 v90, v90
  v_exp_f32 v91, v91
  v_cvt_pk_bf16_f32 v64, v88, v89
  v_cvt_pk_bf16_f32 v65, v90, v91
  v_mfma_f32_32x32x16_bf16 v[104:119], v[60:63], v[68:71], v[104:119]
  ds_read_b128 v[52:55], v142 offset:3104
  v_exp_f32 v92, v92
  v_exp_f32 v93, v93
  v_exp_f32 v94, v94
  v_exp_f32 v95, v95
  v_cvt_pk_bf16_f32 v66, v92, v93
  v_cvt_pk_bf16_f32 v67, v94, v95
  v_mfma_f32_32x32x8bf16_1k v[72:87], v[40:41], v[24:25], v[72:87]
  s_add_u32 s13, s52, 0
  v_exp_f32 v96, v96
  v_exp_f32 v97, v97
  v_exp_f32 v98, v98
  v_exp_f32 v99, v99
  v_cvt_pk_bf16_f32 v68, v96, v97
  v_cvt_pk_bf16_f32 v69, v98, v99
  s_add_u32 m0, s32, 0
  v_mfma_f32_32x32x16_bf16 v[120:135], v[56:59], v[64:67], v[120:135]
  buffer_load_dwordx4 v2, s[60:63], s13 offen offset:0 lds
  buffer_load_dwordx4 v2, s[60:63], s13 offen offset:1024 lds
  buffer_load_dwordx4 v2, s[60:63], s13 offen offset:2048 lds
  v_exp_f32 v100, v100
  v_exp_f32 v101, v101
  v_exp_f32 v102, v102
  v_exp_f32 v103, v103
  v_cvt_pk_bf16_f32 v70, v100, v101
  v_cvt_pk_bf16_f32 v71, v102, v103
  v_mfma_f32_32x32x16_bf16 v[88:103], v[32:35], v[20:23], 0
  v_exp_f32 v72, v72
  v_exp_f32 v73, v73
  v_exp_f32 v74, v74
  v_exp_f32 v75, v75
  v_cvt_pk_bf16_f32 v64, v72, v73
  v_cvt_pk_bf16_f32 v65, v74, v75
  v_mfma_f32_32x32x16_bf16 v[120:135], v[60:63], v[68:71], v[120:135]
  ds_read_b64_tr_b16 v[32:33], v140 offset:3200
  v_exp_f32 v76, v76
  v_exp_f32 v77, v77
  v_exp_f32 v78, v78
  v_exp_f32 v79, v79
  v_cvt_pk_bf16_f32 v66, v76, v77
  v_cvt_pk_bf16_f32 v67, v78, v79
  v_mfma_f32_32x32x8bf16_1k v[88:103], v[40:41], v[26:27], v[88:103]
  s_waitcnt lgkmcnt(1)
  ds_read_b64_tr_b16 v[34:35], v140 offset:19840
  v_exp_f32 v80, v80
  v_exp_f32 v81, v81
  v_exp_f32 v82, v82
  v_exp_f32_e64 v83, v83
  v_cvt_pk_bf16_f32 v68, v80, v81
  v_cvt_pk_bf16_f32 v69, v82, v83
  v_mfma_f32_32x32x16_bf16 v[104:119], v[48:51], v[64:67], v[104:119]
  ds_read_b64_tr_b16 v[40:41], v141 offset:3200
  v_exp_f32 v84, v84
  v_exp_f32 v85, v85
  v_exp_f32 v86, v86
  v_exp_f32 v87, v87
  v_cvt_pk_bf16_f32 v70, v84, v85
  v_cvt_pk_bf16_f32 v71, v86, v87
  v_mfma_f32_32x32x16_bf16 v[72:87], v[36:39], v[16:19], 0
  s_add_u32 s34, s52, 145408
  ds_read_b128 v[56:59], v142 offset:3136
  v_exp_f32 v88, v88
  v_exp_f32 v89, v89
  v_exp_f32 v90, v90
  v_exp_f32 v91, v91
  v_cvt_pk_bf16_f32 v64, v88, v89
  v_cvt_pk_bf16_f32 v65, v90, v91
  v_mfma_f32_32x32x16_bf16 v[104:119], v[52:55], v[68:71], v[104:119]
  s_add_u32 s13, s52, 3072
  ds_read_b128 v[60:63], v142 offset:3168
  v_exp_f32 v92, v92
  v_exp_f32 v93, v93
  v_exp_f32_e64 v94, v94
  v_exp_f32 v95, v95
  v_cvt_pk_bf16_f32 v66, v92, v93
  v_cvt_pk_bf16_f32 v67, v94, v95
  s_add_u32 m0, s37, 64
  v_mfma_f32_32x32x8bf16_1k v[72:87], v[42:43], v[24:25], v[72:87]
  buffer_load_dwordx4 v2, s[60:63], s13 offen offset:0 lds
  buffer_load_dwordx4 v2, s[60:63], s13 offen offset:1024 lds
  buffer_load_dwordx4 v2, s[60:63], s34 offen offset:2048 lds
  v_exp_f32 v96, v96
  v_exp_f32 v97, v97
  v_exp_f32 v98, v98
  v_exp_f32 v99, v99
  v_cvt_pk_bf16_f32 v68, v96, v97
  v_cvt_pk_bf16_f32 v69, v98, v99
  v_mfma_f32_32x32x16_bf16 v[120:135], v[48:51], v[64:67], v[120:135]
  v_exp_f32 v100, v100
  v_exp_f32 v101, v101
  v_exp_f32 v102, v102
  v_exp_f32 v103, v103
  v_cvt_pk_bf16_f32 v70, v100, v101
  v_cvt_pk_bf16_f32 v71, v102, v103
  v_mfma_f32_32x32x16_bf16 v[88:103], v[36:39], v[20:23], 0
  v_exp_f32 v72, v72
  v_exp_f32 v73, v73
  v_exp_f32 v74, v74
  v_exp_f32 v75, v75
  v_cvt_pk_bf16_f32 v64, v72, v73
  v_cvt_pk_bf16_f32 v65, v74, v75
  v_mfma_f32_32x32x16_bf16 v[120:135], v[52:55], v[68:71], v[120:135]
  ds_read_b64_tr_b16 v[36:37], v140 offset:3264
  v_exp_f32 v76, v76
  v_exp_f32 v77, v77
  v_exp_f32 v78, v78
  v_exp_f32 v79, v79
  v_cvt_pk_bf16_f32 v66, v76, v77
  v_cvt_pk_bf16_f32 v67, v78, v79
  v_mfma_f32_32x32x8bf16_1k v[88:103], v[42:43], v[26:27], v[88:103]
  s_waitcnt lgkmcnt(1)
  ds_read_b64_tr_b16 v[38:39], v140 offset:19904
  v_exp_f32 v80, v80
  v_exp_f32 v81, v81
  v_exp_f32 v82, v82
  v_exp_f32_e64 v83, v83
  v_cvt_pk_bf16_f32 v68, v80, v81
  v_cvt_pk_bf16_f32 v69, v82, v83
  v_mfma_f32_32x32x16_bf16 v[104:119], v[56:59], v[64:67], v[104:119]
  ds_read_b64_tr_b16 v[42:43], v141 offset:3264
  v_exp_f32 v84, v84
  v_exp_f32 v85, v85
  v_exp_f32 v86, v86
  v_exp_f32 v87, v87
  v_cvt_pk_bf16_f32 v70, v84, v85
  v_cvt_pk_bf16_f32 v71, v86, v87
  v_mfma_f32_32x32x16_bf16 v[72:87], v[32:35], v[16:19], 0
  s_add_u32 s13, s52, 148480
  ds_read_b128 v[48:51], v142 offset:3200
  v_exp_f32 v88, v88
  v_exp_f32 v89, v89
  v_exp_f32 v90, v90
  v_exp_f32 v91, v91
  v_cvt_pk_bf16_f32 v64, v88, v89
  v_cvt_pk_bf16_f32 v65, v90, v91
  s_add_u32 m0, s38, 128
  v_mfma_f32_32x32x16_bf16 v[104:119], v[60:63], v[68:71], v[104:119]
  buffer_load_dwordx4 v2, s[60:63], s13 offen offset:0 lds
  buffer_load_dwordx4 v2, s[60:63], s13 offen offset:1024 lds
  buffer_load_dwordx4 v2, s[60:63], s13 offen offset:2048 lds
  ds_read_b128 v[52:55], v142 offset:3232
  v_exp_f32 v92, v92
  v_exp_f32 v93, v93
  v_exp_f32 v94, v94
  v_exp_f32 v95, v95
  v_cvt_pk_bf16_f32 v66, v92, v93
  v_cvt_pk_bf16_f32 v67, v94, v95
  v_mfma_f32_32x32x8bf16_1k v[72:87], v[40:41], v[24:25], v[72:87]
  v_exp_f32 v96, v96
  v_exp_f32 v97, v97
  v_exp_f32 v98, v98
  v_exp_f32 v99, v99
  v_cvt_pk_bf16_f32 v68, v96, v97
  v_cvt_pk_bf16_f32 v69, v98, v99
  v_mfma_f32_32x32x16_bf16 v[120:135], v[56:59], v[64:67], v[120:135]
  v_exp_f32 v100, v100
  v_exp_f32 v101, v101
  v_exp_f32 v102, v102
  v_exp_f32 v103, v103
  v_cvt_pk_bf16_f32 v70, v100, v101
  v_cvt_pk_bf16_f32 v71, v102, v103
  v_mfma_f32_32x32x16_bf16 v[88:103], v[32:35], v[20:23], 0
  s_add_u32 s34, s52, 293888
  v_exp_f32 v72, v72
  v_exp_f32 v73, v73
  v_exp_f32 v74, v74
  v_exp_f32 v75, v75
  v_cvt_pk_bf16_f32 v64, v72, v73
  v_cvt_pk_bf16_f32 v65, v74, v75
  v_mfma_f32_32x32x16_bf16 v[120:135], v[60:63], v[68:71], v[120:135]
  s_add_u32 s13, s52, 151552
  ds_read_b64_tr_b16 v[32:33], v140 offset:3328
  v_exp_f32 v76, v76
  v_exp_f32 v77, v77
  v_exp_f32 v78, v78
  v_exp_f32 v79, v79
  v_cvt_pk_bf16_f32 v66, v76, v77
  v_cvt_pk_bf16_f32 v67, v78, v79
  v_mfma_f32_32x32x8bf16_1k v[88:103], v[40:41], v[26:27], v[88:103]
  s_waitcnt lgkmcnt(1)
  ds_read_b64_tr_b16 v[34:35], v140 offset:19968
  v_exp_f32 v80, v80
  v_exp_f32 v81, v81
  v_exp_f32 v82, v82
  v_exp_f32_e64 v83, v83
  v_cvt_pk_bf16_f32 v68, v80, v81
  v_cvt_pk_bf16_f32 v69, v82, v83
  v_mfma_f32_32x32x16_bf16 v[104:119], v[48:51], v[64:67], v[104:119]
  s_add_u32 m0, s39, 192
  ds_read_b64_tr_b16 v[40:41], v141 offset:3328
  v_exp_f32 v84, v84
  v_exp_f32 v85, v85
  v_exp_f32_e64 v86, v86
  v_exp_f32 v87, v87
  v_cvt_pk_bf16_f32 v70, v84, v85
  v_cvt_pk_bf16_f32 v71, v86, v87
  s_getpc_b64 s[94:95]
  v_mfma_f32_32x32x16_bf16 v[72:87], v[36:39], v[16:19], 0
  buffer_load_dwordx4 v2, s[60:63], s13 offen offset:0 lds
  buffer_load_dwordx4 v2, s[60:63], s34 offen offset:1024 lds
  buffer_load_dwordx4 v2, s[60:63], s34 offen offset:2048 lds
  global_load_dword v231, v230, s[94:95]
  ds_read_b128 v[56:59], v142 offset:3264
L_pg_9:
  s_cbranch_execz L_wr_1
  v_exp_f32_e64 v88, v88
  v_exp_f32 v89, v89
  v_exp_f32 v90, v90
  v_exp_f32 v91, v91
  v_cvt_pk_bf16_f32 v64, v88, v89
  v_cvt_pk_bf16_f32 v65, v90, v91
  v_mfma_f32_32x32x16_bf16 v[104:119], v[52:55], v[68:71], v[104:119]
  s_waitcnt vmcnt(13)
  ds_read_b128 v[60:63], v142 offset:3296
  v_exp_f32 v92, v92
  v_exp_f32 v93, v93
  v_exp_f32 v94, v94
  v_exp_f32_e64 v95, v95
  v_cvt_pk_bf16_f32 v66, v92, v93
  v_cvt_pk_bf16_f32 v67, v94, v95
  v_mfma_f32_32x32x8bf16_1k v[72:87], v[42:43], v[24:25], v[72:87]
  s_mov_b64 exec, 1
  ds_add_rtn_u32 v237, v236, v240
  s_mov_b64 exec, -1
  v_exp_f32 v96, v96
  v_exp_f32 v97, v97
  v_exp_f32 v98, v98
  v_exp_f32 v99, v99
  v_cvt_pk_bf16_f32 v68, v96, v97
  v_cvt_pk_bf16_f32 v69, v98, v99
  v_mfma_f32_32x32x16_bf16 v[120:135], v[48:51], v[64:67], v[120:135]
  v_exp_f32 v100, v100
  v_exp_f32 v101, v101
  v_exp_f32 v102, v102
  v_exp_f32 v103, v103
  v_cvt_pk_bf16_f32 v70, v100, v101
  v_cvt_pk_bf16_f32 v71, v102, v103
  v_mfma_f32_32x32x16_bf16 v[88:103], v[36:39], v[20:23], 0
  v_exp_f32 v72, v72
  v_exp_f32 v73, v73
  v_exp_f32 v74, v74
  v_exp_f32 v75, v75
  v_cvt_pk_bf16_f32 v64, v72, v73
  v_cvt_pk_bf16_f32 v65, v74, v75
  v_mfma_f32_32x32x16_bf16 v[120:135], v[52:55], v[68:71], v[120:135]
  s_add_u32 s13, s52, 296960
  ds_read_b64_tr_b16 v[36:37], v140 offset:3392
  v_exp_f32 v76, v76
  v_exp_f32 v77, v77
  v_exp_f32 v78, v78
  v_exp_f32 v79, v79
  v_cvt_pk_bf16_f32 v66, v76, v77
  v_cvt_pk_bf16_f32 v67, v78, v79
  v_mfma_f32_32x32x8bf16_1k v[88:103], v[42:43], v[26:27], v[88:103]
  s_waitcnt lgkmcnt(1)
  ds_read_b64_tr_b16 v[38:39], v140 offset:20032
  v_exp_f32 v80, v80
  v_exp_f32 v81, v81
  v_exp_f32 v82, v82
  v_exp_f32_e64 v83, v83
  v_cvt_pk_bf16_f32 v68, v80, v81
  v_cvt_pk_bf16_f32 v69, v82, v83
  s_add_u32 m0, s40, 256
  v_mfma_f32_32x32x16_bf16 v[104:119], v[56:59], v[64:67], v[104:119]
  v_cmp_eq_u32_e64 vcc, 3, v237
  v_cndmask_b32 v238, v238, 0, vcc
  buffer_store_dword v240, v238, s[96:99], s79 offen sc0 sc1
  buffer_load_dwordx4 v2, s[60:63], s13 offen offset:0 lds
  buffer_load_dwordx4 v2, s[60:63], s13 offen offset:1024 lds
  buffer_load_dwordx4 v2, s[60:63], s13 offen offset:2048 lds
  ds_read_b64_tr_b16 v[42:43], v141 offset:3392
  v_exp_f32 v84, v84
  v_exp_f32 v85, v85
  v_exp_f32 v86, v86
  v_exp_f32 v87, v87
  v_cvt_pk_bf16_f32 v70, v84, v85
  v_cvt_pk_bf16_f32 v71, v86, v87
  v_mfma_f32_32x32x16_bf16 v[72:87], v[32:35], v[16:19], 0
  ds_read_b128 v[48:51], v142 offset:3328
  v_exp_f32 v88, v88
  v_exp_f32 v89, v89
  v_exp_f32 v90, v90
  v_exp_f32 v91, v91
  v_cvt_pk_bf16_f32 v64, v88, v89
  v_cvt_pk_bf16_f32 v65, v90, v91
  v_mfma_f32_32x32x16_bf16 v[104:119], v[60:63], v[68:71], v[104:119]
  ds_read_b128 v[52:55], v142 offset:3360
  v_exp_f32 v92, v92
  v_exp_f32 v93, v93
  v_exp_f32 v94, v94
  v_exp_f32 v95, v95
  v_cvt_pk_bf16_f32 v66, v92, v93
  v_cvt_pk_bf16_f32 v67, v94, v95
  v_mfma_f32_32x32x8bf16_1k v[72:87], v[40:41], v[24:25], v[72:87]
  v_exp_f32 v96, v96
  v_exp_f32 v97, v97
  v_exp_f32 v98, v98
  v_exp_f32 v99, v99
  v_cvt_pk_bf16_f32 v68, v96, v97
  v_cvt_pk_bf16_f32 v69, v98, v99
  v_mfma_f32_32x32x16_bf16 v[120:135], v[56:59], v[64:67], v[120:135]
  v_exp_f32 v100, v100
  v_exp_f32 v101, v101
  v_exp_f32 v102, v102
  v_exp_f32 v103, v103
  v_cvt_pk_bf16_f32 v70, v100, v101
  v_cvt_pk_bf16_f32 v71, v102, v103
  v_mfma_f32_32x32x16_bf16 v[88:103], v[32:35], v[20:23], 0
  v_exp_f32 v72, v72
  v_exp_f32 v73, v73
  v_exp_f32 v74, v74
  v_exp_f32 v75, v75
  v_cvt_pk_bf16_f32 v64, v72, v73
  v_cvt_pk_bf16_f32 v65, v74, v75
  v_mfma_f32_32x32x16_bf16 v[120:135], v[60:63], v[68:71], v[120:135]
  s_add_u32 s13, s52, 442368
  ds_read_b64_tr_b16 v[32:33], v140 offset:3456
  v_exp_f32 v76, v76
  v_exp_f32 v77, v77
  v_exp_f32 v78, v78
  v_exp_f32 v79, v79
  v_cvt_pk_bf16_f32 v66, v76, v77
  v_cvt_pk_bf16_f32 v67, v78, v79
  v_mfma_f32_32x32x8bf16_1k v[88:103], v[40:41], v[26:27], v[88:103]
  s_waitcnt lgkmcnt(1)
  ds_read_b64_tr_b16 v[34:35], v140 offset:20096
  v_exp_f32 v80, v80
  v_exp_f32 v81, v81
  v_exp_f32 v82, v82
  v_exp_f32_e64 v83, v83
  v_cvt_pk_bf16_f32 v68, v80, v81
  v_cvt_pk_bf16_f32 v69, v82, v83
  s_add_u32 m0, s41, 320
  v_mfma_f32_32x32x16_bf16 v[104:119], v[48:51], v[64:67], v[104:119]
  buffer_load_dwordx4 v2, s[60:63], s13 offen offset:0 lds
  buffer_load_dwordx4 v2, s[60:63], s13 offen offset:1024 lds
  buffer_load_dwordx4 v2, s[60:63], s13 offen offset:2048 lds
  ds_read_b64_tr_b16 v[40:41], v141 offset:3456
  v_exp_f32 v84, v84
  v_exp_f32 v85, v85
  v_exp_f32 v86, v86
  v_exp_f32 v87, v87
  v_cvt_pk_bf16_f32 v70, v84, v85
  v_cvt_pk_bf16_f32 v71, v86, v87
  v_mfma_f32_32x32x16_bf16 v[72:87], v[36:39], v[16:19], 0
  ds_read_b128 v[56:59], v142 offset:3392
  v_exp_f32 v88, v88
  v_exp_f32 v89, v89
  v_exp_f32 v90, v90
  v_exp_f32 v91, v91
  v_cvt_pk_bf16_f32 v64, v88, v89
  v_cvt_pk_bf16_f32 v65, v90, v91
  v_mfma_f32_32x32x16_bf16 v[104:119], v[52:55], v[68:71], v[104:119]
  ds_read_b128 v[60:63], v142 offset:3424
  v_exp_f32 v92, v92
  v_exp_f32 v93, v93
  v_exp_f32 v94, v94
  v_exp_f32 v95, v95
  v_cvt_pk_bf16_f32 v66, v92, v93
  v_cvt_pk_bf16_f32 v67, v94, v95
  v_mfma_f32_32x32x8bf16_1k v[72:87], v[42:43], v[24:25], v[72:87]
  v_exp_f32 v96, v96
  v_exp_f32 v97, v97
  v_exp_f32 v98, v98
  v_exp_f32 v99, v99
  v_cvt_pk_bf16_f32 v68, v96, v97
  v_cvt_pk_bf16_f32 v69, v98, v99
  v_mfma_f32_32x32x16_bf16 v[120:135], v[48:51], v[64:67], v[120:135]
  v_exp_f32 v100, v100
  v_exp_f32 v101, v101
  v_exp_f32 v102, v102
  v_exp_f32 v103, v103
  v_cvt_pk_bf16_f32 v70, v100, v101
  v_cvt_pk_bf16_f32 v71, v102, v103
  v_mfma_f32_32x32x16_bf16 v[88:103], v[36:39], v[20:23], 0
  s_add_u32 s13, s52, 445440
  v_exp_f32 v72, v72
  v_exp_f32 v73, v73
  v_exp_f32 v74, v74
  v_exp_f32 v75, v75
  v_cvt_pk_bf16_f32 v64, v72, v73
  v_cvt_pk_bf16_f32 v65, v74, v75
  s_add_u32 m0, s42, 384
  v_mfma_f32_32x32x16_bf16 v[120:135], v[52:55], v[68:71], v[120:135]
  buffer_load_dwordx4 v2, s[60:63], s13 offen offset:0 lds
  buffer_load_dwordx4 v2, s[60:63], s13 offen offset:1024 lds
  global_load_dword v229, v228, s[22:23]
  ds_read_b64_tr_b16 v[36:37], v140 offset:3520
  v_exp_f32 v76, v76
  v_exp_f32 v77, v77
  v_exp_f32 v78, v78
  v_exp_f32 v79, v79
  v_cvt_pk_bf16_f32 v66, v76, v77
  v_cvt_pk_bf16_f32 v67, v78, v79
  v_mfma_f32_32x32x8bf16_1k v[88:103], v[42:43], v[26:27], v[88:103]
  s_waitcnt lgkmcnt(1)
  ds_read_b64_tr_b16 v[38:39], v140 offset:20160
  v_exp_f32 v80, v80
  v_exp_f32 v81, v81
  v_exp_f32 v82, v82
  v_exp_f32_e64 v83, v83
  v_cvt_pk_bf16_f32 v68, v80, v81
  v_cvt_pk_bf16_f32 v69, v82, v83
  v_mfma_f32_32x32x16_bf16 v[104:119], v[56:59], v[64:67], v[104:119]
  ds_read_b64_tr_b16 v[42:43], v141 offset:3520
  v_exp_f32 v84, v84
  v_exp_f32 v85, v85
  v_exp_f32 v86, v86
  v_exp_f32 v87, v87
  v_cvt_pk_bf16_f32 v70, v84, v85
  v_cvt_pk_bf16_f32 v71, v86, v87
  v_mfma_f32_32x32x16_bf16 v[72:87], v[32:35], v[16:19], 0
  ds_read_b128 v[48:51], v142 offset:3456
  v_exp_f32 v88, v88
  v_exp_f32 v89, v89
  v_exp_f32 v90, v90
  v_exp_f32 v91, v91
  v_cvt_pk_bf16_f32 v64, v88, v89
  v_cvt_pk_bf16_f32 v65, v90, v91
  v_mfma_f32_32x32x16_bf16 v[104:119], v[60:63], v[68:71], v[104:119]
  ds_read_b128 v[52:55], v142 offset:3488
  v_exp_f32 v92, v92
  v_exp_f32 v93, v93
  v_exp_f32 v94, v94
  v_exp_f32 v95, v95
  v_cvt_pk_bf16_f32 v66, v92, v93
  v_cvt_pk_bf16_f32 v67, v94, v95
  v_mfma_f32_32x32x8bf16_1k v[72:87], v[40:41], v[24:25], v[72:87]
  s_add_u32 s13, s52, 589824
  v_exp_f32 v96, v96
  v_exp_f32 v97, v97
  v_exp_f32 v98, v98
  v_exp_f32 v99, v99
  v_cvt_pk_bf16_f32 v68, v96, v97
  v_cvt_pk_bf16_f32 v69, v98, v99
  v_mfma_f32_32x32x16_bf16 v[120:135], v[56:59], v[64:67], v[120:135]
  s_add_u32 m0, s43, 448
  v_exp_f32 v100, v100
  v_exp_f32 v101, v101
  v_exp_f32 v102, v102
  v_exp_f32 v103, v103
  v_cvt_pk_bf16_f32 v70, v100, v101
  v_cvt_pk_bf16_f32 v71, v102, v103
  s_cmp_ge_u32 s12, 2
  v_mfma_f32_32x32x16_bf16 v[88:103], v[32:35], v[20:23], 0
  s_cbranch_scc1 L_k2_now7
  buffer_load_dwordx4 v2, s[60:63], s13 offen offset:0 lds
  buffer_load_dwordx4 v2, s[60:63], s13 offen offset:1024 lds
  buffer_load_dwordx4 v2, s[60:63], s13 offen offset:2048 lds
L_k2_now7:
  v_exp_f32 v72, v72
  v_exp_f32 v73, v73
  v_exp_f32 v74, v74
  v_exp_f32 v75, v75
  v_cvt_pk_bf16_f32 v64, v72, v73
  v_cvt_pk_bf16_f32 v65, v74, v75
  v_mfma_f32_32x32x16_bf16 v[120:135], v[60:63], v[68:71], v[120:135]
  ds_read_b64_tr_b16 v[32:33], v140 offset:3584
  v_exp_f32 v76, v76
  v_exp_f32 v77, v77
  v_exp_f32 v78, v78
  v_exp_f32 v79, v79
  v_cvt_pk_bf16_f32 v66, v76, v77
  v_cvt_pk_bf16_f32 v67, v78, v79
  v_mfma_f32_32x32x8bf16_1k v[88:103], v[40:41], v[26:27], v[88:103]
  s_waitcnt lgkmcnt(1)
  ds_read_b64_tr_b16 v[34:35], v140 offset:20224
  v_exp_f32 v80, v80
  v_exp_f32 v81, v81
  v_exp_f32 v82, v82
  v_exp_f32_e64 v83, v83
  v_cvt_pk_bf16_f32 v68, v80, v81
  v_cvt_pk_bf16_f32 v69, v82, v83
  v_mfma_f32_32x32x16_bf16 v[104:119], v[48:51], v[64:67], v[104:119]
  ds_read_b64_tr_b16 v[40:41], v141 offset:3584
  v_exp_f32 v84, v84
  v_exp_f32 v85, v85
  v_exp_f32 v86, v86
  v_exp_f32 v87, v87
  v_cvt_pk_bf16_f32 v70, v84, v85
  v_cvt_pk_bf16_f32 v71, v86, v87
  v_mfma_f32_32x32x16_bf16 v[72:87], v[36:39], v[16:19], 0
  ds_read_b128 v[56:59], v142 offset:3520
  v_exp_f32 v88, v88
  v_exp_f32 v89, v89
  v_exp_f32 v90, v90
  v_exp_f32 v91, v91
  v_cvt_pk_bf16_f32 v64, v88, v89
  v_cvt_pk_bf16_f32 v65, v90, v91
  v_mfma_f32_32x32x16_bf16 v[104:119], v[52:55], v[68:71], v[104:119]
  s_add_u32 s13, s52, 592896
  ds_read_b128 v[60:63], v142 offset:3552
  v_exp_f32 v92, v92
  v_exp_f32 v93, v93
  v_exp_f32 v94, v94
  v_exp_f32 v95, v95
  v_cvt_pk_bf16_f32 v66, v92, v93
  v_cvt_pk_bf16_f32 v67, v94, v95
  v_mfma_f32_32x32x8bf16_1k v[72:87], v[42:43], v[24:25], v[72:87]
  s_add_u32 m0, s44, 512
  v_exp_f32 v96, v96
  v_exp_f32 v97, v97
  v_exp_f32 v98, v98
  v_exp_f32 v99, v99
  v_cvt_pk_bf16_f32 v68, v96, v97
  v_cvt_pk_bf16_f32 v69, v98, v99
  s_cmp_ge_u32 s12, 2
  v_mfma_f32_32x32x16_bf16 v[120:135], v[48:51], v[64:67], v[120:135]
  s_cbranch_scc1 L_k2_now8
  buffer_load_dwordx4 v2, s[60:63], s13 offen offset:0 lds
  buffer_load_dwordx4 v2, s[60:63], s13 offen offset:1024 lds
L_k2_now8:
  v_exp_f32 v100, v100
  v_exp_f32 v101, v101
  v_exp_f32 v102, v102
  v_exp_f32 v103, v103
  v_cvt_pk_bf16_f32 v70, v100, v101
  v_cvt_pk_bf16_f32 v71, v102, v103
  v_mfma_f32_32x32x16_bf16 v[88:103], v[36:39], v[20:23], 0
  v_exp_f32 v72, v72
  v_exp_f32 v73, v73
  v_exp_f32 v74, v74
  v_exp_f32 v75, v75
  v_cvt_pk_bf16_f32 v64, v72, v73
  v_cvt_pk_bf16_f32 v65, v74, v75
  v_mfma_f32_32x32x16_bf16 v[120:135], v[52:55], v[68:71], v[120:135]
  ds_read_b64_tr_b16 v[36:37], v140 offset:3648
  v_exp_f32 v76, v76
  v_exp_f32 v77, v77
  v_exp_f32 v78, v78
  v_exp_f32 v79, v79
  v_cvt_pk_bf16_f32 v66, v76, v77
  v_cvt_pk_bf16_f32 v67, v78, v79
  v_mfma_f32_32x32x8bf16_1k v[88:103], v[42:43], v[26:27], v[88:103]
  s_waitcnt lgkmcnt(1)
  ds_read_b64_tr_b16 v[38:39], v140 offset:20288
  v_exp_f32 v80, v80
  v_exp_f32 v81, v81
  v_exp_f32 v82, v82
  v_exp_f32_e64 v83, v83
  v_cvt_pk_bf16_f32 v68, v80, v81
  v_cvt_pk_bf16_f32 v69, v82, v83
  v_mfma_f32_32x32x16_bf16 v[104:119], v[56:59], v[64:67], v[104:119]
  ds_read_b64_tr_b16 v[42:43], v141 offset:3648
  v_exp_f32 v84, v84
  v_exp_f32 v85, v85
  v_exp_f32 v86, v86
  v_exp_f32 v87, v87
  v_cvt_pk_bf16_f32 v70, v84, v85
  v_cvt_pk_bf16_f32 v71, v86, v87
  v_mfma_f32_32x32x16_bf16 v[72:87], v[32:35], v[16:19], 0
  ds_read_b128 v[48:51], v142 offset:3584
  v_exp_f32 v88, v88
  v_exp_f32 v89, v89
  v_exp_f32 v90, v90
  v_exp_f32 v91, v91
  v_cvt_pk_bf16_f32 v64, v88, v89
  v_cvt_pk_bf16_f32 v65, v90, v91
  v_mfma_f32_32x32x16_bf16 v[104:119], v[60:63], v[68:71], v[104:119]
  ds_read_b128 v[52:55], v142 offset:3616
  v_exp_f32 v92, v92
  v_exp_f32 v93, v93
  v_exp_f32_e64 v94, v94
  v_exp_f32 v95, v95
  v_cvt_pk_bf16_f32 v66, v92, v93
  v_cvt_pk_bf16_f32 v67, v94, v95
  s_mov_b32 m0, s54
  v_mfma_f32_32x32x8bf16_1k v[72:87], v[40:41], v[24:25], v[72:87]
  buffer_load_dwordx4 v138, s[4:7], s53 offen offset:0 lds
  buffer_load_dwordx4 v139, s[4:7], s53 offen offset:1024 lds
  buffer_load_dwordx4 v31, s[4:7], s53 offen offset:2048 lds
  v_exp_f32 v96, v96
  v_exp_f32 v97, v97
  v_exp_f32 v98, v98
  v_exp_f32 v99, v99
  v_cvt_pk_bf16_f32 v68, v96, v97
  v_cvt_pk_bf16_f32 v69, v98, v99
  v_mfma_f32_32x32x16_bf16 v[120:135], v[56:59], v[64:67], v[120:135]
  v_exp_f32 v100, v100
  v_exp_f32 v101, v101
  v_exp_f32 v102, v102
  v_exp_f32 v103, v103
  v_cvt_pk_bf16_f32 v70, v100, v101
  v_cvt_pk_bf16_f32 v71, v102, v103
  v_mfma_f32_32x32x16_bf16 v[88:103], v[32:35], v[20:23], 0
  v_exp_f32 v72, v72
  v_exp_f32 v73, v73
  v_exp_f32 v74, v74
  v_exp_f32 v75, v75
  v_cvt_pk_bf16_f32 v64, v72, v73
  v_cvt_pk_bf16_f32 v65, v74, v75
  v_mfma_f32_32x32x16_bf16 v[120:135], v[60:63], v[68:71], v[120:135]
  ds_read_b64_tr_b16 v[32:33], v140 offset:3712
  v_exp_f32 v76, v76
  v_exp_f32 v77, v77
  v_exp_f32 v78, v78
  v_exp_f32 v79, v79
  v_cvt_pk_bf16_f32 v66, v76, v77
  v_cvt_pk_bf16_f32 v67, v78, v79
  v_mfma_f32_32x32x8bf16_1k v[88:103], v[40:41], v[26:27], v[88:103]
  s_waitcnt lgkmcnt(1)
  ds_read_b64_tr_b16 v[34:35], v140 offset:20352
  v_exp_f32 v80, v80
  v_exp_f32 v81, v81
  v_exp_f32 v82, v82
  v_exp_f32_e64 v83, v83
  v_cvt_pk_bf16_f32 v68, v80, v81
  v_cvt_pk_bf16_f32 v69, v82, v83
  v_mfma_f32_32x32x16_bf16 v[104:119], v[48:51], v[64:67], v[104:119]
  ds_read_b64_tr_b16 v[40:41], v141 offset:3712
  v_exp_f32 v84, v84
  v_exp_f32 v85, v85
  v_exp_f32 v86, v86
  v_exp_f32 v87, v87
  v_cvt_pk_bf16_f32 v70, v84, v85
  v_cvt_pk_bf16_f32 v71, v86, v87
  v_mfma_f32_32x32x16_bf16 v[72:87], v[36:39], v[16:19], 0
  ds_read_b128 v[56:59], v142 offset:3648
  v_exp_f32 v88, v88
  v_exp_f32 v89, v89
  v_exp_f32 v90, v90
  v_exp_f32 v91, v91
  v_cvt_pk_bf16_f32 v64, v88, v89
  v_cvt_pk_bf16_f32 v65, v90, v91
  v_mfma_f32_32x32x16_bf16 v[104:119], v[52:55], v[68:71], v[104:119]
  ds_read_b128 v[60:63], v142 offset:3680
  v_exp_f32 v92, v92
  v_exp_f32 v93, v93
  v_exp_f32 v94, v94
  v_exp_f32 v95, v95
  v_cvt_pk_bf16_f32 v66, v92, v93
  v_cvt_pk_bf16_f32 v67, v94, v95
  v_mfma_f32_32x32x8bf16_1k v[72:87], v[42:43], v[24:25], v[72:87]
  v_exp_f32 v96, v96
  v_exp_f32 v97, v97
  v_exp_f32 v98, v98
  v_exp_f32 v99, v99
  v_cvt_pk_bf16_f32 v68, v96, v97
  v_cvt_pk_bf16_f32 v69, v98, v99
  v_mfma_f32_32x32x16_bf16 v[120:135], v[48:51], v[64:67], v[120:135]
  v_exp_f32 v100, v100
  v_exp_f32 v101, v101
  v_exp_f32 v102, v102
  v_exp_f32 v103, v103
  v_cvt_pk_bf16_f32 v70, v100, v101
  v_cvt_pk_bf16_f32 v71, v102, v103
  v_mfma_f32_32x32x16_bf16 v[88:103], v[36:39], v[20:23], 0
  v_exp_f32 v72, v72
  v_exp_f32 v73, v73
  v_exp_f32 v74, v74
  v_exp_f32 v75, v75
  v_cvt_pk_bf16_f32 v64, v72, v73
  v_cvt_pk_bf16_f32 v65, v74, v75
  v_mfma_f32_32x32x16_bf16 v[120:135], v[52:55], v[68:71], v[120:135]
  ds_read_b64_tr_b16 v[36:37], v140 offset:3776
  v_exp_f32 v76, v76
  v_exp_f32 v77, v77
  v_exp_f32 v78, v78
  v_exp_f32 v79, v79
  v_cvt_pk_bf16_f32 v66, v76, v77
  v_cvt_pk_bf16_f32 v67, v78, v79
  v_mfma_f32_32x32x8bf16_1k v[88:103], v[42:43], v[26:27], v[88:103]
  s_waitcnt lgkmcnt(1)
  ds_read_b64_tr_b16 v[38:39], v140 offset:20416
  v_exp_f32 v80, v80
  v_exp_f32 v81, v81
  v_exp_f32 v82, v82
  v_exp_f32_e64 v83, v83
  v_cvt_pk_bf16_f32 v68, v80, v81
  v_cvt_pk_bf16_f32 v69, v82, v83
  v_mfma_f32_32x32x16_bf16 v[104:119], v[56:59], v[64:67], v[104:119]
  ds_read_b64_tr_b16 v[42:43], v141 offset:3776
  v_exp_f32 v84, v84
  v_exp_f32 v85, v85
  v_exp_f32 v86, v86
  v_exp_f32 v87, v87
  v_cvt_pk_bf16_f32 v70, v84, v85
  v_cvt_pk_bf16_f32 v71, v86, v87
  v_mfma_f32_32x32x16_bf16 v[72:87], v[32:35], v[16:19], 0
  ds_read_b128 v[48:51], v142 offset:3712
  v_exp_f32 v88, v88
  v_exp_f32 v89, v89
  v_exp_f32 v90, v90
  v_exp_f32 v91, v91
  v_cvt_pk_bf16_f32 v64, v88, v89
  v_cvt_pk_bf16_f32 v65, v90, v91
  v_mfma_f32_32x32x16_bf16 v[104:119], v[60:63], v[68:71], v[104:119]
  ds_read_b128 v[52:55], v142 offset:3744
  v_exp_f32 v92, v92
  v_exp_f32 v93, v93
  v_exp_f32 v94, v94
  v_exp_f32 v95, v95
  v_cvt_pk_bf16_f32 v66, v92, v93
  v_cvt_pk_bf16_f32 v67, v94, v95
  v_mfma_f32_32x32x8bf16_1k v[72:87], v[40:41], v[24:25], v[72:87]
  v_exp_f32 v96, v96
  v_exp_f32 v97, v97
  v_exp_f32 v98, v98
  v_exp_f32 v99, v99
  v_cvt_pk_bf16_f32 v68, v96, v97
  v_cvt_pk_bf16_f32 v69, v98, v99
  v_mfma_f32_32x32x16_bf16 v[120:135], v[56:59], v[64:67], v[120:135]
  v_exp_f32 v100, v100
  v_exp_f32 v101, v101
  v_exp_f32 v102, v102
  v_exp_f32 v103, v103
  v_cvt_pk_bf16_f32 v70, v100, v101
  v_cvt_pk_bf16_f32 v71, v102, v103
  v_mfma_f32_32x32x16_bf16 v[88:103], v[32:35], v[20:23], 0
  v_exp_f32 v72, v72
  v_exp_f32 v73, v73
  v_exp_f32 v74, v74
  v_exp_f32 v75, v75
  v_cvt_pk_bf16_f32 v64, v72, v73
  v_cvt_pk_bf16_f32 v65, v74, v75
  v_mfma_f32_32x32x16_bf16 v[120:135], v[60:63], v[68:71], v[120:135]
  ds_read_b64_tr_b16 v[32:33], v140 offset:3840
  v_exp_f32 v76, v76
  v_exp_f32 v77, v77
  v_exp_f32 v78, v78
  v_exp_f32 v79, v79
  v_cvt_pk_bf16_f32 v66, v76, v77
  v_cvt_pk_bf16_f32 v67, v78, v79
  v_mfma_f32_32x32x8bf16_1k v[88:103], v[40:41], v[26:27], v[88:103]
  s_waitcnt lgkmcnt(1)
  ds_read_b64_tr_b16 v[34:35], v140 offset:20480
  v_exp_f32 v80, v80
  v_exp_f32 v81, v81
  v_exp_f32 v82, v82
  v_exp_f32_e64 v83, v83
  v_cvt_pk_bf16_f32 v68, v80, v81
  v_cvt_pk_bf16_f32 v69, v82, v83
  v_mfma_f32_32x32x16_bf16 v[104:119], v[48:51], v[64:67], v[104:119]
  ds_read_b64_tr_b16 v[40:41], v141 offset:3840
  v_exp_f32 v84, v84
  v_exp_f32 v85, v85
  v_exp_f32 v86, v86
  v_exp_f32 v87, v87
  v_cvt_pk_bf16_f32 v70, v84, v85
  v_cvt_pk_bf16_f32 v71, v86, v87
  v_mfma_f32_32x32x16_bf16 v[72:87], v[36:39], v[16:19], 0
  ds_read_b128 v[56:59], v142 offset:3776
  v_exp_f32 v88, v88
  v_exp_f32 v89, v89
  v_exp_f32 v90, v90
  v_exp_f32 v91, v91
  v_cvt_pk_bf16_f32 v64, v88, v89
  v_cvt_pk_bf16_f32 v65, v90, v91
  v_mfma_f32_32x32x16_bf16 v[104:119], v[52:55], v[68:71], v[104:119]
  ds_read_b128 v[60:63], v142 offset:3808
  v_exp_f32 v92, v92
  v_exp_f32 v93, v93
  v_exp_f32 v94, v94
  v_exp_f32 v95, v95
  v_cvt_pk_bf16_f32 v66, v92, v93
  v_cvt_pk_bf16_f32 v67, v94, v95
  v_mfma_f32_32x32x8bf16_1k v[72:87], v[42:43], v[24:25], v[72:87]
  v_exp_f32 v96, v96
  v_exp_f32 v97, v97
  v_exp_f32 v98, v98
  v_exp_f32 v99, v99
  v_cvt_pk_bf16_f32 v68, v96, v97
  v_cvt_pk_bf16_f32 v69, v98, v99
  v_mfma_f32_32x32x16_bf16 v[120:135], v[48:51], v[64:67], v[120:135]
  v_exp_f32 v100, v100
  v_exp_f32 v101, v101
  v_exp_f32 v102, v102
  v_exp_f32 v103, v103
  v_cvt_pk_bf16_f32 v70, v100, v101
  v_cvt_pk_bf16_f32 v71, v102, v103
  v_mfma_f32_32x32x16_bf16 v[88:103], v[36:39], v[20:23], 0
  v_exp_f32 v72, v72
  v_exp_f32 v73, v73
  v_exp_f32_e64 v74, v74
  v_exp_f32 v75, v75
  v_cvt_pk_bf16_f32 v64, v72, v73
  v_cvt_pk_bf16_f32 v65, v74, v75
  s_getpc_b64 s[94:95]
  v_mfma_f32_32x32x16_bf16 v[120:135], v[52:55], v[68:71], v[120:135]
  global_load_dword v231, v230, s[94:95]
  ds_read_b64_tr_b16 v[36:37], v140 offset:3904
  v_exp_f32 v76, v76
  v_exp_f32 v77, v77
  v_exp_f32 v78, v78
  v_exp_f32 v79, v79
  v_cvt_pk_bf16_f32 v66, v76, v77
  v_cvt_pk_bf16_f32 v67, v78, v79
  v_mfma_f32_32x32x8bf16_1k v[88:103], v[42:43], v[26:27], v[88:103]
  s_waitcnt lgkmcnt(1)
  ds_read_b64_tr_b16 v[38:39], v140 offset:20544
  v_exp_f32 v80, v80
  v_exp_f32 v81, v81
  v_exp_f32 v82, v82
  v_exp_f32_e64 v83, v83
  v_cvt_pk_bf16_f32 v68, v80, v81
  v_cvt_pk_bf16_f32 v69, v82, v83
  v_mfma_f32_32x32x16_bf16 v[104:119], v[56:59], v[64:67], v[104:119]
  ds_read_b64_tr_b16 v[42:43], v141 offset:3904
  v_exp_f32 v84, v84
  v_exp_f32 v85, v85
  v_exp_f32 v86, v86
  v_exp_f32 v87, v87
  v_cvt_pk_bf16_f32 v70, v84, v85
  v_cvt_pk_bf16_f32 v71, v86, v87
  v_mfma_f32_32x32x16_bf16 v[72:87], v[32:35], v[16:19], 0
  ds_read_b128 v[48:51], v142 offset:3840
  v_exp_f32 v88, v88
  v_exp_f32 v89, v89
  v_exp_f32 v90, v90
  v_exp_f32 v91, v91
  v_cvt_pk_bf16_f32 v64, v88, v89
  v_cvt_pk_bf16_f32 v65, v90, v91
  v_mfma_f32_32x32x16_bf16 v[104:119], v[60:63], v[68:71], v[104:119]
  ds_read_b128 v[52:55], v142 offset:3872
  v_exp_f32 v92, v92
  v_exp_f32 v93, v93
  v_exp_f32 v94, v94
  v_exp_f32 v95, v95
  v_cvt_pk_bf16_f32 v66, v92, v93
  v_cvt_pk_bf16_f32 v67, v94, v95
  v_mfma_f32_32x32x8bf16_1k v[72:87], v[40:41], v[24:25], v[72:87]
  v_exp_f32 v96, v96
  v_exp_f32 v97, v97
  v_exp_f32 v98, v98
  v_exp_f32 v99, v99
  v_cvt_pk_bf16_f32 v68, v96, v97
  v_cvt_pk_bf16_f32 v69, v98, v99
  v_mfma_f32_32x32x16_bf16 v[120:135], v[56:59], v[64:67], v[120:135]
  v_exp_f32 v100, v100
  v_exp_f32 v101, v101
  v_exp_f32 v102, v102
  v_exp_f32 v103, v103
  v_cvt_pk_bf16_f32 v70, v100, v101
  v_cvt_pk_bf16_f32 v71, v102, v103
  v_mfma_f32_32x32x16_bf16 v[88:103], v[32:35], v[20:23], 0
  v_exp_f32 v72, v72
  v_exp_f32 v73, v73
  v_exp_f32 v74, v74
  v_exp_f32 v75, v75
  v_cvt_pk_bf16_f32 v64, v72, v73
  v_cvt_pk_bf16_f32 v65, v74, v75
  v_mfma_f32_32x32x16_bf16 v[120:135], v[60:63], v[68:71], v[120:135]
  ds_read_b64_tr_b16 v[32:33], v140 offset:3968
  v_exp_f32 v76, v76
  v_exp_f32 v77, v77
  v_exp_f32 v78, v78
  v_exp_f32 v79, v79
  v_cvt_pk_bf16_f32 v66, v76, v77
  v_cvt_pk_bf16_f32 v67, v78, v79
  v_mfma_f32_32x32x8bf16_1k v[88:103], v[40:41], v[26:27], v[88:103]
  s_waitcnt lgkmcnt(1)
  ds_read_b64_tr_b16 v[34:35], v140 offset:20608
  v_exp_f32 v80, v80
  v_exp_f32 v81, v81
  v_exp_f32 v82, v82
  v_exp_f32_e64 v83, v83
  v_cvt_pk_bf16_f32 v68, v80, v81
  v_cvt_pk_bf16_f32 v69, v82, v83
  v_mfma_f32_32x32x16_bf16 v[104:119], v[48:51], v[64:67], v[104:119]
  ds_read_b64_tr_b16 v[40:41], v141 offset:3968
  v_exp_f32 v84, v84
  v_exp_f32 v85, v85
  v_exp_f32 v86, v86
  v_exp_f32 v87, v87
  v_cvt_pk_bf16_f32 v70, v84, v85
  v_cvt_pk_bf16_f32 v71, v86, v87
  v_mfma_f32_32x32x16_bf16 v[72:87], v[36:39], v[16:19], 0
  ds_read_b128 v[56:59], v142 offset:3904
  v_exp_f32 v88, v88
  v_exp_f32 v89, v89
  v_exp_f32 v90, v90
  v_exp_f32 v91, v91
  v_cvt_pk_bf16_f32 v64, v88, v89
  v_cvt_pk_bf16_f32 v65, v90, v91
  v_mfma_f32_32x32x16_bf16 v[104:119], v[52:55], v[68:71], v[104:119]
  ds_read_b128 v[60:63], v142 offset:3936
  v_exp_f32 v92, v92
  v_exp_f32 v93, v93
  v_exp_f32 v94, v94
  v_exp_f32 v95, v95
  v_cvt_pk_bf16_f32 v66, v92, v93
  v_cvt_pk_bf16_f32 v67, v94, v95
  v_mfma_f32_32x32x8bf16_1k v[72:87], v[42:43], v[24:25], v[72:87]
L_pg_10:
  s_cbranch_execz L_wr_1
  v_exp_f32_e64 v96, v96
  v_exp_f32 v97, v97
  v_exp_f32 v98, v98
  v_exp_f32 v99, v99
  v_cvt_pk_bf16_f32 v68, v96, v97
  v_cvt_pk_bf16_f32 v69, v98, v99
  v_mfma_f32_32x32x16_bf16 v[120:135], v[48:51], v[64:67], v[120:135]
  v_exp_f32 v100, v100
  v_exp_f32 v101, v101
  v_exp_f32 v102, v102
  v_exp_f32 v103, v103
  v_cvt_pk_bf16_f32 v70, v100, v101
  v_cvt_pk_bf16_f32 v71, v102, v103
  v_mfma_f32_32x32x16_bf16 v[88:103], v[36:39], v[20:23], 0
  v_exp_f32 v72, v72
  v_exp_f32 v73, v73
  v_exp_f32 v74, v74
  v_exp_f32 v75, v75
  v_cvt_pk_bf16_f32 v64, v72, v73
  v_cvt_pk_bf16_f32 v65, v74, v75
  v_mfma_f32_32x32x16_bf16 v[120:135], v[52:55], v[68:71], v[120:135]
  ds_read_b64_tr_b16 v[36:37], v140 offset:4032
  v_exp_f32 v76, v76
  v_exp_f32 v77, v77
  v_exp_f32 v78, v78
  v_exp_f32 v79, v79
  v_cvt_pk_bf16_f32 v66, v76, v77
  v_cvt_pk_bf16_f32 v67, v78, v79
  v_mfma_f32_32x32x8bf16_1k v[88:103], v[42:43], v[26:27], v[88:103]
  s_waitcnt lgkmcnt(1)
  ds_read_b64_tr_b16 v[38:39], v140 offset:20672
  v_exp_f32 v80, v80
  v_exp_f32 v81, v81
  v_exp_f32 v82, v82
  v_exp_f32_e64 v83, v83
  v_cvt_pk_bf16_f32 v68, v80, v81
  v_cvt_pk_bf16_f32 v69, v82, v83
  v_mfma_f32_32x32x16_bf16 v[104:119], v[56:59], v[64:67], v[104:119]
  ds_read_b64_tr_b16 v[42:43], v141 offset:4032
  v_exp_f32 v84, v84
  v_exp_f32 v85, v85
  v_exp_f32 v86, v86
  v_exp_f32 v87, v87
  v_cvt_pk_bf16_f32 v70, v84, v85
  v_cvt_pk_bf16_f32 v71, v86, v87
  v_mfma_f32_32x32x16_bf16 v[72:87], v[32:35], v[16:19], 0
  ds_read_b128 v[48:51], v142 offset:3968
  v_exp_f32 v88, v88
  v_exp_f32 v89, v89
  v_exp_f32 v90, v90
  v_exp_f32 v91, v91
  v_cvt_pk_bf16_f32 v64, v88, v89
  v_cvt_pk_bf16_f32 v65, v90, v91
  v_mfma_f32_32x32x16_bf16 v[104:119], v[60:63], v[68:71], v[104:119]
  buffer_load_dword v245, v246, s[96:99], 0 offen
  ds_read_b128 v[52:55], v142 offset:4000
  v_exp_f32 v92, v92
  v_exp_f32 v93, v93
  v_exp_f32 v94, v94
  v_exp_f32 v95, v95
  v_cvt_pk_bf16_f32 v66, v92, v93
  v_cvt_pk_bf16_f32 v67, v94, v95
  v_mfma_f32_32x32x8bf16_1k v[72:87], v[40:41], v[24:25], v[72:87]
  v_exp_f32 v96, v96
  v_exp_f32 v97, v97
  v_exp_f32 v98, v98
  v_exp_f32 v99, v99
  v_cvt_pk_bf16_f32 v68, v96, v97
  v_cvt_pk_bf16_f32 v69, v98, v99
  v_mfma_f32_32x32x16_bf16 v[120:135], v[56:59], v[64:67], v[120:135]
  v_exp_f32 v100, v100
  v_exp_f32 v101, v101
  v_exp_f32 v102, v102
  v_exp_f32 v103, v103
  v_cvt_pk_bf16_f32 v70, v100, v101
  v_cvt_pk_bf16_f32 v71, v102, v103
  v_mfma_f32_32x32x16_bf16 v[88:103], v[32:35], v[20:23], 0
  v_exp_f32 v72, v72
  v_exp_f32 v73, v73
  v_exp_f32 v74, v74
  v_exp_f32 v75, v75
  v_cvt_pk_bf16_f32 v64, v72, v73
  v_cvt_pk_bf16_f32 v65, v74, v75
  v_mfma_f32_32x32x16_bf16 v[120:135], v[60:63], v[68:71], v[120:135]
  ds_read_b64_tr_b16 v[32:33], v140 offset:4096
  v_exp_f32 v76, v76
  v_exp_f32 v77, v77
  v_exp_f32 v78, v78
  v_exp_f32 v79, v79
  v_cvt_pk_bf16_f32 v66, v76, v77
  v_cvt_pk_bf16_f32 v67, v78, v79
  v_mfma_f32_32x32x8bf16_1k v[88:103], v[40:41], v[26:27], v[88:103]
  s_waitcnt lgkmcnt(1)
  ds_read_b64_tr_b16 v[34:35], v140 offset:20736
  v_exp_f32 v80, v80
  v_exp_f32 v81, v81
  v_exp_f32 v82, v82
  v_exp_f32_e64 v83, v83
  v_cvt_pk_bf16_f32 v68, v80, v81
  v_cvt_pk_bf16_f32 v69, v82, v83
  v_mfma_f32_32x32x16_bf16 v[104:119], v[48:51], v[64:67], v[104:119]
  ds_read_b64_tr_b16 v[40:41], v141 offset:4096
  v_exp_f32 v84, v84
  v_exp_f32 v85, v85
  v_exp_f32 v86, v86
  v_exp_f32 v87, v87
  v_cvt_pk_bf16_f32 v70, v84, v85
  v_cvt_pk_bf16_f32 v71, v86, v87
  v_mfma_f32_32x32x16_bf16 v[72:87], v[36:39], v[16:19], 0
  ds_read_b128 v[56:59], v142 offset:4032
  v_exp_f32 v88, v88
  v_exp_f32 v89, v89
  v_exp_f32 v90, v90
  v_exp_f32 v91, v91
  v_cvt_pk_bf16_f32 v64, v88, v89
  v_cvt_pk_bf16_f32 v65, v90, v91
  v_mfma_f32_32x32x16_bf16 v[104:119], v[52:55], v[68:71], v[104:119]
  ds_read_b128 v[60:63], v142 offset:4064
  v_exp_f32 v92, v92
  v_exp_f32 v93, v93
  v_exp_f32 v94, v94
  v_exp_f32 v95, v95
  v_cvt_pk_bf16_f32 v66, v92, v93
  v_cvt_pk_bf16_f32 v67, v94, v95
  v_mfma_f32_32x32x8bf16_1k v[72:87], v[42:43], v[24:25], v[72:87]
  v_exp_f32 v96, v96
  v_exp_f32 v97, v97
  v_exp_f32 v98, v98
  v_exp_f32 v99, v99
  v_cvt_pk_bf16_f32 v68, v96, v97
  v_cvt_pk_bf16_f32 v69, v98, v99
  v_mfma_f32_32x32x16_bf16 v[120:135], v[48:51], v[64:67], v[120:135]
  v_exp_f32 v100, v100
  v_exp_f32 v101, v101
  v_exp_f32 v102, v102
  v_exp_f32 v103, v103
  v_cvt_pk_bf16_f32 v70, v100, v101
  v_cvt_pk_bf16_f32 v71, v102, v103
  v_mfma_f32_32x32x16_bf16 v[88:103], v[36:39], v[20:23], 0
  v_exp_f32 v72, v72
  v_exp_f32 v73, v73
  v_exp_f32 v74, v74
  v_exp_f32 v75, v75
  v_cvt_pk_bf16_f32 v64, v72, v73
  v_cvt_pk_bf16_f32 v65, v74, v75
  v_mfma_f32_32x32x16_bf16 v[120:135], v[52:55], v[68:71], v[120:135]
  ds_read_b64_tr_b16 v[36:37], v140 offset:4160
  v_exp_f32 v76, v76
  v_exp_f32 v77, v77
  v_exp_f32 v78, v78
  v_exp_f32 v79, v79
  v_cvt_pk_bf16_f32 v66, v76, v77
  v_cvt_pk_bf16_f32 v67, v78, v79
  v_mfma_f32_32x32x8bf16_1k v[88:103], v[42:43], v[26:27], v[88:103]
  s_waitcnt lgkmcnt(1)
  ds_read_b64_tr_b16 v[38:39], v140 offset:20800
  v_exp_f32 v80, v80
  v_exp_f32 v81, v81
  v_exp_f32 v82, v82
  v_exp_f32_e64 v83, v83
  v_cvt_pk_bf16_f32 v68, v80, v81
  v_cvt_pk_bf16_f32 v69, v82, v83
  v_mfma_f32_32x32x16_bf16 v[104:119], v[56:59], v[64:67], v[104:119]
  ds_read_b64_tr_b16 v[42:43], v141 offset:4160
  v_exp_f32 v84, v84
  v_exp_f32 v85, v85
  v_exp_f32 v86, v86
  v_exp_f32 v87, v87
  v_cvt_pk_bf16_f32 v70, v84, v85
  v_cvt_pk_bf16_f32 v71, v86, v87
  v_mfma_f32_32x32x16_bf16 v[72:87], v[32:35], v[16:19], 0
  ds_read_b128 v[48:51], v142 offset:4096
  v_exp_f32 v88, v88
  v_exp_f32 v89, v89
  v_exp_f32 v90, v90
  v_exp_f32 v91, v91
  v_cvt_pk_bf16_f32 v64, v88, v89
  v_cvt_pk_bf16_f32 v65, v90, v91
  v_mfma_f32_32x32x16_bf16 v[104:119], v[60:63], v[68:71], v[104:119]
  ds_read_b128 v[52:55], v142 offset:4128
  v_exp_f32 v92, v92
  v_exp_f32 v93, v93
  v_exp_f32 v94, v94
  v_exp_f32 v95, v95
  v_cvt_pk_bf16_f32 v66, v92, v93
  v_cvt_pk_bf16_f32 v67, v94, v95
  v_mfma_f32_32x32x8bf16_1k v[72:87], v[40:41], v[24:25], v[72:87]
  v_exp_f32 v96, v96
  v_exp_f32 v97, v97
  v_exp_f32 v98, v98
  v_exp_f32 v99, v99
  v_cvt_pk_bf16_f32 v68, v96, v97
  v_cvt_pk_bf16_f32 v69, v98, v99
  v_mfma_f32_32x32x16_bf16 v[120:135], v[56:59], v[64:67], v[120:135]
  v_exp_f32 v100, v100
  v_exp_f32 v101, v101
  v_exp_f32 v102, v102
  v_exp_f32 v103, v103
  v_cvt_pk_bf16_f32 v70, v100, v101
  v_cvt_pk_bf16_f32 v71, v102, v103
L_k2_lend:
  s_nop 1
  v_mfma_f32_32x32x16_bf16 v[120:135], v[60:63], v[68:71], v[120:135]
  s_waitcnt lgkmcnt(0)
  s_nop 15
  s_nop 3
  v_mov_b32 v8, v114
  v_mov_b32 v10, v114
  s_nop 1
  v_permlane32_swap_b32 v8, v10
  s_nop 1
  v_mov_b32 v9, v130
  v_mov_b32 v10, v130
  s_nop 1
  v_permlane32_swap_b32 v9, v10
  s_nop 1
  s_cmp_lg_u32 s31, 0
  s_cbranch_scc1 L_k2_store
  v_max3_f32 v10, abs(v104), abs(v105), abs(v106)
  v_max3_f32 v10, v10, abs(v107), abs(v108)
  v_max3_f32 v10, v10, abs(v109), abs(v110)
  v_max3_f32 v10, v10, abs(v111), abs(v112)
  v_max3_f32 v10, v10, abs(v113), abs(v114)
  v_max3_f32 v10, v10, abs(v115), abs(v116)
  v_max3_f32 v10, v10, abs(v117), abs(v118)
  v_max3_f32 v10, v10, abs(v119), abs(v120)
  v_max3_f32 v10, v10, abs(v121), abs(v122)
  v_max3_f32 v10, v10, abs(v123), abs(v124)
  v_max3_f32 v10, v10, abs(v125), abs(v126)
  v_max3_f32 v10, v10, abs(v127), abs(v128)
  v_max3_f32 v10, v10, abs(v129), abs(v130)
  v_max3_f32 v10, v10, abs(v131), abs(v132)
  v_max3_f32 v10, v10, abs(v133), abs(v134)
  v_max_f32 v10, v10, abs(v135)
  v_mov_b32 v11, 0x5d800000
  v_mov_b32 v12, 0x7b800000
  v_cmp_lt_f32 s[48:49], v8, v11
  v_cmp_lt_f32 s[50:51], v9, v11
  s_and_b64 s[48:49], s[48:49], s[50:51]
  v_min_f32 v11, v8, v9
  v_cmp_lt_f32 vcc, 0x21800000, v11
  s_and_b64 s[48:49], s[48:49], vcc
  v_cmp_lt_f32 s[50:51], v10, v12
  v_cmp_o_f32 vcc, v104, v105
  s_and_b64 s[48:49], s[48:49], vcc
  v_cmp_o_f32 vcc, v106, v107
  s_and_b64 s[48:49], s[48:49], vcc
  v_cmp_o_f32 vcc, v108, v109
  s_and_b64 s[48:49], s[48:49], vcc
  v_cmp_o_f32 vcc, v110, v111
  s_and_b64 s[48:49], s[48:49], vcc
  v_cmp_o_f32 vcc, v112, v113
  s_and_b64 s[48:49], s[48:49], vcc
  v_cmp_o_f32 vcc, v114, v115
  s_and_b64 s[48:49], s[48:49], vcc
  v_cmp_o_f32 vcc, v116, v117
  s_and_b64 s[48:49], s[48:49], vcc
  v_cmp_o_f32 vcc, v118, v119
  s_and_b64 s[48:49], s[48:49], vcc
  v_cmp_o_f32 vcc, v120, v121
  s_and_b64 s[48:49], s[48:49], vcc
  v_cmp_o_f32 vcc, v122, v123
  s_and_b64 s[48:49], s[48:49], vcc
  v_cmp_o_f32 vcc, v124, v125
  s_and_b64 s[48:49], s[48:49], vcc
  v_cmp_o_f32 vcc, v126, v127
  s_and_b64 s[48:49], s[48:49], vcc
  v_cmp_o_f32 vcc, v128, v129
  s_and_b64 s[48:49], s[48:49], vcc
  v_cmp_o_f32 vcc, v130, v131
  s_and_b64 s[48:49], s[48:49], vcc
  v_cmp_o_f32 vcc, v132, v133
  s_and_b64 s[48:49], s[48:49], vcc
  v_cmp_o_f32 vcc, v134, v135
  s_and_b64 s[48:49], s[48:49], vcc
  s_and_b64 s[48:49], s[48:49], s[50:51]
  s_cmp_eq_u64 s[48:49], exec
  s_cbranch_scc1 L_k2_store
  s_mov_b32 s31, 1
  s_mov_b32 s30, 64
  ds_write_b32 v236, v240 offset:4
  s_waitcnt vmcnt(0)
  s_branch L_k2_vote
L_k2_store:
  v_rcp_f32 v8, v8
  v_rcp_f32 v9, v9
  v_mul_f32 v104, v104, v8
  v_mul_f32 v105, v105, v8
  v_mul_f32 v106, v106, v8
  v_mul_f32 v107, v107, v8
  v_mul_f32 v108, v108, v8
  v_mul_f32 v109, v109, v8
  v_mul_f32 v110, v110, v8
  v_mul_f32 v111, v111, v8
  v_mul_f32 v112, v112, v8
  v_mul_f32 v113, v113, v8
  v_cvt_pk_bf16_f32 v72, v104, v105
  v_cvt_pk_bf16_f32 v73, v106, v107
  v_cvt_pk_bf16_f32 v74, v108, v109
  v_cvt_pk_bf16_f32 v75, v110, v111
  v_cvt_pk_bf16_f32 v76, v112, v113
  buffer_store_dwordx4 v[72:75], v29, s[24:27], 0 offen sc0 sc1
  buffer_store_dword v76, v28, s[24:27], 0 offen sc0 sc1
  v_mul_f32 v120, v120, v9
  v_mul_f32 v121, v121, v9
  v_mul_f32 v122, v122, v9
  v_mul_f32 v123, v123, v9
  v_mul_f32 v124, v124, v9
  v_mul_f32 v125, v125, v9
  v_mul_f32 v126, v126, v9
  v_mul_f32 v127, v127, v9
  v_mul_f32 v128, v128, v9
  v_mul_f32 v129, v129, v9
  v_cvt_pk_bf16_f32 v88, v120, v121
  v_cvt_pk_bf16_f32 v89, v122, v123
  v_cvt_pk_bf16_f32 v90, v124, v125
  v_cvt_pk_bf16_f32 v91, v126, v127
  v_cvt_pk_bf16_f32 v92, v128, v129
  buffer_store_dwordx4 v[88:91], v29, s[24:27], s85 offen sc0 sc1
  buffer_store_dword v92, v28, s[24:27], s85 offen sc0 sc1
  buffer_store_dwordx4 v[240:243], v244, s[96:99], 0 offen sc0 sc1
  s_cmp_lg_u32 s31, 0
  s_cbranch_scc1 L_k2_join
L_k2_vote:
  s_waitcnt vmcnt(5)
  s_mov_b32 s34, 0
L_d2_chk:
  v_cmp_ne_u32_e64 vcc, 1, v245
  s_cmp_eq_u64 vcc, 0
  s_cbranch_scc1 L_d2_go
  s_add_u32 s34, s34, 1
  s_cmp_lt_u32 s34, 0x40000
  s_cbranch_scc0 L_d2_go
  buffer_load_dword v245, v246, s[96:99], 0 offen sc0 sc1
  s_waitcnt vmcnt(0)
  s_branch L_d2_chk
L_d2_go:
  s_waitcnt lgkmcnt(0)
  s_barrier
  ds_read_b32 v237, v236 offset:4
  s_waitcnt lgkmcnt(0)
  v_cmp_ne_u32 vcc, 0, v237
  s_cmp_eq_u64 vcc, 0
  s_cbranch_scc0 L_k2_slow
L_k2_done:
  s_load_dwordx4 s[76:79], s[0:1], 32
  s_load_dwordx4 s[80:83], s[0:1], 48
  s_load_dwordx2 s[84:85], s[0:1], 64
  s_load_dwordx2 s[86:87], s[0:1], 0
  s_mov_b32 s10, s8
  s_mov_b32 s11, s9
L_k2_end:
L_kb_start:
  v_and_b32_e64 v2, 15, v0
  v_bfe_u32 v3, v0, 4, 2
L_kb_pf0:
  s_and_b32 s13, s2, 7
  s_lshr_b32 s14, s2, 3
  s_and_b32 s15, s13, 1
  s_lshl_b32 s15, s15, 3
  s_and_b32 s28, s14, 7
  s_add_u32 s28, s28, s15
  s_lshr_b32 s15, s13, 1
  s_lshl_b32 s15, s15, 2
  s_lshr_b32 s29, s14, 3
  s_add_u32 s29, s29, s15
  v_lshlrev_b32_e64 v4, 4, v1
  v_add_u32 v5, 0x10000, v4
  v_add_u32 v6, 0x20000, v4
  v_add_u32 v7, 18432, v4
  s_mul_i32 s30, s29, 288
  s_mul_i32 s31, s29, 331776
  s_mul_i32 s64, s12, 3072
  s_mul_i32 s65, s12, 9216
  s_add_u32 s66, s31, s64
  s_add_u32 s67, s31, s65
  s_lshl_b32 s33, s28, 2
  s_add_u32 s33, s33, s12
  s_mul_i32 s34, s33, 36864
  s_add_u32 s16, s10, 9437184
  s_addc_u32 s17, s11, 0
  s_mov_b32 s18, 2359296
  s_mov_b32 s19, 0x00020000
  s_add_u32 s20, s10, 40894464
  s_addc_u32 s21, s11, 0
  s_mov_b32 s22, 5308416
  s_mov_b32 s23, 0x00020000
L_kb_pf1:
  s_and_b32 s71, s29, 7
  s_lshr_b32 s72, s71, 1
  s_mul_i32 s73, s72, 9
  s_and_b32 s74, s71, 1
  s_mul_i32 s75, s74, 5
  s_add_u32 s73, s73, s75
  s_lshr_b32 s75, s29, 3
  s_lshl_b32 s75, s75, 2
  s_lshl_b32 s71, s28, 3
  s_add_u32 s71, s71, s75
  s_add_u32 s71, s71, s12
  s_mul_i32 s70, s71, 18432
  s_add_u32 s48, s10, 7077888
  s_addc_u32 s49, s11, 0
  s_mov_b32 s50, 2359296
  s_mov_b32 s51, 0x00020000
  v_lshlrev_b32_e64 v16, 8, v3
  v_lshl_add_u32 v16, v2, 2, v16
  v_mul_u32_u24 v9, 160, v2
  v_lshl_add_u32 v9, v3, 3, v9
  v_add_u32_e64 v9, s54, v9
  ds_read_b64 v[52:53], v9 offset:0
  ds_read_b64 v[54:55], v9 offset:32
  ds_read_b64 v[56:57], v9 offset:64
  ds_read_b64 v[58:59], v9 offset:96
  ds_read_b64 v[60:61], v9 offset:128
  s_lshr_b32 s37, s71, 2
  s_lshl_b32 s37, s37, 11
  s_add_u32 s37, s37, 16384
  v_and_b32 v17, 0x1f0, v4
  v_lshlrev_b32_e64 v17, 2, v17
  v_and_b32 v20, 0x1c0, v17
  s_lshl_b32 s38, s12, 9
  v_add_u32 v20, s38, v20
  v_mov_b32_e64 v240, 2
  buffer_load_dword v18, v20, s[96:99], s37 offen sc0 sc1
  s_add_u32 s44, s10, 40108032
  s_addc_u32 s45, s11, 0
  s_mov_b32 s46, 55296
  s_mov_b32 s47, 0x00020000
  s_lshl_b32 s41, s30, 1
  buffer_load_dwordx4 v[116:119], v4, s[44:47], s41 offen
  s_add_u32 s41, s41, 9216
  buffer_load_dwordx4 v[120:123], v4, s[44:47], s41 offen
  s_add_u32 s41, s41, 9216
  buffer_load_dwordx4 v[124:127], v4, s[44:47], s41 offen
  s_add_u32 s41, s41, 9216
  buffer_load_dwordx4 v[128:131], v4, s[44:47], s41 offen
  s_add_u32 s41, s41, 9216
  buffer_load_dwordx4 v[132:135], v4, s[44:47], s41 offen
  s_add_u32 s41, s41, 9216
  buffer_load_dwordx4 v[136:139], v4, s[44:47], s41 offen
  s_lshl_b32 s41, s12, 267
  s_add_u32 s41, s41, 74880
  v_add_u32_e64 v140, s41, v4
  v_lshl_add_u32 v202, v2, 2, s41
  v_lshl_add_u32 v203, v3, 4, s41
  ds_read_b128 a[144:147], v4 offset:0
  ds_read_b128 a[148:151], v4 offset:1024
  ds_read_b128 a[152:155], v4 offset:2048
  ds_read_b128 a[156:159], v4 offset:4160
  ds_read_b128 a[160:163], v4 offset:5184
  ds_read_b128 a[164:167], v4 offset:37440
  ds_read_b128 a[168:171], v4 offset:38464
  ds_read_b128 a[172:175], v4 offset:39488
  s_and_b32 s38, s28, 7
  s_lshl_b32 s38, s38, 2
  s_add_u32 s38, s38, s12
  s_lshl_b32 s38, s38, 6
  s_add_u32 s38, s38, s31
  v_lshlrev_b32 v11, 7, v4
  s_waitcnt lgkmcnt(0)
  s_mov_b64 exec, 0
  s_bitcmp1_b32 s12, 1
  s_cbranch_scc1 L_wh_2
  s_bitcmp1_b32 s12, 0
  s_cbranch_scc1 L_pg_12
  s_branch L_pg_11
L_wh_2:
  s_bitcmp1_b32 s12, 0
  s_cbranch_scc1 L_pg_14
  s_branch L_pg_13
L_wr_2:
  s_mov_b64 exec, -1
  s_waitcnt vmcnt(0)
  buffer_store_dwordx4 v[240:243], v244, s[96:99], 0 offen sc0 sc1
  v_add_f32 v116, v116, v124
  v_add_f32 v117, v117, v125
  v_add_f32 v118, v118, v126
  v_add_f32 v119, v119, v127
  v_add_f32 v120, v120, v128
  v_add_f32 v121, v121, v129
  v_add_f32 v122, v122, v130
  v_add_f32 v123, v123, v131
  v_add_f32 v116, v116, v132
  v_add_f32 v117, v117, v133
  v_add_f32 v118, v118, v134
  v_add_f32 v119, v119, v135
  v_add_f32 v120, v120, v136
  v_add_f32 v121, v121, v137
  v_add_f32_e64 v122, v122, v138
  v_add_f32 v123, v123, v139
  ds_write_b128 v140, v[116:119] offset:0
  ds_write_b128 v140, v[120:123] offset:1024
  s_waitcnt lgkmcnt(0)
  ds_read_b32 v192, v202 offset:1024
  ds_read_b128 v[204:207], v203 offset:0
  ds_read_b32 v193, v202 offset:1088
  ds_read_b128 v[208:211], v203 offset:64
  ds_read_b32 v194, v202 offset:1152
  ds_read_b128 v[212:215], v203 offset:128
  ds_read_b32 v195, v202 offset:1216
  ds_read_b128 v[216:219], v203 offset:192
  ds_read_b32 v196, v202 offset:1280
  ds_read_b128 v[220:223], v203 offset:256
  ds_read_b32 v197, v202 offset:1344
  ds_read_b128 v[224:227], v203 offset:320
  ds_read_b32 v198, v202 offset:1408
  ds_read_b128 v[228:231], v203 offset:384
  ds_read_b32 v199, v202 offset:1472
  ds_read_b128 v[232:235], v203 offset:448
  ds_read_b32 v200, v202 offset:1536
  ds_read_b128 v[236:239], v203 offset:512
  s_mov_b32 s40, 0
L_f2_chk:
  v_cmp_lt_u32 vcc, 2, v18
  s_cmp_eq_u64 vcc, 0
  s_cbranch_scc1 L_f2_go
  s_add_u32 s40, s40, 1
  s_cmp_lt_u32 s40, 0x40000
  s_cbranch_scc0 L_f2_go
  buffer_load_dword v18, v20, s[96:99], s37 offen sc0 sc1
  s_waitcnt vmcnt(0)
  s_branch L_f2_chk
L_f2_go:
  s_barrier
  s_add_u32 s36, s70, 0
  buffer_load_dwordx4 a[0:3], v4, s[48:51], s36 offen offset:0
  buffer_load_dwordx4 a[4:7], v4, s[48:51], s36 offen offset:1024
  buffer_load_dwordx4 a[8:11], v4, s[48:51], s36 offen offset:2048
  buffer_load_dwordx4 a[12:15], v4, s[48:51], s36 offen offset:3072
  s_add_u32 s36, s70, 4096
  buffer_load_dwordx4 a[16:19], v4, s[48:51], s36 offen offset:0
  buffer_load_dwordx4 a[20:23], v4, s[48:51], s36 offen offset:1024
  buffer_load_dwordx4 a[24:27], v4, s[48:51], s36 offen offset:2048
  buffer_load_dwordx4 a[28:31], v4, s[48:51], s36 offen offset:3072
  s_add_u32 s36, s70, 8192
  buffer_load_dwordx4 a[32:35], v4, s[48:51], s36 offen offset:0
  buffer_load_dwordx4 a[36:39], v4, s[48:51], s36 offen offset:1024
  buffer_load_dwordx4 a[40:43], v4, s[48:51], s36 offen offset:2048
  buffer_load_dwordx4 a[44:47], v4, s[48:51], s36 offen offset:3072
  s_add_u32 s36, s70, 12288
  buffer_load_dwordx4 a[48:51], v4, s[48:51], s36 offen offset:0
  buffer_load_dwordx4 a[52:55], v4, s[48:51], s36 offen offset:1024
  buffer_load_dwordx4 a[56:59], v4, s[48:51], s36 offen offset:2048
  buffer_load_dwordx4 a[60:63], v4, s[48:51], s36 offen offset:3072
  s_add_u32 s36, s70, 16384
  buffer_load_dword a64, v16, s[48:51], s36 offen offset:0
  buffer_load_dword a65, v16, s[48:51], s36 offen offset:64
  buffer_load_dword a66, v16, s[48:51], s36 offen offset:128
  buffer_load_dword a67, v16, s[48:51], s36 offen offset:192
  buffer_load_dword a68, v16, s[48:51], s36 offen offset:1024
  buffer_load_dword a69, v16, s[48:51], s36 offen offset:1088
  buffer_load_dword a70, v16, s[48:51], s36 offen offset:1152
  buffer_load_dword a71, v16, s[48:51], s36 offen offset:1216
  buffer_load_dword a249, v11, s[20:23], s38 offen
  s_add_u32 s24, s10, 60030976
  s_addc_u32 s25, s11, 0
  s_mov_b32 s26, 131072
  s_mov_b32 s27, 0x00020000
  v_lshlrev_b32_e64 v10, 3, v2
  v_lshl_add_u32 v10, v3, 28, v10
  s_waitcnt vmcnt(24)
  v_mfma_f32_16x16x32_bf16 v[32:35], a[144:147], a[0:3], 0
  ds_read_b128 a[176:179], v4 offset:41600
  v_mfma_f32_16x16x32_bf16 v[36:39], a[148:151], a[0:3], 0
  ds_read_b128 a[180:183], v4 offset:42624
  v_mfma_f32_16x16x32_bf16 v[40:43], a[152:155], a[0:3], 0
  ds_read_b128 a[184:187], v5 offset:17760
  v_mfma_f32_16x16x32_bf16 v[44:47], a[156:159], a[0:3], 0
  ds_read_b128 a[188:191], v5 offset:18784
  v_mfma_f32_16x16x32_bf16 v[48:51], a[160:163], a[0:3], 0
  ds_read_b128 a[192:195], v5 offset:19808
  s_waitcnt vmcnt(23)
  v_mfma_f32_16x16x32_bf16 v[32:35], a[164:167], a[4:7], v[32:35]
  ds_read_b128 a[196:199], v5 offset:21872
  v_mfma_f32_16x16x32_bf16 v[36:39], a[168:171], a[4:7], v[36:39]
  ds_read_b128 a[200:203], v5 offset:22896
  v_mfma_f32_16x16x32_bf16 v[40:43], a[172:175], a[4:7], v[40:43]
  ds_read_b128 a[204:207], v5 offset:54768
  s_waitcnt lgkmcnt(6)
  v_mfma_f32_16x16x32_bf16 v[44:47], a[176:179], a[4:7], v[44:47]
  ds_read_b128 a[208:211], v5 offset:55792
  v_mfma_f32_16x16x32_bf16 v[48:51], a[180:183], a[4:7], v[48:51]
  ds_read_b128 a[212:215], v5 offset:56816
  s_waitcnt vmcnt(22)
  s_waitcnt lgkmcnt(6)
  v_mfma_f32_16x16x32_bf16 v[32:35], a[184:187], a[8:11], v[32:35]
  ds_read_b128 a[144:147], v5 offset:58880
  v_mfma_f32_16x16x32_bf16 v[36:39], a[188:191], a[8:11], v[36:39]
  ds_read_b128 a[148:151], v5 offset:59904
  s_waitcnt lgkmcnt(6)
  v_mfma_f32_16x16x32_bf16 v[40:43], a[192:195], a[8:11], v[40:43]
  ds_read_b128 a[152:155], v4 offset:6208
  v_mfma_f32_16x16x32_bf16 v[44:47], a[196:199], a[8:11], v[44:47]
  ds_read_b128 a[156:159], v4 offset:8320
  s_waitcnt lgkmcnt(6)
  v_mfma_f32_16x16x32_bf16 v[48:51], a[200:203], a[8:11], v[48:51]
  ds_read_b128 a[160:163], v4 offset:9344
  s_waitcnt vmcnt(21)
  v_mfma_f32_16x16x32_bf16 v[32:35], a[204:207], a[12:15], v[32:35]
  ds_read_b128 a[164:167], v4 offset:10368
  s_waitcnt lgkmcnt(6)
  v_mfma_f32_16x16x32_bf16 v[36:39], a[208:211], a[12:15], v[36:39]
  ds_read_b128 a[168:171], v4 offset:12480
  v_mfma_f32_16x16x32_bf16 v[40:43], a[212:215], a[12:15], v[40:43]
  ds_read_b128 a[172:175], v4 offset:43648
  s_waitcnt lgkmcnt(6)
  v_mfma_f32_16x16x32_bf16 v[44:47], a[144:147], a[12:15], v[44:47]
  ds_read_b128 a[176:179], v4 offset:45760
  v_mfma_f32_16x16x32_bf16 v[48:51], a[148:151], a[12:15], v[48:51]
  ds_read_b128 a[180:183], v4 offset:46784
  s_waitcnt vmcnt(20)
  s_waitcnt lgkmcnt(6)
  v_mfma_f32_16x16x32_bf16 v[32:35], a[152:155], a[16:19], v[32:35]
  ds_read_b128 a[184:187], v4 offset:47808
  v_mfma_f32_16x16x32_bf16 v[36:39], a[156:159], a[16:19], v[36:39]
  ds_read_b128 a[188:191], v4 offset:49920
  s_waitcnt lgkmcnt(6)
  v_mfma_f32_16x16x32_bf16 v[40:43], a[160:163], a[16:19], v[40:43]
  ds_read_b128 a[192:195], v5 offset:23920
  v_mfma_f32_16x16x32_bf16 v[44:47], a[164:167], a[16:19], v[44:47]
  ds_read_b128 a[196:199], v5 offset:25984
  s_waitcnt lgkmcnt(6)
  v_mfma_f32_16x16x32_bf16 v[48:51], a[168:171], a[16:19], v[48:51]
  ds_read_b128 a[200:203], v5 offset:27008
  s_waitcnt vmcnt(19)
  v_mfma_f32_16x16x32_bf16 v[32:35], a[172:175], a[20:23], v[32:35]
  ds_read_b128 a[204:207], v5 offset:28032
  s_waitcnt lgkmcnt(6)
  v_mfma_f32_16x16x32_bf16 v[36:39], a[176:179], a[20:23], v[36:39]
  ds_read_b128 a[208:211], v5 offset:30096
  v_mfma_f32_16x16x32_bf16 v[40:43], a[180:183], a[20:23], v[40:43]
  ds_read_b128 a[212:215], v5 offset:60928
  s_waitcnt lgkmcnt(6)
  v_mfma_f32_16x16x32_bf16 v[44:47], a[184:187], a[20:23], v[44:47]
  ds_read_b128 a[144:147], v5 offset:62992
  v_mfma_f32_16x16x32_bf16 v[48:51], a[188:191], a[20:23], v[48:51]
  ds_read_b128 a[148:151], v5 offset:64016
  s_waitcnt vmcnt(18)
  s_waitcnt lgkmcnt(6)
  v_mfma_f32_16x16x32_bf16 v[32:35], a[192:195], a[24:27], v[32:35]
  ds_read_b128 a[152:155], v5 offset:65040
  v_mfma_f32_16x16x32_bf16 v[36:39], a[196:199], a[24:27], v[36:39]
  ds_read_b128 a[156:159], v6 offset:1568
  s_waitcnt lgkmcnt(6)
  v_mfma_f32_16x16x32_bf16 v[40:43], a[200:203], a[24:27], v[40:43]
  ds_read_b128 a[160:163], v4 offset:13504
  v_mfma_f32_16x16x32_bf16 v[44:47], a[204:207], a[24:27], v[44:47]
  ds_read_b128 a[164:167], v4 offset:14528
  s_waitcnt lgkmcnt(6)
  v_mfma_f32_16x16x32_bf16 v[48:51], a[208:211], a[24:27], v[48:51]
  ds_read_b128 a[168:171], v4 offset:16640
  s_waitcnt vmcnt(17)
  v_mfma_f32_16x16x32_bf16 v[32:35], a[212:215], a[28:31], v[32:35]
  ds_read_b128 a[172:175], v4 offset:17664
  s_waitcnt lgkmcnt(6)
  v_mfma_f32_16x16x32_bf16 v[36:39], a[144:147], a[28:31], v[36:39]
  ds_read_b128 a[176:179], v4 offset:18688
  v_mfma_f32_16x16x32_bf16 v[40:43], a[148:151], a[28:31], v[40:43]
  ds_read_b128 a[180:183], v4 offset:50944
  s_waitcnt lgkmcnt(6)
  v_mfma_f32_16x16x32_bf16 v[44:47], a[152:155], a[28:31], v[44:47]
  ds_read_b128 a[184:187], v4 offset:51968
  v_mfma_f32_16x16x32_bf16 v[48:51], a[156:159], a[28:31], v[48:51]
  ds_read_b128 a[188:191], v4 offset:54080
  s_waitcnt vmcnt(16)
  s_waitcnt lgkmcnt(6)
  v_mfma_f32_16x16x32_bf16 v[32:35], a[160:163], a[32:35], v[32:35]
  ds_read_b128 a[192:195], v4 offset:55104
  v_mfma_f32_16x16x32_bf16 v[36:39], a[164:167], a[32:35], v[36:39]
  ds_read_b128 a[196:199], v4 offset:56128
  s_waitcnt lgkmcnt(6)
  v_mfma_f32_16x16x32_bf16 v[40:43], a[168:171], a[32:35], v[40:43]
  ds_read_b128 a[200:203], v5 offset:31120
  v_mfma_f32_16x16x32_bf16 v[44:47], a[172:175], a[32:35], v[44:47]
  ds_read_b128 a[204:207], v5 offset:32144
  s_waitcnt lgkmcnt(6)
  v_mfma_f32_16x16x32_bf16 v[48:51], a[176:179], a[32:35], v[48:51]
  ds_read_b128 a[208:211], v5 offset:34208
  s_waitcnt vmcnt(15)
  v_mfma_f32_16x16x32_bf16 v[32:35], a[180:183], a[36:39], v[32:35]
  ds_read_b128 a[212:215], v5 offset:35232
  s_waitcnt lgkmcnt(6)
  v_mfma_f32_16x16x32_bf16 v[36:39], a[184:187], a[36:39], v[36:39]
  ds_read_b128 a[144:147], v5 offset:36256
  v_mfma_f32_16x16x32_bf16 v[40:43], a[188:191], a[36:39], v[40:43]
  s_nop 0
L_pg_11:
  s_cbranch_execz L_pg_15
  ds_read_b128 a[148:151], v6 offset:2592
  s_waitcnt lgkmcnt(6)
  v_mfma_f32_16x16x32_bf16 v[44:47], a[192:195], a[36:39], v[44:47]
  ds_read_b128 a[152:155], v6 offset:3616
  v_mfma_f32_16x16x32_bf16 v[48:51], a[196:199], a[36:39], v[48:51]
  ds_read_b128 a[156:159], v6 offset:5680
  s_waitcnt vmcnt(14)
  s_waitcnt lgkmcnt(6)
  v_mfma_f32_16x16x32_bf16 v[32:35], a[200:203], a[40:43], v[32:35]
  ds_read_b128 a[160:163], v6 offset:6704
  v_mfma_f32_16x16x32_bf16 v[36:39], a[204:207], a[40:43], v[36:39]
  ds_read_b128 a[164:167], v6 offset:7728
  s_waitcnt lgkmcnt(6)
  v_mfma_f32_16x16x32_bf16 v[40:43], a[208:211], a[40:43], v[40:43]
  ds_read_b128 a[168:171], v4 offset:20800
  v_mfma_f32_16x16x32_bf16 v[44:47], a[212:215], a[40:43], v[44:47]
  ds_read_b128 a[172:175], v4 offset:21824
  s_waitcnt lgkmcnt(6)
  v_mfma_f32_16x16x32_bf16 v[48:51], a[144:147], a[40:43], v[48:51]
  ds_read_b128 a[176:179], v4 offset:22848
  s_waitcnt vmcnt(13)
  v_mfma_f32_16x16x32_bf16 v[32:35], a[148:151], a[44:47], v[32:35]
  ds_read_b128 a[180:183], v4 offset:24960
  s_waitcnt lgkmcnt(6)
  v_mfma_f32_16x16x32_bf16 v[36:39], a[152:155], a[44:47], v[36:39]
  ds_read_b128 a[184:187], v4 offset:25984
  v_mfma_f32_16x16x32_bf16 v[40:43], a[156:159], a[44:47], v[40:43]
  ds_read_b128 a[188:191], v4 offset:58240
  s_waitcnt lgkmcnt(6)
  v_mfma_f32_16x16x32_bf16 v[44:47], a[160:163], a[44:47], v[44:47]
  ds_read_b128 a[192:195], v4 offset:59264
  v_mfma_f32_16x16x32_bf16 v[48:51], a[164:167], a[44:47], v[48:51]
  ds_read_b128 a[196:199], v4 offset:60288
  s_waitcnt vmcnt(12)
  s_waitcnt lgkmcnt(6)
  v_mfma_f32_16x16x32_bf16 v[32:35], a[168:171], a[48:51], v[32:35]
  ds_read_b128 a[200:203], v4 offset:62400
  v_mfma_f32_16x16x32_bf16 v[36:39], a[172:175], a[48:51], v[36:39]
  ds_read_b128 a[204:207], v4 offset:63424
  s_waitcnt lgkmcnt(6)
  v_mfma_f32_16x16x32_bf16 v[40:43], a[176:179], a[48:51], v[40:43]
  ds_read_b128 a[208:211], v5 offset:38320
  v_mfma_f32_16x16x32_bf16 v[44:47], a[180:183], a[48:51], v[44:47]
  ds_read_b128 a[212:215], v5 offset:39344
  s_waitcnt lgkmcnt(6)
  v_mfma_f32_16x16x32_bf16 v[48:51], a[184:187], a[48:51], v[48:51]
  ds_read_b128 a[144:147], v5 offset:40368
  s_waitcnt vmcnt(11)
  v_mfma_f32_16x16x32_bf16 v[32:35], a[188:191], a[52:55], v[32:35]
  ds_read_b128 a[148:151], v5 offset:42432
  s_waitcnt lgkmcnt(6)
  v_mfma_f32_16x16x32_bf16 v[36:39], a[192:195], a[52:55], v[36:39]
  ds_read_b128 a[152:155], v5 offset:43456
  v_mfma_f32_16x16x32_bf16 v[40:43], a[196:199], a[52:55], v[40:43]
  ds_read_b128 a[156:159], v6 offset:9792
  s_waitcnt lgkmcnt(6)
  v_mfma_f32_16x16x32_bf16 v[44:47], a[200:203], a[52:55], v[44:47]
  ds_read_b128 a[160:163], v6 offset:10816
  v_mfma_f32_16x16x32_bf16 v[48:51], a[204:207], a[52:55], v[48:51]
  ds_read_b128 a[164:167], v6 offset:11840
  s_waitcnt vmcnt(10)
  s_waitcnt lgkmcnt(6)
  v_mfma_f32_16x16x32_bf16 v[32:35], a[208:211], a[56:59], v[32:35]
  ds_read_b128 a[168:171], v6 offset:13904
  v_mfma_f32_16x16x32_bf16 v[36:39], a[212:215], a[56:59], v[36:39]
  ds_read_b128 a[172:175], v6 offset:14928
  s_waitcnt lgkmcnt(6)
  v_mfma_f32_16x16x32_bf16 v[40:43], a[144:147], a[56:59], v[40:43]
  ds_read_b128 a[176:179], v4 offset:29120
  v_mfma_f32_16x16x32_bf16 v[44:47], a[148:151], a[56:59], v[44:47]
  ds_read_b128 a[180:183], v4 offset:30144
  s_waitcnt lgkmcnt(6)
  v_mfma_f32_16x16x32_bf16 v[48:51], a[152:155], a[56:59], v[48:51]
  ds_read_b128 a[184:187], v4 offset:31168
  s_waitcnt vmcnt(9)
  v_mfma_f32_16x16x32_bf16 v[32:35], a[156:159], a[60:63], v[32:35]
  ds_read_b128 a[188:191], v4 offset:33280
  s_waitcnt lgkmcnt(6)
  v_mfma_f32_16x16x32_bf16 v[36:39], a[160:163], a[60:63], v[36:39]
  ds_read_b128 a[192:195], v4 offset:34304
  v_mfma_f32_16x16x32_bf16 v[40:43], a[164:167], a[60:63], v[40:43]
  ds_read_b128 a[196:199], v5 offset:1024
  s_waitcnt lgkmcnt(6)
  v_mfma_f32_16x16x32_bf16 v[44:47], a[168:171], a[60:63], v[44:47]
  ds_read_b128 a[200:203], v5 offset:2048
  v_mfma_f32_16x16x32_bf16 v[48:51], a[172:175], a[60:63], v[48:51]
  ds_read_b128 a[204:207], v5 offset:3072
  s_waitcnt vmcnt(5)
  s_waitcnt lgkmcnt(6)
  v_mfma_f32_16x16x32_bf16 v[32:35], a[176:179], a[64:67], v[32:35]
  ds_read_b128 a[208:211], v5 offset:5184
  v_mfma_f32_16x16x32_bf16 v[36:39], a[180:183], a[64:67], v[36:39]
  ds_read_b128 a[212:215], v5 offset:6208
  s_waitcnt lgkmcnt(6)
  v_mfma_f32_16x16x32_bf16 v[40:43], a[184:187], a[64:67], v[40:43]
  v_mfma_f32_16x16x32_bf16 v[44:47], a[188:191], a[64:67], v[44:47]
  s_waitcnt lgkmcnt(4)
  v_mfma_f32_16x16x32_bf16 v[48:51], a[192:195], a[64:67], v[48:51]
  s_waitcnt vmcnt(1)
  v_mfma_f32_16x16x32_bf16 v[32:35], a[196:199], a[68:71], v[32:35]
  s_waitcnt lgkmcnt(2)
  v_mfma_f32_16x16x32_bf16 v[36:39], a[200:203], a[68:71], v[36:39]
  v_mfma_f32_16x16x32_bf16 v[40:43], a[204:207], a[68:71], v[40:43]
  s_waitcnt lgkmcnt(0)
  v_mfma_f32_16x16x32_bf16 v[44:47], a[208:211], a[68:71], v[44:47]
  v_mfma_f32_16x16x32_bf16 v[48:51], a[212:215], a[68:71], v[48:51]
  s_nop 7
  v_cmp_u_f32 vcc, v32, v32
  s_cmp_eq_u64 vcc, 0
  s_cbranch_scc0 L_p3_redo
L_p3_ok:
  v_mov_b32 v12, 0
  v_mov_b32 v13, 0
  v_mov_b32 v14, 0
  v_mov_b32 v15, 0
  v_cvt_pk_bf16_f32 v64, v32, v33
  v_cvt_pk_bf16_f32 v65, v34, v35
  v_lshlrev_b32_e64 v32, 16, v64
  v_and_b32 v33, 0xffff0000, v64
  v_lshlrev_b32_e64 v66, 16, v52
  v_and_b32 v67, 0xffff0000, v52
  v_lshlrev_b32_e64 v34, 16, v65
  v_and_b32 v35, 0xffff0000, v65
  v_lshlrev_b32_e64 v68, 16, v53
  v_and_b32 v69, 0xffff0000, v53
  v_pk_add_f32 v[32:33], v[32:33], v[66:67]
  v_pk_add_f32 v[34:35], v[34:35], v[68:69]
  v_cvt_pk_bf16_f32 v104, v32, v33
  v_cvt_pk_bf16_f32 v105, v34, v35
  v_cvt_pk_bf16_f32 v72, v36, v37
  v_cvt_pk_bf16_f32 v73, v38, v39
  v_lshlrev_b32_e64 v36, 16, v72
  v_and_b32 v37, 0xffff0000, v72
  v_lshlrev_b32_e64 v74, 16, v54
  v_and_b32 v75, 0xffff0000, v54
  v_lshlrev_b32_e64 v38, 16, v73
  v_and_b32 v39, 0xffff0000, v73
  v_lshlrev_b32_e64 v76, 16, v55
  v_and_b32 v77, 0xffff0000, v55
  v_pk_add_f32 v[36:37], v[36:37], v[74:75]
  v_pk_add_f32 v[38:39], v[38:39], v[76:77]
  v_cvt_pk_bf16_f32 v106, v36, v37
  v_cvt_pk_bf16_f32 v107, v38, v39
  v_cvt_pk_bf16_f32 v80, v40, v41
  v_cvt_pk_bf16_f32 v81, v42, v43
  v_lshlrev_b32_e64 v40, 16, v80
  v_and_b32 v41, 0xffff0000, v80
  v_lshlrev_b32_e64 v82, 16, v56
  v_and_b32 v83, 0xffff0000, v56
  v_lshlrev_b32_e64 v42, 16, v81
  v_and_b32 v43, 0xffff0000, v81
  v_lshlrev_b32_e64 v84, 16, v57
  v_and_b32 v85, 0xffff0000, v57
  v_pk_add_f32 v[40:41], v[40:41], v[82:83]
  v_pk_add_f32 v[42:43], v[42:43], v[84:85]
  v_cvt_pk_bf16_f32 v108, v40, v41
  v_cvt_pk_bf16_f32 v109, v42, v43
  v_cvt_pk_bf16_f32 v88, v44, v45
  v_cvt_pk_bf16_f32 v89, v46, v47
  v_lshlrev_b32_e64 v44, 16, v88
  v_and_b32 v45, 0xffff0000, v88
  v_lshlrev_b32_e64 v90, 16, v58
  v_and_b32 v91, 0xffff0000, v58
  v_lshlrev_b32_e64 v46, 16, v89
  v_and_b32 v47, 0xffff0000, v89
  v_lshlrev_b32_e64 v92, 16, v59
  v_and_b32 v93, 0xffff0000, v59
  v_pk_add_f32 v[44:45], v[44:45], v[90:91]
  v_pk_add_f32 v[46:47], v[46:47], v[92:93]
  v_cvt_pk_bf16_f32 v110, v44, v45
  v_cvt_pk_bf16_f32 v111, v46, v47
  v_cvt_pk_bf16_f32 v96, v48, v49
  v_cvt_pk_bf16_f32 v97, v50, v51
  v_lshlrev_b32_e64 v48, 16, v96
  v_and_b32 v49, 0xffff0000, v96
  v_lshlrev_b32_e64 v98, 16, v60
  v_and_b32 v99, 0xffff0000, v60
  v_lshlrev_b32_e64 v50, 16, v97
  v_and_b32 v51, 0xffff0000, v97
  v_lshlrev_b32_e64 v100, 16, v61
  v_and_b32 v101, 0xffff0000, v61
  v_pk_add_f32 v[48:49], v[48:49], v[98:99]
  v_pk_add_f32 v[50:51], v[50:51], v[100:101]
  v_cvt_pk_bf16_f32 v112, v48, v49
  v_cvt_pk_bf16_f32 v113, v50, v51
  s_lshr_b32 s36, s72, 1
  s_mul_i32 s36, s36, 9216
  s_add_u32 s36, s36, s70
  s_add_u32 s37, s36, 4096
  v_lshrrev_b32 v11, 1, v4
  s_bitcmp1_b32 s72, 0
  s_cbranch_scc1 L_p3_sc
  s_cmp_eq_u32 s74, 1
  s_cbranch_scc1 L_p3_sb
  buffer_store_dwordx4 v[104:107], v4, s[16:19], s36 offen offset:0 sc0 sc1
  buffer_store_dwordx4 v[108:111], v4, s[16:19], s36 offen offset:1024 sc0 sc1
  buffer_store_dwordx2 v[112:113], v11, s[16:19], s36 offen offset:2048 sc0 sc1
  s_branch L_p3_se
L_p3_sb:
  buffer_store_dwordx2 v[104:105], v11, s[16:19], s36 offen offset:2560 sc0 sc1
  buffer_store_dwordx4 v[106:109], v4, s[16:19], s36 offen offset:3072 sc0 sc1
  buffer_store_dwordx2 v[110:111], v11, s[16:19], s37 offen offset:0 sc0 sc1
  s_branch L_p3_se
L_p3_sc:
  s_cmp_eq_u32 s74, 1
  s_cbranch_scc1 L_p3_sd
  buffer_store_dwordx2 v[104:105], v11, s[16:19], s37 offen offset:512 sc0 sc1
  buffer_store_dwordx4 v[106:109], v4, s[16:19], s37 offen offset:1024 sc0 sc1
  buffer_store_dwordx4 v[110:113], v4, s[16:19], s37 offen offset:2048 sc0 sc1
  s_branch L_p3_se
L_p3_sd:
  s_add_u32 s36, s36, 8192
  buffer_store_dwordx4 v[104:107], v4, s[16:19], s37 offen offset:3072 sc0 sc1
  buffer_store_dwordx4 v[108:111], v4, s[16:19], s36 offen offset:0 sc0 sc1
L_p3_se:
  s_barrier
  v_lshlrev_b32 v32, 16, v104
  v_and_b32 v33, 0xffff0000, v104
  v_lshlrev_b32_e64 v34, 16, v105
  v_and_b32 v35, 0xffff0000, v105
  v_pk_add_f32 v[12:13], v[12:13], v[32:33]
  v_pk_fma_f32 v[14:15], v[32:33], v[32:33], v[14:15]
  v_pk_add_f32 v[12:13], v[12:13], v[34:35]
  v_pk_fma_f32 v[14:15], v[34:35], v[34:35], v[14:15]
  v_lshlrev_b32_e64 v36, 16, v106
  v_and_b32 v37, 0xffff0000, v106
  v_lshlrev_b32_e64 v38, 16, v107
  v_and_b32 v39, 0xffff0000, v107
  v_pk_add_f32 v[12:13], v[12:13], v[36:37]
  v_pk_fma_f32 v[14:15], v[36:37], v[36:37], v[14:15]
  v_pk_add_f32 v[12:13], v[12:13], v[38:39]
  v_pk_fma_f32 v[14:15], v[38:39], v[38:39], v[14:15]
  v_lshlrev_b32_e64 v40, 16, v108
  v_and_b32 v41, 0xffff0000, v108
  v_lshlrev_b32_e64 v42, 16, v109
  v_and_b32 v43, 0xffff0000, v109
  v_pk_add_f32 v[12:13], v[12:13], v[40:41]
  v_pk_fma_f32 v[14:15], v[40:41], v[40:41], v[14:15]
  v_pk_add_f32 v[12:13], v[12:13], v[42:43]
  v_pk_fma_f32 v[14:15], v[42:43], v[42:43], v[14:15]
  v_lshlrev_b32_e64 v44, 16, v110
  v_and_b32 v45, 0xffff0000, v110
  v_lshlrev_b32_e64 v46, 16, v111
  v_and_b32 v47, 0xffff0000, v111
  v_pk_add_f32 v[12:13], v[12:13], v[44:45]
  v_pk_fma_f32 v[14:15], v[44:45], v[44:45], v[14:15]
  v_pk_add_f32 v[12:13], v[12:13], v[46:47]
  v_pk_fma_f32 v[14:15], v[46:47], v[46:47], v[14:15]
  s_cmp_eq_u32 s74, 1
  s_cbranch_scc1 L_p3_no5b
  v_lshlrev_b32_e64 v48, 16, v112
  v_and_b32 v49, 0xffff0000, v112
  v_lshlrev_b32_e64 v50, 16, v113
  v_and_b32 v51, 0xffff0000, v113
  v_pk_add_f32 v[12:13], v[12:13], v[48:49]
  v_pk_fma_f32 v[14:15], v[48:49], v[48:49], v[14:15]
  v_pk_add_f32 v[12:13], v[12:13], v[50:51]
  v_pk_fma_f32 v[14:15], v[50:51], v[50:51], v[14:15]
L_p3_no5b:
  v_add_f32 v12, v12, v13
  v_add_f32 v13, v14, v15
  v_mov_b32 v16, v12
  s_nop 1
  v_permlane32_swap_b32 v12, v16
  s_nop 1
  v_add_f32 v12, v12, v16
  v_mov_b32 v16, v12
  s_nop 1
  v_permlane16_swap_b32 v12, v16
  s_nop 1
  v_add_f32 v12, v12, v16
  v_mov_b32 v16, v13
  s_nop 1
  v_permlane32_swap_b32 v13, v16
  s_nop 1
  v_add_f32 v13, v13, v16
  v_mov_b32 v16, v13
  s_nop 1
  v_permlane16_swap_b32 v13, v16
  s_nop 1
  v_add_f32 v13, v13, v16
  s_lshl_b32 s36, s71, 10
  s_lshl_b32 s37, s72, 8
  s_add_u32 s36, s36, s37
  s_lshl_b32 s37, s74, 7
  s_add_u32 s36, s36, s37
  s_waitcnt vmcnt(0)
  buffer_store_dwordx2 v[12:13], v10, s[24:27], s36 offen sc0 sc1
  s_add_u32 m0, s64, 0
  s_add_u32 s35, s66, 0
  buffer_load_dwordx4 v4, s[20:23], s35 offen offset:0 lds
  buffer_load_dwordx4 v4, s[20:23], s35 offen offset:1024 lds
  buffer_load_dwordx4 v4, s[20:23], s35 offen offset:2048 lds
  s_add_u32 m0, s64, 12288
  s_add_u32 s35, s66, 12288
  buffer_load_dwordx4 v4, s[20:23], s35 offen offset:0 lds
  buffer_load_dwordx4 v4, s[20:23], s35 offen offset:1024 lds
  buffer_load_dwordx4 v4, s[20:23], s35 offen offset:2048 lds
  s_add_u32 m0, s64, 24576
  s_add_u32 s35, s66, 24576
  buffer_load_dwordx4 v4, s[20:23], s35 offen offset:0 lds
  buffer_load_dwordx4 v4, s[20:23], s35 offen offset:1024 lds
  buffer_load_dwordx4 v4, s[20:23], s35 offen offset:2048 lds
  s_add_u32 m0, s64, 36864
  s_add_u32 s35, s66, 36864
  buffer_load_dwordx4 v4, s[20:23], s35 offen offset:0 lds
  buffer_load_dwordx4 v4, s[20:23], s35 offen offset:1024 lds
  buffer_load_dwordx4 v4, s[20:23], s35 offen offset:2048 lds
  s_lshl_b32 s37, s33, 11
  s_mov_b32 s38, 0
  v_lshlrev_b32 v9, 3, v2
  v_lshl_add_u32 v9, v3, 8, v9
  s_sleep 12
  buffer_load_dwordx2 v[116:117], v9, s[24:27], s37 offen offset:0 sc0 sc1
  buffer_load_dwordx2 v[118:119], v9, s[24:27], s37 offen offset:128 sc0 sc1
  buffer_load_dwordx2 v[120:121], v9, s[24:27], s37 offen offset:1024 sc0 sc1
  buffer_load_dwordx2 v[122:123], v9, s[24:27], s37 offen offset:1152 sc0 sc1
  s_mov_b64 exec, 0
  s_bitcmp1_b32 s12, 1
  s_cbranch_scc1 L_wh_3
  s_bitcmp1_b32 s12, 0
  s_cbranch_scc1 L_pg_18
  s_branch L_pg_17
L_wh_3:
  s_bitcmp1_b32 s12, 0
  s_cbranch_scc1 L_pg_20
  s_branch L_pg_19
L_wr_3:
  s_mov_b64 exec, -1
  s_waitcnt vmcnt(4)
  s_barrier
L_p3_spin:
  s_waitcnt vmcnt(0)
  v_max3_u32 v8, v116, v117, v118
  v_max3_u32 v8, v8, v119, v120
  v_max3_u32 v8, v8, v121, v122
  v_max_u32 v8, v8, v123
  v_cmp_eq_u32 vcc, -1, v8
  s_cmp_eq_u64 vcc, 0
  s_cbranch_scc1 L_p3_go
  s_add_u32 s38, s38, 1
  s_cmp_lt_u32 s38, 0x20000
  s_cbranch_scc0 L_p3_go
  s_sleep 1
  buffer_load_dwordx2 v[116:117], v9, s[24:27], s37 offen offset:0 sc0 sc1
  buffer_load_dwordx2 v[118:119], v9, s[24:27], s37 offen offset:128 sc0 sc1
  buffer_load_dwordx2 v[120:121], v9, s[24:27], s37 offen offset:1024 sc0 sc1
  buffer_load_dwordx2 v[122:123], v9, s[24:27], s37 offen offset:1152 sc0 sc1
  s_branch L_p3_spin
L_p3_go:
  s_lshr_b32 s38, s2, 3
  s_lshl_b32 s38, s38, 2
  s_add_u32 s38, s38, s12
  s_lshr_b32 s38, s38, 1
  s_lshl_b32 s38, s38, 6
  s_add_u32 s38, s38, 2560
  v_mov_b32_e64 v201, s38
  v_lshrrev_b32 v114, 1, v4
  v_add_u32 v115, 18432, v114
  s_add_u32 s50, s34, 0
  buffer_load_dwordx4 a[0:3], v4, s[16:19], s50 offen offset:0
  buffer_load_dwordx4 a[72:75], v7, s[16:19], s50 offen offset:0
  buffer_load_dwordx4 a[4:7], v4, s[16:19], s50 offen offset:1024
  buffer_load_dwordx4 a[76:79], v7, s[16:19], s50 offen offset:1024
  buffer_load_dwordx2 a[8:9], v114, s[16:19], s50 offen offset:2048
  buffer_load_dwordx2 a[10:11], v114, s[16:19], s50 offen offset:2560
  buffer_load_dwordx2 a[80:81], v115, s[16:19], s50 offen offset:2048
  buffer_load_dwordx2 a[82:83], v115, s[16:19], s50 offen offset:2560
  buffer_load_dwordx4 a[12:15], v4, s[16:19], s50 offen offset:3072
  buffer_load_dwordx4 a[84:87], v7, s[16:19], s50 offen offset:3072
  s_add_u32 s44, s10, 59768832
  s_addc_u32 s45, s11, 0
  s_mov_b32 s46, 262144
  s_mov_b32 s47, 0x00020000
  s_add_u32 s52, s10, 21233664
  s_addc_u32 s53, s11, 0
  s_mov_b32 s54, 9437184
  s_mov_b32 s55, 0x00020000
  v_pk_add_f32 v[116:117], v[116:117], v[118:119]
  v_pk_add_f32 v[120:121], v[120:121], v[122:123]
  v_mov_b32 v24, v116
  v_mov_b32 v25, v117
  v_mov_b32 v26, v120
  v_mov_b32 v27, v121
  v_permlane32_swap_b32 v116, v24
  v_permlane32_swap_b32 v117, v25
  v_permlane32_swap_b32 v120, v26
  v_permlane32_swap_b32 v121, v27
  v_add_f32 v116, v116, v24
  v_add_f32 v117, v117, v25
  v_add_f32 v120, v120, v26
  v_add_f32 v121, v121, v27
  v_mov_b32 v24, v116
  v_mov_b32 v25, v117
  v_mov_b32 v26, v120
  v_mov_b32 v27, v121
  v_permlane16_swap_b32 v116, v24
  v_permlane16_swap_b32 v117, v25
  v_permlane16_swap_b32 v120, v26
  v_permlane16_swap_b32 v121, v27
  v_add_f32 v116, v116, v24
  v_add_f32 v117, v117, v25
  v_add_f32 v120, v120, v26
  v_add_f32 v121, v121, v27
  s_add_u32 s50, s34, 4096
  buffer_load_dwordx2 a[16:17], v114, s[16:19], s50 offen offset:0
  buffer_load_dwordx2 a[18:19], v114, s[16:19], s50 offen offset:512
  v_mov_b32 v184, v116
  v_mov_b32 v190, v117
  v_mov_b32 v185, v120
  v_mov_b32 v191, v121
  v_mul_f32 v184, 0x3ae38e39, v184
  v_mul_f32 v190, 0x3ae38e39, v190
  v_mul_f32 v185, 0x3ae38e39, v185
  v_mul_f32 v191, 0x3ae38e39, v191
  v_fma_f32 v190, -v184, v184, v190
  v_fma_f32 v191, -v185, v185, v191
  v_max_f32 v190, 0, v190
  v_max_f32 v191, 0, v191
  buffer_load_dwordx2 a[88:89], v115, s[16:19], s50 offen offset:0
  buffer_load_dwordx2 a[90:91], v115, s[16:19], s50 offen offset:512
  v_cvt_pk_bf16_f32 v184, v184, v184
  v_lshlrev_b32_e64 v184, 16, v184
  v_cvt_pk_bf16_f32 v190, v190, v190
  v_lshlrev_b32_e64 v190, 16, v190
  v_cvt_pk_bf16_f32 v185, v185, v185
  v_lshlrev_b32_e64 v185, 16, v185
  v_cvt_pk_bf16_f32 v191, v191, v191
  v_lshlrev_b32_e64 v191, 16, v191
  v_add_f32 v190, 0x3727c5ac, v190
  v_sub_f32_e64 v184, 0, v184
  v_add_f32 v191, 0x3727c5ac, v191
  v_sub_f32_e64 v185, 0, v185
  buffer_load_dwordx4 a[20:23], v4, s[16:19], s50 offen offset:1024
  v_cvt_pk_bf16_f32 v190, v190, v190
  v_lshlrev_b32_e64 v190, 16, v190
  v_cvt_pk_bf16_f32 v191, v191, v191
  v_lshlrev_b32 v191, 16, v191
  v_sqrt_f32 v190, v190
  v_sqrt_f32 v191, v191
  s_nop 0
  v_cvt_pk_bf16_f32 v190, v190, v190
  v_lshlrev_b32_e64 v190, 16, v190
  v_cvt_pk_bf16_f32 v191, v191, v191
  v_lshlrev_b32 v191, 16, v191
  v_lshlrev_b32 v24, 4, v3
  buffer_load_dwordx4 a[92:95], v7, s[16:19], s50 offen offset:1024
  ds_bpermute_b32 v176, v24, v190 offset:0
  ds_bpermute_b32 v152, v24, v184 offset:0
  ds_bpermute_b32 v177, v24, v190 offset:4
  ds_bpermute_b32 v153, v24, v184 offset:4
  ds_bpermute_b32 v178, v24, v190 offset:8
  ds_bpermute_b32 v154, v24, v184 offset:8
  ds_bpermute_b32 v179, v24, v190 offset:12
  ds_bpermute_b32 v155, v24, v184 offset:12
  ds_bpermute_b32 v180, v24, v191 offset:0
  ds_bpermute_b32 v156, v24, v185 offset:0
  ds_bpermute_b32 v181, v24, v191 offset:4
  ds_bpermute_b32 v157, v24, v185 offset:4
  buffer_load_dwordx4 a[24:27], v4, s[16:19], s50 offen offset:2048
  ds_bpermute_b32 v182, v24, v191 offset:8
  ds_bpermute_b32 v158, v24, v185 offset:8
  ds_bpermute_b32 v183, v24, v191 offset:12
  ds_bpermute_b32 v159, v24, v185 offset:12
  v_rcp_f32 v186, v190
  v_rcp_f32 v187, v191
  s_nop 0
  v_mul_f32 v188, v186, v186
  v_mul_f32 v189, v187, v187
  v_mul_f32 v188, v188, v186
  v_mul_f32_e64 v189, v189, v187
  v_mul_f32 v186, 0xc0135761, v186
  buffer_load_dwordx4 a[96:99], v7, s[16:19], s50 offen offset:2048
  v_mul_f32 v188, 0xbdd2d3e8, v188
  v_mul_f32 v187, 0xc0135761, v187
  v_mul_f32 v189, 0xbdd2d3e8, v189
  v_mov_b32 v240, 0
  v_mov_b32 v241, 0
  v_mov_b32 v242, 0
  v_mov_b32 v243, 0
  v_mov_b32 v244, 0
  v_mov_b32 v245, 0
  v_mov_b32 v246, 0
  v_mov_b32 v247, 0
  v_mov_b32_e64 v248, 0
  buffer_load_dwordx4 a[28:31], v4, s[16:19], s50 offen offset:3072
  v_mov_b32 v249, 0
  v_mov_b32 v250, 0
  v_mov_b32 v251, 0
  v_mov_b32 v252, 0
  v_mov_b32 v253, 0
  v_mov_b32 v254, 0
  v_mov_b32_e64 v255, 0
  buffer_load_dwordx4 a[100:103], v7, s[16:19], s50 offen offset:3072
  ds_read_b128 a[144:147], v4 offset:0
  ds_read_b128 a[148:151], v4 offset:1024
  ds_read_b128 a[152:155], v4 offset:2048
  ds_read_b128 a[156:159], v4 offset:3072
  ds_read_b128 a[160:163], v4 offset:4096
  ds_read_b128 a[164:167], v4 offset:5120
  ds_read_b128 a[168:171], v4 offset:6144
  ds_read_b128 a[172:175], v4 offset:7168
  s_waitcnt vmcnt(18)
  s_waitcnt lgkmcnt(5)
  v_mfma_f32_16x16x32_bf16 v[32:35], a[0:3], a[144:147], 0
  ds_read_b128 a[176:179], v4 offset:8192
  s_add_u32 s50, s34, 8192
  v_mfma_f32_16x16x32_bf16 v[36:39], a[72:75], a[144:147], 0
  buffer_load_dwordx4 a[32:35], v4, s[16:19], s50 offen offset:0
  v_mfma_f32_16x16x32_bf16 v[40:43], a[0:3], a[148:151], 0
  ds_read_b128 a[180:183], v4 offset:9216
  v_rcp_f32_e64 v160, v176
  v_mfma_f32_16x16x32_bf16 v[44:47], a[72:75], a[148:151], 0
  buffer_load_dwordx4 a[104:107], v7, s[16:19], s50 offen offset:0
  v_mfma_f32_16x16x32_bf16 v[48:51], a[0:3], a[152:155], 0
  ds_read_b128 a[144:147], v4 offset:10240
  v_rcp_f32_e64 v161, v177
  v_mfma_f32_16x16x32_bf16 v[52:55], a[72:75], a[152:155], 0
  s_waitcnt vmcnt(18) lgkmcnt(5)
  v_rcp_f32 v162, v178
  v_mfma_f32_16x16x32_bf16 v[32:35], a[4:7], a[156:159], v[32:35]
  ds_read_b128 a[148:151], v4 offset:11264
  v_rcp_f32_e64 v163, v179
  v_mfma_f32_16x16x32_bf16 v[36:39], a[76:79], a[156:159], v[36:39]
  buffer_load_dwordx4 a[36:39], v4, s[16:19], s50 offen offset:1024
  v_mfma_f32_16x16x32_bf16 v[40:43], a[4:7], a[160:163], v[40:43]
  ds_read_b128 a[152:155], v4 offset:12288
  v_rcp_f32_e64 v164, v180
  v_mfma_f32_16x16x32_bf16 v[44:47], a[76:79], a[160:163], v[44:47]
  buffer_load_dwordx4 a[108:111], v7, s[16:19], s50 offen offset:1024
  v_mfma_f32_16x16x32_bf16 v[48:51], a[4:7], a[164:167], v[48:51]
  ds_read_b128 a[156:159], v4 offset:13312
  v_rcp_f32_e64 v165, v181
  v_mfma_f32_16x16x32_bf16 v[52:55], a[76:79], a[164:167], v[52:55]
  s_waitcnt vmcnt(16) lgkmcnt(5)
  v_rcp_f32 v166, v182
  v_mfma_f32_16x16x32_bf16 v[32:35], a[8:11], a[168:171], v[32:35]
  ds_read_b128 a[160:163], v4 offset:14336
  v_rcp_f32_e64 v167, v183
  v_mfma_f32_16x16x32_bf16 v[36:39], a[80:83], a[168:171], v[36:39]
  buffer_load_dwordx4 a[40:43], v4, s[16:19], s50 offen offset:2048
  v_mfma_f32_16x16x32_bf16 v[40:43], a[8:11], a[172:175], v[40:43]
  ds_read_b128 a[164:167], v4 offset:15360
  s_nop 0
  v_mul_f32 v168, v160, v160
  v_mfma_f32_16x16x32_bf16 v[44:47], a[80:83], a[172:175], v[44:47]
  buffer_load_dwordx4 a[112:115], v7, s[16:19], s50 offen offset:2048
  v_mfma_f32_16x16x32_bf16 v[48:51], a[8:11], a[176:179], v[48:51]
  ds_read_b128 a[168:171], v4 offset:16384
  v_mul_f32 v169, v161, v161
  v_mul_f32 v170, v162, v162
  v_mfma_f32_16x16x32_bf16 v[52:55], a[80:83], a[176:179], v[52:55]
  s_waitcnt vmcnt(16) lgkmcnt(5)
  v_mul_f32 v171, v163, v163
  v_mul_f32 v172, v164, v164
  v_mul_f32 v173, v165, v165
  v_mfma_f32_16x16x32_bf16 v[32:35], a[12:15], a[180:183], v[32:35]
  ds_read_b128 a[172:175], v4 offset:17408
  v_mul_f32 v174, v166, v166
  v_mul_f32 v175, v167, v167
  v_mfma_f32_16x16x32_bf16 v[36:39], a[84:87], a[180:183], v[36:39]
  buffer_load_dwordx2 a[44:45], v114, s[16:19], s50 offen offset:3072
  buffer_load_dwordx2 a[46:47], v114, s[16:19], s50 offen offset:3584
  v_mfma_f32_16x16x32_bf16 v[40:43], a[12:15], a[144:147], v[40:43]
  ds_read_b128 a[176:179], v4 offset:18432
  v_mul_f32 v168, v168, v160
  v_mul_f32 v169, v169, v161
  v_mfma_f32_16x16x32_bf16 v[44:47], a[84:87], a[144:147], v[44:47]
  buffer_load_dwordx2 a[116:117], v115, s[16:19], s50 offen offset:3072
  buffer_load_dwordx2 a[118:119], v115, s[16:19], s50 offen offset:3584
  v_mfma_f32_16x16x32_bf16 v[48:51], a[12:15], a[148:151], v[48:51]
  ds_read_b128 a[180:183], v4 offset:19456
  s_add_u32 s50, s34, 12288
  v_mul_f32_e64 v170, v170, v162
  v_mfma_f32_16x16x32_bf16 v[52:55], a[84:87], a[148:151], v[52:55]
  s_waitcnt vmcnt(16) lgkmcnt(5)
  v_mul_f32 v171, v171, v163
  v_mul_f32 v172, v172, v164
  v_mul_f32 v173, v173, v165
  v_mfma_f32_16x16x32_bf16 v[32:35], a[16:19], a[152:155], v[32:35]
  ds_read_b128 a[144:147], v4 offset:20480
  v_mul_f32 v174, v174, v166
  v_mul_f32 v175, v175, v167
  v_mfma_f32_16x16x32_bf16 v[36:39], a[88:91], a[152:155], v[36:39]
  buffer_load_dwordx4 a[48:51], v4, s[16:19], s50 offen offset:0
  v_mfma_f32_16x16x32_bf16 v[40:43], a[16:19], a[156:159], v[40:43]
  ds_read_b128 a[148:151], v4 offset:21504
  v_mul_f32 v160, 0xc0135761, v160
  v_mul_f32 v168, 0xbdd2d3e8, v168
  v_mfma_f32_16x16x32_bf16 v[44:47], a[88:91], a[156:159], v[44:47]
  buffer_load_dwordx4 a[120:123], v7, s[16:19], s50 offen offset:0
  v_mfma_f32_16x16x32_bf16 v[48:51], a[16:19], a[160:163], v[48:51]
  ds_read_b128 a[152:155], v4 offset:22528
  v_mul_f32 v161, 0xc0135761, v161
  v_mul_f32 v169, 0xbdd2d3e8, v169
  v_mfma_f32_16x16x32_bf16 v[52:55], a[88:91], a[160:163], v[52:55]
  s_waitcnt vmcnt(16) lgkmcnt(5)
  s_nop 0
  v_mul_f32 v162, 0xc0135761, v162
  v_mul_f32 v170, 0xbdd2d3e8, v170
  v_mul_f32 v163, 0xc0135761, v163
  v_mfma_f32_16x16x32_bf16 v[32:35], a[20:23], a[164:167], v[32:35]
  ds_read_b128 a[156:159], v4 offset:23552
  v_mul_f32 v171, 0xbdd2d3e8, v171
  v_mul_f32 v164, 0xc0135761, v164
  v_mfma_f32_16x16x32_bf16 v[36:39], a[92:95], a[164:167], v[36:39]
  buffer_load_dwordx2 a[52:53], v114, s[16:19], s50 offen offset:1024
  buffer_load_dwordx2 a[54:55], v114, s[16:19], s50 offen offset:1536
  v_mfma_f32_16x16x32_bf16 v[40:43], a[20:23], a[168:171], v[40:43]
  ds_read_b128 a[160:163], v4 offset:24576
  v_mul_f32 v172, 0xbdd2d3e8, v172
  v_mul_f32 v165, 0xc0135761, v165
  v_mfma_f32_16x16x32_bf16 v[44:47], a[92:95], a[168:171], v[44:47]
  buffer_load_dwordx2 a[124:125], v115, s[16:19], s50 offen offset:1024
  buffer_load_dwordx2 a[126:127], v115, s[16:19], s50 offen offset:1536
  v_mfma_f32_16x16x32_bf16 v[48:51], a[20:23], a[172:175], v[48:51]
  ds_read_b128 a[164:167], v4 offset:25600
  s_add_u32 s35, s66, 49152
  v_mul_f32 v173, 0xbdd2d3e8, v173
  v_mfma_f32_16x16x32_bf16 v[52:55], a[92:95], a[172:175], v[52:55]
  s_nop 0
L_pg_12:
  s_cbranch_execz L_pg_16
  s_waitcnt vmcnt(18) lgkmcnt(5)
  s_add_u32 m0, s64, 49152
  v_mul_f32 v166, 0xc0135761, v166
  v_mul_f32 v174, 0xbdd2d3e8, v174
  v_mfma_f32_16x16x32_bf16 v[32:35], a[24:27], a[176:179], v[32:35]
  ds_read_b128 a[168:171], v4 offset:26624
  v_mul_f32 v167, 0xc0135761, v167
  v_mul_f32 v175, 0xbdd2d3e8, v175
  v_mfma_f32_16x16x32_bf16 v[36:39], a[96:99], a[176:179], v[36:39]
  buffer_load_dwordx4 v4, s[20:23], s35 offen offset:0 lds
  v_mfma_f32_16x16x32_bf16 v[40:43], a[24:27], a[180:183], v[40:43]
  ds_read_b128 a[172:175], v4 offset:27648
  s_lshl_b32 s68, s33, 12
  s_lshr_b32 s36, s29, 258
  v_mfma_f32_16x16x32_bf16 v[44:47], a[96:99], a[180:183], v[44:47]
  buffer_load_dwordx4 v4, s[20:23], s35 offen offset:1024 lds
  v_mfma_f32_16x16x32_bf16 v[48:51], a[24:27], a[144:147], v[48:51]
  ds_read_b128 a[176:179], v4 offset:28672
  s_lshl_b32 s36, s36, 10
  s_and_b32 s37, s29, 3
  v_mfma_f32_16x16x32_bf16 v[52:55], a[96:99], a[144:147], v[52:55]
  s_waitcnt vmcnt(18) lgkmcnt(5)
  s_lshl_b32 s37, s37, 6
  s_add_u32 s36, s36, s37
  s_add_u32 s36, s36, s68
  v_mfma_f32_16x16x32_bf16 v[32:35], a[28:31], a[148:151], v[32:35]
  ds_read_b128 a[180:183], v4 offset:29696
  v_lshlrev_b32_e64 v202, 8, v3
  v_lshl_add_u32 v202, v2, 2, v202
  v_mfma_f32_16x16x32_bf16 v[36:39], a[100:103], a[148:151], v[36:39]
  buffer_load_dwordx4 v4, s[20:23], s35 offen offset:2048 lds
  v_mfma_f32_16x16x32_bf16 v[40:43], a[28:31], a[152:155], v[40:43]
  ds_read_b128 a[144:147], v4 offset:30720
  v_and_b32_e64 v203, 3, v2
  s_mul_i32 s70, s29, 576
  v_mfma_f32_16x16x32_bf16 v[44:47], a[100:103], a[152:155], v[44:47]
  buffer_load_dwordx4 a[56:59], v4, s[16:19], s50 offen offset:2048
  v_mfma_f32_16x16x32_bf16 v[48:51], a[28:31], a[156:159], v[48:51]
  ds_read_b128 a[148:151], v4 offset:31744
  s_lshr_b32 s37, s33, 1
  s_mul_i32 s37, s37, 18
  v_mfma_f32_16x16x32_bf16 v[52:55], a[100:103], a[156:159], v[52:55]
  s_waitcnt vmcnt(18) lgkmcnt(5)
  s_add_u32 s70, s70, s37
  s_and_b32 s37, s33, 1
  s_add_u32 s70, s70, s37
  v_mfma_f32_16x16x32_bf16 v[32:35], a[32:35], a[160:163], v[32:35]
  ds_read_b128 a[152:155], v4 offset:32768
  s_lshl_b32 s70, s70, 266
  v_mfma_f32_16x16x32_bf16 v[36:39], a[104:107], a[160:163], v[36:39]
  buffer_load_dwordx4 a[128:131], v7, s[16:19], s50 offen offset:2048
  v_mfma_f32_16x16x32_bf16 v[40:43], a[32:35], a[164:167], v[40:43]
  ds_read_b128 a[156:159], v4 offset:33792
  v_mfma_f32_16x16x32_bf16 v[44:47], a[104:107], a[164:167], v[44:47]
  buffer_load_dwordx4 a[60:63], v4, s[16:19], s50 offen offset:3072
  v_mfma_f32_16x16x32_bf16 v[48:51], a[32:35], a[168:171], v[48:51]
  ds_read_b128 a[160:163], v4 offset:34816
  v_mfma_f32_16x16x32_bf16 v[52:55], a[104:107], a[168:171], v[52:55]
  s_waitcnt vmcnt(18) lgkmcnt(5)
  v_mfma_f32_16x16x32_bf16 v[32:35], a[36:39], a[172:175], v[32:35]
  ds_read_b128 a[164:167], v4 offset:35840
  v_mfma_f32_16x16x32_bf16 v[36:39], a[108:111], a[172:175], v[36:39]
  buffer_load_dwordx4 a[132:135], v7, s[16:19], s50 offen offset:3072
  v_mfma_f32_16x16x32_bf16 v[40:43], a[36:39], a[176:179], v[40:43]
  ds_read_b128 a[168:171], v4 offset:36864
  s_add_u32 s50, s34, 16384
  v_mfma_f32_16x16x32_bf16 v[44:47], a[108:111], a[176:179], v[44:47]
  buffer_load_dwordx4 a[64:67], v4, s[16:19], s50 offen offset:0
  v_mfma_f32_16x16x32_bf16 v[48:51], a[36:39], a[180:183], v[48:51]
  ds_read_b128 a[172:175], v4 offset:37888
  v_mfma_f32_16x16x32_bf16 v[52:55], a[108:111], a[180:183], v[52:55]
  s_waitcnt vmcnt(18) lgkmcnt(5)
  v_mfma_f32_16x16x32_bf16 v[32:35], a[40:43], a[144:147], v[32:35]
  ds_read_b128 a[176:179], v4 offset:38912
  v_mfma_f32_16x16x32_bf16 v[36:39], a[112:115], a[144:147], v[36:39]
  buffer_load_dwordx4 a[136:139], v7, s[16:19], s50 offen offset:0
  v_mfma_f32_16x16x32_bf16 v[40:43], a[40:43], a[148:151], v[40:43]
  ds_read_b128 a[180:183], v4 offset:39936
  v_mfma_f32_16x16x32_bf16 v[44:47], a[112:115], a[148:151], v[44:47]
  buffer_load_dwordx4 a[68:71], v4, s[16:19], s50 offen offset:1024
  v_mfma_f32_16x16x32_bf16 v[48:51], a[40:43], a[152:155], v[48:51]
  ds_read_b128 a[144:147], v4 offset:40960
  v_mfma_f32_16x16x32_bf16 v[52:55], a[112:115], a[152:155], v[52:55]
  s_waitcnt vmcnt(16) lgkmcnt(5)
  v_mfma_f32_16x16x32_bf16 v[32:35], a[44:47], a[156:159], v[32:35]
  ds_read_b128 a[148:151], v4 offset:41984
  v_mfma_f32_16x16x32_bf16 v[36:39], a[116:119], a[156:159], v[36:39]
  buffer_load_dwordx4 a[140:143], v7, s[16:19], s50 offen offset:1024
  v_mfma_f32_16x16x32_bf16 v[40:43], a[44:47], a[160:163], v[40:43]
  ds_read_b128 a[152:155], v4 offset:43008
  s_add_u32 s35, s66, 61440
  v_mfma_f32_16x16x32_bf16 v[44:47], a[116:119], a[160:163], v[44:47]
  s_add_u32 m0, s64, 61440
  s_nop 0
  buffer_load_dwordx4 v4, s[20:23], s35 offen offset:0 lds
  v_mfma_f32_16x16x32_bf16 v[48:51], a[44:47], a[164:167], v[48:51]
  ds_read_b128 a[156:159], v4 offset:44032
  v_mfma_f32_16x16x32_bf16 v[52:55], a[116:119], a[164:167], v[52:55]
  s_waitcnt vmcnt(16) lgkmcnt(5)
  v_mfma_f32_16x16x32_bf16 v[32:35], a[48:51], a[168:171], v[32:35]
  ds_read_b128 a[160:163], v4 offset:45056
  v_mfma_f32_16x16x32_bf16 v[36:39], a[120:123], a[168:171], v[36:39]
  buffer_load_dwordx4 v4, s[20:23], s35 offen offset:1024 lds
  v_mfma_f32_16x16x32_bf16 v[40:43], a[48:51], a[172:175], v[40:43]
  ds_read_b128 a[164:167], v4 offset:46080
  v_mfma_f32_16x16x32_bf16 v[44:47], a[120:123], a[172:175], v[44:47]
  buffer_load_dwordx4 v4, s[20:23], s35 offen offset:2048 lds
  v_mfma_f32_16x16x32_bf16 v[48:51], a[48:51], a[176:179], v[48:51]
  ds_read_b128 a[168:171], v4 offset:47104
  s_add_u32 s35, s66, 73728
  v_mfma_f32_16x16x32_bf16 v[52:55], a[120:123], a[176:179], v[52:55]
  s_waitcnt vmcnt(14) lgkmcnt(5)
  s_add_u32 m0, s64, 73728
  v_mfma_f32_16x16x32_bf16 v[32:35], a[52:55], a[180:183], v[32:35]
  ds_read_b128 a[172:175], v4 offset:48128
  v_mfma_f32_16x16x32_bf16 v[36:39], a[124:127], a[180:183], v[36:39]
  buffer_load_dwordx4 v4, s[20:23], s35 offen offset:0 lds
  v_mfma_f32_16x16x32_bf16 v[40:43], a[52:55], a[144:147], v[40:43]
  s_waitcnt vmcnt(12)
  s_barrier
  ds_read_b128 a[176:179], v4 offset:49152
  v_mfma_f32_16x16x32_bf16 v[44:47], a[124:127], a[144:147], v[44:47]
  s_getpc_b64 s[90:91]
  global_load_dword a248, v201, s[90:91]
  v_mfma_f32_16x16x32_bf16 v[48:51], a[52:55], a[148:151], v[48:51]
  ds_read_b128 a[180:183], v4 offset:50176
  v_mfma_f32_16x16x32_bf16 v[52:55], a[124:127], a[148:151], v[52:55]
  s_waitcnt vmcnt(11) lgkmcnt(5)
  v_mfma_f32_16x16x32_bf16 v[32:35], a[56:59], a[152:155], v[32:35]
  ds_read_b128 a[144:147], v4 offset:51200
  v_mfma_f32_16x16x32_bf16 v[36:39], a[128:131], a[152:155], v[36:39]
  buffer_load_dwordx4 v4, s[20:23], s35 offen offset:1024 lds
  v_mfma_f32_16x16x32_bf16 v[40:43], a[56:59], a[156:159], v[40:43]
  ds_read_b128 a[148:151], v4 offset:52224
  v_mfma_f32_16x16x32_bf16 v[44:47], a[128:131], a[156:159], v[44:47]
  buffer_load_dwordx4 v4, s[20:23], s35 offen offset:2048 lds
  v_mfma_f32_16x16x32_bf16 v[48:51], a[56:59], a[160:163], v[48:51]
  ds_read_b128 a[152:155], v4 offset:53248
  s_add_u32 s35, s66, 86016
  v_mfma_f32_16x16x32_bf16 v[52:55], a[128:131], a[160:163], v[52:55]
  s_waitcnt vmcnt(11) lgkmcnt(5)
  s_add_u32 m0, s64, 86016
  v_mfma_f32_16x16x32_bf16 v[32:35], a[60:63], a[164:167], v[32:35]
  ds_read_b128 a[156:159], v4 offset:54272
  v_mfma_f32_16x16x32_bf16 v[36:39], a[132:135], a[164:167], v[36:39]
  buffer_load_dwordx4 v4, s[20:23], s35 offen offset:0 lds
  v_mfma_f32_16x16x32_bf16 v[40:43], a[60:63], a[168:171], v[40:43]
  ds_read_b128 a[160:163], v4 offset:55296
  v_mfma_f32_16x16x32_bf16 v[44:47], a[132:135], a[168:171], v[44:47]
  buffer_load_dwordx4 v4, s[20:23], s35 offen offset:1024 lds
  v_mfma_f32_16x16x32_bf16 v[48:51], a[60:63], a[172:175], v[48:51]
  ds_read_b128 a[164:167], v4 offset:56320
  v_mfma_f32_16x16x32_bf16 v[52:55], a[132:135], a[172:175], v[52:55]
  s_waitcnt vmcnt(11) lgkmcnt(5)
  v_mfma_f32_16x16x32_bf16 v[32:35], a[64:67], a[176:179], v[32:35]
  ds_read_b128 a[168:171], v4 offset:57344
  v_mfma_f32_16x16x32_bf16 v[36:39], a[136:139], a[176:179], v[36:39]
  buffer_load_dwordx4 v4, s[20:23], s35 offen offset:2048 lds
  v_mfma_f32_16x16x32_bf16 v[40:43], a[64:67], a[180:183], v[40:43]
  ds_read_b128 a[172:175], v4 offset:58368
  s_add_u32 s35, s66, 98304
  v_mfma_f32_16x16x32_bf16 v[44:47], a[136:139], a[180:183], v[44:47]
  s_add_u32 m0, s64, 98304
  s_nop 0
  buffer_load_dwordx4 v4, s[20:23], s35 offen offset:0 lds
  v_mfma_f32_16x16x32_bf16 v[48:51], a[64:67], a[144:147], v[48:51]
  ds_read_b128 a[176:179], v4 offset:59392
  v_mfma_f32_16x16x32_bf16 v[52:55], a[136:139], a[144:147], v[52:55]
  s_waitcnt vmcnt(11) lgkmcnt(5)
  v_mfma_f32_16x16x32_bf16 v[32:35], a[68:71], a[148:151], v[32:35]
  ds_read_b128 a[180:183], v4 offset:60416
  v_mfma_f32_16x16x32_bf16 v[36:39], a[140:143], a[148:151], v[36:39]
  buffer_load_dwordx4 v4, s[20:23], s35 offen offset:1024 lds
  v_mfma_f32_16x16x32_bf16 v[40:43], a[68:71], a[152:155], v[40:43]
  s_waitcnt vmcnt(9)
  s_barrier
  ds_read_b128 a[144:147], v4 offset:61440
  v_mfma_f32_16x16x32_bf16 v[44:47], a[140:143], a[152:155], v[44:47]
  buffer_load_dwordx4 v4, s[20:23], s35 offen offset:2048 lds
  v_mfma_f32_16x16x32_bf16 v[48:51], a[68:71], a[156:159], v[48:51]
  ds_read_b128 a[148:151], v4 offset:62464
  s_add_u32 s35, s67, 110592
  v_pk_fma_f32 v[32:33], v[152:153], v[192:193], v[32:33] op_sel:[0,0,0] op_sel_hi:[1,0,1]
  v_pk_fma_f32 v[34:35], v[154:155], v[192:193], v[34:35] op_sel:[0,0,0] op_sel_hi:[1,0,1]
  v_pk_fma_f32 v[36:37], v[156:157], v[192:193], v[36:37] op_sel:[0,0,0] op_sel_hi:[1,0,1]
  v_pk_fma_f32 v[38:39], v[158:159], v[192:193], v[38:39] op_sel:[0,0,0] op_sel_hi:[1,0,1]
  v_pk_mul_f32 v[8:9], v[32:33], v[32:33]
  v_pk_mul_f32 v[10:11], v[34:35], v[34:35]
  v_pk_mul_f32 v[12:13], v[36:37], v[36:37]
  v_pk_mul_f32 v[14:15], v[38:39], v[38:39]
  v_pk_fma_f32 v[8:9], v[8:9], v[168:169], v[160:161]
  v_pk_fma_f32 v[10:11], v[10:11], v[170:171], v[162:163]
  v_pk_fma_f32 v[12:13], v[12:13], v[172:173], v[164:165]
  v_pk_fma_f32 v[14:15], v[14:15], v[174:175], v[166:167]
  v_pk_mul_f32 v[8:9], v[8:9], v[32:33]
  v_pk_mul_f32 v[10:11], v[10:11], v[34:35]
  v_pk_mul_f32 v[12:13], v[12:13], v[36:37]
  v_pk_mul_f32 v[14:15], v[14:15], v[38:39]
  s_nop 1
  v_mfma_f32_16x16x32_bf16 v[52:55], a[140:143], a[156:159], v[52:55]
  s_waitcnt lgkmcnt(5)
  s_add_u32 m0, s65, 110592
  v_mfma_f32_16x16x32_bf16 v[56:59], a[0:3], a[160:163], 0
  ds_read_b128 a[152:155], v4 offset:63488
  v_pk_fma_f32 v[40:41], v[152:153], v[192:193], v[40:41] op_sel:[0,1,0] op_sel_hi:[1,1,1]
  v_pk_fma_f32 v[42:43], v[154:155], v[192:193], v[42:43] op_sel:[0,1,0] op_sel_hi:[1,1,1]
  v_pk_fma_f32 v[44:45], v[156:157], v[192:193], v[44:45] op_sel:[0,1,0] op_sel_hi:[1,1,1]
  v_pk_fma_f32 v[46:47], v[158:159], v[192:193], v[46:47] op_sel:[0,1,0] op_sel_hi:[1,1,1]
  v_pk_mul_f32 v[16:17], v[40:41], v[40:41]
  v_pk_mul_f32 v[18:19], v[42:43], v[42:43]
  v_pk_mul_f32 v[20:21], v[44:45], v[44:45]
  v_pk_mul_f32 v[22:23], v[46:47], v[46:47]
  v_pk_fma_f32 v[16:17], v[16:17], v[168:169], v[160:161]
  v_pk_fma_f32 v[18:19], v[18:19], v[170:171], v[162:163]
  v_pk_fma_f32 v[20:21], v[20:21], v[172:173], v[164:165]
  v_pk_fma_f32 v[22:23], v[22:23], v[174:175], v[166:167]
  v_pk_mul_f32 v[16:17], v[16:17], v[40:41]
  v_pk_mul_f32 v[18:19], v[18:19], v[42:43]
  v_pk_mul_f32 v[20:21], v[20:21], v[44:45]
  v_pk_mul_f32 v[22:23], v[22:23], v[46:47]
  s_nop 1
  v_mfma_f32_16x16x32_bf16 v[60:63], a[72:75], a[160:163], 0
  buffer_load_dwordx4 v4, s[20:23], s35 offen offset:0 lds
  v_mfma_f32_16x16x32_bf16 v[64:67], a[0:3], a[164:167], 0
  ds_read_b128 a[156:159], v4 offset:64512
  v_exp_f32_e64 v8, v8
  s_nop 0
  v_pk_fma_f32 v[48:49], v[152:153], v[194:195], v[48:49] op_sel:[0,0,0] op_sel_hi:[1,0,1]
  v_pk_fma_f32 v[50:51], v[154:155], v[194:195], v[50:51] op_sel:[0,0,0] op_sel_hi:[1,0,1]
  v_pk_fma_f32 v[52:53], v[156:157], v[194:195], v[52:53] op_sel:[0,0,0] op_sel_hi:[1,0,1]
  v_pk_fma_f32 v[54:55], v[158:159], v[194:195], v[54:55] op_sel:[0,0,0] op_sel_hi:[1,0,1]
  v_pk_mul_f32 v[24:25], v[48:49], v[48:49]
  v_pk_mul_f32 v[26:27], v[50:51], v[50:51]
  v_pk_mul_f32 v[28:29], v[52:53], v[52:53]
  v_pk_mul_f32 v[30:31], v[54:55], v[54:55]
  v_pk_fma_f32 v[24:25], v[24:25], v[168:169], v[160:161]
  v_pk_fma_f32 v[26:27], v[26:27], v[170:171], v[162:163]
  v_pk_fma_f32 v[28:29], v[28:29], v[172:173], v[164:165]
  v_pk_fma_f32 v[30:31], v[30:31], v[174:175], v[166:167]
  v_pk_mul_f32 v[24:25], v[24:25], v[48:49]
  v_pk_mul_f32 v[26:27], v[26:27], v[50:51]
  v_pk_mul_f32 v[28:29], v[28:29], v[52:53]
  v_pk_mul_f32 v[30:31], v[30:31], v[54:55]
  s_nop 1
  v_mfma_f32_16x16x32_bf16 v[68:71], a[72:75], a[164:167], 0
  buffer_load_dwordx4 v4, s[20:23], s35 offen offset:1024 lds
  v_mfma_f32_16x16x32_bf16 v[72:75], a[0:3], a[168:171], 0
  ds_read_b128 a[160:163], v5 offset:0
  v_exp_f32 v9, v9
  v_mfma_f32_16x16x32_bf16 v[76:79], a[72:75], a[168:171], 0
  s_waitcnt lgkmcnt(5)
  v_exp_f32 v10, v10
  v_mfma_f32_16x16x32_bf16 v[56:59], a[4:7], a[172:175], v[56:59]
  ds_read_b128 a[164:167], v5 offset:1024
  v_exp_f32_e64 v11, v11
  v_mfma_f32_16x16x32_bf16 v[60:63], a[76:79], a[172:175], v[60:63]
  buffer_load_dwordx4 v4, s[20:23], s35 offen offset:2048 lds
  v_mfma_f32_16x16x32_bf16 v[64:67], a[4:7], a[176:179], v[64:67]
  ds_read_b128 a[168:171], v5 offset:2048
  v_exp_f32_e64 v12, v12
  v_mfma_f32_16x16x32_bf16 v[68:71], a[76:79], a[176:179], v[68:71]
  buffer_load_dwordx4 v4, s[20:23], s35 offen offset:3072 lds
  v_mfma_f32_16x16x32_bf16 v[72:75], a[4:7], a[180:183], v[72:75]
  ds_read_b128 a[172:175], v5 offset:3072
  s_add_u32 s35, s67, 114688
  v_mfma_f32_16x16x32_bf16 v[76:79], a[76:79], a[180:183], v[76:79]
  s_waitcnt lgkmcnt(5)
  s_add_u32 m0, s65, 114688
  v_exp_f32 v13, v13
  v_mfma_f32_16x16x32_bf16 v[56:59], a[8:11], a[144:147], v[56:59]
  ds_read_b128 a[176:179], v5 offset:4096
  v_exp_f32_e64 v14, v14
  v_mfma_f32_16x16x32_bf16 v[60:63], a[80:83], a[144:147], v[60:63]
  buffer_load_dwordx4 v4, s[20:23], s35 offen offset:0 lds
  v_mfma_f32_16x16x32_bf16 v[64:67], a[8:11], a[148:151], v[64:67]
  ds_read_b128 a[180:183], v5 offset:5120
  v_exp_f32_e64 v15, v15
  v_mfma_f32_16x16x32_bf16 v[68:71], a[80:83], a[148:151], v[68:71]
  buffer_load_dwordx4 v4, s[20:23], s35 offen offset:1024 lds
  v_mfma_f32_16x16x32_bf16 v[72:75], a[8:11], a[152:155], v[72:75]
  ds_read_b128 a[144:147], v5 offset:6144
  v_fma_f32 v8, v8, v176, v176
  v_fma_f32 v9, v9, v177, v177
  v_mfma_f32_16x16x32_bf16 v[76:79], a[80:83], a[152:155], v[76:79]
  s_waitcnt lgkmcnt(5)
  v_exp_f32 v16, v16
  v_fma_f32 v10, v10, v178, v178
  v_mfma_f32_16x16x32_bf16 v[56:59], a[12:15], a[156:159], v[56:59]
  ds_read_b128 a[148:151], v5 offset:7168
  v_fma_f32 v11, v11, v179, v179
  v_fma_f32 v12, v12, v180, v180
  v_mfma_f32_16x16x32_bf16 v[60:63], a[84:87], a[156:159], v[60:63]
  buffer_load_dwordx4 v4, s[20:23], s35 offen offset:2048 lds
  v_mfma_f32_16x16x32_bf16 v[64:67], a[12:15], a[160:163], v[64:67]
  s_waitcnt vmcnt(13)
  s_barrier
  ds_read_b128 a[152:155], v5 offset:8192
  v_mfma_f32_16x16x32_bf16 v[68:71], a[84:87], a[160:163], v[68:71]
  buffer_load_dwordx4 v4, s[20:23], s35 offen offset:3072 lds
  v_mfma_f32_16x16x32_bf16 v[72:75], a[12:15], a[164:167], v[72:75]
  ds_read_b128 a[156:159], v5 offset:9216
  s_add_u32 s35, s67, 118784
  v_fma_f32 v13, v13, v181, v181
  v_mfma_f32_16x16x32_bf16 v[76:79], a[84:87], a[164:167], v[76:79]
  s_waitcnt lgkmcnt(5)
  s_add_u32 m0, s65, 118784
  v_fma_f32 v14, v14, v182, v182
  v_fma_f32 v15, v15, v183, v183
  v_mfma_f32_16x16x32_bf16 v[56:59], a[16:19], a[168:171], v[56:59]
  ds_read_b128 a[160:163], v5 offset:10240
  v_rcp_f32 v8, v8
  v_mfma_f32_16x16x32_bf16 v[60:63], a[88:91], a[168:171], v[60:63]
  buffer_load_dwordx4 v4, s[20:23], s35 offen offset:0 lds
  v_mfma_f32_16x16x32_bf16 v[64:67], a[16:19], a[172:175], v[64:67]
  ds_read_b128 a[164:167], v5 offset:11264
  s_add_u32 s35, s67, 147456
  v_mfma_f32_16x16x32_bf16 v[68:71], a[88:91], a[172:175], v[68:71]
  s_add_u32 m0, s65, 0
  s_nop 0
  buffer_load_dwordx4 v4, s[20:23], s35 offen offset:0 lds
  v_mfma_f32_16x16x32_bf16 v[72:75], a[16:19], a[176:179], v[72:75]
  ds_read_b128 a[168:171], v5 offset:12288
  v_rcp_f32_e64 v9, v9
  v_mfma_f32_16x16x32_bf16 v[76:79], a[88:91], a[176:179], v[76:79]
  s_waitcnt lgkmcnt(5)
  v_rcp_f32 v10, v10
  v_mfma_f32_16x16x32_bf16 v[56:59], a[20:23], a[180:183], v[56:59]
  ds_read_b128 a[172:175], v5 offset:13312
  v_rcp_f32_e64 v11, v11
  v_mfma_f32_16x16x32_bf16 v[60:63], a[92:95], a[180:183], v[60:63]
  buffer_load_dwordx4 v4, s[20:23], s35 offen offset:1024 lds
  v_mfma_f32_16x16x32_bf16 v[64:67], a[20:23], a[144:147], v[64:67]
  ds_read_b128 a[176:179], v5 offset:14336
  v_rcp_f32_e64 v12, v12
  v_mfma_f32_16x16x32_bf16 v[68:71], a[92:95], a[144:147], v[68:71]
  buffer_load_dwordx4 v4, s[20:23], s35 offen offset:2048 lds
  v_mfma_f32_16x16x32_bf16 v[72:75], a[20:23], a[148:151], v[72:75]
  ds_read_b128 a[180:183], v5 offset:15360
  v_rcp_f32_e64 v13, v13
  v_mfma_f32_16x16x32_bf16 v[76:79], a[92:95], a[148:151], v[76:79]
  s_waitcnt lgkmcnt(5)
  v_rcp_f32 v14, v14
  v_mfma_f32_16x16x32_bf16 v[56:59], a[24:27], a[152:155], v[56:59]
  ds_read_b128 a[144:147], v5 offset:16384
  v_rcp_f32 v15, v15
  s_nop 0
  v_pk_mul_f32 v[32:33], v[32:33], v[8:9]
  v_pk_mul_f32 v[34:35], v[34:35], v[10:11]
  v_pk_mul_f32 v[36:37], v[36:37], v[12:13]
  v_pk_mul_f32 v[38:39], v[38:39], v[14:15]
  v_pk_add_f32 v[240:241], v[240:241], v[32:33]
  v_pk_fma_f32 v[248:249], v[32:33], v[32:33], v[248:249]
  v_pk_add_f32 v[242:243], v[242:243], v[34:35]
  v_pk_fma_f32 v[250:251], v[34:35], v[34:35], v[250:251]
  v_pk_add_f32 v[244:245], v[244:245], v[36:37]
  v_pk_fma_f32 v[252:253], v[36:37], v[36:37], v[252:253]
  v_pk_add_f32 v[246:247], v[246:247], v[38:39]
  v_pk_fma_f32 v[254:255], v[38:39], v[38:39], v[254:255]
  s_nop 1
  v_mfma_f32_16x16x32_bf16 v[60:63], a[96:99], a[152:155], v[60:63]
  buffer_load_dwordx4 v4, s[20:23], s35 offen offset:3072 lds
  v_mfma_f32_16x16x32_bf16 v[64:67], a[24:27], a[156:159], v[64:67]
  ds_read_b128 a[148:151], v5 offset:17408
  s_add_u32 s35, s67, 151552
  v_mfma_f32_16x16x32_bf16 v[68:71], a[96:99], a[156:159], v[68:71]
  s_add_u32 m0, s65, 4096
  s_nop 0
  buffer_load_dwordx4 v4, s[20:23], s35 offen offset:0 lds
  v_mfma_f32_16x16x32_bf16 v[72:75], a[24:27], a[160:163], v[72:75]
  s_waitcnt vmcnt(17)
  s_barrier
  ds_read_b128 a[152:155], v5 offset:20480
  v_mfma_f32_16x16x32_bf16 v[76:79], a[96:99], a[160:163], v[76:79]
  s_waitcnt lgkmcnt(5)
  v_exp_f32 v17, v17
  v_mfma_f32_16x16x32_bf16 v[56:59], a[28:31], a[164:167], v[56:59]
  ds_read_b128 a[156:159], v5 offset:23552
  v_cvt_pk_f16_f32 v80, v32, v33
  v_mfma_f32_16x16x32_bf16 v[60:63], a[100:103], a[164:167], v[60:63]
  buffer_load_dwordx4 v4, s[20:23], s35 offen offset:1024 lds
  v_mfma_f32_16x16x32_bf16 v[64:67], a[28:31], a[168:171], v[64:67]
  ds_read_b128 a[160:163], v5 offset:26624
  v_cvt_pk_f16_f32 v81, v34, v35
  v_mfma_f32_16x16x32_bf16 v[68:71], a[100:103], a[168:171], v[68:71]
  buffer_load_dwordx4 v4, s[20:23], s35 offen offset:2048 lds
  v_mfma_f32_16x16x32_bf16 v[72:75], a[28:31], a[172:175], v[72:75]
  ds_read_b128 a[164:167], v5 offset:29696
  v_cvt_pk_f16_f32 v82, v36, v37
  v_mfma_f32_16x16x32_bf16 v[76:79], a[100:103], a[172:175], v[76:79]
  s_waitcnt lgkmcnt(5)
  v_exp_f32 v18, v18
  v_mfma_f32_16x16x32_bf16 v[56:59], a[32:35], a[176:179], v[56:59]
  s_waitcnt vmcnt(16)
  s_barrier
  ds_read_b128 a[168:171], v5 offset:32768
  v_mfma_f32_16x16x32_bf16 v[60:63], a[104:107], a[176:179], v[60:63]
  buffer_load_dwordx4 v4, s[20:23], s35 offen offset:3072 lds
  v_mfma_f32_16x16x32_bf16 v[64:67], a[32:35], a[180:183], v[64:67]
  ds_read_b128 a[172:175], v5 offset:35840
  s_add_u32 s35, s67, 155648
  v_mfma_f32_16x16x32_bf16 v[68:71], a[104:107], a[180:183], v[68:71]
  s_add_u32 m0, s65, 8192
  s_nop 0
  buffer_load_dwordx4 v4, s[20:23], s35 offen offset:0 lds
  v_mfma_f32_16x16x32_bf16 v[72:75], a[32:35], a[144:147], v[72:75]
  ds_read_b128 a[176:179], v5 offset:38912
  s_add_u32 s35, s67, 184320
  v_mfma_f32_16x16x32_bf16 v[76:79], a[104:107], a[144:147], v[76:79]
  s_waitcnt lgkmcnt(5)
  s_add_u32 m0, s65, 36864
  v_cvt_pk_f16_f32 v83, v38, v39
  v_mfma_f32_16x16x32_bf16 v[56:59], a[36:39], a[148:151], v[56:59]
  ds_read_b128 a[180:183], v5 offset:41984
  v_mfma_f32_16x16x32_bf16 v[60:63], a[108:111], a[148:151], v[60:63]
  buffer_load_dwordx4 v4, s[20:23], s35 offen offset:0 lds
  v_mfma_f32_16x16x32_bf16 v[56:59], a[40:43], a[152:155], v[56:59]
  ds_read_b128 a[144:147], v5 offset:18432
  v_mfma_f32_16x16x32_bf16 v[60:63], a[112:115], a[152:155], v[60:63]
  buffer_load_dwordx4 v4, s[20:23], s35 offen offset:1024 lds
  v_mfma_f32_16x16x32_bf16 v[56:59], a[44:47], a[156:159], v[56:59]
  ds_read_b128 a[148:151], v5 offset:21504
  v_mfma_f32_16x16x32_bf16 v[60:63], a[116:119], a[156:159], v[60:63]
  s_waitcnt lgkmcnt(5)
  v_exp_f32 v19, v19
  v_mfma_f32_16x16x32_bf16 v[56:59], a[48:51], a[160:163], v[56:59]
  ds_read_b128 a[152:155], v5 offset:24576
  v_mfma_f32_16x16x32_bf16 v[60:63], a[120:123], a[160:163], v[60:63]
  buffer_load_dwordx4 v4, s[20:23], s35 offen offset:2048 lds
  v_mfma_f32_16x16x32_bf16 v[56:59], a[52:55], a[164:167], v[56:59]
  ds_read_b128 a[156:159], v5 offset:27648
  v_mfma_f32_16x16x32_bf16 v[60:63], a[124:127], a[164:167], v[60:63]
  buffer_load_dwordx4 v4, s[20:23], s35 offen offset:3072 lds
  v_mfma_f32_16x16x32_bf16 v[56:59], a[56:59], a[168:171], v[56:59]
  ds_read_b128 a[160:163], v5 offset:30720
  s_add_u32 s35, s67, 188416
  v_mfma_f32_16x16x32_bf16 v[60:63], a[128:131], a[168:171], v[60:63]
  s_waitcnt lgkmcnt(5)
  s_nop 0
  s_add_u32 m0, s65, 40960
  v_mfma_f32_16x16x32_bf16 v[56:59], a[60:63], a[172:175], v[56:59]
  ds_read_b128 a[164:167], v5 offset:33792
  v_mfma_f32_16x16x32_bf16 v[60:63], a[132:135], a[172:175], v[60:63]
  buffer_load_dwordx4 v4, s[20:23], s35 offen offset:0 lds
  v_mfma_f32_16x16x32_bf16 v[56:59], a[64:67], a[176:179], v[56:59]
  ds_read_b128 a[168:171], v5 offset:36864
  v_mfma_f32_16x16x32_bf16 v[60:63], a[136:139], a[176:179], v[60:63]
  buffer_load_dwordx4 v4, s[20:23], s35 offen offset:1024 lds
  v_mfma_f32_16x16x32_bf16 v[56:59], a[68:71], a[180:183], v[56:59]
  ds_read_b128 a[172:175], v5 offset:39936
  v_mfma_f32_16x16x32_bf16 v[60:63], a[140:143], a[180:183], v[60:63]
  s_waitcnt lgkmcnt(5)
  v_exp_f32 v20, v20
  v_mfma_f32_16x16x32_bf16 v[64:67], a[36:39], a[144:147], v[64:67]
  ds_read_b128 a[176:179], v5 offset:43008
  v_mfma_f32_16x16x32_bf16 v[68:71], a[108:111], a[144:147], v[68:71]
  buffer_load_dwordx4 v4, s[20:23], s35 offen offset:2048 lds
  v_mfma_f32_16x16x32_bf16 v[64:67], a[40:43], a[148:151], v[64:67]
  ds_read_b128 a[180:183], v5 offset:19456
  v_exp_f32 v21, v21
  s_nop 0
  v_pk_fma_f32 v[56:57], v[152:153], v[194:195], v[56:57] op_sel:[0,1,0] op_sel_hi:[1,1,1]
  v_pk_fma_f32 v[58:59], v[154:155], v[194:195], v[58:59] op_sel:[0,1,0] op_sel_hi:[1,1,1]
  v_pk_fma_f32 v[60:61], v[156:157], v[194:195], v[60:61] op_sel:[0,1,0] op_sel_hi:[1,1,1]
  v_pk_fma_f32 v[62:63], v[158:159], v[194:195], v[62:63] op_sel:[0,1,0] op_sel_hi:[1,1,1]
  v_pk_mul_f32 v[8:9], v[56:57], v[56:57]
  v_pk_mul_f32 v[10:11], v[58:59], v[58:59]
  v_pk_mul_f32 v[12:13], v[60:61], v[60:61]
  v_pk_mul_f32 v[14:15], v[62:63], v[62:63]
  v_pk_fma_f32 v[8:9], v[8:9], v[168:169], v[160:161]
  v_pk_fma_f32 v[10:11], v[10:11], v[170:171], v[162:163]
  v_pk_fma_f32 v[12:13], v[12:13], v[172:173], v[164:165]
  v_pk_fma_f32 v[14:15], v[14:15], v[174:175], v[166:167]
  v_pk_mul_f32 v[8:9], v[8:9], v[56:57]
  v_pk_mul_f32 v[10:11], v[10:11], v[58:59]
  v_pk_mul_f32 v[12:13], v[12:13], v[60:61]
  v_pk_mul_f32 v[14:15], v[14:15], v[62:63]
  s_nop 1
  v_mfma_f32_16x16x32_bf16 v[68:71], a[112:115], a[148:151], v[68:71]
  buffer_load_dwordx4 v4, s[20:23], s35 offen offset:3072 lds
  v_mfma_f32_16x16x32_bf16 v[64:67], a[44:47], a[152:155], v[64:67]
  ds_read_b128 a[144:147], v5 offset:22528
  s_add_u32 s35, s67, 192512
  v_mfma_f32_16x16x32_bf16 v[68:71], a[116:119], a[152:155], v[68:71]
  s_waitcnt lgkmcnt(5)
  s_add_u32 m0, s65, 45056
  v_exp_f32_e64 v22, v22
  v_mfma_f32_16x16x32_bf16 v[64:67], a[48:51], a[156:159], v[64:67]
  ds_read_b128 a[148:151], v5 offset:25600
  v_exp_f32_e64 v23, v23
  v_mfma_f32_16x16x32_bf16 v[68:71], a[120:123], a[156:159], v[68:71]
  buffer_load_dwordx4 v4, s[20:23], s35 offen offset:0 lds
  v_mfma_f32_16x16x32_bf16 v[64:67], a[52:55], a[160:163], v[64:67]
  ds_read_b128 a[152:155], v5 offset:28672
  v_fma_f32 v16, v16, v176, v176
  v_fma_f32 v17, v17, v177, v177
  v_mfma_f32_16x16x32_bf16 v[68:71], a[124:127], a[160:163], v[68:71]
  s_getpc_b64 s[90:91]
  global_load_dword a248, v201, s[90:91]
  v_mfma_f32_16x16x32_bf16 v[64:67], a[56:59], a[164:167], v[64:67]
  ds_read_b128 a[156:159], v5 offset:31744
  v_fma_f32 v18, v18, v178, v178
  v_fma_f32 v19, v19, v179, v179
  v_mfma_f32_16x16x32_bf16 v[68:71], a[128:131], a[164:167], v[68:71]
  s_waitcnt lgkmcnt(5)
  v_exp_f32_e64 v24, v24
  v_fma_f32 v20, v20, v180, v180
  v_mfma_f32_16x16x32_bf16 v[64:67], a[60:63], a[168:171], v[64:67]
  ds_read_b128 a[160:163], v5 offset:34816
  v_fma_f32 v21, v21, v181, v181
  v_fma_f32 v22, v22, v182, v182
  v_mfma_f32_16x16x32_bf16 v[68:71], a[132:135], a[168:171], v[68:71]
  v_exp_f32_e64 v25, v25
  v_fma_f32 v23, v23, v183, v183
  v_mfma_f32_16x16x32_bf16 v[64:67], a[64:67], a[172:175], v[64:67]
  ds_read_b128 a[164:167], v5 offset:37888
  v_rcp_f32_e64 v16, v16
  v_mfma_f32_16x16x32_bf16 v[68:71], a[136:139], a[172:175], v[68:71]
  v_rcp_f32_e64 v17, v17
  v_mfma_f32_16x16x32_bf16 v[64:67], a[68:71], a[176:179], v[64:67]
  ds_read_b128 a[168:171], v5 offset:40960
  v_rcp_f32_e64 v18, v18
  v_mfma_f32_16x16x32_bf16 v[68:71], a[140:143], a[176:179], v[68:71]
  s_waitcnt lgkmcnt(5)
  v_rcp_f32 v19, v19
  v_mfma_f32_16x16x32_bf16 v[72:75], a[36:39], a[180:183], v[72:75]
  ds_read_b128 a[172:175], v5 offset:44032
  v_rcp_f32_e64 v20, v20
  v_mfma_f32_16x16x32_bf16 v[76:79], a[108:111], a[180:183], v[76:79]
  v_rcp_f32_e64 v21, v21
  v_mfma_f32_16x16x32_bf16 v[72:75], a[40:43], a[144:147], v[72:75]
  s_waitcnt vmcnt(19)
  s_barrier
  ds_read_b128 a[176:179], v5 offset:45056
  v_mfma_f32_16x16x32_bf16 v[76:79], a[112:115], a[144:147], v[76:79]
  v_rcp_f32_e64 v22, v22
  v_mfma_f32_16x16x32_bf16 v[72:75], a[44:47], a[148:151], v[72:75]
  ds_read_b128 a[180:183], v5 offset:46080
  v_rcp_f32 v23, v23
  s_nop 0
  v_pk_mul_f32 v[40:41], v[40:41], v[16:17]
  v_pk_mul_f32 v[42:43], v[42:43], v[18:19]
  v_pk_mul_f32 v[44:45], v[44:45], v[20:21]
  v_pk_mul_f32 v[46:47], v[46:47], v[22:23]
  v_pk_add_f32 v[240:241], v[240:241], v[40:41]
  v_pk_fma_f32 v[248:249], v[40:41], v[40:41], v[248:249]
  v_pk_add_f32 v[242:243], v[242:243], v[42:43]
  v_pk_fma_f32 v[250:251], v[42:43], v[42:43], v[250:251]
  v_pk_add_f32 v[244:245], v[244:245], v[44:45]
  v_pk_fma_f32 v[252:253], v[44:45], v[44:45], v[252:253]
  v_pk_add_f32 v[246:247], v[246:247], v[46:47]
  v_pk_fma_f32 v[254:255], v[46:47], v[46:47], v[254:255]
  v_pk_fma_f32 v[64:65], v[152:153], v[196:197], v[64:65] op_sel:[0,0,0] op_sel_hi:[1,0,1]
  v_pk_fma_f32 v[66:67], v[154:155], v[196:197], v[66:67] op_sel:[0,0,0] op_sel_hi:[1,0,1]
  s_nop 0
L_pg_13:
  s_cbranch_execz L_wr_2
  v_pk_fma_f32 v[68:69], v[156:157], v[196:197], v[68:69] op_sel:[0,0,0] op_sel_hi:[1,0,1]
  v_pk_fma_f32 v[70:71], v[158:159], v[196:197], v[70:71] op_sel:[0,0,0] op_sel_hi:[1,0,1]
  v_pk_mul_f32 v[16:17], v[64:65], v[64:65]
  v_pk_mul_f32 v[18:19], v[66:67], v[66:67]
  v_pk_mul_f32 v[20:21], v[68:69], v[68:69]
  v_pk_mul_f32 v[22:23], v[70:71], v[70:71]
  v_pk_fma_f32 v[16:17], v[16:17], v[168:169], v[160:161]
  v_pk_fma_f32 v[18:19], v[18:19], v[170:171], v[162:163]
  v_pk_fma_f32 v[20:21], v[20:21], v[172:173], v[164:165]
  v_pk_fma_f32 v[22:23], v[22:23], v[174:175], v[166:167]
  v_pk_mul_f32 v[16:17], v[16:17], v[64:65]
  v_pk_mul_f32 v[18:19], v[18:19], v[66:67]
  v_pk_mul_f32 v[20:21], v[20:21], v[68:69]
  v_pk_mul_f32 v[22:23], v[22:23], v[70:71]
  s_nop 1
  v_mfma_f32_16x16x32_bf16 v[76:79], a[116:119], a[148:151], v[76:79]
  s_waitcnt lgkmcnt(5)
  v_exp_f32_e64 v26, v26
  v_cvt_pk_f16_f32 v84, v40, v41
  v_mfma_f32_16x16x32_bf16 v[72:75], a[48:51], a[152:155], v[72:75]
  ds_read_b128 a[144:147], v5 offset:47104
  v_cvt_pk_f16_f32 v85, v42, v43
  v_cvt_pk_f16_f32 v86, v44, v45
  v_mfma_f32_16x16x32_bf16 v[76:79], a[120:123], a[152:155], v[76:79]
  v_exp_f32_e64 v27, v27
  v_cvt_pk_f16_f32 v87, v46, v47
  v_mfma_f32_16x16x32_bf16 v[72:75], a[52:55], a[156:159], v[72:75]
  ds_read_b128 a[148:151], v5 offset:48128
  v_exp_f32_e64 v28, v28
  v_mfma_f32_16x16x32_bf16 v[76:79], a[124:127], a[156:159], v[76:79]
  v_exp_f32_e64 v29, v29
  v_mfma_f32_16x16x32_bf16 v[72:75], a[56:59], a[160:163], v[72:75]
  ds_read_b128 a[152:155], v5 offset:49152
  v_exp_f32_e64 v30, v30
  v_mfma_f32_16x16x32_bf16 v[76:79], a[128:131], a[160:163], v[76:79]
  s_waitcnt lgkmcnt(5)
  v_exp_f32 v31, v31
  v_fma_f32 v24, v24, v176, v176
  v_mfma_f32_16x16x32_bf16 v[72:75], a[60:63], a[164:167], v[72:75]
  ds_read_b128 a[156:159], v5 offset:50176
  v_fma_f32 v25, v25, v177, v177
  v_fma_f32 v26, v26, v178, v178
  v_mfma_f32_16x16x32_bf16 v[76:79], a[132:135], a[164:167], v[76:79]
  v_exp_f32_e64 v8, v8
  v_fma_f32 v27, v27, v179, v179
  v_mfma_f32_16x16x32_bf16 v[72:75], a[64:67], a[168:171], v[72:75]
  ds_read_b128 a[160:163], v5 offset:51200
  v_fma_f32 v28, v28, v180, v180
  v_fma_f32 v29, v29, v181, v181
  v_mfma_f32_16x16x32_bf16 v[76:79], a[136:139], a[168:171], v[76:79]
  v_exp_f32_e64 v9, v9
  v_fma_f32 v30, v30, v182, v182
  v_mfma_f32_16x16x32_bf16 v[72:75], a[68:71], a[172:175], v[72:75]
  ds_read_b128 a[164:167], v5 offset:52224
  v_fma_f32 v31, v31, v183, v183
  v_mfma_f32_16x16x32_bf16 v[76:79], a[140:143], a[172:175], v[76:79]
  s_waitcnt lgkmcnt(5)
  v_rcp_f32 v24, v24
  v_mfma_f32_16x16x32_bf16 v[116:119], a[0:3], a[176:179], 0
  ds_read_b128 a[168:171], v5 offset:53248
  v_rcp_f32_e64 v25, v25
  v_mfma_f32_16x16x32_bf16 v[120:123], a[72:75], a[176:179], 0
  v_rcp_f32_e64 v26, v26
  v_mfma_f32_16x16x32_bf16 v[124:127], a[0:3], a[180:183], 0
  ds_read_b128 a[172:175], v5 offset:54272
  v_rcp_f32_e64 v27, v27
  v_mfma_f32_16x16x32_bf16 v[128:131], a[72:75], a[180:183], 0
  v_rcp_f32_e64 v28, v28
  v_mfma_f32_16x16x32_bf16 v[132:135], a[0:3], a[144:147], 0
  ds_read_b128 a[176:179], v5 offset:55296
  v_rcp_f32_e64 v29, v29
  v_mfma_f32_16x16x32_bf16 v[136:139], a[72:75], a[144:147], 0
  s_waitcnt lgkmcnt(5)
  v_rcp_f32 v30, v30
  v_mfma_f32_16x16x32_bf16 v[116:119], a[4:7], a[148:151], v[116:119]
  ds_read_b128 a[180:183], v5 offset:56320
  v_rcp_f32 v31, v31
  s_nop 0
  v_pk_mul_f32 v[48:49], v[48:49], v[24:25]
  v_pk_mul_f32 v[50:51], v[50:51], v[26:27]
  v_pk_mul_f32 v[52:53], v[52:53], v[28:29]
  v_pk_mul_f32 v[54:55], v[54:55], v[30:31]
  v_pk_add_f32 v[240:241], v[240:241], v[48:49]
  v_pk_fma_f32 v[248:249], v[48:49], v[48:49], v[248:249]
  v_pk_add_f32 v[242:243], v[242:243], v[50:51]
  v_pk_fma_f32 v[250:251], v[50:51], v[50:51], v[250:251]
  v_pk_add_f32 v[244:245], v[244:245], v[52:53]
  v_pk_fma_f32 v[252:253], v[52:53], v[52:53], v[252:253]
  v_pk_add_f32 v[246:247], v[246:247], v[54:55]
  v_pk_fma_f32 v[254:255], v[54:55], v[54:55], v[254:255]
  v_pk_fma_f32 v[72:73], v[152:153], v[196:197], v[72:73] op_sel:[0,1,0] op_sel_hi:[1,1,1]
  v_pk_fma_f32 v[74:75], v[154:155], v[196:197], v[74:75] op_sel:[0,1,0] op_sel_hi:[1,1,1]
  v_pk_fma_f32 v[76:77], v[156:157], v[196:197], v[76:77] op_sel:[0,1,0] op_sel_hi:[1,1,1]
  v_pk_fma_f32 v[78:79], v[158:159], v[196:197], v[78:79] op_sel:[0,1,0] op_sel_hi:[1,1,1]
  v_pk_mul_f32 v[24:25], v[72:73], v[72:73]
  v_pk_mul_f32 v[26:27], v[74:75], v[74:75]
  v_pk_mul_f32 v[28:29], v[76:77], v[76:77]
  v_pk_mul_f32 v[30:31], v[78:79], v[78:79]
  v_pk_fma_f32 v[24:25], v[24:25], v[168:169], v[160:161]
  v_pk_fma_f32 v[26:27], v[26:27], v[170:171], v[162:163]
  v_pk_fma_f32 v[28:29], v[28:29], v[172:173], v[164:165]
  v_pk_fma_f32 v[30:31], v[30:31], v[174:175], v[166:167]
  v_pk_mul_f32 v[24:25], v[24:25], v[72:73]
  v_pk_mul_f32 v[26:27], v[26:27], v[74:75]
  v_pk_mul_f32 v[28:29], v[28:29], v[76:77]
  v_pk_mul_f32 v[30:31], v[30:31], v[78:79]
  s_nop 1
  v_mfma_f32_16x16x32_bf16 v[120:123], a[76:79], a[148:151], v[120:123]
  v_exp_f32 v10, v10
  v_cvt_pk_f16_f32 v88, v48, v49
  v_mfma_f32_16x16x32_bf16 v[124:127], a[4:7], a[152:155], v[124:127]
  ds_read_b128 a[144:147], v5 offset:57344
  v_cvt_pk_f16_f32 v89, v50, v51
  v_cvt_pk_f16_f32 v90, v52, v53
  v_mfma_f32_16x16x32_bf16 v[128:131], a[76:79], a[152:155], v[128:131]
  v_exp_f32_e64 v11, v11
  v_cvt_pk_f16_f32 v91, v54, v55
  v_mfma_f32_16x16x32_bf16 v[132:135], a[4:7], a[156:159], v[132:135]
  ds_read_b128 a[148:151], v5 offset:58368
  v_exp_f32_e64 v12, v12
  v_mfma_f32_16x16x32_bf16 v[136:139], a[76:79], a[156:159], v[136:139]
  s_waitcnt lgkmcnt(5)
  v_exp_f32 v13, v13
  v_mfma_f32_16x16x32_bf16 v[116:119], a[8:11], a[160:163], v[116:119]
  ds_read_b128 a[152:155], v5 offset:59392
  v_exp_f32_e64 v14, v14
  v_mfma_f32_16x16x32_bf16 v[120:123], a[80:83], a[160:163], v[120:123]
  v_exp_f32_e64 v15, v15
  v_fma_f32 v8, v8, v176, v176
  v_mfma_f32_16x16x32_bf16 v[124:127], a[8:11], a[164:167], v[124:127]
  ds_read_b128 a[156:159], v5 offset:60416
  v_fma_f32 v9, v9, v177, v177
  v_fma_f32 v10, v10, v178, v178
  v_mfma_f32_16x16x32_bf16 v[128:131], a[80:83], a[164:167], v[128:131]
  v_exp_f32_e64 v16, v16
  v_fma_f32 v11, v11, v179, v179
  v_mfma_f32_16x16x32_bf16 v[132:135], a[8:11], a[168:171], v[132:135]
  ds_read_b128 a[160:163], v5 offset:61440
  v_fma_f32 v12, v12, v180, v180
  v_fma_f32 v13, v13, v181, v181
  v_mfma_f32_16x16x32_bf16 v[136:139], a[80:83], a[168:171], v[136:139]
  s_waitcnt lgkmcnt(5)
  v_exp_f32 v17, v17
  v_fma_f32 v14, v14, v182, v182
  v_mfma_f32_16x16x32_bf16 v[116:119], a[12:15], a[172:175], v[116:119]
  ds_read_b128 a[164:167], v5 offset:62464
  v_fma_f32 v15, v15, v183, v183
  v_mfma_f32_16x16x32_bf16 v[120:123], a[84:87], a[172:175], v[120:123]
  v_rcp_f32_e64 v8, v8
  v_mfma_f32_16x16x32_bf16 v[124:127], a[12:15], a[176:179], v[124:127]
  ds_read_b128 a[168:171], v5 offset:63488
  v_rcp_f32_e64 v9, v9
  v_mfma_f32_16x16x32_bf16 v[128:131], a[84:87], a[176:179], v[128:131]
  v_rcp_f32_e64 v10, v10
  v_mfma_f32_16x16x32_bf16 v[132:135], a[12:15], a[180:183], v[132:135]
  ds_read_b128 a[172:175], v5 offset:64512
  v_rcp_f32_e64 v11, v11
  v_mfma_f32_16x16x32_bf16 v[136:139], a[84:87], a[180:183], v[136:139]
  s_waitcnt lgkmcnt(5)
  v_rcp_f32 v12, v12
  v_mfma_f32_16x16x32_bf16 v[116:119], a[16:19], a[144:147], v[116:119]
  ds_read_b128 a[176:179], v6 offset:0
  v_rcp_f32_e64 v13, v13
  v_mfma_f32_16x16x32_bf16 v[120:123], a[88:91], a[144:147], v[120:123]
  v_rcp_f32_e64 v14, v14
  v_mfma_f32_16x16x32_bf16 v[124:127], a[16:19], a[148:151], v[124:127]
  ds_read_b128 a[180:183], v6 offset:1024
  v_rcp_f32 v15, v15
  s_nop 0
  v_pk_mul_f32 v[56:57], v[56:57], v[8:9]
  v_pk_mul_f32 v[58:59], v[58:59], v[10:11]
  v_pk_mul_f32 v[60:61], v[60:61], v[12:13]
  v_pk_mul_f32 v[62:63], v[62:63], v[14:15]
  v_pk_add_f32 v[240:241], v[240:241], v[56:57]
  v_pk_fma_f32 v[248:249], v[56:57], v[56:57], v[248:249]
  v_pk_add_f32 v[242:243], v[242:243], v[58:59]
  v_pk_fma_f32 v[250:251], v[58:59], v[58:59], v[250:251]
  v_pk_add_f32 v[244:245], v[244:245], v[60:61]
  v_pk_fma_f32 v[252:253], v[60:61], v[60:61], v[252:253]
  v_pk_add_f32 v[246:247], v[246:247], v[62:63]
  v_pk_fma_f32 v[254:255], v[62:63], v[62:63], v[254:255]
  s_nop 1
  v_mfma_f32_16x16x32_bf16 v[128:131], a[88:91], a[148:151], v[128:131]
  v_exp_f32 v18, v18
  v_mfma_f32_16x16x32_bf16 v[132:135], a[16:19], a[152:155], v[132:135]
  ds_read_b128 a[144:147], v6 offset:2048
  v_cvt_pk_f16_f32 v92, v56, v57
  v_mfma_f32_16x16x32_bf16 v[136:139], a[88:91], a[152:155], v[136:139]
  s_waitcnt lgkmcnt(5)
  v_exp_f32 v19, v19
  v_mfma_f32_16x16x32_bf16 v[116:119], a[20:23], a[156:159], v[116:119]
  ds_read_b128 a[148:151], v6 offset:3072
  v_cvt_pk_f16_f32 v93, v58, v59
  v_mfma_f32_16x16x32_bf16 v[120:123], a[92:95], a[156:159], v[120:123]
  v_exp_f32_e64 v20, v20
  v_mfma_f32_16x16x32_bf16 v[124:127], a[20:23], a[160:163], v[124:127]
  ds_read_b128 a[152:155], v6 offset:4096
  v_cvt_pk_f16_f32 v94, v60, v61
  v_mfma_f32_16x16x32_bf16 v[128:131], a[92:95], a[160:163], v[128:131]
  v_exp_f32_e64 v21, v21
  v_mfma_f32_16x16x32_bf16 v[132:135], a[20:23], a[164:167], v[132:135]
  ds_read_b128 a[156:159], v6 offset:5120
  v_cvt_pk_f16_f32 v95, v62, v63
  v_mfma_f32_16x16x32_bf16 v[136:139], a[92:95], a[164:167], v[136:139]
  s_waitcnt lgkmcnt(5)
  v_exp_f32 v22, v22
  v_mfma_f32_16x16x32_bf16 v[116:119], a[24:27], a[168:171], v[116:119]
  ds_read_b128 a[160:163], v6 offset:6144
  v_mfma_f32_16x16x32_bf16 v[120:123], a[96:99], a[168:171], v[120:123]
  v_exp_f32_e64 v23, v23
  v_mfma_f32_16x16x32_bf16 v[124:127], a[24:27], a[172:175], v[124:127]
  ds_read_b128 a[164:167], v6 offset:7168
  v_fma_f32 v16, v16, v176, v176
  v_mfma_f32_16x16x32_bf16 v[128:131], a[96:99], a[172:175], v[128:131]
  v_exp_f32_e64 v24, v24
  v_mfma_f32_16x16x32_bf16 v[132:135], a[24:27], a[176:179], v[132:135]
  ds_read_b128 a[168:171], v6 offset:10240
  v_fma_f32 v17, v17, v177, v177
  v_mfma_f32_16x16x32_bf16 v[136:139], a[96:99], a[176:179], v[136:139]
  s_waitcnt lgkmcnt(5)
  v_exp_f32 v25, v25
  v_mfma_f32_16x16x32_bf16 v[116:119], a[28:31], a[180:183], v[116:119]
  ds_read_b128 a[172:175], v6 offset:13312
  v_fma_f32 v18, v18, v178, v178
  v_mfma_f32_16x16x32_bf16 v[120:123], a[100:103], a[180:183], v[120:123]
  v_exp_f32_e64 v26, v26
  v_mfma_f32_16x16x32_bf16 v[124:127], a[28:31], a[144:147], v[124:127]
  s_waitcnt vmcnt(10)
  s_barrier
  ds_read_b128 a[176:179], v4 offset:0
  v_mfma_f32_16x16x32_bf16 v[128:131], a[100:103], a[144:147], v[128:131]
  s_add_u32 m0, s65, 73728
  s_add_u32 s35, s67, 221184
  buffer_load_dwordx4 v4, s[20:23], s35 offen offset:0 lds
  v_mfma_f32_16x16x32_bf16 v[132:135], a[28:31], a[148:151], v[132:135]
  ds_read_b128 a[180:183], v4 offset:3072
  v_fma_f32 v19, v19, v179, v179
  v_mfma_f32_16x16x32_bf16 v[136:139], a[100:103], a[148:151], v[136:139]
  s_waitcnt lgkmcnt(5)
  v_exp_f32 v27, v27
  v_mfma_f32_16x16x32_bf16 v[116:119], a[32:35], a[152:155], v[116:119]
  ds_read_b128 a[144:147], v4 offset:6144
  v_fma_f32 v20, v20, v180, v180
  v_mfma_f32_16x16x32_bf16 v[120:123], a[104:107], a[152:155], v[120:123]
  v_exp_f32_e64 v28, v28
  v_mfma_f32_16x16x32_bf16 v[124:127], a[32:35], a[156:159], v[124:127]
  ds_read_b128 a[148:151], v4 offset:9216
  v_fma_f32 v21, v21, v181, v181
  v_mfma_f32_16x16x32_bf16 v[128:131], a[104:107], a[156:159], v[128:131]
  buffer_load_dwordx4 v4, s[20:23], s35 offen offset:1024 lds
  v_mfma_f32_16x16x32_bf16 v[132:135], a[32:35], a[160:163], v[132:135]
  ds_read_b128 a[152:155], v4 offset:12288
  v_fma_f32 v22, v22, v182, v182
  v_mfma_f32_16x16x32_bf16 v[136:139], a[104:107], a[160:163], v[136:139]
  s_waitcnt lgkmcnt(5)
  v_exp_f32 v29, v29
  v_mfma_f32_16x16x32_bf16 v[116:119], a[36:39], a[164:167], v[116:119]
  ds_read_b128 a[156:159], v4 offset:15360
  v_fma_f32 v23, v23, v183, v183
  v_mfma_f32_16x16x32_bf16 v[120:123], a[108:111], a[164:167], v[120:123]
  v_rcp_f32_e64 v16, v16
  v_mfma_f32_16x16x32_bf16 v[116:119], a[40:43], a[168:171], v[116:119]
  ds_read_b128 a[160:163], v6 offset:8192
  v_mfma_f32_16x16x32_bf16 v[120:123], a[112:115], a[168:171], v[120:123]
  buffer_load_dwordx4 v4, s[20:23], s35 offen offset:2048 lds
  v_mfma_f32_16x16x32_bf16 v[116:119], a[44:47], a[172:175], v[116:119]
  ds_read_b128 a[164:167], v6 offset:11264
  v_mfma_f32_16x16x32_bf16 v[120:123], a[116:119], a[172:175], v[120:123]
  s_waitcnt lgkmcnt(5)
  v_rcp_f32 v17, v17
  v_mfma_f32_16x16x32_bf16 v[116:119], a[48:51], a[176:179], v[116:119]
  ds_read_b128 a[168:171], v6 offset:14336
  v_mfma_f32_16x16x32_bf16 v[120:123], a[120:123], a[176:179], v[120:123]
  v_rcp_f32_e64 v18, v18
  v_mfma_f32_16x16x32_bf16 v[116:119], a[52:55], a[180:183], v[116:119]
  ds_read_b128 a[172:175], v4 offset:1024
  v_mfma_f32_16x16x32_bf16 v[120:123], a[124:127], a[180:183], v[120:123]
  buffer_load_dwordx4 v4, s[20:23], s35 offen offset:3072 lds
  v_mfma_f32_16x16x32_bf16 v[116:119], a[56:59], a[144:147], v[116:119]
  ds_read_b128 a[176:179], v4 offset:4096
  s_add_u32 s35, s67, 225280
  v_mfma_f32_16x16x32_bf16 v[120:123], a[128:131], a[144:147], v[120:123]
  s_waitcnt lgkmcnt(5)
  s_add_u32 m0, s65, 77824
  v_mfma_f32_16x16x32_bf16 v[116:119], a[60:63], a[148:151], v[116:119]
  ds_read_b128 a[180:183], v4 offset:7168
  v_mfma_f32_16x16x32_bf16 v[120:123], a[132:135], a[148:151], v[120:123]
  v_rcp_f32 v19, v19
  v_mfma_f32_16x16x32_bf16 v[116:119], a[64:67], a[152:155], v[116:119]
  ds_read_b128 a[144:147], v4 offset:10240
  v_mfma_f32_16x16x32_bf16 v[120:123], a[136:139], a[152:155], v[120:123]
  buffer_load_dwordx4 v4, s[20:23], s35 offen offset:0 lds
  v_mfma_f32_16x16x32_bf16 v[116:119], a[68:71], a[156:159], v[116:119]
  ds_read_b128 a[148:151], v4 offset:13312
  v_mfma_f32_16x16x32_bf16 v[120:123], a[140:143], a[156:159], v[120:123]
  s_waitcnt lgkmcnt(5)
  v_rcp_f32 v20, v20
  v_mfma_f32_16x16x32_bf16 v[124:127], a[36:39], a[160:163], v[124:127]
  ds_read_b128 a[152:155], v4 offset:16384
  v_mfma_f32_16x16x32_bf16 v[128:131], a[108:111], a[160:163], v[128:131]
  v_rcp_f32_e64 v21, v21
  v_mfma_f32_16x16x32_bf16 v[124:127], a[40:43], a[164:167], v[124:127]
  ds_read_b128 a[156:159], v6 offset:9216
  v_rcp_f32 v22, v22
  s_nop 0
  v_pk_fma_f32 v[116:117], v[152:153], v[198:199], v[116:117] op_sel:[0,0,0] op_sel_hi:[1,0,1]
  v_pk_fma_f32 v[118:119], v[154:155], v[198:199], v[118:119] op_sel:[0,0,0] op_sel_hi:[1,0,1]
  v_pk_fma_f32 v[120:121], v[156:157], v[198:199], v[120:121] op_sel:[0,0,0] op_sel_hi:[1,0,1]
  v_pk_fma_f32 v[122:123], v[158:159], v[198:199], v[122:123] op_sel:[0,0,0] op_sel_hi:[1,0,1]
  v_pk_mul_f32 v[8:9], v[116:117], v[116:117]
  v_pk_mul_f32 v[10:11], v[118:119], v[118:119]
  v_pk_mul_f32 v[12:13], v[120:121], v[120:121]
  v_pk_mul_f32 v[14:15], v[122:123], v[122:123]
  v_pk_fma_f32 v[8:9], v[8:9], v[168:169], v[160:161]
  v_pk_fma_f32 v[10:11], v[10:11], v[170:171], v[162:163]
  v_pk_fma_f32 v[12:13], v[12:13], v[172:173], v[164:165]
  v_pk_fma_f32 v[14:15], v[14:15], v[174:175], v[166:167]
  v_pk_mul_f32 v[8:9], v[8:9], v[116:117]
  v_pk_mul_f32 v[10:11], v[10:11], v[118:119]
  v_pk_mul_f32 v[12:13], v[12:13], v[120:121]
  v_pk_mul_f32 v[14:15], v[14:15], v[122:123]
  s_nop 1
  v_mfma_f32_16x16x32_bf16 v[128:131], a[112:115], a[164:167], v[128:131]
  buffer_load_dwordx4 v4, s[20:23], s35 offen offset:1024 lds
  v_mfma_f32_16x16x32_bf16 v[124:127], a[44:47], a[168:171], v[124:127]
  ds_read_b128 a[160:163], v6 offset:12288
  v_rcp_f32_e64 v23, v23
  s_nop 0
  v_pk_mul_f32 v[64:65], v[64:65], v[16:17]
  v_pk_mul_f32 v[66:67], v[66:67], v[18:19]
  v_pk_mul_f32 v[68:69], v[68:69], v[20:21]
  v_pk_mul_f32 v[70:71], v[70:71], v[22:23]
  v_pk_add_f32 v[240:241], v[240:241], v[64:65]
  v_pk_fma_f32 v[248:249], v[64:65], v[64:65], v[248:249]
  v_pk_add_f32 v[242:243], v[242:243], v[66:67]
  v_pk_fma_f32 v[250:251], v[66:67], v[66:67], v[250:251]
  v_pk_add_f32 v[244:245], v[244:245], v[68:69]
  v_pk_fma_f32 v[252:253], v[68:69], v[68:69], v[252:253]
  v_pk_add_f32 v[246:247], v[246:247], v[70:71]
  v_pk_fma_f32 v[254:255], v[70:71], v[70:71], v[254:255]
  s_nop 1
  v_mfma_f32_16x16x32_bf16 v[128:131], a[116:119], a[168:171], v[128:131]
  s_waitcnt lgkmcnt(5)
  v_exp_f32_e64 v30, v30
  v_mfma_f32_16x16x32_bf16 v[124:127], a[48:51], a[172:175], v[124:127]
  ds_read_b128 a[164:167], v6 offset:15360
  v_cvt_pk_f16_f32 v96, v64, v65
  v_mfma_f32_16x16x32_bf16 v[128:131], a[120:123], a[172:175], v[128:131]
  v_exp_f32 v31, v31
  v_mfma_f32_16x16x32_bf16 v[124:127], a[52:55], a[176:179], v[124:127]
  ds_read_b128 a[168:171], v4 offset:2048
  v_fma_f32 v24, v24, v176, v176
  v_mfma_f32_16x16x32_bf16 v[128:131], a[124:127], a[176:179], v[128:131]
  s_getpc_b64 s[90:91]
  global_load_dword a248, v201, s[90:91]
  v_mfma_f32_16x16x32_bf16 v[124:127], a[56:59], a[180:183], v[124:127]
  ds_read_b128 a[172:175], v4 offset:5120
  v_fma_f32 v25, v25, v177, v177
  v_mfma_f32_16x16x32_bf16 v[128:131], a[128:131], a[180:183], v[128:131]
  s_waitcnt lgkmcnt(5)
  v_exp_f32 v8, v8
  v_mfma_f32_16x16x32_bf16 v[124:127], a[60:63], a[144:147], v[124:127]
  ds_read_b128 a[176:179], v4 offset:8192
  v_fma_f32 v26, v26, v178, v178
  v_mfma_f32_16x16x32_bf16 v[128:131], a[132:135], a[144:147], v[128:131]
  buffer_load_dwordx4 v4, s[20:23], s35 offen offset:2048 lds
  v_mfma_f32_16x16x32_bf16 v[124:127], a[64:67], a[148:151], v[124:127]
  ds_read_b128 a[180:183], v4 offset:11264
  v_fma_f32 v27, v27, v179, v179
  v_mfma_f32_16x16x32_bf16 v[128:131], a[136:139], a[148:151], v[128:131]
  v_exp_f32_e64 v9, v9
  v_mfma_f32_16x16x32_bf16 v[124:127], a[68:71], a[152:155], v[124:127]
  ds_read_b128 a[144:147], v4 offset:14336
  v_fma_f32 v28, v28, v180, v180
  v_mfma_f32_16x16x32_bf16 v[128:131], a[140:143], a[152:155], v[128:131]
  s_waitcnt lgkmcnt(5)
  v_exp_f32 v10, v10
  v_mfma_f32_16x16x32_bf16 v[132:135], a[36:39], a[156:159], v[132:135]
  ds_read_b128 a[148:151], v4 offset:17408
  v_fma_f32 v29, v29, v181, v181
  v_mfma_f32_16x16x32_bf16 v[136:139], a[108:111], a[156:159], v[136:139]
  buffer_load_dwordx4 v4, s[20:23], s35 offen offset:3072 lds
  v_mfma_f32_16x16x32_bf16 v[132:135], a[40:43], a[160:163], v[132:135]
  ds_read_b128 a[152:155], v4 offset:18432
  s_add_u32 s35, s67, 229376
  v_fma_f32 v30, v30, v182, v182
  v_pk_fma_f32 v[124:125], v[152:153], v[198:199], v[124:125] op_sel:[0,1,0] op_sel_hi:[1,1,1]
  v_pk_fma_f32 v[126:127], v[154:155], v[198:199], v[126:127] op_sel:[0,1,0] op_sel_hi:[1,1,1]
  v_pk_fma_f32 v[128:129], v[156:157], v[198:199], v[128:129] op_sel:[0,1,0] op_sel_hi:[1,1,1]
  v_pk_fma_f32 v[130:131], v[158:159], v[198:199], v[130:131] op_sel:[0,1,0] op_sel_hi:[1,1,1]
  v_pk_mul_f32 v[16:17], v[124:125], v[124:125]
  v_pk_mul_f32 v[18:19], v[126:127], v[126:127]
  v_pk_mul_f32 v[20:21], v[128:129], v[128:129]
  v_pk_mul_f32 v[22:23], v[130:131], v[130:131]
  v_pk_fma_f32 v[16:17], v[16:17], v[168:169], v[160:161]
  v_pk_fma_f32 v[18:19], v[18:19], v[170:171], v[162:163]
  v_pk_fma_f32 v[20:21], v[20:21], v[172:173], v[164:165]
  v_pk_fma_f32 v[22:23], v[22:23], v[174:175], v[166:167]
  v_pk_mul_f32 v[16:17], v[16:17], v[124:125]
  v_pk_mul_f32 v[18:19], v[18:19], v[126:127]
  v_pk_mul_f32 v[20:21], v[20:21], v[128:129]
  v_pk_mul_f32 v[22:23], v[22:23], v[130:131]
  s_nop 1
  v_mfma_f32_16x16x32_bf16 v[136:139], a[112:115], a[160:163], v[136:139]
  s_add_u32 m0, s65, 81920
  v_exp_f32 v11, v11
  v_fma_f32 v31, v31, v183, v183
  v_mfma_f32_16x16x32_bf16 v[132:135], a[44:47], a[164:167], v[132:135]
  ds_read_b128 a[156:159], v4 offset:19456
  v_cvt_pk_f16_f32 v97, v66, v67
  v_cvt_pk_f16_f32 v98, v68, v69
  v_mfma_f32_16x16x32_bf16 v[136:139], a[116:119], a[164:167], v[136:139]
  s_waitcnt lgkmcnt(5)
  v_rcp_f32 v24, v24
  v_cvt_pk_f16_f32 v99, v70, v71
  v_mfma_f32_16x16x32_bf16 v[132:135], a[48:51], a[168:171], v[132:135]
  ds_read_b128 a[160:163], v4 offset:20480
  v_rcp_f32_e64 v25, v25
  v_mfma_f32_16x16x32_bf16 v[136:139], a[120:123], a[168:171], v[136:139]
  buffer_load_dwordx4 v4, s[20:23], s35 offen offset:0 lds
  v_mfma_f32_16x16x32_bf16 v[132:135], a[52:55], a[172:175], v[132:135]
  ds_read_b128 a[164:167], v4 offset:21504
  v_rcp_f32_e64 v26, v26
  v_mfma_f32_16x16x32_bf16 v[136:139], a[124:127], a[172:175], v[136:139]
  v_rcp_f32_e64 v27, v27
  v_mfma_f32_16x16x32_bf16 v[132:135], a[56:59], a[176:179], v[132:135]
  ds_read_b128 a[168:171], v4 offset:22528
  v_rcp_f32_e64 v28, v28
  v_mfma_f32_16x16x32_bf16 v[136:139], a[128:131], a[176:179], v[136:139]
  s_waitcnt lgkmcnt(5)
  v_rcp_f32 v29, v29
  v_mfma_f32_16x16x32_bf16 v[132:135], a[60:63], a[180:183], v[132:135]
  ds_read_b128 a[172:175], v4 offset:23552
  v_rcp_f32_e64 v30, v30
  v_mfma_f32_16x16x32_bf16 v[136:139], a[132:135], a[180:183], v[136:139]
  v_rcp_f32 v31, v31
  s_nop 0
  v_pk_mul_f32 v[72:73], v[72:73], v[24:25]
  v_pk_mul_f32 v[74:75], v[74:75], v[26:27]
  v_pk_mul_f32 v[76:77], v[76:77], v[28:29]
  v_pk_mul_f32 v[78:79], v[78:79], v[30:31]
  v_pk_add_f32 v[240:241], v[240:241], v[72:73]
  v_pk_fma_f32 v[248:249], v[72:73], v[72:73], v[248:249]
  v_pk_add_f32 v[242:243], v[242:243], v[74:75]
  v_pk_fma_f32 v[250:251], v[74:75], v[74:75], v[250:251]
  v_pk_add_f32 v[244:245], v[244:245], v[76:77]
  v_pk_fma_f32 v[252:253], v[76:77], v[76:77], v[252:253]
  v_pk_add_f32 v[246:247], v[246:247], v[78:79]
  v_pk_fma_f32 v[254:255], v[78:79], v[78:79], v[254:255]
  s_nop 1
  v_mfma_f32_16x16x32_bf16 v[132:135], a[64:67], a[144:147], v[132:135]
  ds_read_b128 a[176:179], v4 offset:24576
  v_cvt_pk_f16_f32 v100, v72, v73
  v_mfma_f32_16x16x32_bf16 v[136:139], a[136:139], a[144:147], v[136:139]
  v_exp_f32 v12, v12
  v_mfma_f32_16x16x32_bf16 v[132:135], a[68:71], a[148:151], v[132:135]
  ds_read_b128 a[180:183], v4 offset:25600
  v_cvt_pk_f16_f32 v101, v74, v75
  v_mfma_f32_16x16x32_bf16 v[136:139], a[140:143], a[148:151], v[136:139]
  s_waitcnt lgkmcnt(5)
  v_exp_f32 v13, v13
  v_mfma_f32_16x16x32_bf16 v[32:35], a[152:155], a[0:3], 0
  ds_read_b128 a[144:147], v4 offset:26624
  v_cvt_pk_f16_f32 v102, v76, v77
  v_mfma_f32_16x16x32_bf16 v[36:39], a[152:155], a[72:75], 0
  v_exp_f32_e64 v14, v14
  v_mfma_f32_16x16x32_bf16 v[40:43], a[156:159], a[0:3], 0
  ds_read_b128 a[148:151], v4 offset:27648
  v_exp_f32 v15, v15
  v_exp_f32 v16, v16
  v_exp_f32 v17, v17
  v_exp_f32 v18, v18
  v_exp_f32_e64 v19, v19
  v_exp_f32 v20, v20
  s_nop 0
  v_pk_fma_f32 v[132:133], v[152:153], v[200:201], v[132:133] op_sel:[0,0,0] op_sel_hi:[1,0,1]
  v_pk_fma_f32 v[134:135], v[154:155], v[200:201], v[134:135] op_sel:[0,0,0] op_sel_hi:[1,0,1]
  v_pk_fma_f32 v[136:137], v[156:157], v[200:201], v[136:137] op_sel:[0,0,0] op_sel_hi:[1,0,1]
  v_pk_fma_f32 v[138:139], v[158:159], v[200:201], v[138:139] op_sel:[0,0,0] op_sel_hi:[1,0,1]
  v_pk_mul_f32 v[24:25], v[132:133], v[132:133]
  v_pk_mul_f32 v[26:27], v[134:135], v[134:135]
  v_pk_mul_f32 v[28:29], v[136:137], v[136:137]
  v_pk_mul_f32 v[30:31], v[138:139], v[138:139]
  v_pk_fma_f32 v[24:25], v[24:25], v[168:169], v[160:161]
  v_pk_fma_f32 v[26:27], v[26:27], v[170:171], v[162:163]
  v_pk_fma_f32 v[28:29], v[28:29], v[172:173], v[164:165]
  v_pk_fma_f32 v[30:31], v[30:31], v[174:175], v[166:167]
  v_pk_mul_f32 v[24:25], v[24:25], v[132:133]
  v_pk_mul_f32 v[26:27], v[26:27], v[134:135]
  v_pk_mul_f32 v[28:29], v[28:29], v[136:137]
  v_pk_mul_f32 v[30:31], v[30:31], v[138:139]
  s_nop 1
  v_mfma_f32_16x16x32_bf16 v[44:47], a[156:159], a[72:75], 0
  v_exp_f32 v21, v21
  v_exp_f32 v22, v22
  v_exp_f32 v23, v23
  v_exp_f32 v24, v24
  v_exp_f32 v25, v25
  v_exp_f32_e64 v26, v26
  v_fma_f32 v8, v8, v176, v176
  v_mfma_f32_16x16x32_bf16 v[48:51], a[160:163], a[0:3], 0
  ds_read_b128 a[152:155], v4 offset:28672
  v_fma_f32 v9, v9, v177, v177
  v_exp_f32 v27, v27
  v_exp_f32 v28, v28
  v_exp_f32 v29, v29
  v_exp_f32 v30, v30
  v_exp_f32 v31, v31
  v_fma_f32 v10, v10, v178, v178
  v_mfma_f32_16x16x32_bf16 v[52:55], a[160:163], a[72:75], 0
  s_waitcnt lgkmcnt(5)
  v_fma_f32 v11, v11, v179, v179
  v_fma_f32 v12, v12, v180, v180
  v_fma_f32 v13, v13, v181, v181
  v_fma_f32 v14, v14, v182, v182
  v_fma_f32 v15, v15, v183, v183
  v_rcp_f32 v8, v8
  v_rcp_f32 v9, v9
  v_rcp_f32 v10, v10
  v_rcp_f32 v11, v11
  v_mfma_f32_16x16x32_bf16 v[32:35], a[164:167], a[4:7], v[32:35]
  ds_read_b128 a[156:159], v4 offset:29696
  v_fma_f32 v16, v16, v176, v176
  v_rcp_f32 v12, v12
  v_rcp_f32 v13, v13
  v_rcp_f32 v14, v14
  v_rcp_f32 v15, v15
  v_fma_f32 v17, v17, v177, v177
  v_fma_f32 v18, v18, v178, v178
  v_fma_f32 v19, v19, v179, v179
  v_pk_mul_f32 v[116:117], v[116:117], v[8:9]
  v_pk_mul_f32 v[118:119], v[118:119], v[10:11]
  v_pk_mul_f32 v[120:121], v[120:121], v[12:13]
  v_pk_mul_f32 v[122:123], v[122:123], v[14:15]
  v_pk_add_f32 v[240:241], v[240:241], v[116:117]
  v_pk_fma_f32 v[248:249], v[116:117], v[116:117], v[248:249]
  v_pk_add_f32 v[242:243], v[242:243], v[118:119]
  v_pk_fma_f32 v[250:251], v[118:119], v[118:119], v[250:251]
  v_pk_add_f32 v[244:245], v[244:245], v[120:121]
  v_pk_fma_f32 v[252:253], v[120:121], v[120:121], v[252:253]
  v_pk_add_f32 v[246:247], v[246:247], v[122:123]
  v_pk_fma_f32 v[254:255], v[122:123], v[122:123], v[254:255]
  s_nop 1
  v_mfma_f32_16x16x32_bf16 v[36:39], a[164:167], a[76:79], v[36:39]
  v_fma_f32 v20, v20, v180, v180
  v_fma_f32 v21, v21, v181, v181
  v_fma_f32 v22, v22, v182, v182
  v_fma_f32 v23, v23, v183, v183
  v_rcp_f32 v16, v16
  v_rcp_f32 v17, v17
  v_rcp_f32 v18, v18
  v_rcp_f32_e64 v19, v19
  v_mfma_f32_16x16x32_bf16 v[40:43], a[168:171], a[4:7], v[40:43]
  ds_read_b128 a[160:163], v4 offset:30720
  v_fma_f32 v24, v24, v176, v176
L_pg_14:
  s_cbranch_execz L_wr_2
  v_rcp_f32_e64 v20, v20
  v_rcp_f32 v21, v21
  v_rcp_f32 v22, v22
  v_rcp_f32 v23, v23
  v_fma_f32 v25, v25, v177, v177
  v_fma_f32 v26, v26, v178, v178
  v_pk_mul_f32 v[124:125], v[124:125], v[16:17]
  v_pk_mul_f32 v[126:127], v[126:127], v[18:19]
  v_pk_mul_f32 v[128:129], v[128:129], v[20:21]
  v_pk_mul_f32 v[130:131], v[130:131], v[22:23]
  v_pk_add_f32 v[240:241], v[240:241], v[124:125]
  v_pk_fma_f32 v[248:249], v[124:125], v[124:125], v[248:249]
  v_pk_add_f32 v[242:243], v[242:243], v[126:127]
  v_pk_fma_f32 v[250:251], v[126:127], v[126:127], v[250:251]
  v_pk_add_f32 v[244:245], v[244:245], v[128:129]
  v_pk_fma_f32 v[252:253], v[128:129], v[128:129], v[252:253]
  v_pk_add_f32 v[246:247], v[246:247], v[130:131]
  v_pk_fma_f32 v[254:255], v[130:131], v[130:131], v[254:255]
  s_nop 1
  v_mfma_f32_16x16x32_bf16 v[44:47], a[168:171], a[76:79], v[44:47]
  v_fma_f32 v27, v27, v179, v179
  v_fma_f32 v28, v28, v180, v180
  v_fma_f32 v29, v29, v181, v181
  v_fma_f32 v30, v30, v182, v182
  v_fma_f32 v31, v31, v183, v183
  v_rcp_f32 v24, v24
  v_rcp_f32 v25, v25
  v_rcp_f32 v26, v26
  v_mfma_f32_16x16x32_bf16 v[48:51], a[172:175], a[4:7], v[48:51]
  ds_read_b128 a[164:167], v4 offset:31744
  v_rcp_f32 v27, v27
  v_rcp_f32 v28, v28
  v_rcp_f32 v29, v29
  v_rcp_f32 v30, v30
  v_rcp_f32 v31, v31
  s_nop 0
  v_pk_mul_f32 v[132:133], v[132:133], v[24:25]
  v_pk_mul_f32 v[134:135], v[134:135], v[26:27]
  v_pk_mul_f32 v[136:137], v[136:137], v[28:29]
  v_pk_mul_f32 v[138:139], v[138:139], v[30:31]
  v_pk_add_f32 v[240:241], v[240:241], v[132:133]
  v_pk_fma_f32 v[248:249], v[132:133], v[132:133], v[248:249]
  v_pk_add_f32 v[242:243], v[242:243], v[134:135]
  v_pk_fma_f32 v[250:251], v[134:135], v[134:135], v[250:251]
  v_pk_add_f32 v[244:245], v[244:245], v[136:137]
  v_pk_fma_f32 v[252:253], v[136:137], v[136:137], v[252:253]
  v_pk_add_f32 v[246:247], v[246:247], v[138:139]
  v_pk_fma_f32 v[254:255], v[138:139], v[138:139], v[254:255]
  s_nop 1
  s_nop 0
  v_mfma_f32_16x16x32_bf16 v[52:55], a[172:175], a[76:79], v[52:55]
  s_waitcnt lgkmcnt(5)
  s_nop 1
  v_add_f32_dpp v240, v240, v240 row_mirror row_mask:0xf bank_mask:0x3
  v_add_f32_dpp v248, v248, v248 row_mirror row_mask:0xf bank_mask:0x3
  v_add_f32_dpp v241, v241, v241 row_mirror row_mask:0xf bank_mask:0x3
  v_add_f32_dpp v249, v249, v249 row_mirror row_mask:0xf bank_mask:0x3
  v_add_f32_dpp v242, v242, v242 row_mirror row_mask:0xf bank_mask:0x3
  v_add_f32_dpp v250, v250, v250 row_mirror row_mask:0xf bank_mask:0x3
  v_add_f32_dpp v243, v243, v243 row_mirror row_mask:0xf bank_mask:0x3
  v_add_f32_dpp v251, v251, v251 row_mirror row_mask:0xf bank_mask:0x3
  v_add_f32_dpp v240, v244, v244 row_mirror row_mask:0xf bank_mask:0xc
  v_add_f32_dpp v248, v252, v252 row_mirror row_mask:0xf bank_mask:0xc
  v_add_f32_dpp v241, v245, v245 row_mirror row_mask:0xf bank_mask:0xc
  v_add_f32_dpp v249, v253, v253 row_mirror row_mask:0xf bank_mask:0xc
  v_mfma_f32_16x16x32_bf16 v[32:35], a[176:179], a[8:11], v[32:35]
  ds_read_b128 a[168:171], v4 offset:32768
  v_add_f32_dpp v242, v246, v246 row_mirror row_mask:0xf bank_mask:0xc
  v_add_f32_dpp v250, v254, v254 row_mirror row_mask:0xf bank_mask:0xc
  v_add_f32_dpp v243, v247, v247 row_mirror row_mask:0xf bank_mask:0xc
  v_add_f32_dpp v251, v255, v255 row_mirror row_mask:0xf bank_mask:0xc
  v_add_f32_dpp v240, v240, v240 row_half_mirror row_mask:0xf bank_mask:0x5
  v_add_f32_dpp v248, v248, v248 row_half_mirror row_mask:0xf bank_mask:0x5
  v_add_f32_dpp v241, v241, v241 row_half_mirror row_mask:0xf bank_mask:0x5
  v_add_f32_dpp v249, v249, v249 row_half_mirror row_mask:0xf bank_mask:0x5
  v_add_f32_dpp v240, v242, v242 row_half_mirror row_mask:0xf bank_mask:0xa
  v_add_f32_dpp v248, v250, v250 row_half_mirror row_mask:0xf bank_mask:0xa
  v_add_f32_dpp v241, v243, v243 row_half_mirror row_mask:0xf bank_mask:0xa
  v_add_f32_dpp v249, v251, v251 row_half_mirror row_mask:0xf bank_mask:0xa
  v_mfma_f32_16x16x32_bf16 v[36:39], a[176:179], a[80:83], v[36:39]
  v_add_f32_dpp v240, v240, v240 quad_perm:[2,3,0,1] row_mask:0xf bank_mask:0xf
  v_add_f32_dpp v248, v248, v248 quad_perm:[2,3,0,1] row_mask:0xf bank_mask:0xf
  v_add_f32_dpp v241, v241, v241 quad_perm:[2,3,0,1] row_mask:0xf bank_mask:0xf
  v_add_f32_dpp v249, v249, v249 quad_perm:[2,3,0,1] row_mask:0xf bank_mask:0xf
  v_add_f32_dpp v240, v240, v240 quad_perm:[1,0,3,2] row_mask:0xf bank_mask:0xf
  v_add_f32_dpp v248, v248, v248 quad_perm:[1,0,3,2] row_mask:0xf bank_mask:0xf
  v_add_f32_dpp v241, v241, v241 quad_perm:[1,0,3,2] row_mask:0xf bank_mask:0xf
  v_add_f32_dpp v249, v249, v249 quad_perm:[1,0,3,2] row_mask:0xf bank_mask:0xf
  s_nop 0
  v_cmp_eq_u32 vcc, 1, v203
  v_cndmask_b32 v240, v240, v248, vcc
  v_cmp_eq_u32 vcc, 2, v203
  v_cndmask_b32 v240, v240, v241, vcc
  v_cmp_eq_u32 vcc, 3, v203
  v_cndmask_b32 v240, v240, v249, vcc
  buffer_store_dword v240, v202, s[44:47], s36 offen sc0 sc1
  v_mfma_f32_16x16x32_bf16 v[40:43], a[180:183], a[8:11], v[40:43]
  ds_read_b128 a[172:175], v4 offset:33792
  v_cvt_pk_f16_f32 v103, v78, v79
  v_mfma_f32_16x16x32_bf16 v[44:47], a[180:183], a[80:83], v[44:47]
  v_cvt_pk_f16_f32 v104, v116, v117
  v_cvt_pk_f16_f32 v105, v118, v119
  v_mfma_f32_16x16x32_bf16 v[48:51], a[144:147], a[8:11], v[48:51]
  ds_read_b128 a[176:179], v4 offset:34816
  v_cvt_pk_f16_f32 v106, v120, v121
  v_mfma_f32_16x16x32_bf16 v[52:55], a[144:147], a[80:83], v[52:55]
  s_waitcnt lgkmcnt(5)
  v_cvt_pk_f16_f32 v107, v122, v123
  v_cvt_pk_f16_f32 v108, v124, v125
  v_mfma_f32_16x16x32_bf16 v[32:35], a[148:151], a[12:15], v[32:35]
  ds_read_b128 a[180:183], v4 offset:35840
  v_cvt_pk_f16_f32 v109, v126, v127
  v_mfma_f32_16x16x32_bf16 v[36:39], a[148:151], a[84:87], v[36:39]
  v_cvt_pk_f16_f32 v110, v128, v129
  v_cvt_pk_f16_f32 v111, v130, v131
  v_mfma_f32_16x16x32_bf16 v[40:43], a[152:155], a[12:15], v[40:43]
  s_waitcnt vmcnt(12)
  s_barrier
  ds_read_b128 a[144:147], v4 offset:36864
  v_mfma_f32_16x16x32_bf16 v[44:47], a[152:155], a[84:87], v[44:47]
  s_add_u32 m0, s65, 110592
  s_add_u32 s35, s67, 258048
  buffer_load_dwordx4 v4, s[20:23], s35 offen offset:0 lds
  v_mfma_f32_16x16x32_bf16 v[48:51], a[156:159], a[12:15], v[48:51]
  ds_read_b128 a[148:151], v4 offset:37888
  v_cvt_pk_f16_f32 v112, v132, v133
  v_mfma_f32_16x16x32_bf16 v[52:55], a[156:159], a[84:87], v[52:55]
  s_waitcnt lgkmcnt(5)
  v_cvt_pk_f16_f32 v113, v134, v135
  v_cvt_pk_f16_f32 v114, v136, v137
  v_mfma_f32_16x16x32_bf16 v[32:35], a[160:163], a[16:19], v[32:35]
  ds_read_b128 a[152:155], v4 offset:38912
  v_cvt_pk_f16_f32 v115, v138, v139
  v_mfma_f32_16x16x32_bf16 v[36:39], a[160:163], a[88:91], v[36:39]
  v_mfma_f32_16x16x32_bf16 v[40:43], a[164:167], a[16:19], v[40:43]
  ds_read_b128 a[156:159], v4 offset:39936
  v_mfma_f32_16x16x32_bf16 v[44:47], a[164:167], a[88:91], v[44:47]
  buffer_load_dwordx4 v4, s[20:23], s35 offen offset:1024 lds
  v_mfma_f32_16x16x32_bf16 v[48:51], a[168:171], a[16:19], v[48:51]
  ds_read_b128 a[160:163], v4 offset:40960
  v_mfma_f32_16x16x32_bf16 v[52:55], a[168:171], a[88:91], v[52:55]
  s_waitcnt lgkmcnt(5)
  v_mfma_f32_16x16x32_bf16 v[32:35], a[172:175], a[20:23], v[32:35]
  ds_read_b128 a[164:167], v4 offset:41984
  v_mfma_f32_16x16x32_bf16 v[36:39], a[172:175], a[92:95], v[36:39]
  v_mfma_f32_16x16x32_bf16 v[40:43], a[176:179], a[20:23], v[40:43]
  ds_read_b128 a[168:171], v4 offset:43008
  v_mfma_f32_16x16x32_bf16 v[44:47], a[176:179], a[92:95], v[44:47]
  buffer_load_dwordx4 v4, s[20:23], s35 offen offset:2048 lds
  v_mfma_f32_16x16x32_bf16 v[48:51], a[180:183], a[20:23], v[48:51]
  ds_read_b128 a[172:175], v4 offset:44032
  v_mfma_f32_16x16x32_bf16 v[52:55], a[180:183], a[92:95], v[52:55]
  s_waitcnt lgkmcnt(5)
  v_mfma_f32_16x16x32_bf16 v[32:35], a[144:147], a[24:27], v[32:35]
  ds_read_b128 a[176:179], v4 offset:45056
  v_mfma_f32_16x16x32_bf16 v[36:39], a[144:147], a[96:99], v[36:39]
  v_mfma_f32_16x16x32_bf16 v[40:43], a[148:151], a[24:27], v[40:43]
  ds_read_b128 a[180:183], v4 offset:46080
  v_mfma_f32_16x16x32_bf16 v[44:47], a[148:151], a[96:99], v[44:47]
  buffer_load_dwordx4 v4, s[20:23], s35 offen offset:3072 lds
  v_mfma_f32_16x16x32_bf16 v[48:51], a[152:155], a[24:27], v[48:51]
  ds_read_b128 a[144:147], v4 offset:47104
  s_add_u32 s35, s67, 262144
  v_mfma_f32_16x16x32_bf16 v[52:55], a[152:155], a[96:99], v[52:55]
  s_waitcnt lgkmcnt(5)
  s_add_u32 m0, s65, 114688
  v_mfma_f32_16x16x32_bf16 v[32:35], a[156:159], a[28:31], v[32:35]
  ds_read_b128 a[148:151], v4 offset:48128
  v_mfma_f32_16x16x32_bf16 v[36:39], a[156:159], a[100:103], v[36:39]
  v_mfma_f32_16x16x32_bf16 v[40:43], a[160:163], a[28:31], v[40:43]
  ds_read_b128 a[152:155], v4 offset:49152
  v_mfma_f32_16x16x32_bf16 v[44:47], a[160:163], a[100:103], v[44:47]
  buffer_load_dwordx4 v4, s[20:23], s35 offen offset:0 lds
  v_mfma_f32_16x16x32_bf16 v[48:51], a[164:167], a[28:31], v[48:51]
  ds_read_b128 a[156:159], v4 offset:50176
  v_mfma_f32_16x16x32_bf16 v[52:55], a[164:167], a[100:103], v[52:55]
  s_waitcnt lgkmcnt(5)
  v_mfma_f32_16x16x32_bf16 v[32:35], a[168:171], a[32:35], v[32:35]
  ds_read_b128 a[160:163], v4 offset:51200
  v_mfma_f32_16x16x32_bf16 v[36:39], a[168:171], a[104:107], v[36:39]
  v_mfma_f32_16x16x32_bf16 v[40:43], a[172:175], a[32:35], v[40:43]
  ds_read_b128 a[164:167], v4 offset:52224
  v_mfma_f32_16x16x32_bf16 v[44:47], a[172:175], a[104:107], v[44:47]
  buffer_load_dwordx4 v4, s[20:23], s35 offen offset:1024 lds
  v_mfma_f32_16x16x32_bf16 v[48:51], a[176:179], a[32:35], v[48:51]
  ds_read_b128 a[168:171], v4 offset:53248
  v_mfma_f32_16x16x32_bf16 v[52:55], a[176:179], a[104:107], v[52:55]
  s_waitcnt lgkmcnt(5)
  v_mfma_f32_16x16x32_bf16 v[32:35], a[180:183], a[36:39], v[32:35]
  ds_read_b128 a[172:175], v4 offset:54272
  v_mfma_f32_16x16x32_bf16 v[36:39], a[180:183], a[108:111], v[36:39]
  v_mfma_f32_16x16x32_bf16 v[40:43], a[144:147], a[36:39], v[40:43]
  ds_read_b128 a[176:179], v4 offset:55296
  v_mfma_f32_16x16x32_bf16 v[44:47], a[144:147], a[108:111], v[44:47]
  buffer_load_dwordx4 v4, s[20:23], s35 offen offset:2048 lds
  v_mfma_f32_16x16x32_bf16 v[48:51], a[148:151], a[36:39], v[48:51]
  ds_read_b128 a[180:183], v4 offset:56320
  v_mfma_f32_16x16x32_bf16 v[52:55], a[148:151], a[108:111], v[52:55]
  s_waitcnt lgkmcnt(5)
  v_mfma_f32_16x16x32_bf16 v[32:35], a[152:155], a[40:43], v[32:35]
  ds_read_b128 a[144:147], v4 offset:57344
  v_mfma_f32_16x16x32_bf16 v[36:39], a[152:155], a[112:115], v[36:39]
  v_mfma_f32_16x16x32_bf16 v[40:43], a[156:159], a[40:43], v[40:43]
  ds_read_b128 a[148:151], v4 offset:58368
  v_mfma_f32_16x16x32_bf16 v[44:47], a[156:159], a[112:115], v[44:47]
  buffer_load_dwordx4 v4, s[20:23], s35 offen offset:3072 lds
  v_mfma_f32_16x16x32_bf16 v[48:51], a[160:163], a[40:43], v[48:51]
  ds_read_b128 a[152:155], v4 offset:59392
  s_add_u32 s35, s67, 266240
  v_mfma_f32_16x16x32_bf16 v[52:55], a[160:163], a[112:115], v[52:55]
  s_waitcnt lgkmcnt(5)
  s_add_u32 m0, s65, 118784
  v_mfma_f32_16x16x32_bf16 v[32:35], a[164:167], a[44:47], v[32:35]
  ds_read_b128 a[156:159], v4 offset:60416
  v_mfma_f32_16x16x32_bf16 v[36:39], a[164:167], a[116:119], v[36:39]
  v_mfma_f32_16x16x32_bf16 v[40:43], a[168:171], a[44:47], v[40:43]
  ds_read_b128 a[160:163], v4 offset:61440
  v_mfma_f32_16x16x32_bf16 v[44:47], a[168:171], a[116:119], v[44:47]
  buffer_load_dwordx4 v4, s[20:23], s35 offen offset:0 lds
  v_mfma_f32_16x16x32_bf16 v[48:51], a[172:175], a[44:47], v[48:51]
  ds_read_b128 a[164:167], v4 offset:62464
  v_mfma_f32_16x16x32_bf16 v[52:55], a[172:175], a[116:119], v[52:55]
  s_waitcnt lgkmcnt(5)
  v_mfma_f32_16x16x32_bf16 v[32:35], a[176:179], a[48:51], v[32:35]
  ds_read_b128 a[168:171], v4 offset:63488
  v_mfma_f32_16x16x32_bf16 v[36:39], a[176:179], a[120:123], v[36:39]
  v_mfma_f32_16x16x32_bf16 v[40:43], a[180:183], a[48:51], v[40:43]
  ds_read_b128 a[172:175], v4 offset:64512
  v_mfma_f32_16x16x32_bf16 v[44:47], a[180:183], a[120:123], v[44:47]
  v_mfma_f32_16x16x32_bf16 v[48:51], a[144:147], a[48:51], v[48:51]
  ds_read_b128 a[176:179], v5 offset:0
  v_mfma_f32_16x16x32_bf16 v[52:55], a[144:147], a[120:123], v[52:55]
  s_waitcnt lgkmcnt(5)
  v_mfma_f32_16x16x32_bf16 v[32:35], a[148:151], a[52:55], v[32:35]
  ds_read_b128 a[180:183], v5 offset:1024
  v_mfma_f32_16x16x32_bf16 v[36:39], a[148:151], a[124:127], v[36:39]
  buffer_load_dwordx4 v[240:243], v4, s[44:47], s68 offen offset:0 sc0 sc1
  buffer_load_dwordx4 v[244:247], v4, s[44:47], s68 offen offset:1024 sc0 sc1
  buffer_load_dwordx4 v[248:251], v4, s[44:47], s68 offen offset:2048 sc0 sc1
  buffer_load_dwordx4 v[252:255], v4, s[44:47], s68 offen offset:3072 sc0 sc1
  v_mfma_f32_16x16x32_bf16 v[40:43], a[152:155], a[52:55], v[40:43]
  ds_read_b128 a[144:147], v5 offset:2048
  v_mfma_f32_16x16x32_bf16 v[44:47], a[152:155], a[124:127], v[44:47]
  s_getpc_b64 s[90:91]
  global_load_dword a248, v201, s[90:91]
  v_mfma_f32_16x16x32_bf16 v[48:51], a[156:159], a[52:55], v[48:51]
  ds_read_b128 a[148:151], v5 offset:3072
  v_mfma_f32_16x16x32_bf16 v[52:55], a[156:159], a[124:127], v[52:55]
  s_waitcnt lgkmcnt(5)
  v_mfma_f32_16x16x32_bf16 v[32:35], a[160:163], a[56:59], v[32:35]
  ds_read_b128 a[152:155], v5 offset:4096
  v_mfma_f32_16x16x32_bf16 v[36:39], a[160:163], a[128:131], v[36:39]
  v_mfma_f32_16x16x32_bf16 v[40:43], a[164:167], a[56:59], v[40:43]
  ds_read_b128 a[156:159], v5 offset:5120
  v_mfma_f32_16x16x32_bf16 v[44:47], a[164:167], a[128:131], v[44:47]
  v_mfma_f32_16x16x32_bf16 v[48:51], a[168:171], a[56:59], v[48:51]
  ds_read_b128 a[160:163], v5 offset:6144
  v_mfma_f32_16x16x32_bf16 v[52:55], a[168:171], a[128:131], v[52:55]
  s_waitcnt lgkmcnt(5)
  v_mfma_f32_16x16x32_bf16 v[32:35], a[172:175], a[60:63], v[32:35]
  ds_read_b128 a[164:167], v5 offset:7168
  v_mfma_f32_16x16x32_bf16 v[36:39], a[172:175], a[132:135], v[36:39]
  v_mfma_f32_16x16x32_bf16 v[40:43], a[176:179], a[60:63], v[40:43]
  s_waitcnt vmcnt(15)
  s_barrier
  ds_read_b128 a[168:171], v5 offset:8192
  v_mfma_f32_16x16x32_bf16 v[44:47], a[176:179], a[132:135], v[44:47]
  s_add_u32 m0, s65, 0
  s_add_u32 s35, s67, 294912
  buffer_load_dwordx4 v4, s[20:23], s35 offen offset:0 lds
  v_mfma_f32_16x16x32_bf16 v[48:51], a[180:183], a[60:63], v[48:51]
  ds_read_b128 a[172:175], v5 offset:9216
  v_mfma_f32_16x16x32_bf16 v[52:55], a[180:183], a[132:135], v[52:55]
  s_waitcnt lgkmcnt(5)
  s_nop 0
  v_mfma_f32_16x16x32_bf16 v[32:35], a[144:147], a[64:67], v[32:35]
  ds_read_b128 a[176:179], v5 offset:10240
  v_mfma_f32_16x16x32_bf16 v[36:39], a[144:147], a[136:139], v[36:39]
  v_mfma_f32_16x16x32_bf16 v[40:43], a[148:151], a[64:67], v[40:43]
  ds_read_b128 a[180:183], v5 offset:11264
  v_mfma_f32_16x16x32_bf16 v[44:47], a[148:151], a[136:139], v[44:47]
  buffer_load_dwordx4 v4, s[20:23], s35 offen offset:1024 lds
  v_mfma_f32_16x16x32_bf16 v[48:51], a[152:155], a[64:67], v[48:51]
  ds_read_b128 a[144:147], v5 offset:12288
  v_mfma_f32_16x16x32_bf16 v[52:55], a[152:155], a[136:139], v[52:55]
  s_waitcnt lgkmcnt(5)
  v_mfma_f32_16x16x32_bf16 v[32:35], a[156:159], a[68:71], v[32:35]
  ds_read_b128 a[148:151], v5 offset:13312
  v_mfma_f32_16x16x32_bf16 v[36:39], a[156:159], a[140:143], v[36:39]
  v_mfma_f32_16x16x32_bf16 v[40:43], a[160:163], a[68:71], v[40:43]
  ds_read_b128 a[152:155], v5 offset:14336
  v_mfma_f32_16x16x32_bf16 v[44:47], a[160:163], a[140:143], v[44:47]
  buffer_load_dwordx4 v4, s[20:23], s35 offen offset:2048 lds
  v_mfma_f32_16x16x32_bf16 v[48:51], a[164:167], a[68:71], v[48:51]
  ds_read_b128 a[156:159], v5 offset:15360
  v_mfma_f32_16x16x32_bf16 v[52:55], a[164:167], a[140:143], v[52:55]
  s_waitcnt lgkmcnt(5)
  v_mfma_f32_16x16x32_bf16 v[56:59], a[168:171], a[0:3], 0
  ds_read_b128 a[160:163], v5 offset:16384
  v_mfma_f32_16x16x32_bf16 v[60:63], a[168:171], a[72:75], 0
  v_mfma_f32_16x16x32_bf16 v[64:67], a[172:175], a[0:3], 0
  ds_read_b128 a[164:167], v5 offset:17408
  v_pk_fma_f32 v[32:33], v[204:205], v[184:185], v[32:33] op_sel:[0,0,0] op_sel_hi:[1,0,1]
  v_pk_fma_f32 v[34:35], v[206:207], v[184:185], v[34:35] op_sel:[0,0,0] op_sel_hi:[1,0,1]
  v_pk_fma_f32 v[36:37], v[204:205], v[184:185], v[36:37] op_sel:[0,1,0] op_sel_hi:[1,1,1]
  v_pk_fma_f32 v[38:39], v[206:207], v[184:185], v[38:39] op_sel:[0,1,0] op_sel_hi:[1,1,1]
  v_pk_fma_f32 v[40:41], v[208:209], v[184:185], v[40:41] op_sel:[0,0,0] op_sel_hi:[1,0,1]
  v_pk_fma_f32 v[42:43], v[210:211], v[184:185], v[42:43] op_sel:[0,0,0] op_sel_hi:[1,0,1]
  v_pk_fma_f32 v[44:45], v[208:209], v[184:185], v[44:45] op_sel:[0,1,0] op_sel_hi:[1,1,1]
  v_pk_fma_f32 v[46:47], v[210:211], v[184:185], v[46:47] op_sel:[0,1,0] op_sel_hi:[1,1,1]
  v_pk_fma_f32 v[48:49], v[212:213], v[184:185], v[48:49] op_sel:[0,0,0] op_sel_hi:[1,0,1]
  v_pk_fma_f32 v[50:51], v[214:215], v[184:185], v[50:51] op_sel:[0,0,0] op_sel_hi:[1,0,1]
  v_pk_fma_f32 v[52:53], v[212:213], v[184:185], v[52:53] op_sel:[0,1,0] op_sel_hi:[1,1,1]
  v_pk_fma_f32 v[54:55], v[214:215], v[184:185], v[54:55] op_sel:[0,1,0] op_sel_hi:[1,1,1]
  s_nop 1
  v_mfma_f32_16x16x32_bf16 v[68:71], a[172:175], a[72:75], 0
  buffer_load_dwordx4 v4, s[20:23], s35 offen offset:3072 lds
  v_mfma_f32_16x16x32_bf16 v[72:75], a[176:179], a[0:3], 0
  ds_read_b128 a[168:171], v5 offset:18432
  s_add_u32 s35, s67, 299008
  v_cvt_pk_f16_f32 v116, v32, v33
  v_mfma_f32_16x16x32_bf16 v[76:79], a[176:179], a[72:75], 0
  s_waitcnt lgkmcnt(5)
  s_add_u32 m0, s65, 4096
  v_cvt_pk_f16_f32 v117, v34, v35
  v_cvt_pk_f16_f32 v118, v36, v37
  v_mfma_f32_16x16x32_bf16 v[56:59], a[180:183], a[4:7], v[56:59]
  ds_read_b128 a[172:175], v5 offset:19456
  v_cvt_pk_f16_f32 v119, v38, v39
  v_cvt_pk_f16_f32 v120, v40, v41
  v_mfma_f32_16x16x32_bf16 v[60:63], a[180:183], a[76:79], v[60:63]
  v_cvt_pk_f16_f32 v121, v42, v43
  v_cvt_pk_f16_f32 v122, v44, v45
  v_cvt_pk_f16_f32 v123, v46, v47
  v_mfma_f32_16x16x32_bf16 v[64:67], a[144:147], a[4:7], v[64:67]
  ds_read_b128 a[176:179], v5 offset:20480
  v_cvt_pk_f16_f32 v124, v48, v49
  v_cvt_pk_f16_f32 v125, v50, v51
  v_mfma_f32_16x16x32_bf16 v[68:71], a[144:147], a[76:79], v[68:71]
  buffer_load_dwordx4 v4, s[20:23], s35 offen offset:0 lds
  v_mfma_f32_16x16x32_bf16 v[72:75], a[148:151], a[4:7], v[72:75]
  ds_read_b128 a[180:183], v5 offset:21504
  v_cvt_pk_f16_f32 v126, v52, v53
  v_cvt_pk_f16_f32 v127, v54, v55
  v_mfma_f32_16x16x32_bf16 v[76:79], a[148:151], a[76:79], v[76:79]
  s_waitcnt lgkmcnt(5)
  v_mfma_f32_16x16x32_bf16 v[56:59], a[152:155], a[8:11], v[56:59]
  ds_read_b128 a[144:147], v5 offset:22528
  v_mfma_f32_16x16x32_bf16 v[60:63], a[152:155], a[80:83], v[60:63]
  v_mfma_f32_16x16x32_bf16 v[64:67], a[156:159], a[8:11], v[64:67]
  ds_read_b128 a[148:151], v5 offset:23552
  v_mfma_f32_16x16x32_bf16 v[68:71], a[156:159], a[80:83], v[68:71]
  buffer_load_dwordx4 v4, s[20:23], s35 offen offset:1024 lds
  v_mfma_f32_16x16x32_bf16 v[72:75], a[160:163], a[8:11], v[72:75]
  ds_read_b128 a[152:155], v5 offset:24576
  s_waitcnt vmcnt(7)
  v_add_f32 v240, v240, v244
  v_add_f32 v241, v241, v245
  v_add_f32 v242, v242, v246
  v_add_f32 v243, v243, v247
  v_add_f32 v248, v248, v252
  v_add_f32 v249, v249, v253
  v_add_f32 v250, v250, v254
  v_add_f32 v251, v251, v255
  v_add_f32 v240, v240, v248
  v_add_f32 v241, v241, v249
  v_mfma_f32_16x16x32_bf16 v[76:79], a[160:163], a[80:83], v[76:79]
  s_waitcnt lgkmcnt(5)
  v_add_f32 v242, v242, v250
  v_add_f32 v243, v243, v251
  s_nop 0
  v_add_f32_dpp v240, v240, v240 row_ror:8 row_mask:0xf bank_mask:0x3
  v_add_f32_dpp v241, v241, v241 row_ror:8 row_mask:0xf bank_mask:0x3
  v_add_f32_dpp v240, v242, v242 row_ror:8 row_mask:0xf bank_mask:0xc
  v_add_f32_dpp v241, v243, v243 row_ror:8 row_mask:0xf bank_mask:0xc
  s_nop 0
  v_add_f32_dpp v240, v240, v240 row_shr:4 row_mask:0xf bank_mask:0xa
  v_add_f32_dpp v241, v241, v241 row_shr:4 row_mask:0xf bank_mask:0xa
  v_cmp_u_f32 vcc, v240, v241
  s_cmp_eq_u64 vcc, 0
  s_cbranch_scc0 L_k4_spin0
L_k4_go:
  v_mul_f32 v240, 0x39e38e39, v240
  v_mfma_f32_16x16x32_bf16 v[56:59], a[164:167], a[12:15], v[56:59]
  ds_read_b128 a[156:159], v5 offset:25600
  v_mul_f32 v241, 0x39e38e39, v241
  v_fma_f32 v241, -v240, v240, v241
  v_max_f32_e64 v241, 0, v241
  v_cvt_pk_bf16_f32 v240, v240, v240
  v_lshlrev_b32_e64 v240, 16, v240
  v_cvt_pk_bf16_f32 v241, v241, v241
  v_lshlrev_b32_e64 v241, 16, v241
  v_add_f32 v241, 0x3727c5ac, v241
  v_cvt_pk_bf16_f32 v241, v241, v241
  v_lshlrev_b32 v241, 16, v241
  v_sqrt_f32 v241, v241
  v_mfma_f32_16x16x32_bf16 v[60:63], a[164:167], a[84:87], v[60:63]
  s_nop 0
  v_cvt_pk_bf16_f32 v241, v241, v241
  v_lshlrev_b32 v241, 16, v241
  v_rcp_f32 v241, v241
  s_nop 0
  v_mul_f32 v240, v240, v241
  v_sub_f32 v240, 0, v240
  s_lshr_b32 s37, s12, 257
  s_mul_i32 s37, s37, 16384
  s_lshl_b32 s38, s12, 10
  s_add_u32 s37, s37, s38
  s_add_u32 s37, s37, 36864
  v_add_u32_e64 v202, s37, v4
  v_mfma_f32_16x16x32_bf16 v[64:67], a[168:171], a[12:15], v[64:67]
  ds_read_b128 a[160:163], v5 offset:26624
  v_mov_b32_dpp v152, v240 row_newbcast:4 row_mask:0xf bank_mask:0xf
  v_mov_b32_dpp v160, v241 row_newbcast:4 row_mask:0xf bank_mask:0xf
  v_mov_b32_dpp v153, v240 row_newbcast:12 row_mask:0xf bank_mask:0xf
  v_mov_b32_dpp v161, v241 row_newbcast:12 row_mask:0xf bank_mask:0xf
  v_mov_b32_dpp v154, v240 row_newbcast:5 row_mask:0xf bank_mask:0xf
  v_mov_b32_dpp v162, v241 row_newbcast:5 row_mask:0xf bank_mask:0xf
  v_mov_b32_dpp v155, v240 row_newbcast:13 row_mask:0xf bank_mask:0xf
  v_mov_b32_dpp v163, v241 row_newbcast:13 row_mask:0xf bank_mask:0xf
  v_mov_b32_dpp v156, v240 row_newbcast:6 row_mask:0xf bank_mask:0xf
  v_mov_b32_dpp v164, v241 row_newbcast:6 row_mask:0xf bank_mask:0xf
  v_mov_b32_dpp v157, v240 row_newbcast:14 row_mask:0xf bank_mask:0xf
  v_mov_b32_dpp v165, v241 row_newbcast:14 row_mask:0xf bank_mask:0xf
  v_mfma_f32_16x16x32_bf16 v[68:71], a[168:171], a[84:87], v[68:71]
  buffer_load_dwordx4 v4, s[20:23], s35 offen offset:2048 lds
  v_mov_b32_dpp v158, v240 row_newbcast:7 row_mask:0xf bank_mask:0xf
  v_mov_b32_dpp v166, v241 row_newbcast:7 row_mask:0xf bank_mask:0xf
  v_mov_b32_dpp v159, v240 row_newbcast:15 row_mask:0xf bank_mask:0xf
  v_mov_b32_dpp v167, v241 row_newbcast:15 row_mask:0xf bank_mask:0xf
  v_fma_mix_f32 v168, v80, v160, v152 op_sel:[0,0,0] op_sel_hi:[1,0,0]
  v_fma_mix_f32 v169, v80, v161, v153 op_sel:[1,0,0] op_sel_hi:[1,0,0]
  v_fma_mix_f32 v170, v81, v162, v154 op_sel:[0,0,0] op_sel_hi:[1,0,0]
  v_fma_mix_f32 v171, v81, v163, v155 op_sel:[1,0,0] op_sel_hi:[1,0,0]
  v_fma_mix_f32 v172, v82, v164, v156 op_sel:[0,0,0] op_sel_hi:[1,0,0]
  v_fma_mix_f32 v173, v82, v165, v157 op_sel:[1,0,0] op_sel_hi:[1,0,0]
  v_fma_mix_f32 v174, v83, v166, v158 op_sel:[0,0,0] op_sel_hi:[1,0,0]
  v_fma_mix_f32 v175, v83, v167, v159 op_sel:[1,0,0] op_sel_hi:[1,0,0]
  v_cvt_pk_bf16_f32 v80, v168, v169
  v_cvt_pk_bf16_f32 v81, v170, v171
  v_cvt_pk_bf16_f32 v82, v172, v173
  v_cvt_pk_bf16_f32 v83, v174, v175
  s_add_u32 s37, s70, 0
  s_nop 0
  buffer_store_dwordx4 v[80:83], v4, s[52:55], s37 offen sc0 sc1
  v_fma_mix_f32 v168, v84, v160, v152 op_sel:[0,0,0] op_sel_hi:[1,0,0]
  v_fma_mix_f32 v169, v84, v161, v153 op_sel:[1,0,0] op_sel_hi:[1,0,0]
  v_fma_mix_f32 v170, v85, v162, v154 op_sel:[0,0,0] op_sel_hi:[1,0,0]
  v_fma_mix_f32 v171, v85, v163, v155 op_sel:[1,0,0] op_sel_hi:[1,0,0]
  v_fma_mix_f32 v172, v86, v164, v156 op_sel:[0,0,0] op_sel_hi:[1,0,0]
  v_fma_mix_f32 v173, v86, v165, v157 op_sel:[1,0,0] op_sel_hi:[1,0,0]
  v_fma_mix_f32 v174, v87, v166, v158 op_sel:[0,0,0] op_sel_hi:[1,0,0]
  v_fma_mix_f32 v175, v87, v167, v159 op_sel:[1,0,0] op_sel_hi:[1,0,0]
  v_mfma_f32_16x16x32_bf16 v[72:75], a[172:175], a[12:15], v[72:75]
  ds_read_b128 a[164:167], v5 offset:27648
  v_cvt_pk_bf16_f32 v84, v168, v169
  v_cvt_pk_bf16_f32 v85, v170, v171
  v_cvt_pk_bf16_f32 v86, v172, v173
  v_cvt_pk_bf16_f32 v87, v174, v175
  s_add_u32 s37, s70, 2048
  buffer_store_dwordx4 v[84:87], v4, s[52:55], s37 offen sc0 sc1
  v_fma_mix_f32 v168, v88, v160, v152 op_sel:[0,0,0] op_sel_hi:[1,0,0]
  v_fma_mix_f32 v169, v88, v161, v153 op_sel:[1,0,0] op_sel_hi:[1,0,0]
  v_fma_mix_f32 v170, v89, v162, v154 op_sel:[0,0,0] op_sel_hi:[1,0,0]
  v_fma_mix_f32 v171, v89, v163, v155 op_sel:[1,0,0] op_sel_hi:[1,0,0]
  v_fma_mix_f32 v172, v90, v164, v156 op_sel:[0,0,0] op_sel_hi:[1,0,0]
  v_fma_mix_f32 v173, v90, v165, v157 op_sel:[1,0,0] op_sel_hi:[1,0,0]
  v_fma_mix_f32 v174, v91, v166, v158 op_sel:[0,0,0] op_sel_hi:[1,0,0]
  v_fma_mix_f32 v175, v91, v167, v159 op_sel:[1,0,0] op_sel_hi:[1,0,0]
  v_cvt_pk_bf16_f32 v88, v168, v169
  v_cvt_pk_bf16_f32 v89, v170, v171
  v_cvt_pk_bf16_f32 v90, v172, v173
  v_cvt_pk_bf16_f32 v91, v174, v175
  s_add_u32 s37, s70, 4096
  buffer_store_dwordx4 v[88:91], v4, s[52:55], s37 offen sc0 sc1
  v_fma_mix_f32 v168, v92, v160, v152 op_sel:[0,0,0] op_sel_hi:[1,0,0]
  v_fma_mix_f32 v169, v92, v161, v153 op_sel:[1,0,0] op_sel_hi:[1,0,0]
  v_fma_mix_f32 v170, v93, v162, v154 op_sel:[0,0,0] op_sel_hi:[1,0,0]
  v_fma_mix_f32 v171, v93, v163, v155 op_sel:[1,0,0] op_sel_hi:[1,0,0]
  v_fma_mix_f32 v172, v94, v164, v156 op_sel:[0,0,0] op_sel_hi:[1,0,0]
  v_fma_mix_f32 v173, v94, v165, v157 op_sel:[1,0,0] op_sel_hi:[1,0,0]
  v_fma_mix_f32 v174, v95, v166, v158 op_sel:[0,0,0] op_sel_hi:[1,0,0]
  v_mfma_f32_16x16x32_bf16 v[76:79], a[172:175], a[84:87], v[76:79]
  s_waitcnt lgkmcnt(5)
  s_nop 0
  v_fma_mix_f32 v175, v95, v167, v159 op_sel:[1,0,0] op_sel_hi:[1,0,0]
  v_cvt_pk_bf16_f32 v92, v168, v169
  v_cvt_pk_bf16_f32 v93, v170, v171
  v_cvt_pk_bf16_f32 v94, v172, v173
  v_cvt_pk_bf16_f32 v95, v174, v175
  s_add_u32 s37, s70, 6144
  buffer_store_dwordx4 v[92:95], v4, s[52:55], s37 offen sc0 sc1
  v_fma_mix_f32 v168, v96, v160, v152 op_sel:[0,0,0] op_sel_hi:[1,0,0]
  v_fma_mix_f32 v169, v96, v161, v153 op_sel:[1,0,0] op_sel_hi:[1,0,0]
  v_fma_mix_f32 v170, v97, v162, v154 op_sel:[0,0,0] op_sel_hi:[1,0,0]
  v_fma_mix_f32 v171, v97, v163, v155 op_sel:[1,0,0] op_sel_hi:[1,0,0]
  v_fma_mix_f32 v172, v98, v164, v156 op_sel:[0,0,0] op_sel_hi:[1,0,0]
  v_fma_mix_f32 v173, v98, v165, v157 op_sel:[1,0,0] op_sel_hi:[1,0,0]
  v_fma_mix_f32 v174, v99, v166, v158 op_sel:[0,0,0] op_sel_hi:[1,0,0]
  v_fma_mix_f32 v175, v99, v167, v159 op_sel:[1,0,0] op_sel_hi:[1,0,0]
  v_cvt_pk_bf16_f32 v96, v168, v169
  v_cvt_pk_bf16_f32 v97, v170, v171
  v_cvt_pk_bf16_f32 v98, v172, v173
  v_cvt_pk_bf16_f32 v99, v174, v175
  s_add_u32 s37, s70, 8192
  buffer_store_dwordx4 v[96:99], v4, s[52:55], s37 offen sc0 sc1
  v_fma_mix_f32 v168, v100, v160, v152 op_sel:[0,0,0] op_sel_hi:[1,0,0]
  v_fma_mix_f32 v169, v100, v161, v153 op_sel:[1,0,0] op_sel_hi:[1,0,0]
  v_fma_mix_f32 v170, v101, v162, v154 op_sel:[0,0,0] op_sel_hi:[1,0,0]
  v_fma_mix_f32 v171, v101, v163, v155 op_sel:[1,0,0] op_sel_hi:[1,0,0]
  v_fma_mix_f32 v172, v102, v164, v156 op_sel:[0,0,0] op_sel_hi:[1,0,0]
  v_fma_mix_f32 v173, v102, v165, v157 op_sel:[1,0,0] op_sel_hi:[1,0,0]
  v_fma_mix_f32 v174, v103, v166, v158 op_sel:[0,0,0] op_sel_hi:[1,0,0]
  v_mfma_f32_16x16x32_bf16 v[56:59], a[176:179], a[16:19], v[56:59]
  ds_read_b128 a[168:171], v5 offset:28672
  v_fma_mix_f32 v175, v103, v167, v159 op_sel:[1,0,0] op_sel_hi:[1,0,0]
  v_cvt_pk_bf16_f32 v100, v168, v169
  v_cvt_pk_bf16_f32 v101, v170, v171
  v_cvt_pk_bf16_f32 v102, v172, v173
  v_cvt_pk_bf16_f32 v103, v174, v175
  s_add_u32 s37, s70, 10240
  buffer_store_dwordx4 v[100:103], v4, s[52:55], s37 offen sc0 sc1
  v_fma_mix_f32 v168, v104, v160, v152 op_sel:[0,0,0] op_sel_hi:[1,0,0]
  v_fma_mix_f32 v169, v104, v161, v153 op_sel:[1,0,0] op_sel_hi:[1,0,0]
  v_fma_mix_f32 v170, v105, v162, v154 op_sel:[0,0,0] op_sel_hi:[1,0,0]
  v_fma_mix_f32 v171, v105, v163, v155 op_sel:[1,0,0] op_sel_hi:[1,0,0]
  v_fma_mix_f32 v172, v106, v164, v156 op_sel:[0,0,0] op_sel_hi:[1,0,0]
  v_fma_mix_f32 v173, v106, v165, v157 op_sel:[1,0,0] op_sel_hi:[1,0,0]
  v_fma_mix_f32 v174, v107, v166, v158 op_sel:[0,0,0] op_sel_hi:[1,0,0]
  v_fma_mix_f32 v175, v107, v167, v159 op_sel:[1,0,0] op_sel_hi:[1,0,0]
  v_cvt_pk_bf16_f32 v104, v168, v169
  v_cvt_pk_bf16_f32 v105, v170, v171
  v_cvt_pk_bf16_f32 v106, v172, v173
  v_cvt_pk_bf16_f32 v107, v174, v175
  s_add_u32 s37, s70, 12288
  buffer_store_dwordx4 v[104:107], v4, s[52:55], s37 offen sc0 sc1
  v_fma_mix_f32 v168, v108, v160, v152 op_sel:[0,0,0] op_sel_hi:[1,0,0]
  v_fma_mix_f32 v169, v108, v161, v153 op_sel:[1,0,0] op_sel_hi:[1,0,0]
  v_fma_mix_f32 v170, v109, v162, v154 op_sel:[0,0,0] op_sel_hi:[1,0,0]
  v_fma_mix_f32 v171, v109, v163, v155 op_sel:[1,0,0] op_sel_hi:[1,0,0]
  v_fma_mix_f32 v172, v110, v164, v156 op_sel:[0,0,0] op_sel_hi:[1,0,0]
  v_fma_mix_f32 v173, v110, v165, v157 op_sel:[1,0,0] op_sel_hi:[1,0,0]
  v_mfma_f32_16x16x32_bf16 v[60:63], a[176:179], a[88:91], v[60:63]
  v_fma_mix_f32 v174, v111, v166, v158 op_sel:[0,0,0] op_sel_hi:[1,0,0]
  v_fma_mix_f32 v175, v111, v167, v159 op_sel:[1,0,0] op_sel_hi:[1,0,0]
  v_cvt_pk_bf16_f32 v108, v168, v169
  v_cvt_pk_bf16_f32 v109, v170, v171
  v_cvt_pk_bf16_f32 v110, v172, v173
  v_cvt_pk_bf16_f32 v111, v174, v175
  s_add_u32 s37, s70, 14336
  buffer_store_dwordx4 v[108:111], v4, s[52:55], s37 offen sc0 sc1
  v_fma_mix_f32 v168, v112, v160, v152 op_sel:[0,0,0] op_sel_hi:[1,0,0]
  v_fma_mix_f32 v169, v112, v161, v153 op_sel:[1,0,0] op_sel_hi:[1,0,0]
  v_fma_mix_f32 v170, v113, v162, v154 op_sel:[0,0,0] op_sel_hi:[1,0,0]
  v_fma_mix_f32 v171, v113, v163, v155 op_sel:[1,0,0] op_sel_hi:[1,0,0]
  v_fma_mix_f32 v172, v114, v164, v156 op_sel:[0,0,0] op_sel_hi:[1,0,0]
  v_fma_mix_f32 v173, v114, v165, v157 op_sel:[1,0,0] op_sel_hi:[1,0,0]
  s_nop 0
L_pg_15:
  s_cbranch_execz L_wr_2
  v_fma_mix_f32 v174, v115, v166, v158 op_sel:[0,0,0] op_sel_hi:[1,0,0]
  v_fma_mix_f32 v175, v115, v167, v159 op_sel:[1,0,0] op_sel_hi:[1,0,0]
  v_cvt_pk_bf16_f32 v112, v168, v169
  v_cvt_pk_bf16_f32 v113, v170, v171
  v_cvt_pk_bf16_f32 v114, v172, v173
  v_cvt_pk_bf16_f32 v115, v174, v175
  s_add_u32 s37, s70, 16384
  buffer_store_dwordx4 v[112:115], v4, s[52:55], s37 offen sc0 sc1
  s_add_u32 s24, s10, 60162048
  s_addc_u32 s25, s11, 0
  s_mov_b32 s26, 196608
  s_mov_b32 s27, 0x00020000
  v_mfma_f32_16x16x32_bf16 v[64:67], a[180:183], a[16:19], v[64:67]
  ds_read_b128 a[172:175], v5 offset:29696
  s_add_u32 s16, s10, 21233664
  s_addc_u32 s17, s11, 0
  s_mov_b32 s18, 9437184
  s_mov_b32 s19, 0x00020000
  s_and_b32 s76, s28, 7
  s_and_b32 s77, s28, 8
  v_cmp_ge_u32_e64 vcc, s76, v2
  v_subb_co_u32 v248, vcc, v2, 0, vcc
  v_xor_b32 v248, s77, v248
  v_and_b32 v248, 15, v248
  v_lshlrev_b32_e64 v248, 6, v248
  s_mul_i32 s36, s29, 1280
  s_add_u32 s36, s36, 0
  s_lshl_b32 s37, s28, 6
  s_add_u32 s37, s37, s36
  v_mov_b32 v252, 1
  v_mov_b32 v253, 1
  v_mov_b32 v254, 1
  v_mov_b32 v255, 1
  v_lshrrev_b32 v250, 2, v0
  v_lshlrev_b32 v250, 24, v250
  v_add_u32 v250, v250, v4
  s_lshr_b32 s31, s12, 257
  s_mul_i32 s31, s31, 9
  s_and_b32 s32, s12, 1
  s_lshl_b32 s32, s32, 2
  s_add_u32 s72, s31, s32
  v_mfma_f32_16x16x32_bf16 v[68:71], a[180:183], a[88:91], v[68:71]
  buffer_load_dwordx4 v4, s[20:23], s35 offen offset:3072 lds
  s_lshl_b32 s72, s72, 10
  s_mul_i32 s78, s29, 589824
  s_and_b32 s32, s12, 1
  s_lshl_b32 s41, s32, 10
  s_add_u32 s41, s41, s72
  s_mul_i32 s43, s32, 13312
  s_add_u32 s43, s43, 4096
  s_add_u32 s42, s41, s43
  s_add_u32 s78, s78, s41
  s_mov_b32 s82, -1
  s_mov_b32 s87, -1
  s_mov_b32 s83, 2
  v_add_u32 v7, 4096, v4
  v_mfma_f32_16x16x32_bf16 v[72:75], a[144:147], a[16:19], v[72:75]
  ds_read_b128 a[176:179], v5 offset:30720
  s_add_u32 s35, s67, 303104
  v_mfma_f32_16x16x32_bf16 v[76:79], a[144:147], a[88:91], v[76:79]
  s_waitcnt lgkmcnt(5)
  s_add_u32 m0, s65, 8192
  v_mfma_f32_16x16x32_bf16 v[56:59], a[148:151], a[20:23], v[56:59]
  ds_read_b128 a[180:183], v5 offset:31744
  v_mfma_f32_16x16x32_bf16 v[60:63], a[148:151], a[92:95], v[60:63]
  v_mfma_f32_16x16x32_bf16 v[64:67], a[152:155], a[20:23], v[64:67]
  ds_read_b128 a[144:147], v5 offset:32768
  v_mfma_f32_16x16x32_bf16 v[68:71], a[152:155], a[92:95], v[68:71]
  buffer_load_dwordx4 v4, s[20:23], s35 offen offset:0 lds
  v_mfma_f32_16x16x32_bf16 v[72:75], a[156:159], a[20:23], v[72:75]
  ds_read_b128 a[148:151], v5 offset:33792
  v_mfma_f32_16x16x32_bf16 v[76:79], a[156:159], a[92:95], v[76:79]
  s_waitcnt lgkmcnt(5)
  v_mfma_f32_16x16x32_bf16 v[56:59], a[160:163], a[24:27], v[56:59]
  ds_read_b128 a[152:155], v5 offset:34816
  v_mfma_f32_16x16x32_bf16 v[60:63], a[160:163], a[96:99], v[60:63]
  v_mfma_f32_16x16x32_bf16 v[64:67], a[164:167], a[24:27], v[64:67]
  ds_read_b128 a[156:159], v5 offset:35840
  v_mfma_f32_16x16x32_bf16 v[68:71], a[164:167], a[96:99], v[68:71]
  v_mfma_f32_16x16x32_bf16 v[72:75], a[168:171], a[24:27], v[72:75]
  ds_read_b128 a[160:163], v5 offset:36864
  v_mfma_f32_16x16x32_bf16 v[76:79], a[168:171], a[96:99], v[76:79]
  s_waitcnt lgkmcnt(5)
  v_mfma_f32_16x16x32_bf16 v[56:59], a[172:175], a[28:31], v[56:59]
  ds_read_b128 a[164:167], v5 offset:37888
  v_mfma_f32_16x16x32_bf16 v[60:63], a[172:175], a[100:103], v[60:63]
  v_mfma_f32_16x16x32_bf16 v[64:67], a[176:179], a[28:31], v[64:67]
  ds_read_b128 a[168:171], v5 offset:38912
  v_mfma_f32_16x16x32_bf16 v[68:71], a[176:179], a[100:103], v[68:71]
  v_mfma_f32_16x16x32_bf16 v[72:75], a[180:183], a[28:31], v[72:75]
  ds_read_b128 a[172:175], v5 offset:39936
  v_mfma_f32_16x16x32_bf16 v[76:79], a[180:183], a[100:103], v[76:79]
  s_waitcnt lgkmcnt(5)
  v_mfma_f32_16x16x32_bf16 v[56:59], a[144:147], a[32:35], v[56:59]
  ds_read_b128 a[176:179], v5 offset:40960
  v_mfma_f32_16x16x32_bf16 v[60:63], a[144:147], a[104:107], v[60:63]
  v_mfma_f32_16x16x32_bf16 v[64:67], a[148:151], a[32:35], v[64:67]
  ds_read_b128 a[180:183], v5 offset:41984
  v_mfma_f32_16x16x32_bf16 v[68:71], a[148:151], a[104:107], v[68:71]
  v_mfma_f32_16x16x32_bf16 v[72:75], a[152:155], a[32:35], v[72:75]
  ds_read_b128 a[144:147], v5 offset:43008
  v_mfma_f32_16x16x32_bf16 v[76:79], a[152:155], a[104:107], v[76:79]
  s_waitcnt lgkmcnt(5)
  v_mfma_f32_16x16x32_bf16 v[56:59], a[156:159], a[36:39], v[56:59]
  ds_read_b128 a[148:151], v5 offset:44032
  v_mfma_f32_16x16x32_bf16 v[60:63], a[156:159], a[108:111], v[60:63]
  v_mfma_f32_16x16x32_bf16 v[64:67], a[160:163], a[36:39], v[64:67]
  s_waitcnt vmcnt(23)
  s_barrier
  ds_read_b128 a[152:155], v5 offset:45056
  v_mfma_f32_16x16x32_bf16 v[68:71], a[160:163], a[108:111], v[68:71]
  ds_write_b128 v202, v[80:83] offset:0
  v_mfma_f32_16x16x32_bf16 v[72:75], a[164:167], a[36:39], v[72:75]
  ds_read_b128 a[156:159], v5 offset:46080
  v_mfma_f32_16x16x32_bf16 v[76:79], a[164:167], a[108:111], v[76:79]
  s_waitcnt lgkmcnt(6)
  ds_write_b128 v202, v[84:87] offset:2048
  v_mfma_f32_16x16x32_bf16 v[56:59], a[168:171], a[40:43], v[56:59]
  ds_read_b128 a[160:163], v5 offset:47104
  v_mfma_f32_16x16x32_bf16 v[60:63], a[168:171], a[112:115], v[60:63]
  s_add_u32 s60, s10, 11796480
  s_addc_u32 s61, s11, 0
  s_mov_b32 s62, 8388608
  s_mov_b32 s63, 0x00020000
  s_lshl_b32 s79, s33, 17
  s_and_b32 s69, s28, 8
  s_lshl_b32 s69, s69, 13
  s_add_u32 s69, s69, s79
  ds_write_b128 v202, v[88:91] offset:4096
  v_mfma_f32_16x16x32_bf16 v[64:67], a[172:175], a[40:43], v[64:67]
  ds_read_b128 a[164:167], v5 offset:48128
  v_mfma_f32_16x16x32_bf16 v[68:71], a[172:175], a[112:115], v[68:71]
  ds_write_b128 v202, v[92:95] offset:6144
  v_mfma_f32_16x16x32_bf16 v[72:75], a[176:179], a[40:43], v[72:75]
  ds_read_b128 a[168:171], v5 offset:49152
  v_mfma_f32_16x16x32_bf16 v[76:79], a[176:179], a[112:115], v[76:79]
  s_waitcnt lgkmcnt(9)
  ds_write_b128 v202, v[96:99] offset:8192
  v_mfma_f32_16x16x32_bf16 v[56:59], a[180:183], a[44:47], v[56:59]
  ds_read_b128 a[172:175], v5 offset:50176
  v_mfma_f32_16x16x32_bf16 v[60:63], a[180:183], a[116:119], v[60:63]
  s_lshl_b32 s71, s28, 269
  s_add_u32 s71, s71, s79
  buffer_load_dwordx4 a[216:219], v4, s[60:63], s71 offen offset:0
  ds_write_b128 v202, v[100:103] offset:10240
  v_mfma_f32_16x16x32_bf16 v[64:67], a[144:147], a[44:47], v[64:67]
  ds_read_b128 a[176:179], v5 offset:51200
  v_mfma_f32_16x16x32_bf16 v[68:71], a[144:147], a[116:119], v[68:71]
  ds_write_b128 v202, v[104:107] offset:12288
  v_mfma_f32_16x16x32_bf16 v[72:75], a[148:151], a[44:47], v[72:75]
  ds_read_b128 a[180:183], v5 offset:52224
  v_mfma_f32_16x16x32_bf16 v[76:79], a[148:151], a[116:119], v[76:79]
  s_waitcnt lgkmcnt(10)
  ds_write_b128 v202, v[108:111] offset:14336
  s_waitcnt vmcnt(3)
  s_barrier
  buffer_store_dwordx4 v[252:255], v250, s[24:27], s37 offen sc0 sc1
  v_mfma_f32_16x16x32_bf16 v[56:59], a[152:155], a[48:51], v[56:59]
  ds_read_b128 a[144:147], v5 offset:53248
  v_mfma_f32_16x16x32_bf16 v[60:63], a[152:155], a[120:123], v[60:63]
  buffer_load_dwordx4 a[220:223], v4, s[60:63], s71 offen offset:1024
  ds_write_b128 v202, v[112:115] offset:16384
  v_mfma_f32_16x16x32_bf16 v[64:67], a[156:159], a[48:51], v[64:67]
  ds_read_b128 a[148:151], v5 offset:54272
  v_mfma_f32_16x16x32_bf16 v[68:71], a[156:159], a[120:123], v[68:71]
  v_mfma_f32_16x16x32_bf16 v[72:75], a[160:163], a[48:51], v[72:75]
  ds_read_b128 a[152:155], v5 offset:55296
  v_mfma_f32_16x16x32_bf16 v[76:79], a[160:163], a[120:123], v[76:79]
  s_waitcnt lgkmcnt(9)
  v_mfma_f32_16x16x32_bf16 v[56:59], a[164:167], a[52:55], v[56:59]
  ds_read_b128 a[156:159], v5 offset:56320
  v_mfma_f32_16x16x32_bf16 v[60:63], a[164:167], a[124:127], v[60:63]
  buffer_load_dwordx4 a[224:227], v4, s[60:63], s71 offen offset:2048
  v_mfma_f32_16x16x32_bf16 v[64:67], a[168:171], a[52:55], v[64:67]
  ds_read_b128 a[160:163], v5 offset:57344
  v_mfma_f32_16x16x32_bf16 v[68:71], a[168:171], a[124:127], v[68:71]
  v_mfma_f32_16x16x32_bf16 v[72:75], a[172:175], a[52:55], v[72:75]
  ds_read_b128 a[164:167], v5 offset:58368
  v_mfma_f32_16x16x32_bf16 v[76:79], a[172:175], a[124:127], v[76:79]
  s_waitcnt lgkmcnt(6)
  v_mfma_f32_16x16x32_bf16 v[56:59], a[176:179], a[56:59], v[56:59]
  ds_read_b128 a[168:171], v5 offset:59392
  v_mfma_f32_16x16x32_bf16 v[60:63], a[176:179], a[128:131], v[60:63]
  s_getpc_b64 s[90:91]
  global_load_dword a248, v201, s[90:91]
  v_mfma_f32_16x16x32_bf16 v[64:67], a[180:183], a[56:59], v[64:67]
  ds_read_b128 a[172:175], v5 offset:60416
  v_mfma_f32_16x16x32_bf16 v[68:71], a[180:183], a[128:131], v[68:71]
  v_mfma_f32_16x16x32_bf16 v[72:75], a[144:147], a[56:59], v[72:75]
  ds_read_b128 a[176:179], v5 offset:61440
  v_mfma_f32_16x16x32_bf16 v[76:79], a[144:147], a[128:131], v[76:79]
  s_waitcnt lgkmcnt(5)
  v_mfma_f32_16x16x32_bf16 v[56:59], a[148:151], a[60:63], v[56:59]
  ds_read_b128 a[180:183], v5 offset:62464
  v_mfma_f32_16x16x32_bf16 v[60:63], a[148:151], a[132:135], v[60:63]
  buffer_load_dwordx4 a[228:231], v4, s[60:63], s71 offen offset:3072
  v_mfma_f32_16x16x32_bf16 v[64:67], a[152:155], a[60:63], v[64:67]
  ds_read_b128 a[144:147], v5 offset:63488
  v_mfma_f32_16x16x32_bf16 v[68:71], a[152:155], a[132:135], v[68:71]
  v_mfma_f32_16x16x32_bf16 v[72:75], a[156:159], a[60:63], v[72:75]
  ds_read_b128 a[148:151], v5 offset:64512
  v_mfma_f32_16x16x32_bf16 v[76:79], a[156:159], a[132:135], v[76:79]
  s_waitcnt lgkmcnt(5)
  v_mfma_f32_16x16x32_bf16 v[56:59], a[160:163], a[64:67], v[56:59]
  ds_read_b128 a[152:155], v6 offset:0
  v_mfma_f32_16x16x32_bf16 v[60:63], a[160:163], a[136:139], v[60:63]
  s_add_u32 s71, s71, 4096
  buffer_load_dwordx4 a[232:235], v4, s[60:63], s71 offen offset:0
  v_mfma_f32_16x16x32_bf16 v[64:67], a[164:167], a[64:67], v[64:67]
  ds_read_b128 a[156:159], v6 offset:1024
  v_mfma_f32_16x16x32_bf16 v[68:71], a[164:167], a[136:139], v[68:71]
  v_mfma_f32_16x16x32_bf16 v[72:75], a[168:171], a[64:67], v[72:75]
  ds_read_b128 a[160:163], v6 offset:2048
  v_mfma_f32_16x16x32_bf16 v[76:79], a[168:171], a[136:139], v[76:79]
  s_waitcnt lgkmcnt(5)
  v_mfma_f32_16x16x32_bf16 v[56:59], a[172:175], a[68:71], v[56:59]
  ds_read_b128 a[164:167], v6 offset:3072
  v_mfma_f32_16x16x32_bf16 v[60:63], a[172:175], a[140:143], v[60:63]
  buffer_load_dwordx4 a[236:239], v4, s[60:63], s71 offen offset:1024
  v_mfma_f32_16x16x32_bf16 v[64:67], a[176:179], a[68:71], v[64:67]
  ds_read_b128 a[168:171], v6 offset:4096
  v_mfma_f32_16x16x32_bf16 v[68:71], a[176:179], a[140:143], v[68:71]
  v_mfma_f32_16x16x32_bf16 v[72:75], a[180:183], a[68:71], v[72:75]
  ds_read_b128 a[172:175], v6 offset:5120
  v_mfma_f32_16x16x32_bf16 v[76:79], a[180:183], a[140:143], v[76:79]
  s_waitcnt lgkmcnt(5)
  v_mfma_f32_16x16x32_bf16 v[32:35], a[144:147], a[0:3], 0
  ds_read_b128 a[176:179], v6 offset:6144
  v_mfma_f32_16x16x32_bf16 v[36:39], a[144:147], a[72:75], 0
  buffer_load_dwordx4 a[240:243], v4, s[60:63], s71 offen offset:2048
  v_mfma_f32_16x16x32_bf16 v[40:43], a[148:151], a[0:3], 0
  ds_read_b128 a[180:183], v6 offset:7168
  v_pk_fma_f32 v[56:57], v[216:217], v[184:185], v[56:57] op_sel:[0,0,0] op_sel_hi:[1,0,1]
  v_pk_fma_f32 v[58:59], v[218:219], v[184:185], v[58:59] op_sel:[0,0,0] op_sel_hi:[1,0,1]
  v_pk_fma_f32 v[60:61], v[216:217], v[184:185], v[60:61] op_sel:[0,1,0] op_sel_hi:[1,1,1]
  v_pk_fma_f32 v[62:63], v[218:219], v[184:185], v[62:63] op_sel:[0,1,0] op_sel_hi:[1,1,1]
  v_pk_fma_f32 v[64:65], v[220:221], v[184:185], v[64:65] op_sel:[0,0,0] op_sel_hi:[1,0,1]
  v_pk_fma_f32 v[66:67], v[222:223], v[184:185], v[66:67] op_sel:[0,0,0] op_sel_hi:[1,0,1]
  v_pk_fma_f32 v[68:69], v[220:221], v[184:185], v[68:69] op_sel:[0,1,0] op_sel_hi:[1,1,1]
  v_pk_fma_f32 v[70:71], v[222:223], v[184:185], v[70:71] op_sel:[0,1,0] op_sel_hi:[1,1,1]
  v_pk_fma_f32 v[72:73], v[224:225], v[184:185], v[72:73] op_sel:[0,0,0] op_sel_hi:[1,0,1]
  v_pk_fma_f32 v[74:75], v[226:227], v[184:185], v[74:75] op_sel:[0,0,0] op_sel_hi:[1,0,1]
  v_pk_fma_f32 v[76:77], v[224:225], v[184:185], v[76:77] op_sel:[0,1,0] op_sel_hi:[1,1,1]
  v_pk_fma_f32 v[78:79], v[226:227], v[184:185], v[78:79] op_sel:[0,1,0] op_sel_hi:[1,1,1]
  s_nop 1
  v_mfma_f32_16x16x32_bf16 v[44:47], a[148:151], a[72:75], 0
  v_cvt_pk_f16_f32 v128, v56, v57
  v_cvt_pk_f16_f32 v129, v58, v59
  v_cvt_pk_f16_f32 v130, v60, v61
  v_mfma_f32_16x16x32_bf16 v[48:51], a[152:155], a[0:3], 0
  ds_read_b128 a[144:147], v6 offset:8192
  v_cvt_pk_f16_f32 v131, v62, v63
  v_cvt_pk_f16_f32 v132, v64, v65
  v_mfma_f32_16x16x32_bf16 v[52:55], a[152:155], a[72:75], 0
  s_waitcnt lgkmcnt(5)
  v_cvt_pk_f16_f32 v133, v66, v67
  v_cvt_pk_f16_f32 v134, v68, v69
  v_cvt_pk_f16_f32 v135, v70, v71
  v_mfma_f32_16x16x32_bf16 v[32:35], a[156:159], a[4:7], v[32:35]
  ds_read_b128 a[148:151], v6 offset:9216
  v_cvt_pk_f16_f32 v136, v72, v73
  v_cvt_pk_f16_f32 v137, v74, v75
  v_mfma_f32_16x16x32_bf16 v[36:39], a[156:159], a[76:79], v[36:39]
  buffer_load_dwordx4 a[244:247], v4, s[60:63], s71 offen offset:3072
  v_mfma_f32_16x16x32_bf16 v[40:43], a[160:163], a[4:7], v[40:43]
  ds_read_b128 a[152:155], v6 offset:10240
  v_cvt_pk_f16_f32 v138, v76, v77
  v_cvt_pk_f16_f32 v139, v78, v79
  v_mfma_f32_16x16x32_bf16 v[44:47], a[160:163], a[76:79], v[44:47]
  v_mfma_f32_16x16x32_bf16 v[48:51], a[164:167], a[4:7], v[48:51]
  ds_read_b128 a[156:159], v6 offset:11264
  v_mfma_f32_16x16x32_bf16 v[52:55], a[164:167], a[76:79], v[52:55]
  s_waitcnt lgkmcnt(5)
  v_mfma_f32_16x16x32_bf16 v[32:35], a[168:171], a[8:11], v[32:35]
  ds_read_b128 a[160:163], v6 offset:12288
  v_mfma_f32_16x16x32_bf16 v[36:39], a[168:171], a[80:83], v[36:39]
  s_and_b32 s73, s28, 7
  s_cmp_le_u32 s73, 0
  s_cselect_b32 s73, 1, 0
  s_lshl_b32 s73, s73, 13
  s_add_u32 s73, s73, s69
  buffer_load_dwordx4 a[184:187], v4, s[60:63], s73 offen offset:0
  v_mfma_f32_16x16x32_bf16 v[40:43], a[172:175], a[8:11], v[40:43]
  ds_read_b128 a[164:167], v6 offset:13312
  v_mfma_f32_16x16x32_bf16 v[44:47], a[172:175], a[80:83], v[44:47]
  v_mfma_f32_16x16x32_bf16 v[48:51], a[176:179], a[8:11], v[48:51]
  ds_read_b128 a[168:171], v6 offset:14336
  v_mfma_f32_16x16x32_bf16 v[52:55], a[176:179], a[80:83], v[52:55]
  s_waitcnt lgkmcnt(5)
  v_mfma_f32_16x16x32_bf16 v[32:35], a[180:183], a[12:15], v[32:35]
  ds_read_b128 a[172:175], v6 offset:15360
  v_mfma_f32_16x16x32_bf16 v[36:39], a[180:183], a[84:87], v[36:39]
  buffer_load_dwordx4 a[188:191], v4, s[60:63], s73 offen offset:1024
  v_mfma_f32_16x16x32_bf16 v[40:43], a[144:147], a[12:15], v[40:43]
  s_waitcnt vmcnt(12)
  s_barrier
  ds_read_b128 a[176:179], v4 offset:0
  v_mfma_f32_16x16x32_bf16 v[44:47], a[144:147], a[84:87], v[44:47]
  v_mfma_f32_16x16x32_bf16 v[48:51], a[148:151], a[12:15], v[48:51]
  ds_read_b128 a[180:183], v4 offset:1024
  v_mfma_f32_16x16x32_bf16 v[52:55], a[148:151], a[84:87], v[52:55]
  s_waitcnt lgkmcnt(5)
  v_mfma_f32_16x16x32_bf16 v[32:35], a[152:155], a[16:19], v[32:35]
  ds_read_b128 a[144:147], v4 offset:2048
  v_mfma_f32_16x16x32_bf16 v[36:39], a[152:155], a[88:91], v[36:39]
  buffer_load_dwordx4 a[192:195], v4, s[60:63], s73 offen offset:2048
  v_mfma_f32_16x16x32_bf16 v[40:43], a[156:159], a[16:19], v[40:43]
  ds_read_b128 a[148:151], v4 offset:3072
  v_mfma_f32_16x16x32_bf16 v[44:47], a[156:159], a[88:91], v[44:47]
  v_mfma_f32_16x16x32_bf16 v[48:51], a[160:163], a[16:19], v[48:51]
  ds_read_b128 a[152:155], v4 offset:4096
  v_mfma_f32_16x16x32_bf16 v[52:55], a[160:163], a[88:91], v[52:55]
  s_waitcnt lgkmcnt(5)
  v_mfma_f32_16x16x32_bf16 v[32:35], a[164:167], a[20:23], v[32:35]
  ds_read_b128 a[156:159], v4 offset:5120
  v_mfma_f32_16x16x32_bf16 v[36:39], a[164:167], a[92:95], v[36:39]
  buffer_load_dwordx4 a[196:199], v4, s[60:63], s73 offen offset:3072
  v_mfma_f32_16x16x32_bf16 v[40:43], a[168:171], a[20:23], v[40:43]
  ds_read_b128 a[160:163], v4 offset:6144
  v_mfma_f32_16x16x32_bf16 v[44:47], a[168:171], a[92:95], v[44:47]
  v_mfma_f32_16x16x32_bf16 v[48:51], a[172:175], a[20:23], v[48:51]
  ds_read_b128 a[164:167], v4 offset:7168
  v_mfma_f32_16x16x32_bf16 v[52:55], a[172:175], a[92:95], v[52:55]
  s_waitcnt lgkmcnt(5)
  v_mfma_f32_16x16x32_bf16 v[32:35], a[176:179], a[24:27], v[32:35]
  ds_read_b128 a[168:171], v4 offset:8192
  v_mfma_f32_16x16x32_bf16 v[36:39], a[176:179], a[96:99], v[36:39]
  s_add_u32 s73, s73, 4096
  buffer_load_dwordx4 a[200:203], v4, s[60:63], s73 offen offset:0
  v_mfma_f32_16x16x32_bf16 v[40:43], a[180:183], a[24:27], v[40:43]
  ds_read_b128 a[172:175], v4 offset:9216
  v_mfma_f32_16x16x32_bf16 v[44:47], a[180:183], a[96:99], v[44:47]
  buffer_load_dword v249, v248, s[24:27], s36 offen sc0 sc1
  v_mfma_f32_16x16x32_bf16 v[48:51], a[144:147], a[24:27], v[48:51]
  ds_read_b128 a[176:179], v4 offset:10240
  v_mfma_f32_16x16x32_bf16 v[52:55], a[144:147], a[96:99], v[52:55]
  s_waitcnt lgkmcnt(5)
  v_mfma_f32_16x16x32_bf16 v[32:35], a[148:151], a[28:31], v[32:35]
  ds_read_b128 a[180:183], v4 offset:11264
  v_mfma_f32_16x16x32_bf16 v[36:39], a[148:151], a[100:103], v[36:39]
  buffer_load_dwordx4 a[204:207], v4, s[60:63], s73 offen offset:1024
  v_mfma_f32_16x16x32_bf16 v[40:43], a[152:155], a[28:31], v[40:43]
  ds_read_b128 a[144:147], v4 offset:12288
  v_mfma_f32_16x16x32_bf16 v[44:47], a[152:155], a[100:103], v[44:47]
  v_mfma_f32_16x16x32_bf16 v[48:51], a[156:159], a[28:31], v[48:51]
  ds_read_b128 a[148:151], v4 offset:13312
  v_mfma_f32_16x16x32_bf16 v[52:55], a[156:159], a[100:103], v[52:55]
  s_waitcnt lgkmcnt(5)
  v_mfma_f32_16x16x32_bf16 v[32:35], a[160:163], a[32:35], v[32:35]
  ds_read_b128 a[152:155], v4 offset:14336
  v_mfma_f32_16x16x32_bf16 v[36:39], a[160:163], a[104:107], v[36:39]
  buffer_load_dwordx4 a[208:211], v4, s[60:63], s73 offen offset:2048
  v_mfma_f32_16x16x32_bf16 v[40:43], a[164:167], a[32:35], v[40:43]
  ds_read_b128 a[156:159], v4 offset:15360
  v_mfma_f32_16x16x32_bf16 v[44:47], a[164:167], a[104:107], v[44:47]
  v_mfma_f32_16x16x32_bf16 v[48:51], a[168:171], a[32:35], v[48:51]
  ds_read_b128 a[160:163], v4 offset:16384
  v_mfma_f32_16x16x32_bf16 v[52:55], a[168:171], a[104:107], v[52:55]
  s_waitcnt lgkmcnt(5)
  v_mfma_f32_16x16x32_bf16 v[32:35], a[172:175], a[36:39], v[32:35]
  ds_read_b128 a[164:167], v4 offset:17408
  v_mfma_f32_16x16x32_bf16 v[36:39], a[172:175], a[108:111], v[36:39]
  buffer_load_dwordx4 a[212:215], v4, s[60:63], s73 offen offset:3072
  v_mfma_f32_16x16x32_bf16 v[40:43], a[176:179], a[36:39], v[40:43]
  ds_read_b128 a[168:171], v4 offset:18432
  v_mfma_f32_16x16x32_bf16 v[44:47], a[176:179], a[108:111], v[44:47]
  v_mfma_f32_16x16x32_bf16 v[48:51], a[180:183], a[36:39], v[48:51]
  ds_read_b128 a[172:175], v4 offset:19456
  v_mfma_f32_16x16x32_bf16 v[52:55], a[180:183], a[108:111], v[52:55]
  s_waitcnt lgkmcnt(5)
  v_mfma_f32_16x16x32_bf16 v[32:35], a[144:147], a[40:43], v[32:35]
  ds_read_b128 a[176:179], v4 offset:20480
  v_mfma_f32_16x16x32_bf16 v[36:39], a[144:147], a[112:115], v[36:39]
  s_mov_b32 s56, s80
  s_mov_b32 s57, s81
  s_mov_b32 s58, 4096
  s_mov_b32 s59, 0x00020000
  v_lshlrev_b32 v200, 1, v2
  s_lshl_b32 s35, s33, 6
  buffer_load_ushort v192, v200, s[56:59], s35 offen offset:0
  buffer_load_ushort v196, v200, s[56:59], s35 offen offset:32
  v_mfma_f32_16x16x32_bf16 v[40:43], a[148:151], a[40:43], v[40:43]
  ds_read_b128 a[180:183], v4 offset:21504
  v_mfma_f32_16x16x32_bf16 v[44:47], a[148:151], a[112:115], v[44:47]
  v_mfma_f32_16x16x32_bf16 v[48:51], a[152:155], a[40:43], v[48:51]
  ds_read_b128 a[144:147], v4 offset:22528
  v_mfma_f32_16x16x32_bf16 v[52:55], a[152:155], a[112:115], v[52:55]
  s_waitcnt lgkmcnt(5)
  v_mfma_f32_16x16x32_bf16 v[32:35], a[156:159], a[44:47], v[32:35]
  ds_read_b128 a[148:151], v4 offset:23552
  v_mfma_f32_16x16x32_bf16 v[36:39], a[156:159], a[116:119], v[36:39]
  s_and_b32 s71, s28, 7
  s_cmp_le_u32 s71, 1
  s_cselect_b32 s71, 2, 1
  s_lshl_b32 s71, s71, 269
  s_add_u32 s71, s71, s69
  buffer_load_dwordx4 a[72:75], v4, s[60:63], s71 offen offset:0
  v_mfma_f32_16x16x32_bf16 v[40:43], a[160:163], a[44:47], v[40:43]
  ds_read_b128 a[152:155], v4 offset:24576
  v_mfma_f32_16x16x32_bf16 v[44:47], a[160:163], a[116:119], v[44:47]
  v_mfma_f32_16x16x32_bf16 v[48:51], a[164:167], a[44:47], v[48:51]
  ds_read_b128 a[156:159], v4 offset:25600
  v_mfma_f32_16x16x32_bf16 v[52:55], a[164:167], a[116:119], v[52:55]
  s_waitcnt lgkmcnt(5)
  v_mfma_f32_16x16x32_bf16 v[32:35], a[168:171], a[48:51], v[32:35]
  ds_read_b128 a[160:163], v4 offset:26624
  v_mfma_f32_16x16x32_bf16 v[36:39], a[168:171], a[120:123], v[36:39]
  buffer_load_dwordx4 a[76:79], v4, s[60:63], s71 offen offset:1024
  v_mfma_f32_16x16x32_bf16 v[40:43], a[172:175], a[48:51], v[40:43]
  ds_read_b128 a[164:167], v4 offset:27648
  v_mfma_f32_16x16x32_bf16 v[44:47], a[172:175], a[120:123], v[44:47]
  v_mfma_f32_16x16x32_bf16 v[48:51], a[176:179], a[48:51], v[48:51]
  ds_read_b128 a[168:171], v4 offset:28672
  v_mfma_f32_16x16x32_bf16 v[52:55], a[176:179], a[120:123], v[52:55]
  s_waitcnt lgkmcnt(5)
  v_mfma_f32_16x16x32_bf16 v[32:35], a[180:183], a[52:55], v[32:35]
  ds_read_b128 a[172:175], v4 offset:29696
  v_mfma_f32_16x16x32_bf16 v[36:39], a[180:183], a[124:127], v[36:39]
  buffer_load_dwordx4 a[80:83], v4, s[60:63], s71 offen offset:2048
  s_getpc_b64 s[90:91]
  global_load_dword a248, v201, s[90:91]
  v_mfma_f32_16x16x32_bf16 v[40:43], a[144:147], a[52:55], v[40:43]
  ds_read_b128 a[176:179], v4 offset:30720
  v_mfma_f32_16x16x32_bf16 v[44:47], a[144:147], a[124:127], v[44:47]
  v_mfma_f32_16x16x32_bf16 v[48:51], a[148:151], a[52:55], v[48:51]
  ds_read_b128 a[180:183], v4 offset:31744
  v_mfma_f32_16x16x32_bf16 v[52:55], a[148:151], a[124:127], v[52:55]
  s_waitcnt lgkmcnt(5)
  v_mfma_f32_16x16x32_bf16 v[32:35], a[152:155], a[56:59], v[32:35]
  ds_read_b128 a[144:147], v4 offset:32768
  v_mfma_f32_16x16x32_bf16 v[36:39], a[152:155], a[128:131], v[36:39]
  buffer_load_dwordx4 a[84:87], v4, s[60:63], s71 offen offset:3072
  v_mfma_f32_16x16x32_bf16 v[40:43], a[156:159], a[56:59], v[40:43]
  ds_read_b128 a[148:151], v4 offset:33792
  v_mfma_f32_16x16x32_bf16 v[44:47], a[156:159], a[128:131], v[44:47]
  s_waitcnt vmcnt(10)
  s_cmp_eq_u32 s87, 0
  s_cbranch_scc0 L_f4s_0
L_f4g_0:
  s_add_u32 s82, s82, 1
  s_cmp_eq_u32 s82, s76
  s_addc_u32 s82, s82, 0
  s_xor_b32 s40, s82, s77
  v_mfma_f32_16x16x32_bf16 v[48:51], a[160:163], a[56:59], v[48:51]
  ds_read_b128 a[152:155], v4 offset:34816
  v_mfma_f32_16x16x32_bf16 v[52:55], a[160:163], a[128:131], v[52:55]
  s_waitcnt lgkmcnt(5)
  v_mfma_f32_16x16x32_bf16 v[32:35], a[164:167], a[60:63], v[32:35]
  ds_read_b128 a[156:159], v4 offset:35840
  v_mfma_f32_16x16x32_bf16 v[36:39], a[164:167], a[132:135], v[36:39]
  s_mul_i32 s40, s40, 36864
  s_add_u32 s40, s40, s78
  s_add_u32 m0, s41, 73728
  s_nop 0
  buffer_load_dwordx4 v4, s[16:19], s40 offen offset:0 lds
  v_mfma_f32_16x16x32_bf16 v[40:43], a[168:171], a[60:63], v[40:43]
  v_mfma_f32_16x16x32_bf16 v[44:47], a[168:171], a[132:135], v[44:47]
  v_mfma_f32_16x16x32_bf16 v[48:51], a[172:175], a[60:63], v[48:51]
  s_waitcnt lgkmcnt(3)
  v_mfma_f32_16x16x32_bf16 v[52:55], a[172:175], a[132:135], v[52:55]
  buffer_load_dwordx4 v4, s[16:19], s40 offen offset:1024 lds
  v_mfma_f32_16x16x32_bf16 v[32:35], a[176:179], a[64:67], v[32:35]
  v_mfma_f32_16x16x32_bf16 v[36:39], a[176:179], a[136:139], v[36:39]
  v_mfma_f32_16x16x32_bf16 v[40:43], a[180:183], a[64:67], v[40:43]
  v_mfma_f32_16x16x32_bf16 v[44:47], a[180:183], a[136:139], v[44:47]
  buffer_load_dwordx4 v4, s[16:19], s40 offen offset:2048 lds
  v_mfma_f32_16x16x32_bf16 v[48:51], a[144:147], a[64:67], v[48:51]
  s_waitcnt lgkmcnt(0)
  v_mfma_f32_16x16x32_bf16 v[52:55], a[144:147], a[136:139], v[52:55]
  v_mfma_f32_16x16x32_bf16 v[32:35], a[148:151], a[68:71], v[32:35]
  v_mfma_f32_16x16x32_bf16 v[36:39], a[148:151], a[140:143], v[36:39]
  buffer_load_dwordx4 v4, s[16:19], s40 offen offset:3072 lds
  v_mfma_f32_16x16x32_bf16 v[40:43], a[152:155], a[68:71], v[40:43]
  v_mfma_f32_16x16x32_bf16 v[44:47], a[152:155], a[140:143], v[44:47]
  v_mfma_f32_16x16x32_bf16 v[48:51], a[156:159], a[68:71], v[48:51]
  v_mfma_f32_16x16x32_bf16 v[52:55], a[156:159], a[140:143], v[52:55]
  s_add_u32 m0, s42, 73728
  s_add_u32 s51, s40, s43
  s_nop 0
  buffer_load_dwordx4 v4, s[16:19], s51 offen offset:0 lds
  s_add_u32 s40, s40, 18432
  s_nop 7
  v_pk_fma_f32 v[32:33], v[228:229], v[184:185], v[32:33] op_sel:[0,0,0] op_sel_hi:[1,0,1]
  v_pk_fma_f32 v[34:35], v[230:231], v[184:185], v[34:35] op_sel:[0,0,0] op_sel_hi:[1,0,1]
  v_pk_fma_f32 v[36:37], v[228:229], v[184:185], v[36:37] op_sel:[0,1,0] op_sel_hi:[1,1,1]
  v_pk_fma_f32 v[38:39], v[230:231], v[184:185], v[38:39] op_sel:[0,1,0] op_sel_hi:[1,1,1]
  v_pk_fma_f32 v[40:41], v[232:233], v[184:185], v[40:41] op_sel:[0,0,0] op_sel_hi:[1,0,1]
  v_pk_fma_f32 v[42:43], v[234:235], v[184:185], v[42:43] op_sel:[0,0,0] op_sel_hi:[1,0,1]
  v_pk_fma_f32 v[44:45], v[232:233], v[184:185], v[44:45] op_sel:[0,1,0] op_sel_hi:[1,1,1]
  v_pk_fma_f32 v[46:47], v[234:235], v[184:185], v[46:47] op_sel:[0,1,0] op_sel_hi:[1,1,1]
  v_pk_fma_f32 v[48:49], v[236:237], v[184:185], v[48:49] op_sel:[0,0,0] op_sel_hi:[1,0,1]
  v_pk_fma_f32 v[50:51], v[238:239], v[184:185], v[50:51] op_sel:[0,0,0] op_sel_hi:[1,0,1]
  v_pk_fma_f32 v[52:53], v[236:237], v[184:185], v[52:53] op_sel:[0,1,0] op_sel_hi:[1,1,1]
  v_pk_fma_f32 v[54:55], v[238:239], v[184:185], v[54:55] op_sel:[0,1,0] op_sel_hi:[1,1,1]
  s_add_u32 m0, s41, 92160
  s_nop 0
  s_nop 0
  buffer_load_dwordx4 v4, s[16:19], s40 offen offset:0 lds
  v_cvt_pk_f16_f32 v140, v32, v33
  v_cvt_pk_f16_f32 v141, v34, v35
  v_cvt_pk_f16_f32 v142, v36, v37
  v_cvt_pk_f16_f32 v143, v38, v39
  buffer_load_dwordx4 v4, s[16:19], s40 offen offset:1024 lds
  v_cvt_pk_f16_f32 v144, v40, v41
  v_cvt_pk_f16_f32 v145, v42, v43
  v_cvt_pk_f16_f32 v146, v44, v45
  v_cvt_pk_f16_f32 v147, v46, v47
  buffer_load_dwordx4 v4, s[16:19], s40 offen offset:2048 lds
  v_cvt_pk_f16_f32 v148, v48, v49
  v_cvt_pk_f16_f32 v149, v50, v51
  v_cvt_pk_f16_f32 v150, v52, v53
  v_cvt_pk_f16_f32 v151, v54, v55
  buffer_load_dwordx4 v4, s[16:19], s40 offen offset:3072 lds
  s_add_u32 s71, s71, 4096
  buffer_load_dwordx4 a[88:91], v4, s[60:63], s71 offen offset:0
  buffer_load_dwordx4 a[92:95], v4, s[60:63], s71 offen offset:1024
  buffer_load_dwordx4 a[96:99], v4, s[60:63], s71 offen offset:2048
  buffer_load_dwordx4 a[100:103], v4, s[60:63], s71 offen offset:3072
  s_and_b32 s73, s28, 7
  s_cmp_le_u32 s73, 2
  s_cselect_b32 s73, 3, 2
  s_lshl_b32 s73, s73, 269
  s_add_u32 s73, s73, s69
  buffer_load_dwordx4 a[104:107], v4, s[60:63], s73 offen offset:0
  buffer_load_dwordx4 a[108:111], v4, s[60:63], s73 offen offset:1024
  buffer_load_dwordx4 a[112:115], v4, s[60:63], s73 offen offset:2048
  buffer_load_dwordx4 a[116:119], v4, s[60:63], s73 offen offset:3072
  s_add_u32 s73, s73, 4096
  buffer_load_dwordx4 a[120:123], v4, s[60:63], s73 offen offset:0
  buffer_load_dwordx4 a[124:127], v4, s[60:63], s73 offen offset:1024
  buffer_load_dwordx4 a[128:131], v4, s[60:63], s73 offen offset:2048
  buffer_load_dwordx4 a[132:135], v4, s[60:63], s73 offen offset:3072
  v_mov_b32 v232, v201
  s_waitcnt vmcnt(26)
  v_lshlrev_b32 v192, 16, v192
  v_mov_b32 v193, v192
  v_mov_b32 v194, v192
  v_mov_b32 v195, v192
  v_lshlrev_b32 v196, 16, v196
  v_mov_b32 v197, v196
  v_mov_b32 v198, v196
  v_mov_b32 v199, v196
  s_lshl_b32 s38, s12, 264
  s_add_u32 s38, s38, 162816
  v_lshrrev_b32 v107, 2, v4
  v_add_u32 v107, s38, v107
  v_mov_b32_e64 v106, 1
  ds_write_b32 v107, v106
  s_waitcnt lgkmcnt(0)
  s_barrier
  ds_read_b128 a[0:3], v4 offset:36864
  ds_read_b128 a[4:7], v4 offset:38912
  ds_read_b128 a[8:11], v4 offset:40960
  ds_read_b128 a[12:15], v4 offset:43008
  ds_read_b128 a[16:19], v4 offset:45056
  ds_read_b128 a[20:23], v4 offset:47104
  ds_read_b128 a[24:27], v4 offset:49152
  ds_read_b128 a[28:31], v4 offset:51200
  ds_read_b128 a[32:35], v4 offset:53248
  s_mov_b32 s50, 0
  v_lshrrev_b32 v105, 6, v248
  v_mov_b32_e64 v104, s78
  v_mov_b32 v110, 36864
  v_mad_u32_u24 v104, v105, v110, v104
  v_lshlrev_b32_e64 v105, 13, v105
  v_add_u32 v105, s79, v105
  v_readlane_b32 s40, v104, 2
  s_waitcnt lgkmcnt(0)
  v_mfma_f32_16x16x32_bf16 v[32:35], a[0:3], a[216:219], v[192:195]
  ds_read_b128 a[36:39], v4 offset:37888
  v_add_u32 v110, 18432, v4
  v_mfma_f32_16x16x32_bf16 v[68:71], a[0:3], a[220:223], v[196:199]
  ds_read_b128 a[40:43], v4 offset:39936
L_pg_16:
  s_cbranch_execz L_wr_2
  v_add_u32 v111, s43, v4
  v_mfma_f32_16x16x32_bf16 v[36:39], a[4:7], a[216:219], v[192:195]
  ds_read_b128 a[44:47], v4 offset:41984
  v_and_b32_e64 v108, 3, v2
  v_mfma_f32_16x16x32_bf16 v[72:75], a[4:7], a[220:223], v[196:199]
  ds_read_b128 a[48:51], v4 offset:44032
  v_mul_u32_u24 v108, 260, v108
  v_mfma_f32_16x16x32_bf16 v[40:43], a[8:11], a[216:219], v[192:195]
  ds_read_b128 a[52:55], v4 offset:46080
  v_add_u32 v108, 162816, v108
  v_mfma_f32_16x16x32_bf16 v[76:79], a[8:11], a[220:223], v[196:199]
  ds_read_b128 a[56:59], v4 offset:48128
  v_add_u32_e64 v106, 1, v106
  v_mfma_f32_16x16x32_bf16 v[44:47], a[12:15], a[216:219], v[192:195]
  ds_read_b128 a[60:63], v4 offset:50176
  s_and_b32 s51, s12, 1
  v_mfma_f32_16x16x32_bf16 v[80:83], a[12:15], a[220:223], v[196:199]
  ds_read_b128 a[64:67], v4 offset:52224
  s_mul_i32 s51, s51, 92160
  v_mfma_f32_16x16x32_bf16 v[48:51], a[16:19], a[216:219], v[192:195]
  ds_read_b128 a[68:71], v4 offset:54272
  s_sub_u32 s51, s42, s51
  v_mfma_f32_16x16x32_bf16 v[84:87], a[16:19], a[220:223], v[196:199]
  v_mfma_f32_16x16x32_bf16 v[52:55], a[20:23], a[216:219], v[192:195]
  v_mfma_f32_16x16x32_bf16 v[88:91], a[20:23], a[220:223], v[196:199]
  v_mfma_f32_16x16x32_bf16 v[56:59], a[24:27], a[216:219], v[192:195]
  v_mfma_f32_16x16x32_bf16 v[92:95], a[24:27], a[220:223], v[196:199]
  v_mfma_f32_16x16x32_bf16 v[60:63], a[28:31], a[216:219], v[192:195]
  v_mfma_f32_16x16x32_bf16 v[96:99], a[28:31], a[220:223], v[196:199]
  v_mfma_f32_16x16x32_bf16 v[64:67], a[32:35], a[216:219], v[192:195]
  v_mfma_f32_16x16x32_bf16 v[100:103], a[32:35], a[220:223], v[196:199]
L_k5_loop:
  v_readlane_b32 s71, v105, 4
  s_waitcnt lgkmcnt(0)
  s_cmp_eq_u32 s87, 0
  s_cbranch_scc0 L_f4s_1
L_f4g_1:
  v_mfma_f32_16x16x32_bf16 v[32:35], a[36:39], a[224:227], v[32:35]
  ds_read_b128 a[0:3], v4 offset:55296
  v_lshrrev_b32_e64 v1, 4, v4
  v_mfma_f32_16x16x32_bf16 v[68:71], a[36:39], a[228:231], v[68:71]
  ds_read_b128 a[4:7], v4 offset:57344
  s_nop 0
  v_mfma_f32_16x16x32_bf16 v[36:39], a[40:43], a[224:227], v[36:39]
  s_add_u32 m0, s41, 110592
  ds_read_b128 a[8:11], v4 offset:59392
  v_mfma_f32_16x16x32_bf16 v[72:75], a[40:43], a[228:231], v[72:75]
  buffer_load_dwordx4 v4, s[16:19], s40 offen offset:0 lds
  v_mfma_f32_16x16x32_bf16 v[40:43], a[44:47], a[224:227], v[40:43]
  ds_read_b128 a[12:15], v4 offset:61440
  v_fma_mix_f32 v8, v118, v118, 0 op_sel:[0,0,0] op_sel_hi:[1,1,0]
  v_mfma_f32_16x16x32_bf16 v[76:79], a[44:47], a[228:231], v[76:79]
  ds_read_b128 a[16:19], v4 offset:63488
  v_fma_mix_f32 v9, v118, v118, 0 op_sel:[1,1,0] op_sel_hi:[1,1,0]
  v_mfma_f32_16x16x32_bf16 v[44:47], a[48:51], a[224:227], v[44:47]
  ds_read_b128 a[20:23], v5 offset:0
  v_fma_mix_f32 v10, v119, v119, 0 op_sel:[0,0,0] op_sel_hi:[1,1,0]
  v_mfma_f32_16x16x32_bf16 v[80:83], a[48:51], a[228:231], v[80:83]
  buffer_load_dwordx4 a[136:139], v4, s[60:63], s71 offen offset:0
  v_mfma_f32_16x16x32_bf16 v[48:51], a[52:55], a[224:227], v[48:51]
  ds_read_b128 a[24:27], v5 offset:2048
  v_fma_mix_f32 v11, v119, v119, 0 op_sel:[1,1,0] op_sel_hi:[1,1,0]
  v_mfma_f32_16x16x32_bf16 v[84:87], a[52:55], a[228:231], v[84:87]
  ds_read_b128 a[28:31], v5 offset:4096
  v_fma_mix_f32 v12, v122, v122, 0 op_sel:[0,0,0] op_sel_hi:[1,1,0]
  v_mfma_f32_16x16x32_bf16 v[52:55], a[56:59], a[224:227], v[52:55]
  ds_read_b128 a[32:35], v5 offset:6144
  v_fma_mix_f32 v13, v122, v122, 0 op_sel:[1,1,0] op_sel_hi:[1,1,0]
  v_mfma_f32_16x16x32_bf16 v[88:91], a[56:59], a[228:231], v[88:91]
  buffer_load_dwordx4 v4, s[16:19], s40 offen offset:1024 lds
  v_mfma_f32_16x16x32_bf16 v[56:59], a[60:63], a[224:227], v[56:59]
  s_add_u32 s52, s10, 30670848
  s_addc_u32 s53, s11, 0
  s_mov_b32 s54, 9437184
  v_mfma_f32_16x16x32_bf16 v[92:95], a[60:63], a[228:231], v[92:95]
  s_mov_b32 s55, 0x00020000
  s_add_u32 s20, s10, 46399488
  s_addc_u32 s21, s11, 0
  v_mfma_f32_16x16x32_bf16 v[60:63], a[64:67], a[224:227], v[60:63]
  s_mov_b32 s22, 2654208
  s_mov_b32 s23, 0x00020000
  s_and_b32 s74, s29, 3
  v_mfma_f32_16x16x32_bf16 v[96:99], a[64:67], a[228:231], v[96:99]
  buffer_load_dwordx4 a[140:143], v4, s[60:63], s71 offen offset:1024
  v_mfma_f32_16x16x32_bf16 v[64:67], a[68:71], a[224:227], v[64:67]
  s_lshr_b32 s75, s29, 258
  s_mul_i32 s69, s12, 2304
  s_mul_i32 s34, s29, 165888
  v_mfma_f32_16x16x32_bf16 v[100:103], a[68:71], a[228:231], v[100:103]
  s_waitcnt vmcnt(41) lgkmcnt(5)
  s_add_u32 s35, s74, 0
  s_and_b32 s35, s35, 3
  v_mfma_f32_16x16x32_bf16 v[32:35], a[0:3], a[232:235], v[32:35]
  ds_read_b128 a[36:39], v4 offset:56320
  s_mul_i32 s35, s35, 36864
  v_mfma_f32_16x16x32_bf16 v[68:71], a[0:3], a[236:239], v[68:71]
  buffer_load_dwordx4 v4, s[16:19], s40 offen offset:2048 lds
  v_mfma_f32_16x16x32_bf16 v[36:39], a[4:7], a[232:235], v[36:39]
  s_waitcnt vmcnt(21)
  ds_write_b32 v107, v106
  v_mfma_f32_16x16x32_bf16 v[72:75], a[4:7], a[236:239], v[72:75]
  ds_read_b128 a[40:43], v4 offset:58368
  s_add_u32 s35, s35, s34
  v_mfma_f32_16x16x32_bf16 v[40:43], a[8:11], a[232:235], v[40:43]
  ds_read_b128 a[44:47], v4 offset:60416
  s_add_u32 s64, s35, s72
  v_mfma_f32_16x16x32_bf16 v[76:79], a[8:11], a[236:239], v[76:79]
  buffer_load_dwordx4 a[144:147], v4, s[60:63], s71 offen offset:2048
  v_mfma_f32_16x16x32_bf16 v[44:47], a[12:15], a[232:235], v[44:47]
  s_waitcnt lgkmcnt(4)
  ds_read_b128 a[48:51], v4 offset:62464
  v_mfma_f32_16x16x32_bf16 v[80:83], a[12:15], a[236:239], v[80:83]
  ds_read_b128 a[52:55], v4 offset:64512
  s_add_u32 s35, s74, 1
  v_mfma_f32_16x16x32_bf16 v[48:51], a[16:19], a[232:235], v[48:51]
  ds_read_b128 a[56:59], v5 offset:1024
  s_and_b32 s35, s35, 3
  v_mfma_f32_16x16x32_bf16 v[84:87], a[16:19], a[236:239], v[84:87]
  buffer_load_dwordx4 v4, s[16:19], s40 offen offset:3072 lds
  v_mfma_f32_16x16x32_bf16 v[52:55], a[20:23], a[232:235], v[52:55]
  ds_read_b32 v109, v108
  v_add_u32_e64 v106, 1, v106
  v_mfma_f32_16x16x32_bf16 v[88:91], a[20:23], a[236:239], v[88:91]
  s_add_u32 m0, s42, 110592
  ds_read_b128 a[60:63], v5 offset:3072
  v_mfma_f32_16x16x32_bf16 v[56:59], a[24:27], a[232:235], v[56:59]
  ds_read_b128 a[64:67], v5 offset:5120
  s_mul_i32 s35, s35, 36864
  v_mfma_f32_16x16x32_bf16 v[92:95], a[24:27], a[236:239], v[92:95]
  ds_read_b128 a[68:71], v5 offset:7168
  s_add_u32 s35, s35, s34
  v_mfma_f32_16x16x32_bf16 v[60:63], a[28:31], a[232:235], v[60:63]
  buffer_load_dwordx4 v111, s[16:19], s40 offen offset:0 lds
  v_mfma_f32_16x16x32_bf16 v[96:99], a[28:31], a[236:239], v[96:99]
  s_waitcnt lgkmcnt(3)
  v_cmp_gt_u32_e64 vcc, 2, v109
  s_add_u32 s65, s35, s72
  v_mfma_f32_16x16x32_bf16 v[64:67], a[32:35], a[232:235], v[64:67]
  s_add_u32 s35, s74, 2
  s_and_b32 s35, s35, 3
  s_mul_i32 s35, s35, 36864
  v_mfma_f32_16x16x32_bf16 v[100:103], a[32:35], a[236:239], v[100:103]
  s_add_u32 s35, s35, s34
  s_add_u32 s66, s35, s72
  s_add_u32 s35, s74, 3
  v_mfma_f32_16x16x32_bf16 v[32:35], a[36:39], a[240:243], v[32:35]
  s_cbranch_vccnz L_k5s_0
L_k5g_0:
  v_mfma_f32_16x16x32_bf16 v[68:71], a[36:39], a[244:247], v[68:71]
  ds_read_b128 a[0:3], v5 offset:8192
  s_and_b32 s35, s35, 3
  v_mfma_f32_16x16x32_bf16 v[36:39], a[40:43], a[240:243], v[36:39]
  s_add_u32 m0, s41, 129024
  ds_read_b128 a[4:7], v5 offset:10240
  v_mfma_f32_16x16x32_bf16 v[72:75], a[40:43], a[244:247], v[72:75]
  buffer_load_dwordx4 v110, s[16:19], s40 offen offset:0 lds
  v_mfma_f32_16x16x32_bf16 v[40:43], a[44:47], a[240:243], v[40:43]
  ds_read_b128 a[8:11], v5 offset:12288
  s_mul_i32 s35, s35, 36864
  v_mfma_f32_16x16x32_bf16 v[76:79], a[44:47], a[244:247], v[76:79]
  ds_read_b128 a[12:15], v5 offset:14336
  s_add_u32 s35, s35, s34
  v_mfma_f32_16x16x32_bf16 v[44:47], a[48:51], a[240:243], v[44:47]
  s_waitcnt lgkmcnt(4)
  ds_read_b128 a[16:19], v5 offset:16384
  v_mfma_f32_16x16x32_bf16 v[80:83], a[48:51], a[244:247], v[80:83]
  buffer_load_dwordx4 a[148:151], v4, s[60:63], s71 offen offset:3072
  v_mfma_f32_16x16x32_bf16 v[48:51], a[52:55], a[240:243], v[48:51]
  ds_read_b128 a[20:23], v5 offset:18432
  s_add_u32 s67, s35, s72
  v_mfma_f32_16x16x32_bf16 v[84:87], a[52:55], a[244:247], v[84:87]
  ds_read_b128 a[24:27], v5 offset:20480
  s_add_u32 s68, s34, 147456
  v_mfma_f32_16x16x32_bf16 v[52:55], a[56:59], a[240:243], v[52:55]
  ds_read_b128 a[28:31], v5 offset:22528
  s_add_u32 s68, s68, s69
  v_mfma_f32_16x16x32_bf16 v[88:91], a[56:59], a[244:247], v[88:91]
  buffer_load_dwordx4 v110, s[16:19], s40 offen offset:1024 lds
  v_mfma_f32_16x16x32_bf16 v[56:59], a[60:63], a[240:243], v[56:59]
  ds_read_b128 a[32:35], v5 offset:24576
  s_lshl_b32 s46, s33, 258
  v_mfma_f32_16x16x32_bf16 v[92:95], a[60:63], a[244:247], v[92:95]
  s_add_u32 s46, s46, s75
  s_lshl_b32 s46, s46, 8
  s_add_u32 s46, s46, 65536
  v_mfma_f32_16x16x32_bf16 v[60:63], a[64:67], a[240:243], v[60:63]
  s_lshl_b32 s35, s74, 262
  s_add_u32 s47, s46, s35
  s_add_u32 s35, s75, 0
  v_mfma_f32_16x16x32_bf16 v[96:99], a[64:67], a[244:247], v[96:99]
  buffer_load_dwordx4 a[152:155], v7, s[60:63], s71 offen offset:0
  v_mfma_f32_16x16x32_bf16 v[64:67], a[68:71], a[240:243], v[64:67]
  s_and_b32 s35, s35, 3
  s_lshl_b32 s35, s35, 11
  v_add_u32_e64 v236, s35, v4
  v_mfma_f32_16x16x32_bf16 v[100:103], a[68:71], a[244:247], v[100:103]
  s_waitcnt vmcnt(45) lgkmcnt(5)
  v_add_u32 v237, s35, v5
  v_add_u32 v238, s35, v6
  v_mfma_f32_16x16x32_bf16 v[32:35], a[0:3], a[184:187], v[32:35]
  s_getpc_b64 s[94:95]
  ds_read_b128 a[36:39], v5 offset:9216
  v_mfma_f32_16x16x32_bf16 v[68:71], a[0:3], a[188:191], v[68:71]
  global_load_dword a248, v232, s[94:95]
  v_mfma_f32_16x16x32_bf16 v[36:39], a[4:7], a[184:187], v[36:39]
  s_waitcnt vmcnt(25)
  ds_write_b32 v107, v106
  v_mfma_f32_16x16x32_bf16 v[72:75], a[4:7], a[188:191], v[72:75]
  buffer_load_dwordx4 v110, s[16:19], s40 offen offset:2048 lds
  v_mfma_f32_16x16x32_bf16 v[40:43], a[8:11], a[184:187], v[40:43]
  s_lshl4_add_u32 s50, s87, 3
  ds_read_b128 a[40:43], v5 offset:11264
  v_mfma_f32_16x16x32_bf16 v[76:79], a[8:11], a[188:191], v[76:79]
  ds_read_b128 a[44:47], v5 offset:13312
  s_add_u32 s35, s75, 1
  v_mfma_f32_16x16x32_bf16 v[44:47], a[12:15], a[184:187], v[44:47]
  s_waitcnt lgkmcnt(4)
  ds_read_b128 a[48:51], v5 offset:15360
  v_mfma_f32_16x16x32_bf16 v[80:83], a[12:15], a[188:191], v[80:83]
  buffer_load_dwordx4 a[156:159], v7, s[60:63], s71 offen offset:1024
  v_mfma_f32_16x16x32_bf16 v[48:51], a[16:19], a[184:187], v[48:51]
  ds_read_b128 a[52:55], v5 offset:17408
  v_readlane_b32 s73, v105, 5
  v_mfma_f32_16x16x32_bf16 v[84:87], a[16:19], a[188:191], v[84:87]
  ds_read_b128 a[56:59], v5 offset:19456
  s_and_b32 s35, s35, 3
  v_mfma_f32_16x16x32_bf16 v[52:55], a[20:23], a[184:187], v[52:55]
  ds_read_b32 v109, v108
  v_add_u32 v106, 1, v106
  v_mfma_f32_16x16x32_bf16 v[88:91], a[20:23], a[188:191], v[88:91]
  ds_read_b128 a[60:63], v5 offset:21504
  s_lshl_b32 s35, s35, 267
  v_mfma_f32_16x16x32_bf16 v[56:59], a[24:27], a[184:187], v[56:59]
  buffer_load_dwordx4 v110, s[16:19], s40 offen offset:3072 lds
  v_mfma_f32_16x16x32_bf16 v[92:95], a[24:27], a[188:191], v[92:95]
  ds_read_b128 a[64:67], v5 offset:23552
  v_add_u32_e64 v239, s35, v4
  v_mfma_f32_16x16x32_bf16 v[60:63], a[28:31], a[184:187], v[60:63]
  ds_read_b128 a[68:71], v5 offset:25600
  v_add_u32_e64 v240, s35, v5
  v_mfma_f32_16x16x32_bf16 v[96:99], a[28:31], a[188:191], v[96:99]
  s_waitcnt lgkmcnt(3)
  v_cmp_gt_u32 vcc, s50, v109
  v_add_u32_e64 v241, s35, v6
  v_mfma_f32_16x16x32_bf16 v[64:67], a[32:35], a[184:187], v[64:67]
  s_add_u32 s35, s75, 2
  s_and_b32 s35, s35, 3
  s_lshl_b32 s35, s35, 267
  v_mfma_f32_16x16x32_bf16 v[100:103], a[32:35], a[188:191], v[100:103]
  v_readlane_b32 s40, v104, 3
  v_add_u32 v242, s35, v4
  v_mfma_f32_16x16x32_bf16 v[32:35], a[36:39], a[192:195], v[32:35]
  s_cbranch_vccnz L_k5s_1
L_k5g_1:
  v_mfma_f32_16x16x32_bf16 v[68:71], a[36:39], a[196:199], v[68:71]
  ds_read_b128 a[0:3], v5 offset:26624
  v_add_u32 v243, s35, v5
  v_mfma_f32_16x16x32_bf16 v[36:39], a[40:43], a[192:195], v[36:39]
  s_add_u32 m0, s41, 0
  ds_read_b128 a[4:7], v5 offset:28672
  v_mfma_f32_16x16x32_bf16 v[72:75], a[40:43], a[196:199], v[72:75]
  buffer_load_dwordx4 v4, s[16:19], s40 offen offset:0 lds
  v_mfma_f32_16x16x32_bf16 v[40:43], a[44:47], a[192:195], v[40:43]
  ds_read_b128 a[8:11], v5 offset:30720
  v_add_u32_e64 v244, s35, v6
  v_mfma_f32_16x16x32_bf16 v[76:79], a[44:47], a[196:199], v[76:79]
  ds_read_b128 a[12:15], v5 offset:32768
  s_add_u32 s35, s75, 3
  v_mfma_f32_16x16x32_bf16 v[44:47], a[48:51], a[192:195], v[44:47]
  s_waitcnt lgkmcnt(4)
  ds_read_b128 a[16:19], v5 offset:34816
  v_mfma_f32_16x16x32_bf16 v[80:83], a[48:51], a[196:199], v[80:83]
  buffer_load_dwordx4 a[160:163], v7, s[60:63], s71 offen offset:2048
  v_mfma_f32_16x16x32_bf16 v[48:51], a[52:55], a[192:195], v[48:51]
  ds_read_b128 a[20:23], v5 offset:36864
  s_and_b32 s35, s35, 3
  v_mfma_f32_16x16x32_bf16 v[84:87], a[52:55], a[196:199], v[84:87]
  ds_read_b128 a[24:27], v5 offset:38912
  s_lshl_b32 s35, s35, 11
  v_mfma_f32_16x16x32_bf16 v[52:55], a[56:59], a[192:195], v[52:55]
  ds_read_b128 a[28:31], v5 offset:40960
  v_add_u32_e64 v245, s35, v4
  v_mfma_f32_16x16x32_bf16 v[88:91], a[56:59], a[196:199], v[88:91]
  buffer_load_dwordx4 v4, s[16:19], s40 offen offset:1024 lds
  v_mfma_f32_16x16x32_bf16 v[56:59], a[60:63], a[192:195], v[56:59]
  ds_read_b128 a[32:35], v5 offset:43008
  v_add_u32_e64 v246, s35, v5
  v_mfma_f32_16x16x32_bf16 v[92:95], a[60:63], a[196:199], v[92:95]
  v_add_u32 v247, s35, v6
  v_lshrrev_b32 v250, 2, v1
  v_mfma_f32_16x16x32_bf16 v[60:63], a[64:67], a[192:195], v[60:63]
  v_lshlrev_b32_e64 v250, 24, v250
  v_add_u32 v250, v250, v4
  v_mfma_f32_16x16x32_bf16 v[96:99], a[64:67], a[196:199], v[96:99]
  buffer_load_dwordx4 a[164:167], v7, s[60:63], s71 offen offset:3072
  v_mfma_f32_16x16x32_bf16 v[64:67], a[68:71], a[192:195], v[64:67]
  v_fma_mix_f32 v14, v123, v123, 0 op_sel:[0,0,0] op_sel_hi:[1,1,0]
  v_fma_mix_f32 v15, v123, v123, 0 op_sel:[1,1,0] op_sel_hi:[1,1,0]
  v_mfma_f32_16x16x32_bf16 v[100:103], a[68:71], a[196:199], v[100:103]
  s_waitcnt vmcnt(48) lgkmcnt(5)
  v_fma_f32 v8, v8, v189, v187
  v_fma_f32 v9, v9, v189, v187
  v_mfma_f32_16x16x32_bf16 v[32:35], a[0:3], a[200:203], v[32:35]
  ds_read_b128 a[36:39], v5 offset:27648
  v_fma_f32 v10, v10, v189, v187
  v_mfma_f32_16x16x32_bf16 v[68:71], a[0:3], a[204:207], v[68:71]
  buffer_load_dwordx4 v4, s[16:19], s40 offen offset:2048 lds
  v_mfma_f32_16x16x32_bf16 v[36:39], a[4:7], a[200:203], v[36:39]
  s_waitcnt vmcnt(13)
  ds_write_b32 v107, v106
  v_mfma_f32_16x16x32_bf16 v[72:75], a[4:7], a[204:207], v[72:75]
  ds_read_b128 a[40:43], v5 offset:29696
  v_fma_f32 v11, v11, v189, v187
  v_mfma_f32_16x16x32_bf16 v[40:43], a[8:11], a[200:203], v[40:43]
  ds_read_b128 a[44:47], v5 offset:31744
  v_fma_f32 v12, v12, v189, v187
  v_mfma_f32_16x16x32_bf16 v[76:79], a[8:11], a[204:207], v[76:79]
  buffer_load_dwordx4 a[168:171], v4, s[60:63], s73 offen offset:0
  v_mfma_f32_16x16x32_bf16 v[44:47], a[12:15], a[200:203], v[44:47]
  s_waitcnt lgkmcnt(4)
  ds_read_b128 a[48:51], v5 offset:33792
  v_mfma_f32_16x16x32_bf16 v[80:83], a[12:15], a[204:207], v[80:83]
  ds_read_b128 a[52:55], v5 offset:35840
  v_fma_f32 v13, v13, v189, v187
  v_mfma_f32_16x16x32_bf16 v[48:51], a[16:19], a[200:203], v[48:51]
  ds_read_b128 a[56:59], v5 offset:37888
  v_fma_f32 v14, v14, v189, v187
  v_mfma_f32_16x16x32_bf16 v[84:87], a[16:19], a[204:207], v[84:87]
  buffer_load_dwordx4 v4, s[16:19], s40 offen offset:3072 lds
  v_mfma_f32_16x16x32_bf16 v[52:55], a[20:23], a[200:203], v[52:55]
  ds_read_b32 v109, v108
  v_add_u32 v106, 1, v106
  v_mfma_f32_16x16x32_bf16 v[88:91], a[20:23], a[204:207], v[88:91]
  s_add_u32 m0, s42, 0
  ds_read_b128 a[60:63], v5 offset:39936
  v_mfma_f32_16x16x32_bf16 v[56:59], a[24:27], a[200:203], v[56:59]
  ds_read_b128 a[64:67], v5 offset:41984
  v_fma_f32 v15, v15, v189, v187
  v_mfma_f32_16x16x32_bf16 v[92:95], a[24:27], a[204:207], v[92:95]
  buffer_load_dwordx4 a[172:175], v4, s[60:63], s73 offen offset:1024
  v_mfma_f32_16x16x32_bf16 v[60:63], a[28:31], a[200:203], v[60:63]
  ds_read_b128 a[68:71], v5 offset:44032
  v_fma_mix_f32 v8, v118, v8, 0 op_sel:[0,0,0] op_sel_hi:[1,0,0]
  v_mfma_f32_16x16x32_bf16 v[96:99], a[28:31], a[204:207], v[96:99]
  s_waitcnt lgkmcnt(3)
  v_cmp_gt_u32 vcc, 4, v109
  v_fma_mix_f32 v9, v118, v9, 0 op_sel:[1,0,0] op_sel_hi:[1,0,0]
  v_mfma_f32_16x16x32_bf16 v[64:67], a[32:35], a[200:203], v[64:67]
  buffer_load_dwordx4 v111, s[16:19], s40 offen offset:0 lds
  v_mfma_f32_16x16x32_bf16 v[100:103], a[32:35], a[204:207], v[100:103]
  v_fma_mix_f32 v10, v119, v10, 0 op_sel:[0,0,0] op_sel_hi:[1,0,0]
  v_fma_mix_f32 v11, v119, v11, 0 op_sel:[1,0,0] op_sel_hi:[1,0,0]
  v_mfma_f32_16x16x32_bf16 v[32:35], a[36:39], a[208:211], v[32:35]
  s_cbranch_vccnz L_k5s_2
L_k5g_2:
  v_mfma_f32_16x16x32_bf16 v[68:71], a[36:39], a[212:215], v[68:71]
  ds_read_b128 a[0:3], v5 offset:45056
  v_fma_mix_f32 v12, v122, v12, 0 op_sel:[0,0,0] op_sel_hi:[1,0,0]
  v_mfma_f32_16x16x32_bf16 v[36:39], a[40:43], a[208:211], v[36:39]
  s_add_u32 m0, s41, 18432
  ds_read_b128 a[4:7], v5 offset:47104
  v_mfma_f32_16x16x32_bf16 v[72:75], a[40:43], a[212:215], v[72:75]
  buffer_load_dwordx4 v110, s[16:19], s40 offen offset:0 lds
  v_mfma_f32_16x16x32_bf16 v[40:43], a[44:47], a[208:211], v[40:43]
  ds_read_b128 a[8:11], v5 offset:49152
  v_fma_mix_f32 v13, v122, v13, 0 op_sel:[1,0,0] op_sel_hi:[1,0,0]
  v_mfma_f32_16x16x32_bf16 v[76:79], a[44:47], a[212:215], v[76:79]
  ds_read_b128 a[12:15], v5 offset:51200
  v_fma_mix_f32 v14, v123, v14, 0 op_sel:[0,0,0] op_sel_hi:[1,0,0]
  v_mfma_f32_16x16x32_bf16 v[44:47], a[48:51], a[208:211], v[44:47]
  s_waitcnt lgkmcnt(4)
  ds_read_b128 a[16:19], v5 offset:53248
  v_mfma_f32_16x16x32_bf16 v[80:83], a[48:51], a[212:215], v[80:83]
  buffer_load_dwordx4 a[176:179], v4, s[60:63], s73 offen offset:2048
  v_mfma_f32_16x16x32_bf16 v[48:51], a[52:55], a[208:211], v[48:51]
  ds_read_b128 a[20:23], v5 offset:55296
  v_fma_mix_f32 v15, v123, v15, 0 op_sel:[1,0,0] op_sel_hi:[1,0,0]
  v_mfma_f32_16x16x32_bf16 v[84:87], a[52:55], a[212:215], v[84:87]
  ds_read_b128 a[24:27], v5 offset:57344
  v_fma_mix_f32 v24, v134, v134, 0 op_sel:[0,0,0] op_sel_hi:[1,1,0]
  v_mfma_f32_16x16x32_bf16 v[52:55], a[56:59], a[208:211], v[52:55]
  ds_read_b128 a[28:31], v5 offset:59392
  v_fma_mix_f32 v16, v126, v126, 0 op_sel:[0,0,0] op_sel_hi:[1,1,0]
  v_mfma_f32_16x16x32_bf16 v[88:91], a[56:59], a[212:215], v[88:91]
  buffer_load_dwordx4 v110, s[16:19], s40 offen offset:1024 lds
  v_mfma_f32_16x16x32_bf16 v[56:59], a[60:63], a[208:211], v[56:59]
  ds_read_b128 a[32:35], v5 offset:61440
  v_fma_mix_f32 v25, v134, v134, 0 op_sel:[1,1,0] op_sel_hi:[1,1,0]
  v_mfma_f32_16x16x32_bf16 v[92:95], a[60:63], a[212:215], v[92:95]
  v_exp_f32_e64 v8, v8
  v_mfma_f32_16x16x32_bf16 v[60:63], a[64:67], a[208:211], v[60:63]
  v_exp_f32_e64 v9, v9
  v_mfma_f32_16x16x32_bf16 v[96:99], a[64:67], a[212:215], v[96:99]
  buffer_load_dwordx4 a[180:183], v4, s[60:63], s73 offen offset:3072
  v_mfma_f32_16x16x32_bf16 v[64:67], a[68:71], a[208:211], v[64:67]
  v_exp_f32 v10, v10
  v_mfma_f32_16x16x32_bf16 v[100:103], a[68:71], a[212:215], v[100:103]
  s_waitcnt vmcnt(50) lgkmcnt(5)
  v_exp_f32 v11, v11
  v_mfma_f32_16x16x32_bf16 v[32:35], a[0:3], a[72:75], v[32:35]
  ds_read_b128 a[36:39], v5 offset:46080
  v_fma_mix_f32 v26, v135, v135, 0 op_sel:[0,0,0] op_sel_hi:[1,1,0]
  v_mfma_f32_16x16x32_bf16 v[68:71], a[0:3], a[76:79], v[68:71]
  ds_read_b128 a[40:43], v5 offset:48128
  v_fma_mix_f32 v27, v135, v135, 0 op_sel:[1,1,0] op_sel_hi:[1,1,0]
  v_mfma_f32_16x16x32_bf16 v[36:39], a[4:7], a[72:75], v[36:39]
  s_waitcnt vmcnt(13)
  ds_write_b32 v107, v106
  v_mfma_f32_16x16x32_bf16 v[72:75], a[4:7], a[76:79], v[72:75]
  buffer_load_dwordx4 v110, s[16:19], s40 offen offset:2048 lds
  v_mfma_f32_16x16x32_bf16 v[40:43], a[8:11], a[72:75], v[40:43]
  s_lshl4_add_u32 s50, s87, 5
  ds_read_b128 a[44:47], v5 offset:50176
  v_mfma_f32_16x16x32_bf16 v[76:79], a[8:11], a[76:79], v[76:79]
  ds_read_b128 a[48:51], v5 offset:52224
  v_fma_mix_f32 v28, v138, v138, 0 op_sel:[0,0,0] op_sel_hi:[1,1,0]
  v_mfma_f32_16x16x32_bf16 v[44:47], a[12:15], a[72:75], v[44:47]
  s_waitcnt lgkmcnt(5)
  ds_read_b128 a[52:55], v5 offset:54272
  v_mfma_f32_16x16x32_bf16 v[80:83], a[12:15], a[76:79], v[80:83]
  buffer_load_dwordx4 a[216:219], v7, s[60:63], s73 offen offset:0
  v_mfma_f32_16x16x32_bf16 v[48:51], a[16:19], a[72:75], v[48:51]
  ds_read_b128 a[56:59], v5 offset:56320
  v_readlane_b32 s71, v105, 6
  v_mfma_f32_16x16x32_bf16 v[84:87], a[16:19], a[76:79], v[84:87]
  ds_read_b128 a[60:63], v5 offset:58368
  v_fma_mix_f32 v29, v138, v138, 0 op_sel:[1,1,0] op_sel_hi:[1,1,0]
  v_mfma_f32_16x16x32_bf16 v[52:55], a[20:23], a[72:75], v[52:55]
  ds_read_b32 v109, v108
  v_add_u32_e64 v106, 1, v106
  v_mfma_f32_16x16x32_bf16 v[88:91], a[20:23], a[76:79], v[88:91]
  ds_read_b128 a[64:67], v5 offset:60416
  v_fma_mix_f32 v30, v139, v139, 0 op_sel:[0,0,0] op_sel_hi:[1,1,0]
  v_mfma_f32_16x16x32_bf16 v[56:59], a[24:27], a[72:75], v[56:59]
  buffer_load_dwordx4 v110, s[16:19], s40 offen offset:3072 lds
  v_mfma_f32_16x16x32_bf16 v[92:95], a[24:27], a[76:79], v[92:95]
  ds_read_b128 a[68:71], v5 offset:62464
  v_fma_mix_f32 v31, v139, v139, 0 op_sel:[1,1,0] op_sel_hi:[1,1,0]
  v_mfma_f32_16x16x32_bf16 v[60:63], a[28:31], a[72:75], v[60:63]
  v_exp_f32_e64 v12, v12
  v_mfma_f32_16x16x32_bf16 v[96:99], a[28:31], a[76:79], v[96:99]
  s_waitcnt lgkmcnt(2)
  v_cmp_gt_u32 vcc, s50, v109
  v_fma_f32 v24, v24, v189, v187
  v_mfma_f32_16x16x32_bf16 v[64:67], a[32:35], a[72:75], v[64:67]
  v_exp_f32_e64 v13, v13
  v_mfma_f32_16x16x32_bf16 v[100:103], a[32:35], a[76:79], v[100:103]
  v_readlane_b32 s40, v104, 4
  v_fma_f32 v25, v25, v189, v187
  v_mfma_f32_16x16x32_bf16 v[32:35], a[36:39], a[80:83], v[32:35]
  s_cbranch_vccnz L_k5s_3
L_k5g_3:
  v_mfma_f32_16x16x32_bf16 v[68:71], a[36:39], a[84:87], v[68:71]
  ds_read_b128 a[0:3], v5 offset:63488
  v_fma_f32 v26, v26, v189, v187
  v_mfma_f32_16x16x32_bf16 v[36:39], a[40:43], a[80:83], v[36:39]
  s_add_u32 m0, s41, 36864
  ds_read_b128 a[4:7], v6 offset:0
  v_mfma_f32_16x16x32_bf16 v[72:75], a[40:43], a[84:87], v[72:75]
  buffer_load_dwordx4 v4, s[16:19], s40 offen offset:0 lds
  v_mfma_f32_16x16x32_bf16 v[40:43], a[44:47], a[80:83], v[40:43]
  ds_read_b128 a[8:11], v6 offset:2048
  v_fma_f32 v27, v27, v189, v187
  v_mfma_f32_16x16x32_bf16 v[76:79], a[44:47], a[84:87], v[76:79]
  ds_read_b128 a[12:15], v6 offset:4096
  v_fma_f32 v28, v28, v189, v187
  v_mfma_f32_16x16x32_bf16 v[44:47], a[48:51], a[80:83], v[44:47]
  s_waitcnt lgkmcnt(4)
  ds_read_b128 a[16:19], v6 offset:6144
  v_mfma_f32_16x16x32_bf16 v[80:83], a[48:51], a[84:87], v[80:83]
  buffer_load_dwordx4 a[220:223], v7, s[60:63], s73 offen offset:1024
  v_mfma_f32_16x16x32_bf16 v[48:51], a[52:55], a[80:83], v[48:51]
  ds_read_b128 a[20:23], v6 offset:8192
  v_fma_f32 v29, v29, v189, v187
  v_mfma_f32_16x16x32_bf16 v[84:87], a[52:55], a[84:87], v[84:87]
  ds_read_b128 a[24:27], v6 offset:10240
  v_fma_f32 v30, v30, v189, v187
  v_mfma_f32_16x16x32_bf16 v[52:55], a[56:59], a[80:83], v[52:55]
  ds_read_b128 a[28:31], v6 offset:12288
  v_fma_f32 v31, v31, v189, v187
  v_mfma_f32_16x16x32_bf16 v[88:91], a[56:59], a[84:87], v[88:91]
  buffer_load_dwordx4 v4, s[16:19], s40 offen offset:1024 lds
  v_mfma_f32_16x16x32_bf16 v[56:59], a[60:63], a[80:83], v[56:59]
  ds_read_b128 a[32:35], v6 offset:14336
  v_fma_mix_f32 v24, v134, v24, 0 op_sel:[0,0,0] op_sel_hi:[1,0,0]
  v_mfma_f32_16x16x32_bf16 v[92:95], a[60:63], a[84:87], v[92:95]
  v_exp_f32_e64 v14, v14
  v_mfma_f32_16x16x32_bf16 v[60:63], a[64:67], a[80:83], v[60:63]
  v_exp_f32 v15, v15
  v_mfma_f32_16x16x32_bf16 v[96:99], a[64:67], a[84:87], v[96:99]
  buffer_load_dwordx4 a[224:227], v7, s[60:63], s73 offen offset:2048
  v_mfma_f32_16x16x32_bf16 v[64:67], a[68:71], a[80:83], v[64:67]
  v_fma_mix_f32 v25, v134, v25, 0 op_sel:[1,0,0] op_sel_hi:[1,0,0]
  v_fma_mix_f32 v26, v135, v26, 0 op_sel:[0,0,0] op_sel_hi:[1,0,0]
  v_mfma_f32_16x16x32_bf16 v[100:103], a[68:71], a[84:87], v[100:103]
  s_waitcnt vmcnt(44) lgkmcnt(5)
  v_fma_mix_f32 v27, v135, v27, 0 op_sel:[1,0,0] op_sel_hi:[1,0,0]
  v_fma_mix_f32 v28, v138, v28, 0 op_sel:[0,0,0] op_sel_hi:[1,0,0]
  v_mfma_f32_16x16x32_bf16 v[32:35], a[0:3], a[88:91], v[32:35]
  ds_read_b128 a[36:39], v5 offset:64512
  v_fma_mix_f32 v29, v138, v29, 0 op_sel:[1,0,0] op_sel_hi:[1,0,0]
  v_mfma_f32_16x16x32_bf16 v[68:71], a[0:3], a[92:95], v[68:71]
  buffer_load_dwordx4 v4, s[16:19], s40 offen offset:2048 lds
  v_mfma_f32_16x16x32_bf16 v[36:39], a[4:7], a[88:91], v[36:39]
  s_waitcnt vmcnt(12)
  ds_write_b32 v107, v106
  v_mfma_f32_16x16x32_bf16 v[72:75], a[4:7], a[92:95], v[72:75]
  ds_read_b128 a[40:43], v6 offset:1024
  v_fma_mix_f32 v30, v139, v30, 0 op_sel:[0,0,0] op_sel_hi:[1,0,0]
  v_mfma_f32_16x16x32_bf16 v[40:43], a[8:11], a[88:91], v[40:43]
  ds_read_b128 a[44:47], v6 offset:3072
  v_fma_mix_f32 v31, v139, v31, 0 op_sel:[1,0,0] op_sel_hi:[1,0,0]
  v_mfma_f32_16x16x32_bf16 v[76:79], a[8:11], a[92:95], v[76:79]
  buffer_load_dwordx4 a[228:231], v7, s[60:63], s73 offen offset:3072
  v_mfma_f32_16x16x32_bf16 v[44:47], a[12:15], a[88:91], v[44:47]
  s_waitcnt lgkmcnt(4)
  ds_read_b128 a[48:51], v6 offset:5120
  v_mfma_f32_16x16x32_bf16 v[80:83], a[12:15], a[92:95], v[80:83]
  ds_read_b128 a[52:55], v6 offset:7168
  v_fma_mix_f32 v17, v126, v126, 0 op_sel:[1,1,0] op_sel_hi:[1,1,0]
  v_mfma_f32_16x16x32_bf16 v[48:51], a[16:19], a[88:91], v[48:51]
  ds_read_b128 a[56:59], v6 offset:9216
  v_fma_mix_f32 v18, v127, v127, 0 op_sel:[0,0,0] op_sel_hi:[1,1,0]
  v_mfma_f32_16x16x32_bf16 v[84:87], a[16:19], a[92:95], v[84:87]
  buffer_load_dwordx4 v4, s[16:19], s40 offen offset:3072 lds
  v_mfma_f32_16x16x32_bf16 v[52:55], a[20:23], a[88:91], v[52:55]
  ds_read_b32 v109, v108
  v_add_u32_e64 v106, 1, v106
  v_mfma_f32_16x16x32_bf16 v[88:91], a[20:23], a[92:95], v[88:91]
  s_add_u32 m0, s42, 36864
  ds_read_b128 a[60:63], v6 offset:11264
  v_mfma_f32_16x16x32_bf16 v[56:59], a[24:27], a[88:91], v[56:59]
  ds_read_b128 a[64:67], v6 offset:13312
  v_fma_mix_f32 v19, v127, v127, 0 op_sel:[1,1,0] op_sel_hi:[1,1,0]
  v_mfma_f32_16x16x32_bf16 v[92:95], a[24:27], a[92:95], v[92:95]
  buffer_load_dwordx4 a[232:235], v4, s[60:63], s71 offen offset:0
  v_mfma_f32_16x16x32_bf16 v[60:63], a[28:31], a[88:91], v[60:63]
  ds_read_b128 a[68:71], v6 offset:15360
  v_fma_mix_f32 v20, v130, v130, 0 op_sel:[0,0,0] op_sel_hi:[1,1,0]
  v_mfma_f32_16x16x32_bf16 v[96:99], a[28:31], a[92:95], v[96:99]
  s_waitcnt lgkmcnt(3)
  v_cmp_gt_u32 vcc, 6, v109
  v_fma_mix_f32 v21, v130, v130, 0 op_sel:[1,1,0] op_sel_hi:[1,1,0]
  v_mfma_f32_16x16x32_bf16 v[64:67], a[32:35], a[88:91], v[64:67]
  buffer_load_dwordx4 v111, s[16:19], s40 offen offset:0 lds
  v_mfma_f32_16x16x32_bf16 v[100:103], a[32:35], a[92:95], v[100:103]
  v_exp_f32_e64 v24, v24
  v_mfma_f32_16x16x32_bf16 v[32:35], a[36:39], a[96:99], v[32:35]
  s_cbranch_vccnz L_k5s_4
L_k5g_4:
  v_mfma_f32_16x16x32_bf16 v[68:71], a[36:39], a[100:103], v[68:71]
  ds_read_b128 a[0:3], v4 offset:0
  v_fma_mix_f32 v22, v131, v131, 0 op_sel:[0,0,0] op_sel_hi:[1,1,0]
  v_mfma_f32_16x16x32_bf16 v[36:39], a[40:43], a[96:99], v[36:39]
  s_add_u32 m0, s41, 55296
  ds_read_b128 a[4:7], v4 offset:2048
  v_mfma_f32_16x16x32_bf16 v[72:75], a[40:43], a[100:103], v[72:75]
  buffer_load_dwordx4 v110, s[16:19], s40 offen offset:0 lds
  v_mfma_f32_16x16x32_bf16 v[40:43], a[44:47], a[96:99], v[40:43]
  ds_read_b128 a[8:11], v4 offset:4096
  v_fma_mix_f32 v23, v131, v131, 0 op_sel:[1,1,0] op_sel_hi:[1,1,0]
  v_mfma_f32_16x16x32_bf16 v[76:79], a[44:47], a[100:103], v[76:79]
  ds_read_b128 a[12:15], v4 offset:6144
  v_fma_f32 v16, v16, v189, v187
  v_mfma_f32_16x16x32_bf16 v[44:47], a[48:51], a[96:99], v[44:47]
  s_nop 0
L_pg_17:
  s_cbranch_execz L_pg_21
  s_waitcnt lgkmcnt(4)
  ds_read_b128 a[16:19], v4 offset:8192
  v_mfma_f32_16x16x32_bf16 v[80:83], a[48:51], a[100:103], v[80:83]
  buffer_load_dwordx4 a[236:239], v4, s[60:63], s71 offen offset:1024
  v_mfma_f32_16x16x32_bf16 v[48:51], a[52:55], a[96:99], v[48:51]
  ds_read_b128 a[20:23], v4 offset:10240
  v_fma_f32 v17, v17, v189, v187
  v_mfma_f32_16x16x32_bf16 v[84:87], a[52:55], a[100:103], v[84:87]
  ds_read_b128 a[24:27], v4 offset:12288
  v_fma_f32 v18, v18, v189, v187
  v_mfma_f32_16x16x32_bf16 v[52:55], a[56:59], a[96:99], v[52:55]
  ds_read_b128 a[28:31], v4 offset:14336
  v_fma_f32 v19, v19, v189, v187
  v_mfma_f32_16x16x32_bf16 v[88:91], a[56:59], a[100:103], v[88:91]
  buffer_load_dwordx4 v110, s[16:19], s40 offen offset:1024 lds
  v_mfma_f32_16x16x32_bf16 v[56:59], a[60:63], a[96:99], v[56:59]
  ds_read_b128 a[32:35], v4 offset:16384
  v_fma_f32 v20, v20, v189, v187
  v_mfma_f32_16x16x32_bf16 v[92:95], a[60:63], a[100:103], v[92:95]
  v_exp_f32_e64 v25, v25
  v_mfma_f32_16x16x32_bf16 v[60:63], a[64:67], a[96:99], v[60:63]
  v_exp_f32_e64 v26, v26
  v_mfma_f32_16x16x32_bf16 v[96:99], a[64:67], a[100:103], v[96:99]
  buffer_load_dwordx4 a[240:243], v4, s[60:63], s71 offen offset:2048
  v_mfma_f32_16x16x32_bf16 v[64:67], a[68:71], a[96:99], v[64:67]
  v_exp_f32_e64 v27, v27
  v_mfma_f32_16x16x32_bf16 v[100:103], a[68:71], a[100:103], v[100:103]
  s_waitcnt vmcnt(49) lgkmcnt(5)
  v_exp_f32 v28, v28
  v_mfma_f32_16x16x32_bf16 v[32:35], a[0:3], a[104:107], v[32:35]
  s_getpc_b64 s[94:95]
  ds_read_b128 a[36:39], v4 offset:1024
  v_mfma_f32_16x16x32_bf16 v[68:71], a[0:3], a[108:111], v[68:71]
  global_load_dword a248, v232, s[94:95]
  v_mfma_f32_16x16x32_bf16 v[36:39], a[4:7], a[104:107], v[36:39]
  s_waitcnt vmcnt(14)
  ds_write_b32 v107, v106
  v_mfma_f32_16x16x32_bf16 v[72:75], a[4:7], a[108:111], v[72:75]
  buffer_load_dwordx4 v110, s[16:19], s40 offen offset:2048 lds
  v_mfma_f32_16x16x32_bf16 v[40:43], a[8:11], a[104:107], v[40:43]
  s_lshl4_add_u32 s50, s87, 7
  ds_read_b128 a[40:43], v4 offset:3072
  v_mfma_f32_16x16x32_bf16 v[76:79], a[8:11], a[108:111], v[76:79]
  ds_read_b128 a[44:47], v4 offset:5120
  v_fma_f32 v8, v8, v191, v191
  v_mfma_f32_16x16x32_bf16 v[44:47], a[12:15], a[104:107], v[44:47]
  s_waitcnt lgkmcnt(4)
  ds_read_b128 a[48:51], v4 offset:7168
  v_mfma_f32_16x16x32_bf16 v[80:83], a[12:15], a[108:111], v[80:83]
  buffer_load_dwordx4 a[244:247], v4, s[60:63], s71 offen offset:3072
  v_mfma_f32_16x16x32_bf16 v[48:51], a[16:19], a[104:107], v[48:51]
  ds_read_b128 a[52:55], v4 offset:9216
  v_fma_f32 v9, v9, v191, v191
  v_mfma_f32_16x16x32_bf16 v[84:87], a[16:19], a[108:111], v[84:87]
  ds_read_b128 a[56:59], v4 offset:11264
  v_fma_f32 v10, v10, v191, v191
  v_mfma_f32_16x16x32_bf16 v[52:55], a[20:23], a[104:107], v[52:55]
  ds_read_b32 v109, v108
  v_add_u32_e64 v106, 1, v106
  v_mfma_f32_16x16x32_bf16 v[88:91], a[20:23], a[108:111], v[88:91]
  ds_read_b128 a[60:63], v4 offset:13312
  v_fma_f32 v11, v11, v191, v191
  v_mfma_f32_16x16x32_bf16 v[56:59], a[24:27], a[104:107], v[56:59]
  buffer_load_dwordx4 v110, s[16:19], s40 offen offset:3072 lds
  v_mfma_f32_16x16x32_bf16 v[92:95], a[24:27], a[108:111], v[92:95]
  ds_read_b128 a[64:67], v4 offset:15360
  v_fma_f32 v12, v12, v191, v191
  v_mfma_f32_16x16x32_bf16 v[60:63], a[28:31], a[104:107], v[60:63]
  ds_read_b128 a[68:71], v4 offset:17408
  v_fma_f32 v13, v13, v191, v191
  v_mfma_f32_16x16x32_bf16 v[96:99], a[28:31], a[108:111], v[96:99]
  s_waitcnt lgkmcnt(3)
  v_cmp_gt_u32 vcc, s50, v109
  v_fma_f32 v14, v14, v191, v191
  v_mfma_f32_16x16x32_bf16 v[64:67], a[32:35], a[104:107], v[64:67]
  v_exp_f32_e64 v29, v29
  v_mfma_f32_16x16x32_bf16 v[100:103], a[32:35], a[108:111], v[100:103]
  v_readlane_b32 s40, v104, 5
  v_fma_f32 v15, v15, v191, v191
  v_mfma_f32_16x16x32_bf16 v[32:35], a[36:39], a[112:115], v[32:35]
  s_cbranch_vccnz L_k5s_5
L_k5g_5:
  v_mfma_f32_16x16x32_bf16 v[68:71], a[36:39], a[116:119], v[68:71]
  ds_read_b128 a[0:3], v4 offset:18432
  v_fma_f32 v21, v21, v189, v187
  v_mfma_f32_16x16x32_bf16 v[36:39], a[40:43], a[112:115], v[36:39]
  s_add_u32 m0, s41, 73728
  ds_read_b128 a[4:7], v4 offset:20480
  v_mfma_f32_16x16x32_bf16 v[72:75], a[40:43], a[116:119], v[72:75]
  buffer_load_dwordx4 v4, s[16:19], s40 offen offset:0 lds
  v_mfma_f32_16x16x32_bf16 v[40:43], a[44:47], a[112:115], v[40:43]
  ds_read_b128 a[8:11], v4 offset:22528
  v_fma_f32 v22, v22, v189, v187
  v_mfma_f32_16x16x32_bf16 v[76:79], a[44:47], a[116:119], v[76:79]
  ds_read_b128 a[12:15], v4 offset:24576
  v_fma_f32 v23, v23, v189, v187
  v_mfma_f32_16x16x32_bf16 v[44:47], a[48:51], a[112:115], v[44:47]
  s_waitcnt lgkmcnt(4)
  ds_read_b128 a[16:19], v4 offset:26624
  v_mfma_f32_16x16x32_bf16 v[80:83], a[48:51], a[116:119], v[80:83]
  buffer_load_dwordx4 a[184:187], v7, s[60:63], s71 offen offset:0
  v_mfma_f32_16x16x32_bf16 v[48:51], a[52:55], a[112:115], v[48:51]
  ds_read_b128 a[20:23], v4 offset:28672
  v_fma_mix_f32 v16, v126, v16, 0 op_sel:[0,0,0] op_sel_hi:[1,0,0]
  v_mfma_f32_16x16x32_bf16 v[84:87], a[52:55], a[116:119], v[84:87]
  ds_read_b128 a[24:27], v4 offset:30720
  v_fma_mix_f32 v17, v126, v17, 0 op_sel:[1,0,0] op_sel_hi:[1,0,0]
  v_mfma_f32_16x16x32_bf16 v[52:55], a[56:59], a[112:115], v[52:55]
  ds_read_b128 a[28:31], v4 offset:32768
  v_fma_mix_f32 v18, v127, v18, 0 op_sel:[0,0,0] op_sel_hi:[1,0,0]
  v_mfma_f32_16x16x32_bf16 v[88:91], a[56:59], a[116:119], v[88:91]
  buffer_load_dwordx4 v4, s[16:19], s40 offen offset:1024 lds
  v_mfma_f32_16x16x32_bf16 v[56:59], a[60:63], a[112:115], v[56:59]
  ds_read_b128 a[32:35], v4 offset:34816
  v_fma_mix_f32 v19, v127, v19, 0 op_sel:[1,0,0] op_sel_hi:[1,0,0]
  v_mfma_f32_16x16x32_bf16 v[92:95], a[60:63], a[116:119], v[92:95]
  v_exp_f32_e64 v30, v30
  v_mfma_f32_16x16x32_bf16 v[60:63], a[64:67], a[112:115], v[60:63]
  v_exp_f32_e64 v31, v31
  v_mfma_f32_16x16x32_bf16 v[96:99], a[64:67], a[116:119], v[96:99]
  buffer_load_dwordx4 a[188:191], v7, s[60:63], s71 offen offset:1024
  v_mfma_f32_16x16x32_bf16 v[64:67], a[68:71], a[112:115], v[64:67]
  v_rcp_f32_e64 v8, v8
  v_mfma_f32_16x16x32_bf16 v[100:103], a[68:71], a[116:119], v[100:103]
  s_waitcnt vmcnt(53) lgkmcnt(5)
  v_rcp_f32 v9, v9
  v_mfma_f32_16x16x32_bf16 v[32:35], a[0:3], a[120:123], v[32:35]
  ds_read_b128 a[36:39], v4 offset:19456
  v_fma_mix_f32 v20, v130, v20, 0 op_sel:[0,0,0] op_sel_hi:[1,0,0]
  v_mfma_f32_16x16x32_bf16 v[68:71], a[0:3], a[124:127], v[68:71]
  buffer_load_dwordx4 v4, s[16:19], s40 offen offset:2048 lds
  v_mfma_f32_16x16x32_bf16 v[36:39], a[4:7], a[120:123], v[36:39]
  s_waitcnt vmcnt(13)
  ds_write_b32 v107, v106
  v_mfma_f32_16x16x32_bf16 v[72:75], a[4:7], a[124:127], v[72:75]
  ds_read_b128 a[40:43], v4 offset:21504
  v_fma_mix_f32 v21, v130, v21, 0 op_sel:[1,0,0] op_sel_hi:[1,0,0]
  v_mfma_f32_16x16x32_bf16 v[40:43], a[8:11], a[120:123], v[40:43]
  ds_read_b128 a[44:47], v4 offset:23552
  v_fma_mix_f32 v22, v131, v22, 0 op_sel:[0,0,0] op_sel_hi:[1,0,0]
  v_mfma_f32_16x16x32_bf16 v[76:79], a[8:11], a[124:127], v[76:79]
  buffer_load_dwordx4 a[192:195], v7, s[60:63], s71 offen offset:2048
  v_mfma_f32_16x16x32_bf16 v[44:47], a[12:15], a[120:123], v[44:47]
  s_waitcnt lgkmcnt(4)
  ds_read_b128 a[48:51], v4 offset:25600
  v_mfma_f32_16x16x32_bf16 v[80:83], a[12:15], a[124:127], v[80:83]
  ds_read_b128 a[52:55], v4 offset:27648
  v_fma_mix_f32 v23, v131, v23, 0 op_sel:[1,0,0] op_sel_hi:[1,0,0]
  v_mfma_f32_16x16x32_bf16 v[48:51], a[16:19], a[120:123], v[48:51]
  ds_read_b128 a[56:59], v4 offset:29696
  v_readlane_b32 s73, v105, 7
  v_mfma_f32_16x16x32_bf16 v[84:87], a[16:19], a[124:127], v[84:87]
  buffer_load_dwordx4 v4, s[16:19], s40 offen offset:3072 lds
  v_mfma_f32_16x16x32_bf16 v[52:55], a[20:23], a[120:123], v[52:55]
  ds_read_b32 v109, v108
  v_add_u32_e64 v106, 1, v106
  v_mfma_f32_16x16x32_bf16 v[88:91], a[20:23], a[124:127], v[88:91]
  s_add_u32 m0, s42, 73728
  ds_read_b128 a[60:63], v4 offset:31744
  v_mfma_f32_16x16x32_bf16 v[56:59], a[24:27], a[120:123], v[56:59]
  ds_read_b128 a[64:67], v4 offset:33792
  v_fma_f32 v24, v24, v191, v191
  v_mfma_f32_16x16x32_bf16 v[92:95], a[24:27], a[124:127], v[92:95]
  buffer_load_dwordx4 a[196:199], v7, s[60:63], s71 offen offset:3072
  v_mfma_f32_16x16x32_bf16 v[60:63], a[28:31], a[120:123], v[60:63]
  ds_read_b128 a[68:71], v4 offset:35840
  v_fma_f32 v25, v25, v191, v191
  v_mfma_f32_16x16x32_bf16 v[96:99], a[28:31], a[124:127], v[96:99]
  s_waitcnt lgkmcnt(3)
  v_cmp_gt_u32 vcc, 8, v109
  v_fma_f32 v26, v26, v191, v191
  v_mfma_f32_16x16x32_bf16 v[64:67], a[32:35], a[120:123], v[64:67]
  buffer_load_dwordx4 v111, s[16:19], s40 offen offset:0 lds
  v_mfma_f32_16x16x32_bf16 v[100:103], a[32:35], a[124:127], v[100:103]
  v_exp_f32_e64 v16, v16
  v_mfma_f32_16x16x32_bf16 v[32:35], a[36:39], a[128:131], v[32:35]
  s_cbranch_vccnz L_k5s_6
L_k5g_6:
  v_mfma_f32_16x16x32_bf16 v[68:71], a[36:39], a[132:135], v[68:71]
  ds_read_b128 a[0:3], v4 offset:36864
  v_fma_f32 v27, v27, v191, v191
  v_mfma_f32_16x16x32_bf16 v[36:39], a[40:43], a[128:131], v[36:39]
  s_add_u32 m0, s41, 92160
  ds_read_b128 a[4:7], v4 offset:38912
  v_mfma_f32_16x16x32_bf16 v[72:75], a[40:43], a[132:135], v[72:75]
  buffer_load_dwordx4 v110, s[16:19], s40 offen offset:0 lds
  v_mfma_f32_16x16x32_bf16 v[40:43], a[44:47], a[128:131], v[40:43]
  ds_read_b128 a[8:11], v4 offset:40960
  v_fma_f32 v28, v28, v191, v191
  v_mfma_f32_16x16x32_bf16 v[76:79], a[44:47], a[132:135], v[76:79]
  ds_read_b128 a[12:15], v4 offset:43008
  v_fma_f32 v29, v29, v191, v191
  v_mfma_f32_16x16x32_bf16 v[44:47], a[48:51], a[128:131], v[44:47]
  s_waitcnt lgkmcnt(4)
  ds_read_b128 a[16:19], v4 offset:45056
  v_mfma_f32_16x16x32_bf16 v[80:83], a[48:51], a[132:135], v[80:83]
  buffer_load_dwordx4 a[200:203], v4, s[60:63], s73 offen offset:0
  v_mfma_f32_16x16x32_bf16 v[48:51], a[52:55], a[128:131], v[48:51]
  ds_read_b128 a[20:23], v4 offset:47104
  v_fma_f32 v30, v30, v191, v191
  v_mfma_f32_16x16x32_bf16 v[84:87], a[52:55], a[132:135], v[84:87]
  ds_read_b128 a[24:27], v4 offset:49152
  v_fma_f32 v31, v31, v191, v191
  v_mfma_f32_16x16x32_bf16 v[52:55], a[56:59], a[128:131], v[52:55]
  ds_read_b128 a[28:31], v4 offset:51200
  v_mfma_f32_16x16x32_bf16 v[88:91], a[56:59], a[132:135], v[88:91]
  buffer_load_dwordx4 v110, s[16:19], s40 offen offset:1024 lds
  v_mfma_f32_16x16x32_bf16 v[56:59], a[60:63], a[128:131], v[56:59]
  ds_read_b128 a[32:35], v4 offset:53248
  v_mfma_f32_16x16x32_bf16 v[92:95], a[60:63], a[132:135], v[92:95]
  v_exp_f32_e64 v17, v17
  v_mfma_f32_16x16x32_bf16 v[60:63], a[64:67], a[128:131], v[60:63]
  v_exp_f32_e64 v18, v18
  v_mfma_f32_16x16x32_bf16 v[96:99], a[64:67], a[132:135], v[96:99]
  buffer_load_dwordx4 a[204:207], v4, s[60:63], s73 offen offset:1024
  v_mfma_f32_16x16x32_bf16 v[64:67], a[68:71], a[128:131], v[64:67]
  v_exp_f32 v19, v19
  v_mfma_f32_16x16x32_bf16 v[100:103], a[68:71], a[132:135], v[100:103]
  s_waitcnt vmcnt(52) lgkmcnt(5)
  v_exp_f32 v20, v20
  v_mfma_f32_16x16x32_bf16 v[32:35], a[0:3], a[136:139], v[32:35]
  ds_read_b128 a[36:39], v4 offset:37888
  v_mfma_f32_16x16x32_bf16 v[68:71], a[0:3], a[140:143], v[68:71]
  ds_read_b128 a[40:43], v4 offset:39936
  v_mfma_f32_16x16x32_bf16 v[36:39], a[4:7], a[136:139], v[36:39]
  s_waitcnt vmcnt(13)
  ds_write_b32 v107, v106
  v_mfma_f32_16x16x32_bf16 v[72:75], a[4:7], a[140:143], v[72:75]
  buffer_load_dwordx4 v110, s[16:19], s40 offen offset:2048 lds
  v_mfma_f32_16x16x32_bf16 v[40:43], a[8:11], a[136:139], v[40:43]
  s_lshl4_add_u32 s50, s87, 9
  ds_read_b128 a[44:47], v4 offset:41984
  v_mfma_f32_16x16x32_bf16 v[76:79], a[8:11], a[140:143], v[76:79]
  ds_read_b128 a[48:51], v4 offset:44032
  v_mfma_f32_16x16x32_bf16 v[44:47], a[12:15], a[136:139], v[44:47]
  s_waitcnt lgkmcnt(5)
  ds_read_b128 a[52:55], v4 offset:46080
  v_mfma_f32_16x16x32_bf16 v[80:83], a[12:15], a[140:143], v[80:83]
  buffer_load_dwordx4 a[208:211], v4, s[60:63], s73 offen offset:2048
  v_mfma_f32_16x16x32_bf16 v[48:51], a[16:19], a[136:139], v[48:51]
  ds_read_b128 a[56:59], v4 offset:48128
  v_mfma_f32_16x16x32_bf16 v[84:87], a[16:19], a[140:143], v[84:87]
  ds_read_b128 a[60:63], v4 offset:50176
  v_mfma_f32_16x16x32_bf16 v[52:55], a[20:23], a[136:139], v[52:55]
  ds_read_b32 v109, v108
  v_add_u32_e64 v106, 1, v106
  v_mfma_f32_16x16x32_bf16 v[88:91], a[20:23], a[140:143], v[88:91]
  ds_read_b128 a[64:67], v4 offset:52224
  v_mfma_f32_16x16x32_bf16 v[56:59], a[24:27], a[136:139], v[56:59]
  buffer_load_dwordx4 v110, s[16:19], s40 offen offset:3072 lds
  v_mfma_f32_16x16x32_bf16 v[92:95], a[24:27], a[140:143], v[92:95]
  ds_read_b128 a[68:71], v4 offset:54272
  v_mfma_f32_16x16x32_bf16 v[60:63], a[28:31], a[136:139], v[60:63]
  v_exp_f32_e64 v21, v21
  v_mfma_f32_16x16x32_bf16 v[96:99], a[28:31], a[140:143], v[96:99]
  s_waitcnt lgkmcnt(2)
  v_cmp_gt_u32 vcc, s50, v109
  v_mfma_f32_16x16x32_bf16 v[64:67], a[32:35], a[136:139], v[64:67]
  v_exp_f32_e64 v22, v22
  v_mfma_f32_16x16x32_bf16 v[100:103], a[32:35], a[140:143], v[100:103]
  v_readlane_b32 s40, v104, 6
  v_mfma_f32_16x16x32_bf16 v[32:35], a[36:39], a[144:147], v[32:35]
  s_cbranch_vccnz L_k5s_7
L_k5g_7:
  v_mfma_f32_16x16x32_bf16 v[68:71], a[36:39], a[148:151], v[68:71]
  ds_read_b128 a[0:3], v4 offset:55296
  v_mfma_f32_16x16x32_bf16 v[36:39], a[40:43], a[144:147], v[36:39]
  s_add_u32 m0, s41, 110592
  ds_read_b128 a[4:7], v4 offset:57344
  v_mfma_f32_16x16x32_bf16 v[72:75], a[40:43], a[148:151], v[72:75]
  buffer_load_dwordx4 v4, s[16:19], s40 offen offset:0 lds
  v_mfma_f32_16x16x32_bf16 v[40:43], a[44:47], a[144:147], v[40:43]
  ds_read_b128 a[8:11], v4 offset:59392
  v_mfma_f32_16x16x32_bf16 v[76:79], a[44:47], a[148:151], v[76:79]
  ds_read_b128 a[12:15], v4 offset:61440
  v_mfma_f32_16x16x32_bf16 v[44:47], a[48:51], a[144:147], v[44:47]
  s_waitcnt lgkmcnt(4)
  ds_read_b128 a[16:19], v4 offset:63488
  v_mfma_f32_16x16x32_bf16 v[80:83], a[48:51], a[148:151], v[80:83]
  buffer_load_dwordx4 a[212:215], v4, s[60:63], s73 offen offset:3072
  v_mfma_f32_16x16x32_bf16 v[48:51], a[52:55], a[144:147], v[48:51]
  ds_read_b128 a[20:23], v5 offset:0
  v_mfma_f32_16x16x32_bf16 v[84:87], a[52:55], a[148:151], v[84:87]
  ds_read_b128 a[24:27], v5 offset:2048
  v_mfma_f32_16x16x32_bf16 v[52:55], a[56:59], a[144:147], v[52:55]
  ds_read_b128 a[28:31], v5 offset:4096
  v_mfma_f32_16x16x32_bf16 v[88:91], a[56:59], a[148:151], v[88:91]
  buffer_load_dwordx4 v4, s[16:19], s40 offen offset:1024 lds
  v_mfma_f32_16x16x32_bf16 v[56:59], a[60:63], a[144:147], v[56:59]
  ds_read_b128 a[32:35], v5 offset:6144
  v_mfma_f32_16x16x32_bf16 v[92:95], a[60:63], a[148:151], v[92:95]
  v_exp_f32_e64 v23, v23
  v_mfma_f32_16x16x32_bf16 v[60:63], a[64:67], a[144:147], v[60:63]
  v_rcp_f32_e64 v24, v24
  v_mfma_f32_16x16x32_bf16 v[96:99], a[64:67], a[148:151], v[96:99]
  buffer_load_dwordx4 a[72:75], v7, s[60:63], s73 offen offset:0
  v_mfma_f32_16x16x32_bf16 v[64:67], a[68:71], a[144:147], v[64:67]
  v_rcp_f32_e64 v25, v25
  v_mfma_f32_16x16x32_bf16 v[100:103], a[68:71], a[148:151], v[100:103]
  s_waitcnt vmcnt(49) lgkmcnt(5)
  v_rcp_f32 v26, v26
  v_mfma_f32_16x16x32_bf16 v[32:35], a[0:3], a[152:155], v[32:35]
  ds_read_b128 a[36:39], v4 offset:56320
  v_fma_f32 v16, v16, v191, v191
  v_mfma_f32_16x16x32_bf16 v[68:71], a[0:3], a[156:159], v[68:71]
  buffer_load_dwordx4 v4, s[16:19], s40 offen offset:2048 lds
  v_mfma_f32_16x16x32_bf16 v[36:39], a[4:7], a[152:155], v[36:39]
  s_waitcnt vmcnt(12)
  ds_write_b32 v107, v106
  v_mfma_f32_16x16x32_bf16 v[72:75], a[4:7], a[156:159], v[72:75]
  ds_read_b128 a[40:43], v4 offset:58368
  v_fma_f32 v17, v17, v191, v191
  v_mfma_f32_16x16x32_bf16 v[40:43], a[8:11], a[152:155], v[40:43]
  ds_read_b128 a[44:47], v4 offset:60416
  v_fma_f32 v18, v18, v191, v191
  v_mfma_f32_16x16x32_bf16 v[76:79], a[8:11], a[156:159], v[76:79]
  buffer_load_dwordx4 a[76:79], v7, s[60:63], s73 offen offset:1024
  v_mfma_f32_16x16x32_bf16 v[44:47], a[12:15], a[152:155], v[44:47]
  s_waitcnt lgkmcnt(4)
  ds_read_b128 a[48:51], v4 offset:62464
  v_mfma_f32_16x16x32_bf16 v[80:83], a[12:15], a[156:159], v[80:83]
  ds_read_b128 a[52:55], v4 offset:64512
  v_fma_f32 v19, v19, v191, v191
  v_mfma_f32_16x16x32_bf16 v[48:51], a[16:19], a[152:155], v[48:51]
  ds_read_b128 a[56:59], v5 offset:1024
  v_readlane_b32 s71, v105, 8
  v_mfma_f32_16x16x32_bf16 v[84:87], a[16:19], a[156:159], v[84:87]
  buffer_load_dwordx4 v4, s[16:19], s40 offen offset:3072 lds
  v_mfma_f32_16x16x32_bf16 v[52:55], a[20:23], a[152:155], v[52:55]
  ds_read_b32 v109, v108
  v_add_u32_e64 v106, 1, v106
  v_mfma_f32_16x16x32_bf16 v[88:91], a[20:23], a[156:159], v[88:91]
  s_add_u32 m0, s42, 110592
  ds_read_b128 a[60:63], v5 offset:3072
  v_mfma_f32_16x16x32_bf16 v[56:59], a[24:27], a[152:155], v[56:59]
  ds_read_b128 a[64:67], v5 offset:5120
  v_fma_f32 v20, v20, v191, v191
  v_mfma_f32_16x16x32_bf16 v[92:95], a[24:27], a[156:159], v[92:95]
  ds_read_b128 a[68:71], v5 offset:7168
  v_fma_f32 v21, v21, v191, v191
  v_mfma_f32_16x16x32_bf16 v[60:63], a[28:31], a[152:155], v[60:63]
  buffer_load_dwordx4 v111, s[16:19], s40 offen offset:0 lds
  v_mfma_f32_16x16x32_bf16 v[96:99], a[28:31], a[156:159], v[96:99]
  s_waitcnt lgkmcnt(3)
  v_cmp_gt_u32 vcc, 10, v109
  v_fma_f32 v22, v22, v191, v191
  v_mfma_f32_16x16x32_bf16 v[64:67], a[32:35], a[152:155], v[64:67]
  v_rcp_f32_e64 v10, v10
  v_mfma_f32_16x16x32_bf16 v[100:103], a[32:35], a[156:159], v[100:103]
  v_rcp_f32_e64 v27, v27
  v_mfma_f32_16x16x32_bf16 v[32:35], a[36:39], a[160:163], v[32:35]
  s_cbranch_vccnz L_k5s_8
L_k5g_8:
  v_mfma_f32_16x16x32_bf16 v[68:71], a[36:39], a[164:167], v[68:71]
  ds_read_b128 a[0:3], v5 offset:8192
  v_fma_f32 v23, v23, v191, v191
  v_mfma_f32_16x16x32_bf16 v[36:39], a[40:43], a[160:163], v[36:39]
  s_add_u32 m0, s41, 129024
  ds_read_b128 a[4:7], v5 offset:10240
  v_mfma_f32_16x16x32_bf16 v[72:75], a[40:43], a[164:167], v[72:75]
  buffer_load_dwordx4 v110, s[16:19], s40 offen offset:0 lds
  v_mfma_f32_16x16x32_bf16 v[40:43], a[44:47], a[160:163], v[40:43]
  ds_read_b128 a[8:11], v5 offset:12288
  v_mfma_f32_16x16x32_bf16 v[76:79], a[44:47], a[164:167], v[76:79]
  ds_read_b128 a[12:15], v5 offset:14336
  v_mfma_f32_16x16x32_bf16 v[44:47], a[48:51], a[160:163], v[44:47]
  s_waitcnt lgkmcnt(4)
  ds_read_b128 a[16:19], v5 offset:16384
  v_mfma_f32_16x16x32_bf16 v[80:83], a[48:51], a[164:167], v[80:83]
  buffer_load_dwordx4 a[80:83], v7, s[60:63], s73 offen offset:2048
  v_mfma_f32_16x16x32_bf16 v[48:51], a[52:55], a[160:163], v[48:51]
  ds_read_b128 a[20:23], v5 offset:18432
  v_mfma_f32_16x16x32_bf16 v[84:87], a[52:55], a[164:167], v[84:87]
  ds_read_b128 a[24:27], v5 offset:20480
  v_mfma_f32_16x16x32_bf16 v[52:55], a[56:59], a[160:163], v[52:55]
  ds_read_b128 a[28:31], v5 offset:22528
  v_mfma_f32_16x16x32_bf16 v[88:91], a[56:59], a[164:167], v[88:91]
  buffer_load_dwordx4 v110, s[16:19], s40 offen offset:1024 lds
  v_mfma_f32_16x16x32_bf16 v[56:59], a[60:63], a[160:163], v[56:59]
  ds_read_b128 a[32:35], v5 offset:24576
  v_mfma_f32_16x16x32_bf16 v[92:95], a[60:63], a[164:167], v[92:95]
  v_rcp_f32_e64 v16, v16
  v_mfma_f32_16x16x32_bf16 v[60:63], a[64:67], a[160:163], v[60:63]
  v_rcp_f32_e64 v17, v17
  v_mfma_f32_16x16x32_bf16 v[96:99], a[64:67], a[164:167], v[96:99]
  buffer_load_dwordx4 a[84:87], v7, s[60:63], s73 offen offset:3072
  v_mfma_f32_16x16x32_bf16 v[64:67], a[68:71], a[160:163], v[64:67]
  v_rcp_f32_e64 v18, v18
  v_mfma_f32_16x16x32_bf16 v[100:103], a[68:71], a[164:167], v[100:103]
  s_waitcnt vmcnt(48) lgkmcnt(5)
  v_rcp_f32 v11, v11
  v_mfma_f32_16x16x32_bf16 v[32:35], a[0:3], a[168:171], v[32:35]
  s_getpc_b64 s[94:95]
  ds_read_b128 a[36:39], v5 offset:9216
  v_mfma_f32_16x16x32_bf16 v[68:71], a[0:3], a[172:175], v[68:71]
  global_load_dword a248, v232, s[94:95]
  v_mfma_f32_16x16x32_bf16 v[36:39], a[4:7], a[168:171], v[36:39]
  s_waitcnt vmcnt(13)
  ds_write_b32 v107, v106
  v_mfma_f32_16x16x32_bf16 v[72:75], a[4:7], a[172:175], v[72:75]
  buffer_load_dwordx4 v110, s[16:19], s40 offen offset:2048 lds
  v_mfma_f32_16x16x32_bf16 v[40:43], a[8:11], a[168:171], v[40:43]
  s_lshl4_add_u32 s50, s87, 11
  ds_read_b128 a[40:43], v5 offset:11264
  v_mfma_f32_16x16x32_bf16 v[76:79], a[8:11], a[172:175], v[76:79]
  ds_read_b128 a[44:47], v5 offset:13312
  v_mfma_f32_16x16x32_bf16 v[44:47], a[12:15], a[168:171], v[44:47]
  s_waitcnt lgkmcnt(4)
  ds_read_b128 a[48:51], v5 offset:15360
  v_mfma_f32_16x16x32_bf16 v[80:83], a[12:15], a[172:175], v[80:83]
  buffer_load_dwordx4 a[88:91], v4, s[60:63], s71 offen offset:0
  v_mfma_f32_16x16x32_bf16 v[48:51], a[16:19], a[168:171], v[48:51]
  ds_read_b128 a[52:55], v5 offset:17408
  v_mfma_f32_16x16x32_bf16 v[84:87], a[16:19], a[172:175], v[84:87]
  ds_read_b128 a[56:59], v5 offset:19456
  v_mfma_f32_16x16x32_bf16 v[52:55], a[20:23], a[168:171], v[52:55]
  ds_read_b32 v109, v108
  v_add_u32_e64 v106, 1, v106
  v_mfma_f32_16x16x32_bf16 v[88:91], a[20:23], a[172:175], v[88:91]
  ds_read_b128 a[60:63], v5 offset:21504
  v_mfma_f32_16x16x32_bf16 v[56:59], a[24:27], a[168:171], v[56:59]
  buffer_load_dwordx4 v110, s[16:19], s40 offen offset:3072 lds
  v_mfma_f32_16x16x32_bf16 v[92:95], a[24:27], a[172:175], v[92:95]
  ds_read_b128 a[64:67], v5 offset:23552
  v_mfma_f32_16x16x32_bf16 v[60:63], a[28:31], a[168:171], v[60:63]
  ds_read_b128 a[68:71], v5 offset:25600
  v_mfma_f32_16x16x32_bf16 v[96:99], a[28:31], a[172:175], v[96:99]
  s_waitcnt lgkmcnt(3)
  v_cmp_gt_u32_e64 vcc, s50, v109
  v_mfma_f32_16x16x32_bf16 v[64:67], a[32:35], a[168:171], v[64:67]
  buffer_load_dwordx4 a[92:95], v4, s[60:63], s71 offen offset:1024
  v_mfma_f32_16x16x32_bf16 v[100:103], a[32:35], a[172:175], v[100:103]
  v_readlane_b32 s40, v104, 7
  v_mfma_f32_16x16x32_bf16 v[32:35], a[36:39], a[176:179], v[32:35]
  s_cbranch_vccnz L_k5s_9
L_k5g_9:
  v_mfma_f32_16x16x32_bf16 v[68:71], a[36:39], a[180:183], v[68:71]
  ds_read_b128 a[0:3], v5 offset:26624
  v_mfma_f32_16x16x32_bf16 v[36:39], a[40:43], a[176:179], v[36:39]
  s_add_u32 m0, s41, 0
  ds_read_b128 a[4:7], v5 offset:28672
  v_mfma_f32_16x16x32_bf16 v[72:75], a[40:43], a[180:183], v[72:75]
  buffer_load_dwordx4 v4, s[16:19], s40 offen offset:0 lds
  v_mfma_f32_16x16x32_bf16 v[40:43], a[44:47], a[176:179], v[40:43]
  ds_read_b128 a[8:11], v5 offset:30720
  v_mfma_f32_16x16x32_bf16 v[76:79], a[44:47], a[180:183], v[76:79]
  ds_read_b128 a[12:15], v5 offset:32768
  v_mfma_f32_16x16x32_bf16 v[44:47], a[48:51], a[176:179], v[44:47]
  s_waitcnt lgkmcnt(4)
  ds_read_b128 a[16:19], v5 offset:34816
  v_mfma_f32_16x16x32_bf16 v[80:83], a[48:51], a[180:183], v[80:83]
  buffer_load_dwordx4 a[96:99], v4, s[60:63], s71 offen offset:2048
  v_mfma_f32_16x16x32_bf16 v[48:51], a[52:55], a[176:179], v[48:51]
  ds_read_b128 a[20:23], v5 offset:36864
  v_mfma_f32_16x16x32_bf16 v[84:87], a[52:55], a[180:183], v[84:87]
  ds_read_b128 a[24:27], v5 offset:38912
  v_mfma_f32_16x16x32_bf16 v[52:55], a[56:59], a[176:179], v[52:55]
  ds_read_b128 a[28:31], v5 offset:40960
  v_mfma_f32_16x16x32_bf16 v[88:91], a[56:59], a[180:183], v[88:91]
  buffer_load_dwordx4 v4, s[16:19], s40 offen offset:1024 lds
  v_mfma_f32_16x16x32_bf16 v[56:59], a[60:63], a[176:179], v[56:59]
  ds_read_b128 a[32:35], v5 offset:43008
  v_mfma_f32_16x16x32_bf16 v[92:95], a[60:63], a[180:183], v[92:95]
  v_rcp_f32_e64 v19, v19
  v_mfma_f32_16x16x32_bf16 v[60:63], a[64:67], a[176:179], v[60:63]
  v_rcp_f32_e64 v28, v28
  v_mfma_f32_16x16x32_bf16 v[96:99], a[64:67], a[180:183], v[96:99]
  buffer_load_dwordx4 a[100:103], v4, s[60:63], s71 offen offset:3072
  v_mfma_f32_16x16x32_bf16 v[64:67], a[68:71], a[176:179], v[64:67]
  v_rcp_f32_e64 v12, v12
  v_mfma_f32_16x16x32_bf16 v[100:103], a[68:71], a[180:183], v[100:103]
  s_waitcnt vmcnt(48) lgkmcnt(5)
  v_rcp_f32 v20, v20
  v_mfma_f32_16x16x32_bf16 v[32:35], a[0:3], a[216:219], v[32:35]
  ds_read_b128 a[36:39], v5 offset:27648
  v_mfma_f32_16x16x32_bf16 v[68:71], a[0:3], a[220:223], v[68:71]
  buffer_load_dwordx4 v4, s[16:19], s40 offen offset:2048 lds
  v_mfma_f32_16x16x32_bf16 v[36:39], a[4:7], a[216:219], v[36:39]
  s_waitcnt vmcnt(14)
  ds_write_b32 v107, v106
  v_mfma_f32_16x16x32_bf16 v[72:75], a[4:7], a[220:223], v[72:75]
  ds_read_b128 a[40:43], v5 offset:29696
  v_mfma_f32_16x16x32_bf16 v[40:43], a[8:11], a[216:219], v[40:43]
  ds_read_b128 a[44:47], v5 offset:31744
  v_mfma_f32_16x16x32_bf16 v[76:79], a[8:11], a[220:223], v[76:79]
  buffer_load_dwordx4 a[104:107], v7, s[60:63], s71 offen offset:0
  v_mfma_f32_16x16x32_bf16 v[44:47], a[12:15], a[216:219], v[44:47]
  s_waitcnt lgkmcnt(4)
  ds_read_b128 a[48:51], v5 offset:33792
  v_mfma_f32_16x16x32_bf16 v[80:83], a[12:15], a[220:223], v[80:83]
  ds_read_b128 a[52:55], v5 offset:35840
  v_mfma_f32_16x16x32_bf16 v[48:51], a[16:19], a[216:219], v[48:51]
  ds_read_b128 a[56:59], v5 offset:37888
  v_readlane_b32 s73, v105, 9
  v_mfma_f32_16x16x32_bf16 v[84:87], a[16:19], a[220:223], v[84:87]
  buffer_load_dwordx4 v4, s[16:19], s40 offen offset:3072 lds
  v_mfma_f32_16x16x32_bf16 v[52:55], a[20:23], a[216:219], v[52:55]
  ds_read_b32 v109, v108
  v_add_u32 v106, 1, v106
  v_mfma_f32_16x16x32_bf16 v[88:91], a[20:23], a[220:223], v[88:91]
  s_add_u32 m0, s42, 0
  ds_read_b128 a[60:63], v5 offset:39936
  v_mfma_f32_16x16x32_bf16 v[56:59], a[24:27], a[216:219], v[56:59]
  ds_read_b128 a[64:67], v5 offset:41984
  v_mfma_f32_16x16x32_bf16 v[92:95], a[24:27], a[220:223], v[92:95]
  ds_read_b128 a[68:71], v5 offset:44032
  v_mfma_f32_16x16x32_bf16 v[60:63], a[28:31], a[216:219], v[60:63]
  buffer_load_dwordx4 v111, s[16:19], s40 offen offset:0 lds
  v_mfma_f32_16x16x32_bf16 v[96:99], a[28:31], a[220:223], v[96:99]
  s_waitcnt lgkmcnt(3)
  v_cmp_gt_u32 vcc, 12, v109
  v_mfma_f32_16x16x32_bf16 v[64:67], a[32:35], a[216:219], v[64:67]
  v_rcp_f32_e64 v29, v29
  v_mfma_f32_16x16x32_bf16 v[100:103], a[32:35], a[220:223], v[100:103]
  v_rcp_f32_e64 v13, v13
  v_mfma_f32_16x16x32_bf16 v[32:35], a[36:39], a[224:227], v[32:35]
  s_cbranch_vccnz L_k5s_10
L_k5g_10:
  v_mfma_f32_16x16x32_bf16 v[68:71], a[36:39], a[228:231], v[68:71]
  ds_read_b128 a[0:3], v5 offset:45056
  v_mfma_f32_16x16x32_bf16 v[36:39], a[40:43], a[224:227], v[36:39]
  s_add_u32 m0, s41, 18432
  ds_read_b128 a[4:7], v5 offset:47104
  v_mfma_f32_16x16x32_bf16 v[72:75], a[40:43], a[228:231], v[72:75]
  buffer_load_dwordx4 v110, s[16:19], s40 offen offset:0 lds
  v_mfma_f32_16x16x32_bf16 v[40:43], a[44:47], a[224:227], v[40:43]
  ds_read_b128 a[8:11], v5 offset:49152
  v_mfma_f32_16x16x32_bf16 v[76:79], a[44:47], a[228:231], v[76:79]
  ds_read_b128 a[12:15], v5 offset:51200
  v_mfma_f32_16x16x32_bf16 v[44:47], a[48:51], a[224:227], v[44:47]
  s_waitcnt lgkmcnt(4)
  ds_read_b128 a[16:19], v5 offset:53248
  v_mfma_f32_16x16x32_bf16 v[80:83], a[48:51], a[228:231], v[80:83]
  buffer_load_dwordx4 a[108:111], v7, s[60:63], s71 offen offset:1024
  v_mfma_f32_16x16x32_bf16 v[48:51], a[52:55], a[224:227], v[48:51]
  ds_read_b128 a[20:23], v5 offset:55296
  v_mfma_f32_16x16x32_bf16 v[84:87], a[52:55], a[228:231], v[84:87]
  ds_read_b128 a[24:27], v5 offset:57344
  v_mfma_f32_16x16x32_bf16 v[52:55], a[56:59], a[224:227], v[52:55]
  ds_read_b128 a[28:31], v5 offset:59392
  v_mfma_f32_16x16x32_bf16 v[88:91], a[56:59], a[228:231], v[88:91]
  buffer_load_dwordx4 v110, s[16:19], s40 offen offset:1024 lds
  v_mfma_f32_16x16x32_bf16 v[56:59], a[60:63], a[224:227], v[56:59]
  ds_read_b128 a[32:35], v5 offset:61440
  v_mfma_f32_16x16x32_bf16 v[92:95], a[60:63], a[228:231], v[92:95]
L_pg_18:
  s_cbranch_execz L_pg_22
  v_rcp_f32 v21, v21
  v_mfma_f32_16x16x32_bf16 v[60:63], a[64:67], a[224:227], v[60:63]
  v_rcp_f32_e64 v30, v30
  v_mfma_f32_16x16x32_bf16 v[96:99], a[64:67], a[228:231], v[96:99]
  buffer_load_dwordx4 a[112:115], v7, s[60:63], s71 offen offset:2048
  v_mfma_f32_16x16x32_bf16 v[64:67], a[68:71], a[224:227], v[64:67]
  v_rcp_f32 v14, v14
  v_mfma_f32_16x16x32_bf16 v[100:103], a[68:71], a[228:231], v[100:103]
  s_waitcnt vmcnt(46) lgkmcnt(5)
  v_rcp_f32 v22, v22
  v_mfma_f32_16x16x32_bf16 v[32:35], a[0:3], a[232:235], v[32:35]
  ds_read_b128 a[36:39], v5 offset:46080
  v_mfma_f32_16x16x32_bf16 v[68:71], a[0:3], a[236:239], v[68:71]
  ds_read_b128 a[40:43], v5 offset:48128
  v_mfma_f32_16x16x32_bf16 v[36:39], a[4:7], a[232:235], v[36:39]
  s_waitcnt vmcnt(13)
  ds_write_b32 v107, v106
  v_mfma_f32_16x16x32_bf16 v[72:75], a[4:7], a[236:239], v[72:75]
  buffer_load_dwordx4 v110, s[16:19], s40 offen offset:2048 lds
  v_mfma_f32_16x16x32_bf16 v[40:43], a[8:11], a[232:235], v[40:43]
  s_lshl4_add_u32 s50, s87, 13
  ds_read_b128 a[44:47], v5 offset:50176
  v_mfma_f32_16x16x32_bf16 v[76:79], a[8:11], a[236:239], v[76:79]
  ds_read_b128 a[48:51], v5 offset:52224
  v_mfma_f32_16x16x32_bf16 v[44:47], a[12:15], a[232:235], v[44:47]
  s_waitcnt lgkmcnt(5)
  ds_read_b128 a[52:55], v5 offset:54272
  v_mfma_f32_16x16x32_bf16 v[80:83], a[12:15], a[236:239], v[80:83]
  buffer_load_dwordx4 a[116:119], v7, s[60:63], s71 offen offset:3072
  v_mfma_f32_16x16x32_bf16 v[48:51], a[16:19], a[232:235], v[48:51]
  ds_read_b128 a[56:59], v5 offset:56320
  v_mfma_f32_16x16x32_bf16 v[84:87], a[16:19], a[236:239], v[84:87]
  ds_read_b128 a[60:63], v5 offset:58368
  v_mfma_f32_16x16x32_bf16 v[52:55], a[20:23], a[232:235], v[52:55]
  ds_read_b32 v109, v108
  v_add_u32_e64 v106, 1, v106
  v_mfma_f32_16x16x32_bf16 v[88:91], a[20:23], a[236:239], v[88:91]
  ds_read_b128 a[64:67], v5 offset:60416
  v_mfma_f32_16x16x32_bf16 v[56:59], a[24:27], a[232:235], v[56:59]
  buffer_load_dwordx4 v110, s[16:19], s40 offen offset:3072 lds
  v_mfma_f32_16x16x32_bf16 v[92:95], a[24:27], a[236:239], v[92:95]
  ds_read_b128 a[68:71], v5 offset:62464
  v_mfma_f32_16x16x32_bf16 v[60:63], a[28:31], a[232:235], v[60:63]
  v_rcp_f32_e64 v31, v31
  v_mfma_f32_16x16x32_bf16 v[96:99], a[28:31], a[236:239], v[96:99]
  s_waitcnt lgkmcnt(2)
  v_cmp_gt_u32 vcc, s50, v109
  v_fma_mix_f32 v212, v134, v24, 0 op_sel:[0,0,0] op_sel_hi:[1,0,0]
  v_mfma_f32_16x16x32_bf16 v[64:67], a[32:35], a[232:235], v[64:67]
  buffer_load_dwordx4 a[120:123], v4, s[60:63], s73 offen offset:0
  v_mfma_f32_16x16x32_bf16 v[100:103], a[32:35], a[236:239], v[100:103]
  v_readlane_b32 s40, v104, 8
  v_fma_mix_f32 v213, v134, v25, 0 op_sel:[1,0,0] op_sel_hi:[1,0,0]
  v_mfma_f32_16x16x32_bf16 v[32:35], a[36:39], a[240:243], v[32:35]
  s_cbranch_vccnz L_k5s_11
L_k5g_11:
  v_mfma_f32_16x16x32_bf16 v[68:71], a[36:39], a[244:247], v[68:71]
  ds_read_b128 a[0:3], v5 offset:63488
  v_fma_mix_f32 v214, v135, v26, 0 op_sel:[0,0,0] op_sel_hi:[1,0,0]
  v_mfma_f32_16x16x32_bf16 v[36:39], a[40:43], a[240:243], v[36:39]
  s_add_u32 m0, s41, 36864
  ds_read_b128 a[4:7], v6 offset:0
  v_mfma_f32_16x16x32_bf16 v[72:75], a[40:43], a[244:247], v[72:75]
  buffer_load_dwordx4 v4, s[16:19], s40 offen offset:0 lds
  v_mfma_f32_16x16x32_bf16 v[40:43], a[44:47], a[240:243], v[40:43]
  ds_read_b128 a[8:11], v6 offset:2048
  v_fma_mix_f32 v215, v135, v27, 0 op_sel:[1,0,0] op_sel_hi:[1,0,0]
  v_mfma_f32_16x16x32_bf16 v[76:79], a[44:47], a[244:247], v[76:79]
  ds_read_b128 a[12:15], v6 offset:4096
  v_fma_mix_f32 v216, v138, v28, 0 op_sel:[0,0,0] op_sel_hi:[1,0,0]
  v_mfma_f32_16x16x32_bf16 v[44:47], a[48:51], a[240:243], v[44:47]
  s_waitcnt lgkmcnt(4)
  ds_read_b128 a[16:19], v6 offset:6144
  v_mfma_f32_16x16x32_bf16 v[80:83], a[48:51], a[244:247], v[80:83]
  buffer_load_dwordx4 a[124:127], v4, s[60:63], s73 offen offset:1024
  v_mfma_f32_16x16x32_bf16 v[48:51], a[52:55], a[240:243], v[48:51]
  ds_read_b128 a[20:23], v6 offset:8192
  v_fma_mix_f32 v217, v138, v29, 0 op_sel:[1,0,0] op_sel_hi:[1,0,0]
  v_mfma_f32_16x16x32_bf16 v[84:87], a[52:55], a[244:247], v[84:87]
  ds_read_b128 a[24:27], v6 offset:10240
  v_fma_mix_f32 v218, v139, v30, 0 op_sel:[0,0,0] op_sel_hi:[1,0,0]
  v_mfma_f32_16x16x32_bf16 v[52:55], a[56:59], a[240:243], v[52:55]
  ds_read_b128 a[28:31], v6 offset:12288
  v_fma_mix_f32 v219, v139, v31, 0 op_sel:[1,0,0] op_sel_hi:[1,0,0]
  v_mfma_f32_16x16x32_bf16 v[88:91], a[56:59], a[244:247], v[88:91]
  buffer_load_dwordx4 v4, s[16:19], s40 offen offset:1024 lds
  v_mfma_f32_16x16x32_bf16 v[56:59], a[60:63], a[240:243], v[56:59]
  ds_read_b128 a[32:35], v6 offset:14336
  v_fma_mix_f32 v24, v120, v120, 0 op_sel:[0,0,0] op_sel_hi:[1,1,0]
  v_mfma_f32_16x16x32_bf16 v[92:95], a[60:63], a[244:247], v[92:95]
  v_rcp_f32_e64 v15, v15
  v_mfma_f32_16x16x32_bf16 v[60:63], a[64:67], a[240:243], v[60:63]
  v_rcp_f32 v23, v23
  v_mfma_f32_16x16x32_bf16 v[96:99], a[64:67], a[244:247], v[96:99]
  buffer_load_dwordx4 a[128:131], v4, s[60:63], s73 offen offset:2048
  v_mfma_f32_16x16x32_bf16 v[64:67], a[68:71], a[240:243], v[64:67]
  v_fma_mix_f32 v25, v120, v120, 0 op_sel:[1,1,0] op_sel_hi:[1,1,0]
  v_fma_mix_f32 v26, v121, v121, 0 op_sel:[0,0,0] op_sel_hi:[1,1,0]
  v_mfma_f32_16x16x32_bf16 v[100:103], a[68:71], a[244:247], v[100:103]
  s_waitcnt vmcnt(45) lgkmcnt(5)
  v_fma_mix_f32 v27, v121, v121, 0 op_sel:[1,1,0] op_sel_hi:[1,1,0]
  v_fma_mix_f32 v28, v124, v124, 0 op_sel:[0,0,0] op_sel_hi:[1,1,0]
  v_mfma_f32_16x16x32_bf16 v[32:35], a[0:3], a[184:187], v[32:35]
  ds_read_b128 a[36:39], v5 offset:64512
  v_fma_mix_f32 v29, v124, v124, 0 op_sel:[1,1,0] op_sel_hi:[1,1,0]
  v_mfma_f32_16x16x32_bf16 v[68:71], a[0:3], a[188:191], v[68:71]
  buffer_load_dwordx4 v4, s[16:19], s40 offen offset:2048 lds
  v_mfma_f32_16x16x32_bf16 v[36:39], a[4:7], a[184:187], v[36:39]
  s_waitcnt vmcnt(13)
  ds_write_b32 v107, v106
  v_mfma_f32_16x16x32_bf16 v[72:75], a[4:7], a[188:191], v[72:75]
  ds_read_b128 a[40:43], v6 offset:1024
  v_fma_mix_f32 v30, v125, v125, 0 op_sel:[0,0,0] op_sel_hi:[1,1,0]
  v_mfma_f32_16x16x32_bf16 v[40:43], a[8:11], a[184:187], v[40:43]
  ds_read_b128 a[44:47], v6 offset:3072
  v_fma_mix_f32 v31, v125, v125, 0 op_sel:[1,1,0] op_sel_hi:[1,1,0]
  v_mfma_f32_16x16x32_bf16 v[76:79], a[8:11], a[188:191], v[76:79]
  buffer_load_dwordx4 a[132:135], v4, s[60:63], s73 offen offset:3072
  v_mfma_f32_16x16x32_bf16 v[44:47], a[12:15], a[184:187], v[44:47]
  s_waitcnt lgkmcnt(4)
  ds_read_b128 a[48:51], v6 offset:5120
  v_mfma_f32_16x16x32_bf16 v[80:83], a[12:15], a[188:191], v[80:83]
  ds_read_b128 a[52:55], v6 offset:7168
  v_fma_f32 v24, v24, v188, v186
  v_mfma_f32_16x16x32_bf16 v[48:51], a[16:19], a[184:187], v[48:51]
  ds_read_b128 a[56:59], v6 offset:9216
  v_fma_f32 v25, v25, v188, v186
  v_mfma_f32_16x16x32_bf16 v[84:87], a[16:19], a[188:191], v[84:87]
  buffer_load_dwordx4 v4, s[16:19], s40 offen offset:3072 lds
  v_mfma_f32_16x16x32_bf16 v[52:55], a[20:23], a[184:187], v[52:55]
  ds_read_b32 v109, v108
  v_add_u32_e64 v106, 1, v106
  v_mfma_f32_16x16x32_bf16 v[88:91], a[20:23], a[188:191], v[88:91]
  s_add_u32 m0, s42, 36864
  ds_read_b128 a[60:63], v6 offset:11264
  v_mfma_f32_16x16x32_bf16 v[56:59], a[24:27], a[184:187], v[56:59]
  ds_read_b128 a[64:67], v6 offset:13312
  v_fma_f32 v26, v26, v188, v186
  v_mfma_f32_16x16x32_bf16 v[92:95], a[24:27], a[188:191], v[92:95]
  ds_read_b128 a[68:71], v6 offset:15360
  v_fma_f32 v27, v27, v188, v186
  v_mfma_f32_16x16x32_bf16 v[60:63], a[28:31], a[184:187], v[60:63]
  buffer_load_dwordx4 v111, s[16:19], s40 offen offset:0 lds
  v_mfma_f32_16x16x32_bf16 v[96:99], a[28:31], a[188:191], v[96:99]
  s_waitcnt lgkmcnt(3)
  v_cmp_gt_u32 vcc, 14, v109
  v_fma_f32 v28, v28, v188, v186
  v_mfma_f32_16x16x32_bf16 v[64:67], a[32:35], a[184:187], v[64:67]
  v_fma_f32 v29, v29, v188, v186
  v_fma_f32 v30, v30, v188, v186
  v_mfma_f32_16x16x32_bf16 v[100:103], a[32:35], a[188:191], v[100:103]
  v_fma_f32 v31, v31, v188, v186
  v_fma_mix_f32 v24, v120, v24, 0 op_sel:[0,0,0] op_sel_hi:[1,0,0]
  v_mfma_f32_16x16x32_bf16 v[32:35], a[36:39], a[192:195], v[32:35]
  s_cbranch_vccnz L_k5s_12
L_k5g_12:
  v_mfma_f32_16x16x32_bf16 v[68:71], a[36:39], a[196:199], v[68:71]
  ds_read_b128 a[0:3], v4 offset:0
  v_fma_mix_f32 v25, v120, v25, 0 op_sel:[1,0,0] op_sel_hi:[1,0,0]
  v_mfma_f32_16x16x32_bf16 v[36:39], a[40:43], a[192:195], v[36:39]
  s_add_u32 m0, s41, 55296
  ds_read_b128 a[4:7], v4 offset:2048
  v_mfma_f32_16x16x32_bf16 v[72:75], a[40:43], a[196:199], v[72:75]
  buffer_load_dwordx4 v110, s[16:19], s40 offen offset:0 lds
  v_mfma_f32_16x16x32_bf16 v[40:43], a[44:47], a[192:195], v[40:43]
  ds_read_b128 a[8:11], v4 offset:4096
  v_fma_mix_f32 v26, v121, v26, 0 op_sel:[0,0,0] op_sel_hi:[1,0,0]
  v_mfma_f32_16x16x32_bf16 v[76:79], a[44:47], a[196:199], v[76:79]
  ds_read_b128 a[12:15], v4 offset:6144
  v_fma_mix_f32 v27, v121, v27, 0 op_sel:[1,0,0] op_sel_hi:[1,0,0]
  v_mfma_f32_16x16x32_bf16 v[44:47], a[48:51], a[192:195], v[44:47]
  s_waitcnt lgkmcnt(4)
  ds_read_b128 a[16:19], v4 offset:8192
  v_mfma_f32_16x16x32_bf16 v[80:83], a[48:51], a[196:199], v[80:83]
  buffer_load_dwordx4 a[136:139], v7, s[60:63], s73 offen offset:0
  v_mfma_f32_16x16x32_bf16 v[48:51], a[52:55], a[192:195], v[48:51]
  ds_read_b128 a[20:23], v4 offset:10240
  v_fma_mix_f32 v28, v124, v28, 0 op_sel:[0,0,0] op_sel_hi:[1,0,0]
  v_mfma_f32_16x16x32_bf16 v[84:87], a[52:55], a[196:199], v[84:87]
  ds_read_b128 a[24:27], v4 offset:12288
  v_fma_mix_f32 v29, v124, v29, 0 op_sel:[1,0,0] op_sel_hi:[1,0,0]
  v_mfma_f32_16x16x32_bf16 v[52:55], a[56:59], a[192:195], v[52:55]
  ds_read_b128 a[28:31], v4 offset:14336
  v_fma_mix_f32 v30, v125, v30, 0 op_sel:[0,0,0] op_sel_hi:[1,0,0]
  v_mfma_f32_16x16x32_bf16 v[88:91], a[56:59], a[196:199], v[88:91]
  buffer_load_dwordx4 v110, s[16:19], s40 offen offset:1024 lds
  v_mfma_f32_16x16x32_bf16 v[56:59], a[60:63], a[192:195], v[56:59]
  ds_read_b128 a[32:35], v4 offset:16384
  v_fma_mix_f32 v31, v125, v31, 0 op_sel:[1,0,0] op_sel_hi:[1,0,0]
  v_mfma_f32_16x16x32_bf16 v[92:95], a[60:63], a[196:199], v[92:95]
  v_exp_f32_e64 v24, v24
  v_mfma_f32_16x16x32_bf16 v[60:63], a[64:67], a[192:195], v[60:63]
  v_exp_f32_e64 v25, v25
  v_mfma_f32_16x16x32_bf16 v[96:99], a[64:67], a[196:199], v[96:99]
  buffer_load_dwordx4 a[140:143], v7, s[60:63], s73 offen offset:1024
  v_mfma_f32_16x16x32_bf16 v[64:67], a[68:71], a[192:195], v[64:67]
  v_exp_f32_e64 v26, v26
  v_mfma_f32_16x16x32_bf16 v[100:103], a[68:71], a[196:199], v[100:103]
  s_waitcnt vmcnt(43) lgkmcnt(5)
  v_exp_f32 v27, v27
  v_mfma_f32_16x16x32_bf16 v[32:35], a[0:3], a[200:203], v[32:35]
  s_getpc_b64 s[94:95]
  ds_read_b128 a[36:39], v4 offset:1024
  v_mfma_f32_16x16x32_bf16 v[68:71], a[0:3], a[204:207], v[68:71]
  global_load_dword a248, v232, s[94:95]
  v_mfma_f32_16x16x32_bf16 v[36:39], a[4:7], a[200:203], v[36:39]
  s_waitcnt vmcnt(14)
  ds_write_b32 v107, v106
  v_mfma_f32_16x16x32_bf16 v[72:75], a[4:7], a[204:207], v[72:75]
  buffer_load_dwordx4 v110, s[16:19], s40 offen offset:2048 lds
  v_mfma_f32_16x16x32_bf16 v[40:43], a[8:11], a[200:203], v[40:43]
  s_lshl4_add_u32 s50, s87, 15
  ds_read_b128 a[40:43], v4 offset:3072
  v_mfma_f32_16x16x32_bf16 v[76:79], a[8:11], a[204:207], v[76:79]
  ds_read_b128 a[44:47], v4 offset:5120
  v_fma_mix_f32 v196, v118, v8, 0 op_sel:[0,0,0] op_sel_hi:[1,0,0]
  v_mfma_f32_16x16x32_bf16 v[44:47], a[12:15], a[200:203], v[44:47]
  s_waitcnt lgkmcnt(4)
  ds_read_b128 a[48:51], v4 offset:7168
  v_mfma_f32_16x16x32_bf16 v[80:83], a[12:15], a[204:207], v[80:83]
  buffer_load_dwordx4 a[144:147], v7, s[60:63], s73 offen offset:2048
  v_mfma_f32_16x16x32_bf16 v[48:51], a[16:19], a[200:203], v[48:51]
  ds_read_b128 a[52:55], v4 offset:9216
  v_readlane_b32 s71, v105, 10
  v_mfma_f32_16x16x32_bf16 v[84:87], a[16:19], a[204:207], v[84:87]
  ds_read_b128 a[56:59], v4 offset:11264
  v_fma_mix_f32 v197, v118, v9, 0 op_sel:[1,0,0] op_sel_hi:[1,0,0]
  v_mfma_f32_16x16x32_bf16 v[52:55], a[20:23], a[200:203], v[52:55]
  ds_read_b32 v109, v108
  v_add_u32_e64 v106, 1, v106
  v_mfma_f32_16x16x32_bf16 v[88:91], a[20:23], a[204:207], v[88:91]
  ds_read_b128 a[60:63], v4 offset:13312
  v_fma_mix_f32 v198, v119, v10, 0 op_sel:[0,0,0] op_sel_hi:[1,0,0]
  v_mfma_f32_16x16x32_bf16 v[56:59], a[24:27], a[200:203], v[56:59]
  buffer_load_dwordx4 v110, s[16:19], s40 offen offset:3072 lds
  v_mfma_f32_16x16x32_bf16 v[92:95], a[24:27], a[204:207], v[92:95]
  ds_read_b128 a[64:67], v4 offset:15360
  v_fma_mix_f32 v199, v119, v11, 0 op_sel:[1,0,0] op_sel_hi:[1,0,0]
  v_mfma_f32_16x16x32_bf16 v[60:63], a[28:31], a[200:203], v[60:63]
  ds_read_b128 a[68:71], v4 offset:17408
  v_fma_mix_f32 v200, v122, v12, 0 op_sel:[0,0,0] op_sel_hi:[1,0,0]
  v_mfma_f32_16x16x32_bf16 v[96:99], a[28:31], a[204:207], v[96:99]
  s_waitcnt lgkmcnt(3)
  v_cmp_gt_u32 vcc, s50, v109
  v_fma_mix_f32 v201, v122, v13, 0 op_sel:[1,0,0] op_sel_hi:[1,0,0]
  v_mfma_f32_16x16x32_bf16 v[64:67], a[32:35], a[200:203], v[64:67]
  buffer_load_dwordx4 a[148:151], v7, s[60:63], s73 offen offset:3072
  v_mfma_f32_16x16x32_bf16 v[100:103], a[32:35], a[204:207], v[100:103]
  v_readlane_b32 s40, v104, 9
  v_fma_mix_f32 v202, v123, v14, 0 op_sel:[0,0,0] op_sel_hi:[1,0,0]
  v_mfma_f32_16x16x32_bf16 v[32:35], a[36:39], a[208:211], v[32:35]
  s_cbranch_vccnz L_k5s_13
L_k5g_13:
  v_mfma_f32_16x16x32_bf16 v[68:71], a[36:39], a[212:215], v[68:71]
  ds_read_b128 a[0:3], v4 offset:18432
  v_fma_mix_f32 v203, v123, v15, 0 op_sel:[1,0,0] op_sel_hi:[1,0,0]
  v_mfma_f32_16x16x32_bf16 v[36:39], a[40:43], a[208:211], v[36:39]
  s_add_u32 m0, s41, 73728
  ds_read_b128 a[4:7], v4 offset:20480
  v_mfma_f32_16x16x32_bf16 v[72:75], a[40:43], a[212:215], v[72:75]
  buffer_load_dwordx4 v4, s[16:19], s40 offen offset:0 lds
  v_mfma_f32_16x16x32_bf16 v[40:43], a[44:47], a[208:211], v[40:43]
  ds_read_b128 a[8:11], v4 offset:22528
  v_fma_mix_f32 v8, v142, v142, 0 op_sel:[0,0,0] op_sel_hi:[1,1,0]
  v_mfma_f32_16x16x32_bf16 v[76:79], a[44:47], a[212:215], v[76:79]
  ds_read_b128 a[12:15], v4 offset:24576
  v_fma_mix_f32 v9, v142, v142, 0 op_sel:[1,1,0] op_sel_hi:[1,1,0]
  v_mfma_f32_16x16x32_bf16 v[44:47], a[48:51], a[208:211], v[44:47]
  s_waitcnt lgkmcnt(4)
  ds_read_b128 a[16:19], v4 offset:26624
  v_mfma_f32_16x16x32_bf16 v[80:83], a[48:51], a[212:215], v[80:83]
  buffer_load_dwordx4 a[152:155], v4, s[60:63], s71 offen offset:0
  v_mfma_f32_16x16x32_bf16 v[48:51], a[52:55], a[208:211], v[48:51]
  ds_read_b128 a[20:23], v4 offset:28672
  v_fma_mix_f32 v10, v143, v143, 0 op_sel:[0,0,0] op_sel_hi:[1,1,0]
  v_mfma_f32_16x16x32_bf16 v[84:87], a[52:55], a[212:215], v[84:87]
  ds_read_b128 a[24:27], v4 offset:30720
  v_fma_mix_f32 v11, v143, v143, 0 op_sel:[1,1,0] op_sel_hi:[1,1,0]
  v_mfma_f32_16x16x32_bf16 v[52:55], a[56:59], a[208:211], v[52:55]
  ds_read_b128 a[28:31], v4 offset:32768
  v_fma_mix_f32 v12, v146, v146, 0 op_sel:[0,0,0] op_sel_hi:[1,1,0]
  v_mfma_f32_16x16x32_bf16 v[88:91], a[56:59], a[212:215], v[88:91]
  buffer_load_dwordx4 v4, s[16:19], s40 offen offset:1024 lds
  v_mfma_f32_16x16x32_bf16 v[56:59], a[60:63], a[208:211], v[56:59]
  ds_read_b128 a[32:35], v4 offset:34816
  v_fma_mix_f32 v13, v146, v146, 0 op_sel:[1,1,0] op_sel_hi:[1,1,0]
  v_mfma_f32_16x16x32_bf16 v[92:95], a[60:63], a[212:215], v[92:95]
  v_exp_f32_e64 v28, v28
  v_mfma_f32_16x16x32_bf16 v[60:63], a[64:67], a[208:211], v[60:63]
  v_exp_f32_e64 v29, v29
  v_mfma_f32_16x16x32_bf16 v[96:99], a[64:67], a[212:215], v[96:99]
  buffer_load_dwordx4 a[156:159], v4, s[60:63], s71 offen offset:1024
  v_mfma_f32_16x16x32_bf16 v[64:67], a[68:71], a[208:211], v[64:67]
  v_exp_f32_e64 v30, v30
  v_mfma_f32_16x16x32_bf16 v[100:103], a[68:71], a[212:215], v[100:103]
  s_waitcnt vmcnt(42) lgkmcnt(5)
  v_exp_f32 v31, v31
  v_mfma_f32_16x16x32_bf16 v[32:35], a[0:3], a[72:75], v[32:35]
  ds_read_b128 a[36:39], v4 offset:19456
  v_fma_f32 v24, v24, v190, v190
  v_mfma_f32_16x16x32_bf16 v[68:71], a[0:3], a[76:79], v[68:71]
  buffer_load_dwordx4 v4, s[16:19], s40 offen offset:2048 lds
  v_mfma_f32_16x16x32_bf16 v[36:39], a[4:7], a[72:75], v[36:39]
  s_waitcnt vmcnt(14)
  ds_write_b32 v107, v106
  v_mfma_f32_16x16x32_bf16 v[72:75], a[4:7], a[76:79], v[72:75]
  ds_read_b128 a[40:43], v4 offset:21504
  v_fma_f32 v25, v25, v190, v190
  v_mfma_f32_16x16x32_bf16 v[40:43], a[8:11], a[72:75], v[40:43]
  ds_read_b128 a[44:47], v4 offset:23552
  v_fma_f32 v26, v26, v190, v190
  v_mfma_f32_16x16x32_bf16 v[76:79], a[8:11], a[76:79], v[76:79]
  buffer_load_dwordx4 a[160:163], v4, s[60:63], s71 offen offset:2048
  v_mfma_f32_16x16x32_bf16 v[44:47], a[12:15], a[72:75], v[44:47]
  s_waitcnt lgkmcnt(4)
  ds_read_b128 a[48:51], v4 offset:25600
  v_mfma_f32_16x16x32_bf16 v[80:83], a[12:15], a[76:79], v[80:83]
  ds_read_b128 a[52:55], v4 offset:27648
  v_fma_f32 v27, v27, v190, v190
  v_mfma_f32_16x16x32_bf16 v[48:51], a[16:19], a[72:75], v[48:51]
  ds_read_b128 a[56:59], v4 offset:29696
  v_fma_f32 v28, v28, v190, v190
  v_mfma_f32_16x16x32_bf16 v[84:87], a[16:19], a[76:79], v[84:87]
  buffer_load_dwordx4 v4, s[16:19], s40 offen offset:3072 lds
  v_mfma_f32_16x16x32_bf16 v[52:55], a[20:23], a[72:75], v[52:55]
  ds_read_b32 v109, v108
  v_add_u32_e64 v106, 1, v106
  v_mfma_f32_16x16x32_bf16 v[88:91], a[20:23], a[76:79], v[88:91]
  s_add_u32 m0, s42, 73728
  ds_read_b128 a[60:63], v4 offset:31744
  v_mfma_f32_16x16x32_bf16 v[56:59], a[24:27], a[72:75], v[56:59]
  ds_read_b128 a[64:67], v4 offset:33792
  v_fma_f32 v29, v29, v190, v190
  v_mfma_f32_16x16x32_bf16 v[92:95], a[24:27], a[76:79], v[92:95]
  ds_read_b128 a[68:71], v4 offset:35840
  v_fma_f32 v30, v30, v190, v190
  v_mfma_f32_16x16x32_bf16 v[60:63], a[28:31], a[72:75], v[60:63]
  buffer_load_dwordx4 v111, s[16:19], s40 offen offset:0 lds
  v_mfma_f32_16x16x32_bf16 v[96:99], a[28:31], a[76:79], v[96:99]
  s_waitcnt lgkmcnt(3)
  v_cmp_gt_u32 vcc, 16, v109
  v_fma_f32 v31, v31, v190, v190
  v_mfma_f32_16x16x32_bf16 v[64:67], a[32:35], a[72:75], v[64:67]
  v_rcp_f32_e64 v24, v24
  v_mfma_f32_16x16x32_bf16 v[100:103], a[32:35], a[76:79], v[100:103]
  v_rcp_f32_e64 v25, v25
  v_mfma_f32_16x16x32_bf16 v[32:35], a[36:39], a[80:83], v[32:35]
  s_cbranch_vccnz L_k5s_14
L_k5g_14:
  v_mfma_f32_16x16x32_bf16 v[68:71], a[36:39], a[84:87], v[68:71]
  ds_read_b128 a[0:3], v4 offset:36864
  v_fma_mix_f32 v204, v126, v16, 0 op_sel:[0,0,0] op_sel_hi:[1,0,0]
  v_mfma_f32_16x16x32_bf16 v[36:39], a[40:43], a[80:83], v[36:39]
  s_add_u32 m0, s41, 92160
  ds_read_b128 a[4:7], v4 offset:38912
  v_mfma_f32_16x16x32_bf16 v[72:75], a[40:43], a[84:87], v[72:75]
  buffer_load_dwordx4 v110, s[16:19], s40 offen offset:0 lds
  v_mfma_f32_16x16x32_bf16 v[40:43], a[44:47], a[80:83], v[40:43]
  ds_read_b128 a[8:11], v4 offset:40960
  v_fma_mix_f32 v205, v126, v17, 0 op_sel:[1,0,0] op_sel_hi:[1,0,0]
  v_mfma_f32_16x16x32_bf16 v[76:79], a[44:47], a[84:87], v[76:79]
  ds_read_b128 a[12:15], v4 offset:43008
  v_fma_mix_f32 v206, v127, v18, 0 op_sel:[0,0,0] op_sel_hi:[1,0,0]
  v_mfma_f32_16x16x32_bf16 v[44:47], a[48:51], a[80:83], v[44:47]
  s_waitcnt lgkmcnt(4)
  ds_read_b128 a[16:19], v4 offset:45056
  v_mfma_f32_16x16x32_bf16 v[80:83], a[48:51], a[84:87], v[80:83]
  buffer_load_dwordx4 a[164:167], v4, s[60:63], s71 offen offset:3072
  v_mfma_f32_16x16x32_bf16 v[48:51], a[52:55], a[80:83], v[48:51]
  ds_read_b128 a[20:23], v4 offset:47104
  v_fma_mix_f32 v207, v127, v19, 0 op_sel:[1,0,0] op_sel_hi:[1,0,0]
  v_mfma_f32_16x16x32_bf16 v[84:87], a[52:55], a[84:87], v[84:87]
  ds_read_b128 a[24:27], v4 offset:49152
  v_fma_mix_f32 v208, v130, v20, 0 op_sel:[0,0,0] op_sel_hi:[1,0,0]
  v_mfma_f32_16x16x32_bf16 v[52:55], a[56:59], a[80:83], v[52:55]
  ds_read_b128 a[28:31], v4 offset:51200
  v_fma_mix_f32 v209, v130, v21, 0 op_sel:[1,0,0] op_sel_hi:[1,0,0]
  v_mfma_f32_16x16x32_bf16 v[88:91], a[56:59], a[84:87], v[88:91]
  buffer_load_dwordx4 v110, s[16:19], s40 offen offset:1024 lds
  v_mfma_f32_16x16x32_bf16 v[56:59], a[60:63], a[80:83], v[56:59]
  ds_read_b128 a[32:35], v4 offset:53248
  v_fma_mix_f32 v210, v131, v22, 0 op_sel:[0,0,0] op_sel_hi:[1,0,0]
  v_mfma_f32_16x16x32_bf16 v[92:95], a[60:63], a[84:87], v[92:95]
  v_rcp_f32_e64 v26, v26
  v_mfma_f32_16x16x32_bf16 v[60:63], a[64:67], a[80:83], v[60:63]
  v_rcp_f32_e64 v27, v27
  v_mfma_f32_16x16x32_bf16 v[96:99], a[64:67], a[84:87], v[96:99]
  buffer_load_dwordx4 a[168:171], v7, s[60:63], s71 offen offset:0
  v_mfma_f32_16x16x32_bf16 v[64:67], a[68:71], a[80:83], v[64:67]
  v_rcp_f32 v28, v28
  v_mfma_f32_16x16x32_bf16 v[100:103], a[68:71], a[84:87], v[100:103]
  s_waitcnt vmcnt(41) lgkmcnt(5)
  v_rcp_f32 v29, v29
  v_mfma_f32_16x16x32_bf16 v[32:35], a[0:3], a[88:91], v[32:35]
  ds_read_b128 a[36:39], v4 offset:37888
  v_fma_mix_f32 v14, v147, v147, 0 op_sel:[0,0,0] op_sel_hi:[1,1,0]
  v_mfma_f32_16x16x32_bf16 v[68:71], a[0:3], a[92:95], v[68:71]
  ds_read_b128 a[40:43], v4 offset:39936
  v_fma_mix_f32 v15, v147, v147, 0 op_sel:[1,1,0] op_sel_hi:[1,1,0]
  v_mfma_f32_16x16x32_bf16 v[36:39], a[4:7], a[88:91], v[36:39]
  s_waitcnt vmcnt(13)
  ds_write_b32 v107, v106
  v_mfma_f32_16x16x32_bf16 v[72:75], a[4:7], a[92:95], v[72:75]
  buffer_load_dwordx4 v110, s[16:19], s40 offen offset:2048 lds
  v_mfma_f32_16x16x32_bf16 v[40:43], a[8:11], a[88:91], v[40:43]
  s_lshl4_add_u32 s50, s87, 17
  ds_read_b128 a[44:47], v4 offset:41984
  v_mfma_f32_16x16x32_bf16 v[76:79], a[8:11], a[92:95], v[76:79]
  ds_read_b128 a[48:51], v4 offset:44032
  v_fma_f32 v8, v8, v189, v187
  v_mfma_f32_16x16x32_bf16 v[44:47], a[12:15], a[88:91], v[44:47]
  s_waitcnt lgkmcnt(5)
  ds_read_b128 a[52:55], v4 offset:46080
  v_mfma_f32_16x16x32_bf16 v[80:83], a[12:15], a[92:95], v[80:83]
  buffer_load_dwordx4 a[172:175], v7, s[60:63], s71 offen offset:1024
  v_mfma_f32_16x16x32_bf16 v[48:51], a[16:19], a[88:91], v[48:51]
  ds_read_b128 a[56:59], v4 offset:48128
  v_readlane_b32 s73, v105, 11
  v_mfma_f32_16x16x32_bf16 v[84:87], a[16:19], a[92:95], v[84:87]
  ds_read_b128 a[60:63], v4 offset:50176
  v_fma_f32 v9, v9, v189, v187
  v_mfma_f32_16x16x32_bf16 v[52:55], a[20:23], a[88:91], v[52:55]
  ds_read_b32 v109, v108
  v_add_u32_e64 v106, 1, v106
  v_mfma_f32_16x16x32_bf16 v[88:91], a[20:23], a[92:95], v[88:91]
  ds_read_b128 a[64:67], v4 offset:52224
  v_fma_f32 v10, v10, v189, v187
  v_mfma_f32_16x16x32_bf16 v[56:59], a[24:27], a[88:91], v[56:59]
  buffer_load_dwordx4 v110, s[16:19], s40 offen offset:3072 lds
  v_mfma_f32_16x16x32_bf16 v[92:95], a[24:27], a[92:95], v[92:95]
  ds_read_b128 a[68:71], v4 offset:54272
  v_fma_f32 v11, v11, v189, v187
  v_mfma_f32_16x16x32_bf16 v[60:63], a[28:31], a[88:91], v[60:63]
  v_rcp_f32_e64 v30, v30
  v_mfma_f32_16x16x32_bf16 v[96:99], a[28:31], a[92:95], v[96:99]
  s_waitcnt lgkmcnt(2)
  v_cmp_gt_u32 vcc, s50, v109
  v_fma_f32 v12, v12, v189, v187
  v_mfma_f32_16x16x32_bf16 v[64:67], a[32:35], a[88:91], v[64:67]
  v_rcp_f32_e64 v31, v31
  v_mfma_f32_16x16x32_bf16 v[100:103], a[32:35], a[92:95], v[100:103]
  v_readlane_b32 s40, v104, 10
  v_fma_f32 v13, v13, v189, v187
  v_mfma_f32_16x16x32_bf16 v[32:35], a[36:39], a[96:99], v[32:35]
  s_cbranch_vccnz L_k5s_15
L_k5g_15:
  v_mfma_f32_16x16x32_bf16 v[68:71], a[36:39], a[100:103], v[68:71]
  ds_read_b128 a[0:3], v4 offset:55296
  v_fma_f32 v14, v14, v189, v187
  v_mfma_f32_16x16x32_bf16 v[36:39], a[40:43], a[96:99], v[36:39]
  s_add_u32 m0, s41, 110592
  ds_read_b128 a[4:7], v4 offset:57344
  v_mfma_f32_16x16x32_bf16 v[72:75], a[40:43], a[100:103], v[72:75]
  buffer_load_dwordx4 v4, s[16:19], s40 offen offset:0 lds
  v_mfma_f32_16x16x32_bf16 v[40:43], a[44:47], a[96:99], v[40:43]
  ds_read_b128 a[8:11], v4 offset:59392
  v_fma_f32 v15, v15, v189, v187
  v_mfma_f32_16x16x32_bf16 v[76:79], a[44:47], a[100:103], v[76:79]
  ds_read_b128 a[12:15], v4 offset:61440
  v_fma_mix_f32 v8, v142, v8, 0 op_sel:[0,0,0] op_sel_hi:[1,0,0]
  v_mfma_f32_16x16x32_bf16 v[44:47], a[48:51], a[96:99], v[44:47]
  s_waitcnt lgkmcnt(4)
  ds_read_b128 a[16:19], v4 offset:63488
  v_mfma_f32_16x16x32_bf16 v[80:83], a[48:51], a[100:103], v[80:83]
  buffer_load_dwordx4 a[176:179], v7, s[60:63], s71 offen offset:2048
  v_mfma_f32_16x16x32_bf16 v[48:51], a[52:55], a[96:99], v[48:51]
  ds_read_b128 a[20:23], v5 offset:0
  v_fma_mix_f32 v9, v142, v9, 0 op_sel:[1,0,0] op_sel_hi:[1,0,0]
  v_mfma_f32_16x16x32_bf16 v[84:87], a[52:55], a[100:103], v[84:87]
  ds_read_b128 a[24:27], v5 offset:2048
  v_fma_mix_f32 v10, v143, v10, 0 op_sel:[0,0,0] op_sel_hi:[1,0,0]
  v_mfma_f32_16x16x32_bf16 v[52:55], a[56:59], a[96:99], v[52:55]
  ds_read_b128 a[28:31], v5 offset:4096
  v_fma_mix_f32 v11, v143, v11, 0 op_sel:[1,0,0] op_sel_hi:[1,0,0]
  v_mfma_f32_16x16x32_bf16 v[88:91], a[56:59], a[100:103], v[88:91]
  buffer_load_dwordx4 v4, s[16:19], s40 offen offset:1024 lds
  v_mfma_f32_16x16x32_bf16 v[56:59], a[60:63], a[96:99], v[56:59]
  ds_read_b128 a[32:35], v5 offset:6144
  v_fma_mix_f32 v12, v146, v12, 0 op_sel:[0,0,0] op_sel_hi:[1,0,0]
  v_mfma_f32_16x16x32_bf16 v[92:95], a[60:63], a[100:103], v[92:95]
  v_fma_mix_f32 v13, v146, v13, 0 op_sel:[1,0,0] op_sel_hi:[1,0,0]
  v_fma_mix_f32 v14, v147, v14, 0 op_sel:[0,0,0] op_sel_hi:[1,0,0]
  v_mfma_f32_16x16x32_bf16 v[60:63], a[64:67], a[96:99], v[60:63]
  v_fma_mix_f32 v15, v147, v15, 0 op_sel:[1,0,0] op_sel_hi:[1,0,0]
  v_fma_mix_f32 v211, v131, v23, 0 op_sel:[1,0,0] op_sel_hi:[1,0,0]
  v_mfma_f32_16x16x32_bf16 v[96:99], a[64:67], a[100:103], v[96:99]
  buffer_load_dwordx4 a[180:183], v7, s[60:63], s71 offen offset:3072
  v_mfma_f32_16x16x32_bf16 v[64:67], a[68:71], a[96:99], v[64:67]
  v_exp_f32_e64 v8, v8
  v_mfma_f32_16x16x32_bf16 v[100:103], a[68:71], a[100:103], v[100:103]
  s_waitcnt vmcnt(38) lgkmcnt(5)
  v_exp_f32 v9, v9
  v_mfma_f32_16x16x32_bf16 v[32:35], a[0:3], a[104:107], v[32:35]
  ds_read_b128 a[36:39], v4 offset:56320
  v_fma_mix_f32 v16, v150, v150, 0 op_sel:[0,0,0] op_sel_hi:[1,1,0]
  v_mfma_f32_16x16x32_bf16 v[68:71], a[0:3], a[108:111], v[68:71]
  buffer_load_dwordx4 v4, s[16:19], s40 offen offset:2048 lds
  v_mfma_f32_16x16x32_bf16 v[36:39], a[4:7], a[104:107], v[36:39]
  s_waitcnt vmcnt(12)
  ds_write_b32 v107, v106
  v_mfma_f32_16x16x32_bf16 v[72:75], a[4:7], a[108:111], v[72:75]
  ds_read_b128 a[40:43], v4 offset:58368
  v_fma_mix_f32 v17, v150, v150, 0 op_sel:[1,1,0] op_sel_hi:[1,1,0]
  v_mfma_f32_16x16x32_bf16 v[40:43], a[8:11], a[104:107], v[40:43]
  ds_read_b128 a[44:47], v4 offset:60416
  v_fma_mix_f32 v18, v151, v151, 0 op_sel:[0,0,0] op_sel_hi:[1,1,0]
  v_mfma_f32_16x16x32_bf16 v[76:79], a[8:11], a[108:111], v[76:79]
  buffer_load_dwordx4 a[216:219], v4, s[60:63], s73 offen offset:0
  v_mfma_f32_16x16x32_bf16 v[44:47], a[12:15], a[104:107], v[44:47]
  s_waitcnt lgkmcnt(4)
  ds_read_b128 a[48:51], v4 offset:62464
  v_mfma_f32_16x16x32_bf16 v[80:83], a[12:15], a[108:111], v[80:83]
  ds_read_b128 a[52:55], v4 offset:64512
  v_fma_mix_f32 v19, v151, v151, 0 op_sel:[1,1,0] op_sel_hi:[1,1,0]
  v_mfma_f32_16x16x32_bf16 v[48:51], a[16:19], a[104:107], v[48:51]
  ds_read_b128 a[56:59], v5 offset:1024
  v_fma_mix_f32 v20, v116, v116, 0 op_sel:[0,0,0] op_sel_hi:[1,1,0]
  v_mfma_f32_16x16x32_bf16 v[84:87], a[16:19], a[108:111], v[84:87]
  buffer_load_dwordx4 v4, s[16:19], s40 offen offset:3072 lds
  v_mfma_f32_16x16x32_bf16 v[52:55], a[20:23], a[104:107], v[52:55]
  ds_read_b32 v109, v108
  v_add_u32_e64 v106, 1, v106
  v_mfma_f32_16x16x32_bf16 v[88:91], a[20:23], a[108:111], v[88:91]
  s_add_u32 m0, s42, 110592
  ds_read_b128 a[60:63], v5 offset:3072
  v_mfma_f32_16x16x32_bf16 v[56:59], a[24:27], a[104:107], v[56:59]
  ds_read_b128 a[64:67], v5 offset:5120
  v_fma_mix_f32 v21, v116, v116, 0 op_sel:[1,1,0] op_sel_hi:[1,1,0]
  v_mfma_f32_16x16x32_bf16 v[92:95], a[24:27], a[108:111], v[92:95]
  buffer_load_dwordx4 a[220:223], v4, s[60:63], s73 offen offset:1024
  v_mfma_f32_16x16x32_bf16 v[60:63], a[28:31], a[104:107], v[60:63]
  ds_read_b128 a[68:71], v5 offset:7168
  v_fma_mix_f32 v22, v117, v117, 0 op_sel:[0,0,0] op_sel_hi:[1,1,0]
  v_mfma_f32_16x16x32_bf16 v[96:99], a[28:31], a[108:111], v[96:99]
  s_waitcnt lgkmcnt(3)
  v_cmp_gt_u32 vcc, 18, v109
  v_fma_mix_f32 v23, v117, v117, 0 op_sel:[1,1,0] op_sel_hi:[1,1,0]
  v_mfma_f32_16x16x32_bf16 v[64:67], a[32:35], a[104:107], v[64:67]
  buffer_load_dwordx4 v111, s[16:19], s40 offen offset:0 lds
  v_mfma_f32_16x16x32_bf16 v[100:103], a[32:35], a[108:111], v[100:103]
L_pg_19:
  s_cbranch_execz L_pg_23
  v_exp_f32 v10, v10
  v_mfma_f32_16x16x32_bf16 v[32:35], a[36:39], a[112:115], v[32:35]
  s_cbranch_vccnz L_k5s_16
L_k5g_16:
  v_mfma_f32_16x16x32_bf16 v[68:71], a[36:39], a[116:119], v[68:71]
  ds_read_b128 a[0:3], v5 offset:8192
  v_fma_f32 v16, v16, v189, v187
  v_mfma_f32_16x16x32_bf16 v[36:39], a[40:43], a[112:115], v[36:39]
  s_add_u32 m0, s41, 129024
  ds_read_b128 a[4:7], v5 offset:10240
  v_mfma_f32_16x16x32_bf16 v[72:75], a[40:43], a[116:119], v[72:75]
  buffer_load_dwordx4 v110, s[16:19], s40 offen offset:0 lds
  v_mfma_f32_16x16x32_bf16 v[40:43], a[44:47], a[112:115], v[40:43]
  ds_read_b128 a[8:11], v5 offset:12288
  v_fma_f32 v17, v17, v189, v187
  v_mfma_f32_16x16x32_bf16 v[76:79], a[44:47], a[116:119], v[76:79]
  ds_read_b128 a[12:15], v5 offset:14336
  v_fma_f32 v18, v18, v189, v187
  v_mfma_f32_16x16x32_bf16 v[44:47], a[48:51], a[112:115], v[44:47]
  s_waitcnt lgkmcnt(4)
  ds_read_b128 a[16:19], v5 offset:16384
  v_mfma_f32_16x16x32_bf16 v[80:83], a[48:51], a[116:119], v[80:83]
  buffer_load_dwordx4 a[224:227], v4, s[60:63], s73 offen offset:2048
  v_mfma_f32_16x16x32_bf16 v[48:51], a[52:55], a[112:115], v[48:51]
  ds_read_b128 a[20:23], v5 offset:18432
  v_fma_f32 v19, v19, v189, v187
  v_mfma_f32_16x16x32_bf16 v[84:87], a[52:55], a[116:119], v[84:87]
  ds_read_b128 a[24:27], v5 offset:20480
  v_fma_f32 v20, v20, v188, v186
  v_mfma_f32_16x16x32_bf16 v[52:55], a[56:59], a[112:115], v[52:55]
  ds_read_b128 a[28:31], v5 offset:22528
  v_fma_f32 v21, v21, v188, v186
  v_mfma_f32_16x16x32_bf16 v[88:91], a[56:59], a[116:119], v[88:91]
  buffer_load_dwordx4 v110, s[16:19], s40 offen offset:1024 lds
  v_mfma_f32_16x16x32_bf16 v[56:59], a[60:63], a[112:115], v[56:59]
  ds_read_b128 a[32:35], v5 offset:24576
  v_fma_f32 v22, v22, v188, v186
  v_mfma_f32_16x16x32_bf16 v[92:95], a[60:63], a[116:119], v[92:95]
  v_exp_f32_e64 v11, v11
  v_mfma_f32_16x16x32_bf16 v[60:63], a[64:67], a[112:115], v[60:63]
  v_exp_f32_e64 v12, v12
  v_mfma_f32_16x16x32_bf16 v[96:99], a[64:67], a[116:119], v[96:99]
  buffer_load_dwordx4 a[228:231], v4, s[60:63], s73 offen offset:3072
  v_mfma_f32_16x16x32_bf16 v[64:67], a[68:71], a[112:115], v[64:67]
  v_exp_f32_e64 v13, v13
  v_mfma_f32_16x16x32_bf16 v[100:103], a[68:71], a[116:119], v[100:103]
  s_waitcnt vmcnt(39) lgkmcnt(5)
  v_exp_f32 v14, v14
  v_mfma_f32_16x16x32_bf16 v[32:35], a[0:3], a[120:123], v[32:35]
  s_getpc_b64 s[94:95]
  ds_read_b128 a[36:39], v5 offset:9216
  v_mfma_f32_16x16x32_bf16 v[68:71], a[0:3], a[124:127], v[68:71]
  global_load_dword a248, v232, s[94:95]
  v_mfma_f32_16x16x32_bf16 v[36:39], a[4:7], a[120:123], v[36:39]
  s_waitcnt vmcnt(14)
  ds_write_b32 v107, v106
  v_mfma_f32_16x16x32_bf16 v[72:75], a[4:7], a[124:127], v[72:75]
  buffer_load_dwordx4 v110, s[16:19], s40 offen offset:2048 lds
  v_mfma_f32_16x16x32_bf16 v[40:43], a[8:11], a[120:123], v[40:43]
  s_lshl4_add_u32 s50, s87, 19
  ds_read_b128 a[40:43], v5 offset:11264
  v_mfma_f32_16x16x32_bf16 v[76:79], a[8:11], a[124:127], v[76:79]
  ds_read_b128 a[44:47], v5 offset:13312
  v_fma_f32 v23, v23, v188, v186
  v_mfma_f32_16x16x32_bf16 v[44:47], a[12:15], a[120:123], v[44:47]
  s_waitcnt lgkmcnt(4)
  ds_read_b128 a[48:51], v5 offset:15360
  v_mfma_f32_16x16x32_bf16 v[80:83], a[12:15], a[124:127], v[80:83]
  buffer_load_dwordx4 a[232:235], v7, s[60:63], s73 offen offset:0
  v_mfma_f32_16x16x32_bf16 v[48:51], a[16:19], a[120:123], v[48:51]
  ds_read_b128 a[52:55], v5 offset:17408
  v_readlane_b32 s71, v105, 12
  v_mfma_f32_16x16x32_bf16 v[84:87], a[16:19], a[124:127], v[84:87]
  ds_read_b128 a[56:59], v5 offset:19456
  v_fma_mix_f32 v16, v150, v16, 0 op_sel:[0,0,0] op_sel_hi:[1,0,0]
  v_mfma_f32_16x16x32_bf16 v[52:55], a[20:23], a[120:123], v[52:55]
  ds_read_b32 v109, v108
  v_add_u32_e64 v106, 1, v106
  v_mfma_f32_16x16x32_bf16 v[88:91], a[20:23], a[124:127], v[88:91]
  ds_read_b128 a[60:63], v5 offset:21504
  v_fma_mix_f32 v17, v150, v17, 0 op_sel:[1,0,0] op_sel_hi:[1,0,0]
  v_mfma_f32_16x16x32_bf16 v[56:59], a[24:27], a[120:123], v[56:59]
  buffer_load_dwordx4 v110, s[16:19], s40 offen offset:3072 lds
  v_mfma_f32_16x16x32_bf16 v[92:95], a[24:27], a[124:127], v[92:95]
  ds_read_b128 a[64:67], v5 offset:23552
  v_fma_mix_f32 v18, v151, v18, 0 op_sel:[0,0,0] op_sel_hi:[1,0,0]
  v_mfma_f32_16x16x32_bf16 v[60:63], a[28:31], a[120:123], v[60:63]
  ds_read_b128 a[68:71], v5 offset:25600
  v_fma_mix_f32 v19, v151, v19, 0 op_sel:[1,0,0] op_sel_hi:[1,0,0]
  v_mfma_f32_16x16x32_bf16 v[96:99], a[28:31], a[124:127], v[96:99]
  s_waitcnt lgkmcnt(3)
  v_cmp_gt_u32 vcc, s50, v109
  v_fma_mix_f32 v20, v116, v20, 0 op_sel:[0,0,0] op_sel_hi:[1,0,0]
  v_mfma_f32_16x16x32_bf16 v[64:67], a[32:35], a[120:123], v[64:67]
  v_exp_f32 v15, v15
  v_mfma_f32_16x16x32_bf16 v[100:103], a[32:35], a[124:127], v[100:103]
  v_readlane_b32 s40, v104, 11
  v_fma_mix_f32 v21, v116, v21, 0 op_sel:[1,0,0] op_sel_hi:[1,0,0]
  v_mfma_f32_16x16x32_bf16 v[32:35], a[36:39], a[128:131], v[32:35]
  s_cbranch_vccnz L_k5s_17
L_k5g_17:
  v_mfma_f32_16x16x32_bf16 v[68:71], a[36:39], a[132:135], v[68:71]
  ds_read_b128 a[0:3], v5 offset:26624
  v_fma_mix_f32 v22, v117, v22, 0 op_sel:[0,0,0] op_sel_hi:[1,0,0]
  v_mfma_f32_16x16x32_bf16 v[36:39], a[40:43], a[128:131], v[36:39]
  s_add_u32 m0, s41, 0
  ds_read_b128 a[4:7], v5 offset:28672
  v_mfma_f32_16x16x32_bf16 v[72:75], a[40:43], a[132:135], v[72:75]
  buffer_load_dwordx4 v4, s[16:19], s40 offen offset:0 lds
  v_mfma_f32_16x16x32_bf16 v[40:43], a[44:47], a[128:131], v[40:43]
  ds_read_b128 a[8:11], v5 offset:30720
  v_fma_mix_f32 v23, v117, v23, 0 op_sel:[1,0,0] op_sel_hi:[1,0,0]
  v_mfma_f32_16x16x32_bf16 v[76:79], a[44:47], a[132:135], v[76:79]
  ds_read_b128 a[12:15], v5 offset:32768
  v_fma_f32 v8, v8, v191, v191
  v_mfma_f32_16x16x32_bf16 v[44:47], a[48:51], a[128:131], v[44:47]
  s_waitcnt lgkmcnt(4)
  ds_read_b128 a[16:19], v5 offset:34816
  v_mfma_f32_16x16x32_bf16 v[80:83], a[48:51], a[132:135], v[80:83]
  buffer_load_dwordx4 a[236:239], v7, s[60:63], s73 offen offset:1024
  v_mfma_f32_16x16x32_bf16 v[48:51], a[52:55], a[128:131], v[48:51]
  ds_read_b128 a[20:23], v5 offset:36864
  v_fma_f32 v9, v9, v191, v191
  v_mfma_f32_16x16x32_bf16 v[84:87], a[52:55], a[132:135], v[84:87]
  ds_read_b128 a[24:27], v5 offset:38912
  v_fma_f32 v10, v10, v191, v191
  v_mfma_f32_16x16x32_bf16 v[52:55], a[56:59], a[128:131], v[52:55]
  ds_read_b128 a[28:31], v5 offset:40960
  v_fma_f32 v11, v11, v191, v191
  v_mfma_f32_16x16x32_bf16 v[88:91], a[56:59], a[132:135], v[88:91]
  buffer_load_dwordx4 v4, s[16:19], s40 offen offset:1024 lds
  v_mfma_f32_16x16x32_bf16 v[56:59], a[60:63], a[128:131], v[56:59]
  ds_read_b128 a[32:35], v5 offset:43008
  v_fma_f32 v12, v12, v191, v191
  v_mfma_f32_16x16x32_bf16 v[92:95], a[60:63], a[132:135], v[92:95]
  v_exp_f32_e64 v16, v16
  v_mfma_f32_16x16x32_bf16 v[60:63], a[64:67], a[128:131], v[60:63]
  v_exp_f32_e64 v17, v17
  v_mfma_f32_16x16x32_bf16 v[96:99], a[64:67], a[132:135], v[96:99]
  buffer_load_dwordx4 a[240:243], v7, s[60:63], s73 offen offset:2048
  v_mfma_f32_16x16x32_bf16 v[64:67], a[68:71], a[128:131], v[64:67]
  v_exp_f32_e64 v18, v18
  v_mfma_f32_16x16x32_bf16 v[100:103], a[68:71], a[132:135], v[100:103]
  s_waitcnt vmcnt(36) lgkmcnt(5)
  v_exp_f32 v19, v19
  v_mfma_f32_16x16x32_bf16 v[32:35], a[0:3], a[136:139], v[32:35]
  ds_read_b128 a[36:39], v5 offset:27648
  v_fma_f32 v13, v13, v191, v191
  v_mfma_f32_16x16x32_bf16 v[68:71], a[0:3], a[140:143], v[68:71]
  buffer_load_dwordx4 v4, s[16:19], s40 offen offset:2048 lds
  v_mfma_f32_16x16x32_bf16 v[36:39], a[4:7], a[136:139], v[36:39]
  s_waitcnt vmcnt(13)
  ds_write_b32 v107, v106
  v_mfma_f32_16x16x32_bf16 v[72:75], a[4:7], a[140:143], v[72:75]
  ds_read_b128 a[40:43], v5 offset:29696
  v_fma_f32 v14, v14, v191, v191
  v_mfma_f32_16x16x32_bf16 v[40:43], a[8:11], a[136:139], v[40:43]
  ds_read_b128 a[44:47], v5 offset:31744
  v_fma_f32 v15, v15, v191, v191
  v_mfma_f32_16x16x32_bf16 v[76:79], a[8:11], a[140:143], v[76:79]
  buffer_load_dwordx4 a[244:247], v7, s[60:63], s73 offen offset:3072
  v_mfma_f32_16x16x32_bf16 v[44:47], a[12:15], a[136:139], v[44:47]
  s_waitcnt lgkmcnt(4)
  ds_read_b128 a[48:51], v5 offset:33792
  v_mfma_f32_16x16x32_bf16 v[80:83], a[12:15], a[140:143], v[80:83]
  ds_read_b128 a[52:55], v5 offset:35840
  v_fma_mix_f32 v164, v120, v24, 0 op_sel:[0,0,0] op_sel_hi:[1,0,0]
  v_mfma_f32_16x16x32_bf16 v[48:51], a[16:19], a[136:139], v[48:51]
  ds_read_b128 a[56:59], v5 offset:37888
  v_fma_mix_f32 v165, v120, v25, 0 op_sel:[1,0,0] op_sel_hi:[1,0,0]
  v_mfma_f32_16x16x32_bf16 v[84:87], a[16:19], a[140:143], v[84:87]
  buffer_load_dwordx4 v4, s[16:19], s40 offen offset:3072 lds
  v_mfma_f32_16x16x32_bf16 v[52:55], a[20:23], a[136:139], v[52:55]
  ds_read_b32 v109, v108
  v_add_u32 v106, 1, v106
  v_mfma_f32_16x16x32_bf16 v[88:91], a[20:23], a[140:143], v[88:91]
  s_add_u32 m0, s42, 0
  ds_read_b128 a[60:63], v5 offset:39936
  v_mfma_f32_16x16x32_bf16 v[56:59], a[24:27], a[136:139], v[56:59]
  ds_read_b128 a[64:67], v5 offset:41984
  v_fma_mix_f32 v166, v121, v26, 0 op_sel:[0,0,0] op_sel_hi:[1,0,0]
  v_mfma_f32_16x16x32_bf16 v[92:95], a[24:27], a[140:143], v[92:95]
  buffer_load_dwordx4 a[184:187], v4, s[60:63], s71 offen offset:0
  v_mfma_f32_16x16x32_bf16 v[60:63], a[28:31], a[136:139], v[60:63]
  ds_read_b128 a[68:71], v5 offset:44032
  v_fma_mix_f32 v167, v121, v27, 0 op_sel:[1,0,0] op_sel_hi:[1,0,0]
  v_mfma_f32_16x16x32_bf16 v[96:99], a[28:31], a[140:143], v[96:99]
  s_waitcnt lgkmcnt(3)
  v_cmp_gt_u32 vcc, 20, v109
  v_fma_mix_f32 v168, v124, v28, 0 op_sel:[0,0,0] op_sel_hi:[1,0,0]
  v_mfma_f32_16x16x32_bf16 v[64:67], a[32:35], a[136:139], v[64:67]
  buffer_load_dwordx4 v111, s[16:19], s40 offen offset:0 lds
  v_mfma_f32_16x16x32_bf16 v[100:103], a[32:35], a[140:143], v[100:103]
  v_exp_f32_e64 v20, v20
  v_mfma_f32_16x16x32_bf16 v[32:35], a[36:39], a[144:147], v[32:35]
  s_cbranch_vccnz L_k5s_18
L_k5g_18:
  v_mfma_f32_16x16x32_bf16 v[68:71], a[36:39], a[148:151], v[68:71]
  ds_read_b128 a[0:3], v5 offset:45056
  v_fma_mix_f32 v169, v124, v29, 0 op_sel:[1,0,0] op_sel_hi:[1,0,0]
  v_mfma_f32_16x16x32_bf16 v[36:39], a[40:43], a[144:147], v[36:39]
  s_add_u32 m0, s41, 18432
  ds_read_b128 a[4:7], v5 offset:47104
  v_mfma_f32_16x16x32_bf16 v[72:75], a[40:43], a[148:151], v[72:75]
  buffer_load_dwordx4 v110, s[16:19], s40 offen offset:0 lds
  v_mfma_f32_16x16x32_bf16 v[40:43], a[44:47], a[144:147], v[40:43]
  ds_read_b128 a[8:11], v5 offset:49152
  v_fma_mix_f32 v170, v125, v30, 0 op_sel:[0,0,0] op_sel_hi:[1,0,0]
  v_mfma_f32_16x16x32_bf16 v[76:79], a[44:47], a[148:151], v[76:79]
  ds_read_b128 a[12:15], v5 offset:51200
  v_fma_mix_f32 v171, v125, v31, 0 op_sel:[1,0,0] op_sel_hi:[1,0,0]
  v_mfma_f32_16x16x32_bf16 v[44:47], a[48:51], a[144:147], v[44:47]
  s_waitcnt lgkmcnt(4)
  ds_read_b128 a[16:19], v5 offset:53248
  v_mfma_f32_16x16x32_bf16 v[80:83], a[48:51], a[148:151], v[80:83]
  buffer_load_dwordx4 a[188:191], v4, s[60:63], s71 offen offset:1024
  v_mfma_f32_16x16x32_bf16 v[48:51], a[52:55], a[144:147], v[48:51]
  ds_read_b128 a[20:23], v5 offset:55296
  v_fma_mix_f32 v24, v140, v140, 0 op_sel:[0,0,0] op_sel_hi:[1,1,0]
  v_mfma_f32_16x16x32_bf16 v[84:87], a[52:55], a[148:151], v[84:87]
  ds_read_b128 a[24:27], v5 offset:57344
  v_fma_mix_f32 v25, v140, v140, 0 op_sel:[1,1,0] op_sel_hi:[1,1,0]
  v_mfma_f32_16x16x32_bf16 v[52:55], a[56:59], a[144:147], v[52:55]
  ds_read_b128 a[28:31], v5 offset:59392
  v_fma_mix_f32 v26, v141, v141, 0 op_sel:[0,0,0] op_sel_hi:[1,1,0]
  v_mfma_f32_16x16x32_bf16 v[88:91], a[56:59], a[148:151], v[88:91]
  buffer_load_dwordx4 v110, s[16:19], s40 offen offset:1024 lds
  v_mfma_f32_16x16x32_bf16 v[56:59], a[60:63], a[144:147], v[56:59]
  ds_read_b128 a[32:35], v5 offset:61440
  v_fma_mix_f32 v27, v141, v141, 0 op_sel:[1,1,0] op_sel_hi:[1,1,0]
  v_mfma_f32_16x16x32_bf16 v[92:95], a[60:63], a[148:151], v[92:95]
  v_exp_f32_e64 v21, v21
  v_mfma_f32_16x16x32_bf16 v[60:63], a[64:67], a[144:147], v[60:63]
  v_exp_f32_e64 v22, v22
  v_mfma_f32_16x16x32_bf16 v[96:99], a[64:67], a[148:151], v[96:99]
  buffer_load_dwordx4 a[192:195], v4, s[60:63], s71 offen offset:2048
  v_mfma_f32_16x16x32_bf16 v[64:67], a[68:71], a[144:147], v[64:67]
  v_exp_f32 v23, v23
  v_mfma_f32_16x16x32_bf16 v[100:103], a[68:71], a[148:151], v[100:103]
  s_waitcnt vmcnt(35) lgkmcnt(5)
  v_rcp_f32 v8, v8
  v_mfma_f32_16x16x32_bf16 v[32:35], a[0:3], a[152:155], v[32:35]
  ds_read_b128 a[36:39], v5 offset:46080
  v_fma_f32 v16, v16, v191, v191
  v_mfma_f32_16x16x32_bf16 v[68:71], a[0:3], a[156:159], v[68:71]
  ds_read_b128 a[40:43], v5 offset:48128
  v_fma_f32 v17, v17, v191, v191
  v_mfma_f32_16x16x32_bf16 v[36:39], a[4:7], a[152:155], v[36:39]
  s_waitcnt vmcnt(13)
  ds_write_b32 v107, v106
  v_mfma_f32_16x16x32_bf16 v[72:75], a[4:7], a[156:159], v[72:75]
  buffer_load_dwordx4 v110, s[16:19], s40 offen offset:2048 lds
  v_mfma_f32_16x16x32_bf16 v[40:43], a[8:11], a[152:155], v[40:43]
  s_lshl4_add_u32 s50, s87, 21
  ds_read_b128 a[44:47], v5 offset:50176
  v_mfma_f32_16x16x32_bf16 v[76:79], a[8:11], a[156:159], v[76:79]
  ds_read_b128 a[48:51], v5 offset:52224
  v_fma_f32 v18, v18, v191, v191
  v_mfma_f32_16x16x32_bf16 v[44:47], a[12:15], a[152:155], v[44:47]
  s_waitcnt lgkmcnt(5)
  ds_read_b128 a[52:55], v5 offset:54272
  v_mfma_f32_16x16x32_bf16 v[80:83], a[12:15], a[156:159], v[80:83]
  buffer_load_dwordx4 a[196:199], v4, s[60:63], s71 offen offset:3072
  v_mfma_f32_16x16x32_bf16 v[48:51], a[16:19], a[152:155], v[48:51]
  ds_read_b128 a[56:59], v5 offset:56320
  v_fma_f32 v19, v19, v191, v191
  v_mfma_f32_16x16x32_bf16 v[84:87], a[16:19], a[156:159], v[84:87]
  ds_read_b128 a[60:63], v5 offset:58368
  v_fma_f32 v20, v20, v190, v190
  v_mfma_f32_16x16x32_bf16 v[52:55], a[20:23], a[152:155], v[52:55]
  ds_read_b32 v109, v108
  v_add_u32_e64 v106, 1, v106
  v_mfma_f32_16x16x32_bf16 v[88:91], a[20:23], a[156:159], v[88:91]
  ds_read_b128 a[64:67], v5 offset:60416
  v_fma_f32 v21, v21, v190, v190
  v_mfma_f32_16x16x32_bf16 v[56:59], a[24:27], a[152:155], v[56:59]
  buffer_load_dwordx4 v110, s[16:19], s40 offen offset:3072 lds
  v_mfma_f32_16x16x32_bf16 v[92:95], a[24:27], a[156:159], v[92:95]
  ds_read_b128 a[68:71], v5 offset:62464
  v_fma_f32 v22, v22, v190, v190
  v_mfma_f32_16x16x32_bf16 v[60:63], a[28:31], a[152:155], v[60:63]
  v_rcp_f32_e64 v9, v9
  v_mfma_f32_16x16x32_bf16 v[96:99], a[28:31], a[156:159], v[96:99]
  s_waitcnt lgkmcnt(2)
  v_cmp_gt_u32 vcc, s50, v109
  v_fma_f32 v23, v23, v190, v190
  v_mfma_f32_16x16x32_bf16 v[64:67], a[32:35], a[152:155], v[64:67]
  v_rcp_f32_e64 v16, v16
  v_mfma_f32_16x16x32_bf16 v[100:103], a[32:35], a[156:159], v[100:103]
  v_readlane_b32 s40, v104, 12
  v_fma_mix_f32 v28, v144, v144, 0 op_sel:[0,0,0] op_sel_hi:[1,1,0]
  v_mfma_f32_16x16x32_bf16 v[32:35], a[36:39], a[160:163], v[32:35]
  s_cbranch_vccnz L_k5s_19
L_k5g_19:
  v_mfma_f32_16x16x32_bf16 v[68:71], a[36:39], a[164:167], v[68:71]
  ds_read_b128 a[0:3], v5 offset:63488
  v_fma_mix_f32 v29, v144, v144, 0 op_sel:[1,1,0] op_sel_hi:[1,1,0]
  v_mfma_f32_16x16x32_bf16 v[36:39], a[40:43], a[160:163], v[36:39]
  s_add_u32 m0, s41, 36864
  ds_read_b128 a[4:7], v6 offset:0
  v_mfma_f32_16x16x32_bf16 v[72:75], a[40:43], a[164:167], v[72:75]
  buffer_load_dwordx4 v4, s[16:19], s40 offen offset:0 lds
  v_mfma_f32_16x16x32_bf16 v[40:43], a[44:47], a[160:163], v[40:43]
  ds_read_b128 a[8:11], v6 offset:2048
  v_fma_mix_f32 v30, v145, v145, 0 op_sel:[0,0,0] op_sel_hi:[1,1,0]
  v_mfma_f32_16x16x32_bf16 v[76:79], a[44:47], a[164:167], v[76:79]
  ds_read_b128 a[12:15], v6 offset:4096
  v_fma_mix_f32 v31, v145, v145, 0 op_sel:[1,1,0] op_sel_hi:[1,1,0]
  v_mfma_f32_16x16x32_bf16 v[44:47], a[48:51], a[160:163], v[44:47]
  s_waitcnt lgkmcnt(4)
  ds_read_b128 a[16:19], v6 offset:6144
  v_mfma_f32_16x16x32_bf16 v[80:83], a[48:51], a[164:167], v[80:83]
  buffer_load_dwordx4 a[200:203], v7, s[60:63], s71 offen offset:0
  v_mfma_f32_16x16x32_bf16 v[48:51], a[52:55], a[160:163], v[48:51]
  ds_read_b128 a[20:23], v6 offset:8192
  v_fma_f32 v24, v24, v188, v186
  v_mfma_f32_16x16x32_bf16 v[84:87], a[52:55], a[164:167], v[84:87]
  ds_read_b128 a[24:27], v6 offset:10240
  v_fma_f32 v25, v25, v188, v186
  v_mfma_f32_16x16x32_bf16 v[52:55], a[56:59], a[160:163], v[52:55]
  ds_read_b128 a[28:31], v6 offset:12288
  v_fma_f32 v26, v26, v188, v186
  v_mfma_f32_16x16x32_bf16 v[88:91], a[56:59], a[164:167], v[88:91]
  buffer_load_dwordx4 v4, s[16:19], s40 offen offset:1024 lds
  v_mfma_f32_16x16x32_bf16 v[56:59], a[60:63], a[160:163], v[56:59]
  ds_read_b128 a[32:35], v6 offset:14336
  v_fma_f32 v27, v27, v188, v186
  v_mfma_f32_16x16x32_bf16 v[92:95], a[60:63], a[164:167], v[92:95]
  v_rcp_f32_e64 v17, v17
  v_mfma_f32_16x16x32_bf16 v[60:63], a[64:67], a[160:163], v[60:63]
  v_rcp_f32_e64 v10, v10
  v_mfma_f32_16x16x32_bf16 v[96:99], a[64:67], a[164:167], v[96:99]
  buffer_load_dwordx4 a[204:207], v7, s[60:63], s71 offen offset:1024
  v_mfma_f32_16x16x32_bf16 v[64:67], a[68:71], a[160:163], v[64:67]
  v_rcp_f32_e64 v18, v18
  v_mfma_f32_16x16x32_bf16 v[100:103], a[68:71], a[164:167], v[100:103]
  s_waitcnt vmcnt(33) lgkmcnt(5)
  v_rcp_f32 v11, v11
  v_mfma_f32_16x16x32_bf16 v[32:35], a[0:3], a[168:171], v[32:35]
  ds_read_b128 a[36:39], v5 offset:64512
  v_fma_f32 v28, v28, v188, v186
  v_mfma_f32_16x16x32_bf16 v[68:71], a[0:3], a[172:175], v[68:71]
  buffer_load_dwordx4 v4, s[16:19], s40 offen offset:2048 lds
  v_mfma_f32_16x16x32_bf16 v[36:39], a[4:7], a[168:171], v[36:39]
  s_waitcnt vmcnt(12)
  ds_write_b32 v107, v106
  v_mfma_f32_16x16x32_bf16 v[72:75], a[4:7], a[172:175], v[72:75]
  ds_read_b128 a[40:43], v6 offset:1024
  v_fma_f32 v29, v29, v188, v186
  v_mfma_f32_16x16x32_bf16 v[40:43], a[8:11], a[168:171], v[40:43]
  ds_read_b128 a[44:47], v6 offset:3072
  v_fma_f32 v30, v30, v188, v186
  v_mfma_f32_16x16x32_bf16 v[76:79], a[8:11], a[172:175], v[76:79]
  buffer_load_dwordx4 a[208:211], v7, s[60:63], s71 offen offset:2048
  v_mfma_f32_16x16x32_bf16 v[44:47], a[12:15], a[168:171], v[44:47]
  s_waitcnt lgkmcnt(4)
  ds_read_b128 a[48:51], v6 offset:5120
  v_mfma_f32_16x16x32_bf16 v[80:83], a[12:15], a[172:175], v[80:83]
  ds_read_b128 a[52:55], v6 offset:7168
  v_fma_f32 v31, v31, v188, v186
  v_mfma_f32_16x16x32_bf16 v[48:51], a[16:19], a[168:171], v[48:51]
  ds_read_b128 a[56:59], v6 offset:9216
  v_readlane_b32 s73, v105, 13
  v_mfma_f32_16x16x32_bf16 v[84:87], a[16:19], a[172:175], v[84:87]
  buffer_load_dwordx4 v4, s[16:19], s40 offen offset:3072 lds
  v_mfma_f32_16x16x32_bf16 v[52:55], a[20:23], a[168:171], v[52:55]
  ds_read_b32 v109, v108
  v_add_u32_e64 v106, 1, v106
  v_mfma_f32_16x16x32_bf16 v[88:91], a[20:23], a[172:175], v[88:91]
  s_add_u32 m0, s42, 36864
  ds_read_b128 a[60:63], v6 offset:11264
  v_mfma_f32_16x16x32_bf16 v[56:59], a[24:27], a[168:171], v[56:59]
  ds_read_b128 a[64:67], v6 offset:13312
  v_fma_mix_f32 v24, v140, v24, 0 op_sel:[0,0,0] op_sel_hi:[1,0,0]
  v_mfma_f32_16x16x32_bf16 v[92:95], a[24:27], a[172:175], v[92:95]
  buffer_load_dwordx4 a[212:215], v7, s[60:63], s71 offen offset:3072
  v_mfma_f32_16x16x32_bf16 v[60:63], a[28:31], a[168:171], v[60:63]
  ds_read_b128 a[68:71], v6 offset:15360
  v_fma_mix_f32 v25, v140, v25, 0 op_sel:[1,0,0] op_sel_hi:[1,0,0]
  v_mfma_f32_16x16x32_bf16 v[96:99], a[28:31], a[172:175], v[96:99]
  s_waitcnt lgkmcnt(3)
  v_cmp_gt_u32 vcc, 22, v109
  v_fma_mix_f32 v26, v141, v26, 0 op_sel:[0,0,0] op_sel_hi:[1,0,0]
  v_mfma_f32_16x16x32_bf16 v[64:67], a[32:35], a[168:171], v[64:67]
  buffer_load_dwordx4 v111, s[16:19], s40 offen offset:0 lds
  v_mfma_f32_16x16x32_bf16 v[100:103], a[32:35], a[172:175], v[100:103]
  v_rcp_f32_e64 v19, v19
  v_mfma_f32_16x16x32_bf16 v[32:35], a[36:39], a[176:179], v[32:35]
  s_cbranch_vccnz L_k5s_20
L_k5g_20:
  v_mfma_f32_16x16x32_bf16 v[68:71], a[36:39], a[180:183], v[68:71]
  ds_read_b128 a[0:3], v4 offset:0
  v_fma_mix_f32 v27, v141, v27, 0 op_sel:[1,0,0] op_sel_hi:[1,0,0]
  v_mfma_f32_16x16x32_bf16 v[36:39], a[40:43], a[176:179], v[36:39]
  s_add_u32 m0, s41, 55296
  ds_read_b128 a[4:7], v4 offset:2048
  v_mfma_f32_16x16x32_bf16 v[72:75], a[40:43], a[180:183], v[72:75]
  buffer_load_dwordx4 v110, s[16:19], s40 offen offset:0 lds
  v_mfma_f32_16x16x32_bf16 v[40:43], a[44:47], a[176:179], v[40:43]
  ds_read_b128 a[8:11], v4 offset:4096
  v_fma_mix_f32 v28, v144, v28, 0 op_sel:[0,0,0] op_sel_hi:[1,0,0]
  v_mfma_f32_16x16x32_bf16 v[76:79], a[44:47], a[180:183], v[76:79]
  ds_read_b128 a[12:15], v4 offset:6144
  v_fma_mix_f32 v29, v144, v29, 0 op_sel:[1,0,0] op_sel_hi:[1,0,0]
  v_mfma_f32_16x16x32_bf16 v[44:47], a[48:51], a[176:179], v[44:47]
  s_waitcnt lgkmcnt(4)
  ds_read_b128 a[16:19], v4 offset:8192
  v_mfma_f32_16x16x32_bf16 v[80:83], a[48:51], a[180:183], v[80:83]
  buffer_load_dwordx4 a[72:75], v4, s[60:63], s73 offen offset:0
  v_mfma_f32_16x16x32_bf16 v[48:51], a[52:55], a[176:179], v[48:51]
  ds_read_b128 a[20:23], v4 offset:10240
  v_fma_mix_f32 v30, v145, v30, 0 op_sel:[0,0,0] op_sel_hi:[1,0,0]
  v_mfma_f32_16x16x32_bf16 v[84:87], a[52:55], a[180:183], v[84:87]
  ds_read_b128 a[24:27], v4 offset:12288
  v_fma_mix_f32 v31, v145, v31, 0 op_sel:[1,0,0] op_sel_hi:[1,0,0]
  v_mfma_f32_16x16x32_bf16 v[52:55], a[56:59], a[176:179], v[52:55]
  ds_read_b128 a[28:31], v4 offset:14336
  v_mfma_f32_16x16x32_bf16 v[88:91], a[56:59], a[180:183], v[88:91]
  buffer_load_dwordx4 v110, s[16:19], s40 offen offset:1024 lds
  v_mfma_f32_16x16x32_bf16 v[56:59], a[60:63], a[176:179], v[56:59]
  ds_read_b128 a[32:35], v4 offset:16384
  v_mfma_f32_16x16x32_bf16 v[92:95], a[60:63], a[180:183], v[92:95]
  v_rcp_f32_e64 v12, v12
  v_mfma_f32_16x16x32_bf16 v[60:63], a[64:67], a[176:179], v[60:63]
  v_rcp_f32_e64 v20, v20
  v_mfma_f32_16x16x32_bf16 v[96:99], a[64:67], a[180:183], v[96:99]
  buffer_load_dwordx4 a[76:79], v4, s[60:63], s73 offen offset:1024
  v_mfma_f32_16x16x32_bf16 v[64:67], a[68:71], a[176:179], v[64:67]
  v_rcp_f32_e64 v13, v13
  v_mfma_f32_16x16x32_bf16 v[100:103], a[68:71], a[180:183], v[100:103]
  s_waitcnt vmcnt(33) lgkmcnt(5)
  v_rcp_f32 v21, v21
  v_mfma_f32_16x16x32_bf16 v[32:35], a[0:3], a[216:219], v[32:35]
  s_getpc_b64 s[94:95]
  ds_read_b128 a[36:39], v4 offset:1024
  v_mfma_f32_16x16x32_bf16 v[68:71], a[0:3], a[220:223], v[68:71]
  global_load_dword a248, v232, s[94:95]
  v_mfma_f32_16x16x32_bf16 v[36:39], a[4:7], a[216:219], v[36:39]
  s_waitcnt vmcnt(14)
  ds_write_b32 v107, v106
  v_mfma_f32_16x16x32_bf16 v[72:75], a[4:7], a[220:223], v[72:75]
  buffer_load_dwordx4 v110, s[16:19], s40 offen offset:2048 lds
  v_mfma_f32_16x16x32_bf16 v[40:43], a[8:11], a[216:219], v[40:43]
  s_lshl4_add_u32 s50, s87, 23
  ds_read_b128 a[40:43], v4 offset:3072
  v_mfma_f32_16x16x32_bf16 v[76:79], a[8:11], a[220:223], v[76:79]
  ds_read_b128 a[44:47], v4 offset:5120
  v_mfma_f32_16x16x32_bf16 v[44:47], a[12:15], a[216:219], v[44:47]
  s_waitcnt lgkmcnt(4)
  ds_read_b128 a[48:51], v4 offset:7168
  v_mfma_f32_16x16x32_bf16 v[80:83], a[12:15], a[220:223], v[80:83]
  buffer_load_dwordx4 a[80:83], v4, s[60:63], s73 offen offset:2048
  v_mfma_f32_16x16x32_bf16 v[48:51], a[16:19], a[216:219], v[48:51]
  ds_read_b128 a[52:55], v4 offset:9216
  v_mfma_f32_16x16x32_bf16 v[84:87], a[16:19], a[220:223], v[84:87]
  ds_read_b128 a[56:59], v4 offset:11264
  v_mfma_f32_16x16x32_bf16 v[52:55], a[20:23], a[216:219], v[52:55]
  ds_read_b32 v109, v108
  v_add_u32_e64 v106, 1, v106
  v_mfma_f32_16x16x32_bf16 v[88:91], a[20:23], a[220:223], v[88:91]
  ds_read_b128 a[60:63], v4 offset:13312
  v_mfma_f32_16x16x32_bf16 v[56:59], a[24:27], a[216:219], v[56:59]
  buffer_load_dwordx4 v110, s[16:19], s40 offen offset:3072 lds
  v_mfma_f32_16x16x32_bf16 v[92:95], a[24:27], a[220:223], v[92:95]
  ds_read_b128 a[64:67], v4 offset:15360
  v_mfma_f32_16x16x32_bf16 v[60:63], a[28:31], a[216:219], v[60:63]
  ds_read_b128 a[68:71], v4 offset:17408
  v_mfma_f32_16x16x32_bf16 v[96:99], a[28:31], a[220:223], v[96:99]
  s_waitcnt lgkmcnt(3)
  v_cmp_gt_u32 vcc, s50, v109
  v_mfma_f32_16x16x32_bf16 v[64:67], a[32:35], a[216:219], v[64:67]
  v_rcp_f32_e64 v14, v14
  v_mfma_f32_16x16x32_bf16 v[100:103], a[32:35], a[220:223], v[100:103]
  v_readlane_b32 s40, v104, 13
  v_mfma_f32_16x16x32_bf16 v[32:35], a[36:39], a[224:227], v[32:35]
  s_cbranch_vccnz L_k5s_21
L_k5g_21:
  v_mfma_f32_16x16x32_bf16 v[68:71], a[36:39], a[228:231], v[68:71]
  ds_read_b128 a[0:3], v4 offset:18432
  v_mfma_f32_16x16x32_bf16 v[36:39], a[40:43], a[224:227], v[36:39]
  s_add_u32 m0, s41, 73728
  ds_read_b128 a[4:7], v4 offset:20480
  v_mfma_f32_16x16x32_bf16 v[72:75], a[40:43], a[228:231], v[72:75]
  buffer_load_dwordx4 v4, s[16:19], s40 offen offset:0 lds
  v_mfma_f32_16x16x32_bf16 v[40:43], a[44:47], a[224:227], v[40:43]
  ds_read_b128 a[8:11], v4 offset:22528
  v_mfma_f32_16x16x32_bf16 v[76:79], a[44:47], a[228:231], v[76:79]
  ds_read_b128 a[12:15], v4 offset:24576
  v_mfma_f32_16x16x32_bf16 v[44:47], a[48:51], a[224:227], v[44:47]
  s_waitcnt lgkmcnt(4)
  ds_read_b128 a[16:19], v4 offset:26624
  v_mfma_f32_16x16x32_bf16 v[80:83], a[48:51], a[228:231], v[80:83]
  buffer_load_dwordx4 a[84:87], v4, s[60:63], s73 offen offset:3072
  v_mfma_f32_16x16x32_bf16 v[48:51], a[52:55], a[224:227], v[48:51]
  ds_read_b128 a[20:23], v4 offset:28672
  v_mfma_f32_16x16x32_bf16 v[84:87], a[52:55], a[228:231], v[84:87]
  ds_read_b128 a[24:27], v4 offset:30720
  v_mfma_f32_16x16x32_bf16 v[52:55], a[56:59], a[224:227], v[52:55]
  ds_read_b128 a[28:31], v4 offset:32768
  v_mfma_f32_16x16x32_bf16 v[88:91], a[56:59], a[228:231], v[88:91]
  buffer_load_dwordx4 v4, s[16:19], s40 offen offset:1024 lds
  v_mfma_f32_16x16x32_bf16 v[56:59], a[60:63], a[224:227], v[56:59]
  ds_read_b128 a[32:35], v4 offset:34816
  v_mfma_f32_16x16x32_bf16 v[92:95], a[60:63], a[228:231], v[92:95]
  v_rcp_f32_e64 v22, v22
  v_mfma_f32_16x16x32_bf16 v[60:63], a[64:67], a[224:227], v[60:63]
  v_rcp_f32_e64 v15, v15
  v_mfma_f32_16x16x32_bf16 v[96:99], a[64:67], a[228:231], v[96:99]
  buffer_load_dwordx4 a[88:91], v7, s[60:63], s73 offen offset:0
  v_mfma_f32_16x16x32_bf16 v[64:67], a[68:71], a[224:227], v[64:67]
  v_rcp_f32_e64 v23, v23
  v_mfma_f32_16x16x32_bf16 v[100:103], a[68:71], a[228:231], v[100:103]
  s_waitcnt vmcnt(31) lgkmcnt(5)
  v_exp_f32 v24, v24
  v_mfma_f32_16x16x32_bf16 v[32:35], a[0:3], a[232:235], v[32:35]
  ds_read_b128 a[36:39], v4 offset:19456
  v_fma_mix_f32 v220, v142, v8, 0 op_sel:[0,0,0] op_sel_hi:[1,0,0]
  v_mfma_f32_16x16x32_bf16 v[68:71], a[0:3], a[236:239], v[68:71]
  buffer_load_dwordx4 v4, s[16:19], s40 offen offset:2048 lds
  v_mfma_f32_16x16x32_bf16 v[36:39], a[4:7], a[232:235], v[36:39]
  s_waitcnt vmcnt(13)
  ds_write_b32 v107, v106
  v_mfma_f32_16x16x32_bf16 v[72:75], a[4:7], a[236:239], v[72:75]
  ds_read_b128 a[40:43], v4 offset:21504
  v_fma_mix_f32 v228, v150, v16, 0 op_sel:[0,0,0] op_sel_hi:[1,0,0]
  v_mfma_f32_16x16x32_bf16 v[40:43], a[8:11], a[232:235], v[40:43]
  ds_read_b128 a[44:47], v4 offset:23552
  v_fma_mix_f32 v221, v142, v9, 0 op_sel:[1,0,0] op_sel_hi:[1,0,0]
  v_mfma_f32_16x16x32_bf16 v[76:79], a[8:11], a[236:239], v[76:79]
  buffer_load_dwordx4 a[92:95], v7, s[60:63], s73 offen offset:1024
  v_mfma_f32_16x16x32_bf16 v[44:47], a[12:15], a[232:235], v[44:47]
  s_waitcnt lgkmcnt(4)
  ds_read_b128 a[48:51], v4 offset:25600
  v_mfma_f32_16x16x32_bf16 v[80:83], a[12:15], a[236:239], v[80:83]
  ds_read_b128 a[52:55], v4 offset:27648
  v_fma_mix_f32 v229, v150, v17, 0 op_sel:[1,0,0] op_sel_hi:[1,0,0]
  v_mfma_f32_16x16x32_bf16 v[48:51], a[16:19], a[232:235], v[48:51]
  ds_read_b128 a[56:59], v4 offset:29696
  v_readlane_b32 s71, v105, 14
  v_mfma_f32_16x16x32_bf16 v[84:87], a[16:19], a[236:239], v[84:87]
  buffer_load_dwordx4 v4, s[16:19], s40 offen offset:3072 lds
  v_mfma_f32_16x16x32_bf16 v[52:55], a[20:23], a[232:235], v[52:55]
  ds_read_b32 v109, v108
  v_add_u32_e64 v106, 1, v106
  v_mfma_f32_16x16x32_bf16 v[88:91], a[20:23], a[236:239], v[88:91]
  s_add_u32 m0, s42, 73728
  ds_read_b128 a[60:63], v4 offset:31744
  v_mfma_f32_16x16x32_bf16 v[56:59], a[24:27], a[232:235], v[56:59]
  ds_read_b128 a[64:67], v4 offset:33792
  s_nop 0
L_pg_20:
  s_cbranch_execz L_wr_3
  v_fma_mix_f32 v222, v143, v10, 0 op_sel:[0,0,0] op_sel_hi:[1,0,0]
  v_mfma_f32_16x16x32_bf16 v[92:95], a[24:27], a[236:239], v[92:95]
  ds_read_b128 a[68:71], v4 offset:35840
  v_fma_mix_f32 v230, v151, v18, 0 op_sel:[0,0,0] op_sel_hi:[1,0,0]
  v_mfma_f32_16x16x32_bf16 v[60:63], a[28:31], a[232:235], v[60:63]
  buffer_load_dwordx4 v111, s[16:19], s40 offen offset:0 lds
  v_mfma_f32_16x16x32_bf16 v[96:99], a[28:31], a[236:239], v[96:99]
  s_waitcnt lgkmcnt(3)
  v_cmp_gt_u32 vcc, 24, v109
  v_fma_mix_f32 v223, v143, v11, 0 op_sel:[1,0,0] op_sel_hi:[1,0,0]
  v_mfma_f32_16x16x32_bf16 v[64:67], a[32:35], a[232:235], v[64:67]
  v_exp_f32_e64 v25, v25
  v_mfma_f32_16x16x32_bf16 v[100:103], a[32:35], a[236:239], v[100:103]
  v_exp_f32_e64 v26, v26
  v_mfma_f32_16x16x32_bf16 v[32:35], a[36:39], a[240:243], v[32:35]
  s_cbranch_vccnz L_k5s_22
L_k5g_22:
  v_mfma_f32_16x16x32_bf16 v[68:71], a[36:39], a[244:247], v[68:71]
  ds_read_b128 a[0:3], v4 offset:36864
  v_fma_mix_f32 v224, v146, v12, 0 op_sel:[0,0,0] op_sel_hi:[1,0,0]
  v_mfma_f32_16x16x32_bf16 v[36:39], a[40:43], a[240:243], v[36:39]
  s_add_u32 m0, s41, 92160
  ds_read_b128 a[4:7], v4 offset:38912
  v_mfma_f32_16x16x32_bf16 v[72:75], a[40:43], a[244:247], v[72:75]
  buffer_load_dwordx4 v110, s[16:19], s40 offen offset:0 lds
  v_mfma_f32_16x16x32_bf16 v[40:43], a[44:47], a[240:243], v[40:43]
  ds_read_b128 a[8:11], v4 offset:40960
  v_fma_mix_f32 v225, v146, v13, 0 op_sel:[1,0,0] op_sel_hi:[1,0,0]
  v_mfma_f32_16x16x32_bf16 v[76:79], a[44:47], a[244:247], v[76:79]
  ds_read_b128 a[12:15], v4 offset:43008
  v_fma_mix_f32 v226, v147, v14, 0 op_sel:[0,0,0] op_sel_hi:[1,0,0]
  v_mfma_f32_16x16x32_bf16 v[44:47], a[48:51], a[240:243], v[44:47]
  s_waitcnt lgkmcnt(4)
  ds_read_b128 a[16:19], v4 offset:45056
  v_mfma_f32_16x16x32_bf16 v[80:83], a[48:51], a[244:247], v[80:83]
  buffer_load_dwordx4 a[96:99], v7, s[60:63], s73 offen offset:2048
  v_mfma_f32_16x16x32_bf16 v[48:51], a[52:55], a[240:243], v[48:51]
  ds_read_b128 a[20:23], v4 offset:47104
  v_fma_mix_f32 v227, v147, v15, 0 op_sel:[1,0,0] op_sel_hi:[1,0,0]
  v_mfma_f32_16x16x32_bf16 v[84:87], a[52:55], a[244:247], v[84:87]
  ds_read_b128 a[24:27], v4 offset:49152
  v_fma_mix_f32 v8, v128, v128, 0 op_sel:[0,0,0] op_sel_hi:[1,1,0]
  v_mfma_f32_16x16x32_bf16 v[52:55], a[56:59], a[240:243], v[52:55]
  ds_read_b128 a[28:31], v4 offset:51200
  v_fma_mix_f32 v9, v128, v128, 0 op_sel:[1,1,0] op_sel_hi:[1,1,0]
  v_mfma_f32_16x16x32_bf16 v[88:91], a[56:59], a[244:247], v[88:91]
  buffer_load_dwordx4 v110, s[16:19], s40 offen offset:1024 lds
  v_mfma_f32_16x16x32_bf16 v[56:59], a[60:63], a[240:243], v[56:59]
  ds_read_b128 a[32:35], v4 offset:53248
  v_fma_mix_f32 v10, v129, v129, 0 op_sel:[0,0,0] op_sel_hi:[1,1,0]
  v_mfma_f32_16x16x32_bf16 v[92:95], a[60:63], a[244:247], v[92:95]
  v_exp_f32_e64 v27, v27
  v_mfma_f32_16x16x32_bf16 v[60:63], a[64:67], a[240:243], v[60:63]
  v_exp_f32_e64 v28, v28
  v_mfma_f32_16x16x32_bf16 v[96:99], a[64:67], a[244:247], v[96:99]
  buffer_load_dwordx4 a[100:103], v7, s[60:63], s73 offen offset:3072
  v_mfma_f32_16x16x32_bf16 v[64:67], a[68:71], a[240:243], v[64:67]
  v_exp_f32 v29, v29
  v_mfma_f32_16x16x32_bf16 v[100:103], a[68:71], a[244:247], v[100:103]
  s_waitcnt vmcnt(30) lgkmcnt(5)
  v_exp_f32 v30, v30
  v_mfma_f32_16x16x32_bf16 v[32:35], a[0:3], a[184:187], v[32:35]
  ds_read_b128 a[36:39], v4 offset:37888
  v_fma_mix_f32 v11, v129, v129, 0 op_sel:[1,1,0] op_sel_hi:[1,1,0]
  v_mfma_f32_16x16x32_bf16 v[68:71], a[0:3], a[188:191], v[68:71]
  ds_read_b128 a[40:43], v4 offset:39936
  v_fma_mix_f32 v12, v132, v132, 0 op_sel:[0,0,0] op_sel_hi:[1,1,0]
  v_mfma_f32_16x16x32_bf16 v[36:39], a[4:7], a[184:187], v[36:39]
  s_waitcnt vmcnt(12)
  ds_write_b32 v107, v106
  v_mfma_f32_16x16x32_bf16 v[72:75], a[4:7], a[188:191], v[72:75]
  buffer_load_dwordx4 v110, s[16:19], s40 offen offset:2048 lds
  v_mfma_f32_16x16x32_bf16 v[40:43], a[8:11], a[184:187], v[40:43]
  s_lshl4_add_u32 s50, s87, 25
  ds_read_b128 a[44:47], v4 offset:41984
  v_mfma_f32_16x16x32_bf16 v[76:79], a[8:11], a[188:191], v[76:79]
  ds_read_b128 a[48:51], v4 offset:44032
  v_fma_mix_f32 v13, v132, v132, 0 op_sel:[1,1,0] op_sel_hi:[1,1,0]
  v_mfma_f32_16x16x32_bf16 v[44:47], a[12:15], a[184:187], v[44:47]
  s_waitcnt lgkmcnt(5)
  ds_read_b128 a[52:55], v4 offset:46080
  v_mfma_f32_16x16x32_bf16 v[80:83], a[12:15], a[188:191], v[80:83]
  buffer_load_dwordx4 a[104:107], v4, s[60:63], s71 offen offset:0
  v_mfma_f32_16x16x32_bf16 v[48:51], a[16:19], a[184:187], v[48:51]
  ds_read_b128 a[56:59], v4 offset:48128
  v_fma_mix_f32 v14, v133, v133, 0 op_sel:[0,0,0] op_sel_hi:[1,1,0]
  v_mfma_f32_16x16x32_bf16 v[84:87], a[16:19], a[188:191], v[84:87]
  ds_read_b128 a[60:63], v4 offset:50176
  v_fma_mix_f32 v15, v133, v133, 0 op_sel:[1,1,0] op_sel_hi:[1,1,0]
  v_mfma_f32_16x16x32_bf16 v[52:55], a[20:23], a[184:187], v[52:55]
  ds_read_b32 v109, v108
  v_add_u32_e64 v106, 1, v106
  v_mfma_f32_16x16x32_bf16 v[88:91], a[20:23], a[188:191], v[88:91]
  ds_read_b128 a[64:67], v4 offset:52224
  v_fma_f32 v8, v8, v188, v186
  v_mfma_f32_16x16x32_bf16 v[56:59], a[24:27], a[184:187], v[56:59]
  buffer_load_dwordx4 v110, s[16:19], s40 offen offset:3072 lds
  v_mfma_f32_16x16x32_bf16 v[92:95], a[24:27], a[188:191], v[92:95]
  ds_read_b128 a[68:71], v4 offset:54272
  v_fma_f32 v9, v9, v188, v186
  v_mfma_f32_16x16x32_bf16 v[60:63], a[28:31], a[184:187], v[60:63]
  v_exp_f32_e64 v31, v31
  v_mfma_f32_16x16x32_bf16 v[96:99], a[28:31], a[188:191], v[96:99]
  s_waitcnt lgkmcnt(2)
  v_cmp_gt_u32 vcc, s50, v109
  v_fma_f32 v24, v24, v190, v190
  v_mfma_f32_16x16x32_bf16 v[64:67], a[32:35], a[184:187], v[64:67]
  buffer_load_dwordx4 a[108:111], v4, s[60:63], s71 offen offset:1024
  v_mfma_f32_16x16x32_bf16 v[100:103], a[32:35], a[188:191], v[100:103]
  v_readlane_b32 s40, v104, 14
  v_fma_f32 v25, v25, v190, v190
  v_mfma_f32_16x16x32_bf16 v[32:35], a[36:39], a[192:195], v[32:35]
  s_cbranch_vccnz L_k5s_23
L_k5g_23:
  v_mfma_f32_16x16x32_bf16 v[68:71], a[36:39], a[196:199], v[68:71]
  ds_read_b128 a[0:3], v4 offset:55296
  v_fma_f32 v26, v26, v190, v190
  v_mfma_f32_16x16x32_bf16 v[36:39], a[40:43], a[192:195], v[36:39]
  s_add_u32 m0, s41, 110592
  ds_read_b128 a[4:7], v4 offset:57344
  v_mfma_f32_16x16x32_bf16 v[72:75], a[40:43], a[196:199], v[72:75]
  buffer_load_dwordx4 v4, s[16:19], s40 offen offset:0 lds
  v_mfma_f32_16x16x32_bf16 v[40:43], a[44:47], a[192:195], v[40:43]
  ds_read_b128 a[8:11], v4 offset:59392
  v_fma_f32 v27, v27, v190, v190
  v_mfma_f32_16x16x32_bf16 v[76:79], a[44:47], a[196:199], v[76:79]
  ds_read_b128 a[12:15], v4 offset:61440
  v_fma_f32 v28, v28, v190, v190
  v_mfma_f32_16x16x32_bf16 v[44:47], a[48:51], a[192:195], v[44:47]
  s_waitcnt lgkmcnt(4)
  ds_read_b128 a[16:19], v4 offset:63488
  v_mfma_f32_16x16x32_bf16 v[80:83], a[48:51], a[196:199], v[80:83]
  buffer_load_dwordx4 a[112:115], v4, s[60:63], s71 offen offset:2048
  v_mfma_f32_16x16x32_bf16 v[48:51], a[52:55], a[192:195], v[48:51]
  ds_read_b128 a[20:23], v5 offset:0
  v_fma_f32 v29, v29, v190, v190
  v_mfma_f32_16x16x32_bf16 v[84:87], a[52:55], a[196:199], v[84:87]
  ds_read_b128 a[24:27], v5 offset:2048
  v_fma_f32 v30, v30, v190, v190
  v_mfma_f32_16x16x32_bf16 v[52:55], a[56:59], a[192:195], v[52:55]
  ds_read_b128 a[28:31], v5 offset:4096
  v_fma_f32 v31, v31, v190, v190
  v_mfma_f32_16x16x32_bf16 v[88:91], a[56:59], a[196:199], v[88:91]
  buffer_load_dwordx4 v4, s[16:19], s40 offen offset:1024 lds
  v_mfma_f32_16x16x32_bf16 v[56:59], a[60:63], a[192:195], v[56:59]
  ds_read_b128 a[32:35], v5 offset:6144
  v_fma_mix_f32 v231, v151, v19, 0 op_sel:[1,0,0] op_sel_hi:[1,0,0]
  v_mfma_f32_16x16x32_bf16 v[92:95], a[60:63], a[196:199], v[92:95]
  v_rcp_f32_e64 v24, v24
  v_mfma_f32_16x16x32_bf16 v[60:63], a[64:67], a[192:195], v[60:63]
  v_rcp_f32_e64 v25, v25
  v_mfma_f32_16x16x32_bf16 v[96:99], a[64:67], a[196:199], v[96:99]
  buffer_load_dwordx4 a[116:119], v4, s[60:63], s71 offen offset:3072
  v_mfma_f32_16x16x32_bf16 v[64:67], a[68:71], a[192:195], v[64:67]
  v_rcp_f32_e64 v26, v26
  v_mfma_f32_16x16x32_bf16 v[100:103], a[68:71], a[196:199], v[100:103]
  s_waitcnt vmcnt(29) lgkmcnt(5)
  v_rcp_f32 v27, v27
  v_mfma_f32_16x16x32_bf16 v[32:35], a[0:3], a[200:203], v[32:35]
  ds_read_b128 a[36:39], v4 offset:56320
  v_fma_f32 v10, v10, v188, v186
  v_mfma_f32_16x16x32_bf16 v[68:71], a[0:3], a[204:207], v[68:71]
  buffer_load_dwordx4 v4, s[16:19], s40 offen offset:2048 lds
  v_mfma_f32_16x16x32_bf16 v[36:39], a[4:7], a[200:203], v[36:39]
  s_waitcnt vmcnt(13)
  ds_write_b32 v107, v106
  v_mfma_f32_16x16x32_bf16 v[72:75], a[4:7], a[204:207], v[72:75]
  ds_read_b128 a[40:43], v4 offset:58368
  v_fma_f32 v11, v11, v188, v186
  v_mfma_f32_16x16x32_bf16 v[40:43], a[8:11], a[200:203], v[40:43]
  ds_read_b128 a[44:47], v4 offset:60416
  v_fma_f32 v12, v12, v188, v186
  v_mfma_f32_16x16x32_bf16 v[76:79], a[8:11], a[204:207], v[76:79]
  buffer_load_dwordx4 a[120:123], v7, s[60:63], s71 offen offset:0
  v_mfma_f32_16x16x32_bf16 v[44:47], a[12:15], a[200:203], v[44:47]
  s_waitcnt lgkmcnt(4)
  ds_read_b128 a[48:51], v4 offset:62464
  v_mfma_f32_16x16x32_bf16 v[80:83], a[12:15], a[204:207], v[80:83]
  ds_read_b128 a[52:55], v4 offset:64512
  v_fma_f32 v13, v13, v188, v186
  v_mfma_f32_16x16x32_bf16 v[48:51], a[16:19], a[200:203], v[48:51]
  ds_read_b128 a[56:59], v5 offset:1024
  v_readlane_b32 s73, v105, 15
  v_mfma_f32_16x16x32_bf16 v[84:87], a[16:19], a[204:207], v[84:87]
  buffer_load_dwordx4 v4, s[16:19], s40 offen offset:3072 lds
  v_mfma_f32_16x16x32_bf16 v[52:55], a[20:23], a[200:203], v[52:55]
  ds_read_b32 v109, v108
  v_add_u32_e64 v106, 1, v106
  v_mfma_f32_16x16x32_bf16 v[88:91], a[20:23], a[204:207], v[88:91]
  s_add_u32 m0, s51, 110592
  ds_read_b128 a[60:63], v5 offset:3072
  v_mfma_f32_16x16x32_bf16 v[56:59], a[24:27], a[200:203], v[56:59]
  ds_read_b128 a[64:67], v5 offset:5120
  v_fma_f32 v14, v14, v188, v186
  v_mfma_f32_16x16x32_bf16 v[92:95], a[24:27], a[204:207], v[92:95]
  ds_read_b128 a[68:71], v5 offset:7168
  v_fma_f32 v15, v15, v188, v186
  v_mfma_f32_16x16x32_bf16 v[60:63], a[28:31], a[200:203], v[60:63]
  buffer_load_dwordx4 v111, s[16:19], s40 offen offset:0 lds
  v_mfma_f32_16x16x32_bf16 v[96:99], a[28:31], a[204:207], v[96:99]
  s_waitcnt lgkmcnt(3)
  v_cmp_gt_u32 vcc, 26, v109
  v_fma_mix_f32 v8, v128, v8, 0 op_sel:[0,0,0] op_sel_hi:[1,0,0]
  v_mfma_f32_16x16x32_bf16 v[64:67], a[32:35], a[200:203], v[64:67]
  v_rcp_f32_e64 v28, v28
  v_mfma_f32_16x16x32_bf16 v[100:103], a[32:35], a[204:207], v[100:103]
  v_rcp_f32_e64 v29, v29
  v_mfma_f32_16x16x32_bf16 v[32:35], a[36:39], a[208:211], v[32:35]
  s_cbranch_vccnz L_k5s_24
L_k5g_24:
  v_mfma_f32_16x16x32_bf16 v[68:71], a[36:39], a[212:215], v[68:71]
  ds_read_b128 a[0:3], v5 offset:8192
  v_fma_mix_f32 v9, v128, v9, 0 op_sel:[1,0,0] op_sel_hi:[1,0,0]
  v_mfma_f32_16x16x32_bf16 v[36:39], a[40:43], a[208:211], v[36:39]
  s_add_u32 m0, s41, 36864
  ds_read_b128 a[4:7], v5 offset:10240
  v_mfma_f32_16x16x32_bf16 v[72:75], a[40:43], a[212:215], v[72:75]
  buffer_load_dwordx4 v110, s[16:19], s40 offen offset:0 lds
  v_mfma_f32_16x16x32_bf16 v[40:43], a[44:47], a[208:211], v[40:43]
  ds_read_b128 a[8:11], v5 offset:12288
  v_fma_mix_f32 v10, v129, v10, 0 op_sel:[0,0,0] op_sel_hi:[1,0,0]
  v_mfma_f32_16x16x32_bf16 v[76:79], a[44:47], a[212:215], v[76:79]
  ds_read_b128 a[12:15], v5 offset:14336
  v_fma_mix_f32 v11, v129, v11, 0 op_sel:[1,0,0] op_sel_hi:[1,0,0]
  v_mfma_f32_16x16x32_bf16 v[44:47], a[48:51], a[208:211], v[44:47]
  s_waitcnt lgkmcnt(4)
  ds_read_b128 a[16:19], v5 offset:16384
  v_mfma_f32_16x16x32_bf16 v[80:83], a[48:51], a[212:215], v[80:83]
  buffer_load_dwordx4 a[124:127], v7, s[60:63], s71 offen offset:1024
  v_mfma_f32_16x16x32_bf16 v[48:51], a[52:55], a[208:211], v[48:51]
  ds_read_b128 a[20:23], v5 offset:18432
  v_fma_mix_f32 v12, v132, v12, 0 op_sel:[0,0,0] op_sel_hi:[1,0,0]
  v_mfma_f32_16x16x32_bf16 v[84:87], a[52:55], a[212:215], v[84:87]
  ds_read_b128 a[24:27], v5 offset:20480
  v_fma_mix_f32 v13, v132, v13, 0 op_sel:[1,0,0] op_sel_hi:[1,0,0]
  v_mfma_f32_16x16x32_bf16 v[52:55], a[56:59], a[208:211], v[52:55]
  ds_read_b128 a[28:31], v5 offset:22528
  v_fma_mix_f32 v14, v133, v14, 0 op_sel:[0,0,0] op_sel_hi:[1,0,0]
  v_mfma_f32_16x16x32_bf16 v[88:91], a[56:59], a[212:215], v[88:91]
  buffer_load_dwordx4 v110, s[16:19], s40 offen offset:1024 lds
  v_mfma_f32_16x16x32_bf16 v[56:59], a[60:63], a[208:211], v[56:59]
  ds_read_b128 a[32:35], v5 offset:24576
  v_fma_mix_f32 v15, v133, v15, 0 op_sel:[1,0,0] op_sel_hi:[1,0,0]
  v_mfma_f32_16x16x32_bf16 v[92:95], a[60:63], a[212:215], v[92:95]
  v_exp_f32_e64 v8, v8
  v_mfma_f32_16x16x32_bf16 v[60:63], a[64:67], a[208:211], v[60:63]
  v_exp_f32_e64 v9, v9
  v_mfma_f32_16x16x32_bf16 v[96:99], a[64:67], a[212:215], v[96:99]
  buffer_load_dwordx4 a[128:131], v7, s[60:63], s71 offen offset:2048
  v_mfma_f32_16x16x32_bf16 v[64:67], a[68:71], a[208:211], v[64:67]
  v_exp_f32_e64 v10, v10
  v_mfma_f32_16x16x32_bf16 v[100:103], a[68:71], a[212:215], v[100:103]
  s_waitcnt vmcnt(26) lgkmcnt(5)
  v_exp_f32 v11, v11
  v_mfma_f32_16x16x32_bf16 v[32:35], a[0:3], a[72:75], v[32:35]
  s_getpc_b64 s[94:95]
  ds_read_b128 a[36:39], v5 offset:9216
  v_mfma_f32_16x16x32_bf16 v[68:71], a[0:3], a[76:79], v[68:71]
  global_load_dword a248, v232, s[94:95]
  v_mfma_f32_16x16x32_bf16 v[36:39], a[4:7], a[72:75], v[36:39]
  s_waitcnt vmcnt(14)
  ds_write_b32 v107, v106
  v_mfma_f32_16x16x32_bf16 v[72:75], a[4:7], a[76:79], v[72:75]
  buffer_load_dwordx4 v110, s[16:19], s40 offen offset:2048 lds
  v_mfma_f32_16x16x32_bf16 v[40:43], a[8:11], a[72:75], v[40:43]
  s_lshl4_add_u32 s50, s87, 27
  ds_read_b128 a[40:43], v5 offset:11264
  v_mfma_f32_16x16x32_bf16 v[76:79], a[8:11], a[76:79], v[76:79]
  ds_read_b128 a[44:47], v5 offset:13312
  v_fma_mix_f32 v160, v116, v20, 0 op_sel:[0,0,0] op_sel_hi:[1,0,0]
  v_mfma_f32_16x16x32_bf16 v[44:47], a[12:15], a[72:75], v[44:47]
  s_waitcnt lgkmcnt(4)
  ds_read_b128 a[48:51], v5 offset:15360
  v_mfma_f32_16x16x32_bf16 v[80:83], a[12:15], a[76:79], v[80:83]
  buffer_load_dwordx4 a[132:135], v7, s[60:63], s71 offen offset:3072
  v_mfma_f32_16x16x32_bf16 v[48:51], a[16:19], a[72:75], v[48:51]
  ds_read_b128 a[52:55], v5 offset:17408
  v_fma_mix_f32 v161, v116, v21, 0 op_sel:[1,0,0] op_sel_hi:[1,0,0]
  v_mfma_f32_16x16x32_bf16 v[84:87], a[16:19], a[76:79], v[84:87]
  ds_read_b128 a[56:59], v5 offset:19456
  v_fma_mix_f32 v162, v117, v22, 0 op_sel:[0,0,0] op_sel_hi:[1,0,0]
  v_mfma_f32_16x16x32_bf16 v[52:55], a[20:23], a[72:75], v[52:55]
  ds_read_b32 v109, v108
  v_add_u32_e64 v106, 1, v106
  v_mfma_f32_16x16x32_bf16 v[88:91], a[20:23], a[76:79], v[88:91]
  ds_read_b128 a[60:63], v5 offset:21504
  v_fma_mix_f32 v163, v117, v23, 0 op_sel:[1,0,0] op_sel_hi:[1,0,0]
  v_mfma_f32_16x16x32_bf16 v[56:59], a[24:27], a[72:75], v[56:59]
  buffer_load_dwordx4 v110, s[16:19], s40 offen offset:3072 lds
  v_mfma_f32_16x16x32_bf16 v[92:95], a[24:27], a[76:79], v[92:95]
  ds_read_b128 a[64:67], v5 offset:23552
  v_fma_mix_f32 v16, v136, v136, 0 op_sel:[0,0,0] op_sel_hi:[1,1,0]
  v_mfma_f32_16x16x32_bf16 v[60:63], a[28:31], a[72:75], v[60:63]
  ds_read_b128 a[68:71], v5 offset:25600
  v_fma_mix_f32 v17, v136, v136, 0 op_sel:[1,1,0] op_sel_hi:[1,1,0]
  v_mfma_f32_16x16x32_bf16 v[96:99], a[28:31], a[76:79], v[96:99]
  s_waitcnt lgkmcnt(3)
  v_cmp_gt_u32 vcc, s50, v109
  v_fma_mix_f32 v18, v137, v137, 0 op_sel:[0,0,0] op_sel_hi:[1,1,0]
  v_mfma_f32_16x16x32_bf16 v[64:67], a[32:35], a[72:75], v[64:67]
  buffer_load_dwordx4 a[136:139], v4, s[60:63], s73 offen offset:0
  v_mfma_f32_16x16x32_bf16 v[100:103], a[32:35], a[76:79], v[100:103]
  v_readlane_b32 s40, v104, 15
  v_fma_mix_f32 v19, v137, v137, 0 op_sel:[1,1,0] op_sel_hi:[1,1,0]
  v_mfma_f32_16x16x32_bf16 v[32:35], a[36:39], a[80:83], v[32:35]
  s_cbranch_vccnz L_k5s_25
L_k5g_25:
  v_mfma_f32_16x16x32_bf16 v[68:71], a[36:39], a[84:87], v[68:71]
  ds_read_b128 a[0:3], v5 offset:26624
  v_fma_mix_f32 v20, v148, v148, 0 op_sel:[0,0,0] op_sel_hi:[1,1,0]
  v_mfma_f32_16x16x32_bf16 v[36:39], a[40:43], a[80:83], v[36:39]
  s_add_u32 m0, s41, 55296
  ds_read_b128 a[4:7], v5 offset:28672
  v_mfma_f32_16x16x32_bf16 v[72:75], a[40:43], a[84:87], v[72:75]
  buffer_load_dwordx4 v4, s[16:19], s40 offen offset:0 lds
  v_mfma_f32_16x16x32_bf16 v[40:43], a[44:47], a[80:83], v[40:43]
  ds_read_b128 a[8:11], v5 offset:30720
  v_fma_mix_f32 v21, v148, v148, 0 op_sel:[1,1,0] op_sel_hi:[1,1,0]
  v_mfma_f32_16x16x32_bf16 v[76:79], a[44:47], a[84:87], v[76:79]
  ds_read_b128 a[12:15], v5 offset:32768
  v_fma_mix_f32 v22, v149, v149, 0 op_sel:[0,0,0] op_sel_hi:[1,1,0]
  v_mfma_f32_16x16x32_bf16 v[44:47], a[48:51], a[80:83], v[44:47]
  s_waitcnt lgkmcnt(4)
  ds_read_b128 a[16:19], v5 offset:34816
  v_mfma_f32_16x16x32_bf16 v[80:83], a[48:51], a[84:87], v[80:83]
  buffer_load_dwordx4 a[140:143], v4, s[60:63], s73 offen offset:1024
  v_mfma_f32_16x16x32_bf16 v[48:51], a[52:55], a[80:83], v[48:51]
  ds_read_b128 a[20:23], v5 offset:36864
  v_fma_mix_f32 v23, v149, v149, 0 op_sel:[1,1,0] op_sel_hi:[1,1,0]
  v_mfma_f32_16x16x32_bf16 v[84:87], a[52:55], a[84:87], v[84:87]
  ds_read_b128 a[24:27], v5 offset:38912
  v_fma_f32 v16, v16, v188, v186
  v_mfma_f32_16x16x32_bf16 v[52:55], a[56:59], a[80:83], v[52:55]
  ds_read_b128 a[28:31], v5 offset:40960
  v_fma_f32 v17, v17, v188, v186
  v_mfma_f32_16x16x32_bf16 v[88:91], a[56:59], a[84:87], v[88:91]
  buffer_load_dwordx4 v4, s[16:19], s40 offen offset:1024 lds
  v_mfma_f32_16x16x32_bf16 v[56:59], a[60:63], a[80:83], v[56:59]
  ds_read_b128 a[32:35], v5 offset:43008
  v_fma_f32 v18, v18, v188, v186
  v_mfma_f32_16x16x32_bf16 v[92:95], a[60:63], a[84:87], v[92:95]
  v_exp_f32_e64 v12, v12
  v_mfma_f32_16x16x32_bf16 v[60:63], a[64:67], a[80:83], v[60:63]
  v_exp_f32_e64 v13, v13
  v_mfma_f32_16x16x32_bf16 v[96:99], a[64:67], a[84:87], v[96:99]
  buffer_load_dwordx4 a[144:147], v4, s[60:63], s73 offen offset:2048
  v_mfma_f32_16x16x32_bf16 v[64:67], a[68:71], a[80:83], v[64:67]
  v_exp_f32_e64 v14, v14
  v_mfma_f32_16x16x32_bf16 v[100:103], a[68:71], a[84:87], v[100:103]
  s_waitcnt vmcnt(25) lgkmcnt(5)
  v_exp_f32 v15, v15
  v_mfma_f32_16x16x32_bf16 v[32:35], a[0:3], a[88:91], v[32:35]
  ds_read_b128 a[36:39], v5 offset:27648
  v_fma_f32 v8, v8, v190, v190
  v_mfma_f32_16x16x32_bf16 v[68:71], a[0:3], a[92:95], v[68:71]
  buffer_load_dwordx4 v4, s[16:19], s40 offen offset:2048 lds
  v_mfma_f32_16x16x32_bf16 v[36:39], a[4:7], a[88:91], v[36:39]
  s_waitcnt vmcnt(14)
  ds_write_b32 v107, v106
  v_mfma_f32_16x16x32_bf16 v[72:75], a[4:7], a[92:95], v[72:75]
  ds_read_b128 a[40:43], v5 offset:29696
  v_fma_f32 v9, v9, v190, v190
  v_mfma_f32_16x16x32_bf16 v[40:43], a[8:11], a[88:91], v[40:43]
  ds_read_b128 a[44:47], v5 offset:31744
  v_fma_f32 v10, v10, v190, v190
  v_mfma_f32_16x16x32_bf16 v[76:79], a[8:11], a[92:95], v[76:79]
  buffer_load_dwordx4 a[148:151], v4, s[60:63], s73 offen offset:3072
  v_mfma_f32_16x16x32_bf16 v[44:47], a[12:15], a[88:91], v[44:47]
  s_waitcnt lgkmcnt(4)
  ds_read_b128 a[48:51], v5 offset:33792
  v_mfma_f32_16x16x32_bf16 v[80:83], a[12:15], a[92:95], v[80:83]
  ds_read_b128 a[52:55], v5 offset:35840
  v_fma_f32 v11, v11, v190, v190
  v_mfma_f32_16x16x32_bf16 v[48:51], a[16:19], a[88:91], v[48:51]
  ds_read_b128 a[56:59], v5 offset:37888
  v_fma_f32 v12, v12, v190, v190
  v_mfma_f32_16x16x32_bf16 v[84:87], a[16:19], a[92:95], v[84:87]
  buffer_load_dwordx4 v4, s[16:19], s40 offen offset:3072 lds
  v_mfma_f32_16x16x32_bf16 v[52:55], a[20:23], a[88:91], v[52:55]
  ds_read_b32 v109, v108
  v_add_u32_e64 v106, 1, v106
  v_mfma_f32_16x16x32_bf16 v[88:91], a[20:23], a[92:95], v[88:91]
  s_add_u32 m0, s42, 55296
  ds_read_b128 a[60:63], v5 offset:39936
  v_mfma_f32_16x16x32_bf16 v[56:59], a[24:27], a[88:91], v[56:59]
  ds_read_b128 a[64:67], v5 offset:41984
  v_fma_f32 v13, v13, v190, v190
  v_mfma_f32_16x16x32_bf16 v[92:95], a[24:27], a[92:95], v[92:95]
  ds_read_b128 a[68:71], v5 offset:44032
  v_fma_f32 v14, v14, v190, v190
  v_mfma_f32_16x16x32_bf16 v[60:63], a[28:31], a[88:91], v[60:63]
  buffer_load_dwordx4 v111, s[16:19], s40 offen offset:0 lds
  v_mfma_f32_16x16x32_bf16 v[96:99], a[28:31], a[92:95], v[96:99]
  s_waitcnt lgkmcnt(3)
  v_cmp_gt_u32 vcc, 28, v109
  v_fma_f32 v15, v15, v190, v190
  v_mfma_f32_16x16x32_bf16 v[64:67], a[32:35], a[88:91], v[64:67]
  v_rcp_f32_e64 v8, v8
  v_mfma_f32_16x16x32_bf16 v[100:103], a[32:35], a[92:95], v[100:103]
  v_rcp_f32_e64 v9, v9
  v_mfma_f32_16x16x32_bf16 v[32:35], a[36:39], a[96:99], v[32:35]
  s_cbranch_vccnz L_k5s_26
L_k5g_26:
  v_mfma_f32_16x16x32_bf16 v[68:71], a[36:39], a[100:103], v[68:71]
  ds_read_b128 a[0:3], v5 offset:45056
  v_fma_f32 v19, v19, v188, v186
  v_mfma_f32_16x16x32_bf16 v[36:39], a[40:43], a[96:99], v[36:39]
  s_add_u32 m0, s41, 73728
  ds_read_b128 a[4:7], v5 offset:47104
  v_mfma_f32_16x16x32_bf16 v[72:75], a[40:43], a[100:103], v[72:75]
  buffer_load_dwordx4 v110, s[16:19], s40 offen offset:0 lds
  v_mfma_f32_16x16x32_bf16 v[40:43], a[44:47], a[96:99], v[40:43]
  ds_read_b128 a[8:11], v5 offset:49152
  v_fma_f32 v20, v20, v188, v186
  v_mfma_f32_16x16x32_bf16 v[76:79], a[44:47], a[100:103], v[76:79]
  ds_read_b128 a[12:15], v5 offset:51200
  v_fma_f32 v21, v21, v188, v186
  v_mfma_f32_16x16x32_bf16 v[44:47], a[48:51], a[96:99], v[44:47]
  s_waitcnt lgkmcnt(4)
  ds_read_b128 a[16:19], v5 offset:53248
  v_mfma_f32_16x16x32_bf16 v[80:83], a[48:51], a[100:103], v[80:83]
  buffer_load_dwordx4 a[152:155], v7, s[60:63], s73 offen offset:0
  v_mfma_f32_16x16x32_bf16 v[48:51], a[52:55], a[96:99], v[48:51]
  ds_read_b128 a[20:23], v5 offset:55296
  v_fma_f32 v22, v22, v188, v186
  v_mfma_f32_16x16x32_bf16 v[84:87], a[52:55], a[100:103], v[84:87]
  ds_read_b128 a[24:27], v5 offset:57344
  v_fma_f32 v23, v23, v188, v186
  v_mfma_f32_16x16x32_bf16 v[52:55], a[56:59], a[96:99], v[52:55]
  ds_read_b128 a[28:31], v5 offset:59392
  v_fma_mix_f32 v16, v136, v16, 0 op_sel:[0,0,0] op_sel_hi:[1,0,0]
  v_mfma_f32_16x16x32_bf16 v[88:91], a[56:59], a[100:103], v[88:91]
  buffer_load_dwordx4 v110, s[16:19], s40 offen offset:1024 lds
  v_mfma_f32_16x16x32_bf16 v[56:59], a[60:63], a[96:99], v[56:59]
  ds_read_b128 a[32:35], v5 offset:61440
  v_fma_mix_f32 v17, v136, v17, 0 op_sel:[1,0,0] op_sel_hi:[1,0,0]
  v_mfma_f32_16x16x32_bf16 v[92:95], a[60:63], a[100:103], v[92:95]
  v_rcp_f32_e64 v10, v10
  v_mfma_f32_16x16x32_bf16 v[60:63], a[64:67], a[96:99], v[60:63]
  v_rcp_f32_e64 v11, v11
  v_mfma_f32_16x16x32_bf16 v[96:99], a[64:67], a[100:103], v[96:99]
  buffer_load_dwordx4 a[156:159], v7, s[60:63], s73 offen offset:1024
  v_mfma_f32_16x16x32_bf16 v[64:67], a[68:71], a[96:99], v[64:67]
  v_rcp_f32_e64 v12, v12
  v_mfma_f32_16x16x32_bf16 v[100:103], a[68:71], a[100:103], v[100:103]
  s_waitcnt vmcnt(25) lgkmcnt(5)
  v_rcp_f32 v13, v13
  v_mfma_f32_16x16x32_bf16 v[32:35], a[0:3], a[104:107], v[32:35]
  ds_read_b128 a[36:39], v5 offset:46080
  v_fma_mix_f32 v18, v137, v18, 0 op_sel:[0,0,0] op_sel_hi:[1,0,0]
  v_mfma_f32_16x16x32_bf16 v[68:71], a[0:3], a[108:111], v[68:71]
  ds_read_b128 a[40:43], v5 offset:48128
  v_fma_mix_f32 v19, v137, v19, 0 op_sel:[1,0,0] op_sel_hi:[1,0,0]
  v_mfma_f32_16x16x32_bf16 v[36:39], a[4:7], a[104:107], v[36:39]
  ds_read_b128 a[44:47], v5 offset:50176
  v_fma_mix_f32 v20, v148, v20, 0 op_sel:[0,0,0] op_sel_hi:[1,0,0]
  v_mfma_f32_16x16x32_bf16 v[72:75], a[4:7], a[108:111], v[72:75]
  buffer_load_dwordx4 v110, s[16:19], s40 offen offset:2048 lds
  v_mfma_f32_16x16x32_bf16 v[40:43], a[8:11], a[104:107], v[40:43]
  ds_read_b128 a[48:51], v5 offset:52224
  v_fma_mix_f32 v21, v148, v21, 0 op_sel:[1,0,0] op_sel_hi:[1,0,0]
  v_mfma_f32_16x16x32_bf16 v[76:79], a[8:11], a[108:111], v[76:79]
  ds_read_b128 a[52:55], v5 offset:54272
  v_fma_mix_f32 v22, v149, v22, 0 op_sel:[0,0,0] op_sel_hi:[1,0,0]
  v_mfma_f32_16x16x32_bf16 v[44:47], a[12:15], a[104:107], v[44:47]
  s_waitcnt lgkmcnt(5)
  ds_read_b128 a[56:59], v5 offset:56320
  v_mfma_f32_16x16x32_bf16 v[80:83], a[12:15], a[108:111], v[80:83]
  buffer_load_dwordx4 a[160:163], v7, s[60:63], s73 offen offset:2048
  v_mfma_f32_16x16x32_bf16 v[48:51], a[16:19], a[104:107], v[48:51]
  ds_read_b128 a[60:63], v5 offset:58368
  v_fma_mix_f32 v23, v149, v23, 0 op_sel:[1,0,0] op_sel_hi:[1,0,0]
  v_mfma_f32_16x16x32_bf16 v[84:87], a[16:19], a[108:111], v[84:87]
  ds_read_b128 a[64:67], v5 offset:60416
  v_mfma_f32_16x16x32_bf16 v[52:55], a[20:23], a[104:107], v[52:55]
  ds_read_b128 a[68:71], v5 offset:62464
  v_mfma_f32_16x16x32_bf16 v[88:91], a[20:23], a[108:111], v[88:91]
  v_exp_f32 v16, v16
  v_mfma_f32_16x16x32_bf16 v[56:59], a[24:27], a[104:107], v[56:59]
  buffer_load_dwordx4 v110, s[16:19], s40 offen offset:3072 lds
  v_mfma_f32_16x16x32_bf16 v[92:95], a[24:27], a[108:111], v[92:95]
  v_exp_f32_e64 v17, v17
  v_mfma_f32_16x16x32_bf16 v[60:63], a[28:31], a[104:107], v[60:63]
  v_exp_f32_e64 v18, v18
  v_mfma_f32_16x16x32_bf16 v[96:99], a[28:31], a[108:111], v[96:99]
  v_exp_f32_e64 v19, v19
  v_mfma_f32_16x16x32_bf16 v[64:67], a[32:35], a[104:107], v[64:67]
  buffer_load_dwordx4 a[164:167], v7, s[60:63], s73 offen offset:3072
  v_mfma_f32_16x16x32_bf16 v[100:103], a[32:35], a[108:111], v[100:103]
  v_exp_f32_e64 v20, v20
  s_waitcnt vmcnt(17)
  s_waitcnt lgkmcnt(0)
  s_barrier
  v_mfma_f32_16x16x32_bf16 v[32:35], a[36:39], a[112:115], v[32:35]
  ds_read_b128 a[0:3], v4 offset:36864
  v_mfma_f32_16x16x32_bf16 v[68:71], a[36:39], a[116:119], v[68:71]
  ds_read_b128 a[4:7], v4 offset:38912
  s_add_u32 s70, s64, 0
  v_mfma_f32_16x16x32_bf16 v[36:39], a[40:43], a[112:115], v[36:39]
  ds_read_b128 a[8:11], v4 offset:40960
  s_add_u32 m0, s72, 129024
  v_mfma_f32_16x16x32_bf16 v[72:75], a[40:43], a[116:119], v[72:75]
  buffer_load_dwordx4 v4, s[20:23], s70 offen offset:0 lds
  v_mfma_f32_16x16x32_bf16 v[40:43], a[44:47], a[112:115], v[40:43]
  ds_read_b128 a[12:15], v4 offset:43008
  v_mfma_f32_16x16x32_bf16 v[76:79], a[44:47], a[116:119], v[76:79]
  ds_read_b128 a[16:19], v4 offset:45056
  v_mfma_f32_16x16x32_bf16 v[44:47], a[48:51], a[112:115], v[44:47]
  buffer_load_dwordx4 v4, s[20:23], s70 offen offset:1024 lds
  v_mfma_f32_16x16x32_bf16 v[80:83], a[48:51], a[116:119], v[80:83]
  ds_read_b128 a[20:23], v4 offset:47104
  v_mfma_f32_16x16x32_bf16 v[48:51], a[52:55], a[112:115], v[48:51]
  ds_read_b128 a[24:27], v4 offset:49152
  v_mfma_f32_16x16x32_bf16 v[84:87], a[52:55], a[116:119], v[84:87]
  buffer_load_dwordx4 v4, s[20:23], s70 offen offset:2048 lds
  v_mfma_f32_16x16x32_bf16 v[52:55], a[56:59], a[112:115], v[52:55]
  ds_read_b128 a[28:31], v4 offset:51200
  v_mfma_f32_16x16x32_bf16 v[88:91], a[56:59], a[116:119], v[88:91]
  ds_read_b128 a[32:35], v4 offset:53248
  v_mfma_f32_16x16x32_bf16 v[56:59], a[60:63], a[112:115], v[56:59]
  buffer_load_dwordx4 v4, s[20:23], s70 offen offset:3072 lds
  v_mfma_f32_16x16x32_bf16 v[92:95], a[60:63], a[116:119], v[92:95]
  v_rcp_f32_e64 v14, v14
  s_add_u32 m0, s72, 133120
  v_mfma_f32_16x16x32_bf16 v[60:63], a[64:67], a[112:115], v[60:63]
  v_rcp_f32_e64 v15, v15
  v_mfma_f32_16x16x32_bf16 v[96:99], a[64:67], a[116:119], v[96:99]
  buffer_load_dwordx4 v7, s[20:23], s70 offen lds
  v_mfma_f32_16x16x32_bf16 v[64:67], a[68:71], a[112:115], v[64:67]
  v_fma_mix_f32 v172, v128, v8, 0 op_sel:[0,0,0] op_sel_hi:[1,0,0]
  s_add_u32 s70, s64, 18432
  v_mfma_f32_16x16x32_bf16 v[100:103], a[68:71], a[116:119], v[100:103]
  v_fma_mix_f32 v173, v128, v9, 0 op_sel:[1,0,0] op_sel_hi:[1,0,0]
  s_add_u32 m0, s72, 0
  s_waitcnt lgkmcnt(0)
  v_mfma_f32_16x16x32_bf16 v[32:35], a[0:3], a[120:123], v[32:35]
  ds_read_b128 a[36:39], v4 offset:37888
  v_fma_mix_f32 v174, v129, v10, 0 op_sel:[0,0,0] op_sel_hi:[1,0,0]
  v_mfma_f32_16x16x32_bf16 v[68:71], a[0:3], a[124:127], v[68:71]
  buffer_load_dwordx4 v4, s[20:23], s70 offen offset:0 lds
  v_mfma_f32_16x16x32_bf16 v[36:39], a[4:7], a[120:123], v[36:39]
  s_nop 0
L_pg_21:
  s_cbranch_execz L_wr_3
  ds_read_b128 a[40:43], v4 offset:39936
  v_fma_mix_f32 v175, v129, v11, 0 op_sel:[1,0,0] op_sel_hi:[1,0,0]
  v_mfma_f32_16x16x32_bf16 v[72:75], a[4:7], a[124:127], v[72:75]
  ds_read_b128 a[44:47], v4 offset:41984
  v_fma_mix_f32 v176, v132, v12, 0 op_sel:[0,0,0] op_sel_hi:[1,0,0]
  v_mfma_f32_16x16x32_bf16 v[40:43], a[8:11], a[120:123], v[40:43]
  buffer_load_dwordx4 v4, s[20:23], s70 offen offset:1024 lds
  v_mfma_f32_16x16x32_bf16 v[76:79], a[8:11], a[124:127], v[76:79]
  ds_read_b128 a[48:51], v4 offset:44032
  v_fma_mix_f32 v177, v132, v13, 0 op_sel:[1,0,0] op_sel_hi:[1,0,0]
  v_mfma_f32_16x16x32_bf16 v[44:47], a[12:15], a[120:123], v[44:47]
  ds_read_b128 a[52:55], v4 offset:46080
  v_fma_mix_f32 v178, v133, v14, 0 op_sel:[0,0,0] op_sel_hi:[1,0,0]
  v_mfma_f32_16x16x32_bf16 v[80:83], a[12:15], a[124:127], v[80:83]
  buffer_load_dwordx4 v4, s[20:23], s70 offen offset:2048 lds
  v_mfma_f32_16x16x32_bf16 v[48:51], a[16:19], a[120:123], v[48:51]
  ds_read_b128 a[56:59], v4 offset:48128
  v_fma_mix_f32 v179, v133, v15, 0 op_sel:[1,0,0] op_sel_hi:[1,0,0]
  v_mfma_f32_16x16x32_bf16 v[84:87], a[16:19], a[124:127], v[84:87]
  ds_read_b128 a[60:63], v4 offset:50176
  v_mfma_f32_16x16x32_bf16 v[52:55], a[20:23], a[120:123], v[52:55]
  buffer_load_dwordx4 v4, s[20:23], s70 offen offset:3072 lds
  v_mfma_f32_16x16x32_bf16 v[88:91], a[20:23], a[124:127], v[88:91]
  ds_read_b128 a[64:67], v4 offset:52224
  v_mfma_f32_16x16x32_bf16 v[56:59], a[24:27], a[120:123], v[56:59]
  ds_read_b128 a[68:71], v4 offset:54272
  s_add_u32 m0, s72, 4096
  v_mfma_f32_16x16x32_bf16 v[92:95], a[24:27], a[124:127], v[92:95]
  buffer_load_dwordx4 v7, s[20:23], s70 offen lds
  v_mfma_f32_16x16x32_bf16 v[60:63], a[28:31], a[120:123], v[60:63]
  v_exp_f32_e64 v21, v21
  v_mfma_f32_16x16x32_bf16 v[96:99], a[28:31], a[124:127], v[96:99]
  v_exp_f32_e64 v22, v22
  v_mfma_f32_16x16x32_bf16 v[64:67], a[32:35], a[120:123], v[64:67]
  v_exp_f32_e64 v23, v23
  v_mfma_f32_16x16x32_bf16 v[100:103], a[32:35], a[124:127], v[100:103]
  v_fma_f32 v16, v16, v190, v190
  v_fma_f32 v17, v17, v190, v190
  s_waitcnt vmcnt(18)
  s_waitcnt lgkmcnt(0)
  s_barrier
  v_mfma_f32_16x16x32_bf16 v[32:35], a[36:39], a[128:131], v[32:35]
  ds_read_b128 a[0:3], v4 offset:55296
  v_fma_f32 v18, v18, v190, v190
  v_mfma_f32_16x16x32_bf16 v[68:71], a[36:39], a[132:135], v[68:71]
  ds_read_b128 a[4:7], v4 offset:57344
  s_add_u32 s70, s65, 0
  v_mfma_f32_16x16x32_bf16 v[36:39], a[40:43], a[128:131], v[36:39]
  ds_read_b128 a[8:11], v4 offset:59392
  s_add_u32 m0, s72, 18432
  v_mfma_f32_16x16x32_bf16 v[72:75], a[40:43], a[132:135], v[72:75]
  buffer_load_dwordx4 v4, s[20:23], s70 offen offset:0 lds
  v_mfma_f32_16x16x32_bf16 v[40:43], a[44:47], a[128:131], v[40:43]
  ds_read_b128 a[12:15], v4 offset:61440
  v_fma_f32 v19, v19, v190, v190
  v_mfma_f32_16x16x32_bf16 v[76:79], a[44:47], a[132:135], v[76:79]
  ds_read_b128 a[16:19], v4 offset:63488
  v_fma_f32 v20, v20, v190, v190
  v_mfma_f32_16x16x32_bf16 v[44:47], a[48:51], a[128:131], v[44:47]
  buffer_load_dwordx4 v4, s[20:23], s70 offen offset:1024 lds
  v_mfma_f32_16x16x32_bf16 v[80:83], a[48:51], a[132:135], v[80:83]
  ds_read_b128 a[20:23], v5 offset:0
  v_fma_f32 v21, v21, v190, v190
  v_mfma_f32_16x16x32_bf16 v[48:51], a[52:55], a[128:131], v[48:51]
  ds_read_b128 a[24:27], v5 offset:2048
  v_fma_f32 v22, v22, v190, v190
  v_mfma_f32_16x16x32_bf16 v[84:87], a[52:55], a[132:135], v[84:87]
  buffer_load_dwordx4 v4, s[20:23], s70 offen offset:2048 lds
  v_mfma_f32_16x16x32_bf16 v[52:55], a[56:59], a[128:131], v[52:55]
  ds_read_b128 a[28:31], v5 offset:4096
  v_fma_f32 v23, v23, v190, v190
  v_mfma_f32_16x16x32_bf16 v[88:91], a[56:59], a[132:135], v[88:91]
  ds_read_b128 a[32:35], v5 offset:6144
  v_mfma_f32_16x16x32_bf16 v[56:59], a[60:63], a[128:131], v[56:59]
  buffer_load_dwordx4 v4, s[20:23], s70 offen offset:3072 lds
  v_mfma_f32_16x16x32_bf16 v[92:95], a[60:63], a[132:135], v[92:95]
  v_rcp_f32_e64 v16, v16
  s_add_u32 m0, s72, 22528
  v_mfma_f32_16x16x32_bf16 v[60:63], a[64:67], a[128:131], v[60:63]
  v_rcp_f32_e64 v17, v17
  v_mfma_f32_16x16x32_bf16 v[96:99], a[64:67], a[132:135], v[96:99]
  buffer_load_dwordx4 v7, s[20:23], s70 offen lds
  v_mfma_f32_16x16x32_bf16 v[64:67], a[68:71], a[128:131], v[64:67]
  v_rcp_f32_e64 v18, v18
  s_add_u32 s70, s65, 18432
  v_mfma_f32_16x16x32_bf16 v[100:103], a[68:71], a[132:135], v[100:103]
  v_rcp_f32 v19, v19
  s_add_u32 m0, s72, 92160
  s_waitcnt lgkmcnt(0)
  v_mfma_f32_16x16x32_bf16 v[32:35], a[0:3], a[136:139], v[32:35]
  ds_read_b128 a[36:39], v4 offset:56320
  v_mfma_f32_16x16x32_bf16 v[68:71], a[0:3], a[140:143], v[68:71]
  buffer_load_dwordx4 v4, s[20:23], s70 offen offset:0 lds
  v_mfma_f32_16x16x32_bf16 v[36:39], a[4:7], a[136:139], v[36:39]
  ds_read_b128 a[40:43], v4 offset:58368
  v_mfma_f32_16x16x32_bf16 v[72:75], a[4:7], a[140:143], v[72:75]
  ds_read_b128 a[44:47], v4 offset:60416
  v_mfma_f32_16x16x32_bf16 v[40:43], a[8:11], a[136:139], v[40:43]
  buffer_load_dwordx4 v4, s[20:23], s70 offen offset:1024 lds
  v_mfma_f32_16x16x32_bf16 v[76:79], a[8:11], a[140:143], v[76:79]
  ds_read_b128 a[48:51], v4 offset:62464
  v_mfma_f32_16x16x32_bf16 v[44:47], a[12:15], a[136:139], v[44:47]
  ds_read_b128 a[52:55], v4 offset:64512
  v_mfma_f32_16x16x32_bf16 v[80:83], a[12:15], a[140:143], v[80:83]
  buffer_load_dwordx4 v4, s[20:23], s70 offen offset:2048 lds
  v_mfma_f32_16x16x32_bf16 v[48:51], a[16:19], a[136:139], v[48:51]
  ds_read_b128 a[56:59], v5 offset:1024
  v_mfma_f32_16x16x32_bf16 v[84:87], a[16:19], a[140:143], v[84:87]
  ds_read_b128 a[60:63], v5 offset:3072
  v_mfma_f32_16x16x32_bf16 v[52:55], a[20:23], a[136:139], v[52:55]
  buffer_load_dwordx4 v4, s[20:23], s70 offen offset:3072 lds
  v_mfma_f32_16x16x32_bf16 v[88:91], a[20:23], a[140:143], v[88:91]
  ds_read_b128 a[64:67], v5 offset:5120
  v_mfma_f32_16x16x32_bf16 v[56:59], a[24:27], a[136:139], v[56:59]
  ds_read_b128 a[68:71], v5 offset:7168
  s_add_u32 m0, s72, 96256
  v_mfma_f32_16x16x32_bf16 v[92:95], a[24:27], a[140:143], v[92:95]
  buffer_load_dwordx4 v7, s[20:23], s70 offen lds
  v_mfma_f32_16x16x32_bf16 v[60:63], a[28:31], a[136:139], v[60:63]
  v_rcp_f32_e64 v20, v20
  v_mfma_f32_16x16x32_bf16 v[96:99], a[28:31], a[140:143], v[96:99]
  v_rcp_f32_e64 v21, v21
  v_mfma_f32_16x16x32_bf16 v[64:67], a[32:35], a[136:139], v[64:67]
  v_rcp_f32_e64 v22, v22
  v_mfma_f32_16x16x32_bf16 v[100:103], a[32:35], a[140:143], v[100:103]
  v_rcp_f32_e64 v23, v23
  s_waitcnt vmcnt(20)
  s_waitcnt lgkmcnt(0)
  s_barrier
  v_mfma_f32_16x16x32_bf16 v[32:35], a[36:39], a[144:147], v[32:35]
  ds_read_b128 a[0:3], v5 offset:8192
  v_fma_mix_f32 v180, v136, v16, 0 op_sel:[0,0,0] op_sel_hi:[1,0,0]
  v_mfma_f32_16x16x32_bf16 v[68:71], a[36:39], a[148:151], v[68:71]
  ds_read_b128 a[4:7], v5 offset:10240
  s_add_u32 s70, s66, 0
  v_mfma_f32_16x16x32_bf16 v[36:39], a[40:43], a[144:147], v[36:39]
  ds_read_b128 a[8:11], v5 offset:12288
  s_add_u32 m0, s72, 110592
  v_mfma_f32_16x16x32_bf16 v[72:75], a[40:43], a[148:151], v[72:75]
  buffer_load_dwordx4 v4, s[20:23], s70 offen offset:0 lds
  v_mfma_f32_16x16x32_bf16 v[40:43], a[44:47], a[144:147], v[40:43]
  ds_read_b128 a[12:15], v5 offset:14336
  v_fma_mix_f32 v181, v136, v17, 0 op_sel:[1,0,0] op_sel_hi:[1,0,0]
  v_mfma_f32_16x16x32_bf16 v[76:79], a[44:47], a[148:151], v[76:79]
  ds_read_b128 a[16:19], v5 offset:16384
  v_fma_mix_f32 v182, v137, v18, 0 op_sel:[0,0,0] op_sel_hi:[1,0,0]
  v_mfma_f32_16x16x32_bf16 v[44:47], a[48:51], a[144:147], v[44:47]
  buffer_load_dwordx4 v4, s[20:23], s70 offen offset:1024 lds
  v_mfma_f32_16x16x32_bf16 v[80:83], a[48:51], a[148:151], v[80:83]
  ds_read_b128 a[20:23], v5 offset:18432
  v_fma_mix_f32 v183, v137, v19, 0 op_sel:[1,0,0] op_sel_hi:[1,0,0]
  v_mfma_f32_16x16x32_bf16 v[48:51], a[52:55], a[144:147], v[48:51]
  ds_read_b128 a[24:27], v5 offset:20480
  v_fma_mix_f32 v192, v148, v20, 0 op_sel:[0,0,0] op_sel_hi:[1,0,0]
  v_mfma_f32_16x16x32_bf16 v[84:87], a[52:55], a[148:151], v[84:87]
  buffer_load_dwordx4 v4, s[20:23], s70 offen offset:2048 lds
  v_mfma_f32_16x16x32_bf16 v[52:55], a[56:59], a[144:147], v[52:55]
  ds_read_b128 a[28:31], v5 offset:22528
  v_fma_mix_f32 v193, v148, v21, 0 op_sel:[1,0,0] op_sel_hi:[1,0,0]
  v_mfma_f32_16x16x32_bf16 v[88:91], a[56:59], a[148:151], v[88:91]
  ds_read_b128 a[32:35], v5 offset:24576
  v_fma_mix_f32 v194, v149, v22, 0 op_sel:[0,0,0] op_sel_hi:[1,0,0]
  v_mfma_f32_16x16x32_bf16 v[56:59], a[60:63], a[144:147], v[56:59]
  buffer_load_dwordx4 v4, s[20:23], s70 offen offset:3072 lds
  v_mfma_f32_16x16x32_bf16 v[92:95], a[60:63], a[148:151], v[92:95]
  v_fma_mix_f32 v195, v149, v23, 0 op_sel:[1,0,0] op_sel_hi:[1,0,0]
  s_add_u32 m0, s72, 114688
  v_mfma_f32_16x16x32_bf16 v[60:63], a[64:67], a[144:147], v[60:63]
  v_rcp_f32_e64 v30, v30
  v_mfma_f32_16x16x32_bf16 v[96:99], a[64:67], a[148:151], v[96:99]
  buffer_load_dwordx4 v7, s[20:23], s70 offen lds
  v_mfma_f32_16x16x32_bf16 v[64:67], a[68:71], a[144:147], v[64:67]
  v_rcp_f32 v31, v31
  s_add_u32 s70, s66, 18432
  v_mfma_f32_16x16x32_bf16 v[100:103], a[68:71], a[148:151], v[100:103]
  v_fma_mix_f32 v184, v140, v24, 0 op_sel:[0,0,0] op_sel_hi:[1,0,0]
  s_add_u32 m0, s72, 36864
  s_waitcnt lgkmcnt(0)
  v_mfma_f32_16x16x32_bf16 v[32:35], a[0:3], a[152:155], v[32:35]
  ds_read_b128 a[36:39], v5 offset:9216
  v_fma_mix_f32 v185, v140, v25, 0 op_sel:[1,0,0] op_sel_hi:[1,0,0]
  v_mfma_f32_16x16x32_bf16 v[68:71], a[0:3], a[156:159], v[68:71]
  buffer_load_dwordx4 v4, s[20:23], s70 offen offset:0 lds
  v_mfma_f32_16x16x32_bf16 v[36:39], a[4:7], a[152:155], v[36:39]
  ds_read_b128 a[40:43], v5 offset:11264
  v_fma_mix_f32 v186, v141, v26, 0 op_sel:[0,0,0] op_sel_hi:[1,0,0]
  v_mfma_f32_16x16x32_bf16 v[72:75], a[4:7], a[156:159], v[72:75]
  ds_read_b128 a[44:47], v5 offset:13312
  v_fma_mix_f32 v187, v141, v27, 0 op_sel:[1,0,0] op_sel_hi:[1,0,0]
  v_mfma_f32_16x16x32_bf16 v[40:43], a[8:11], a[152:155], v[40:43]
  buffer_load_dwordx4 v4, s[20:23], s70 offen offset:1024 lds
  v_mfma_f32_16x16x32_bf16 v[76:79], a[8:11], a[156:159], v[76:79]
  ds_read_b128 a[48:51], v5 offset:15360
  v_fma_mix_f32 v188, v144, v28, 0 op_sel:[0,0,0] op_sel_hi:[1,0,0]
  v_mfma_f32_16x16x32_bf16 v[44:47], a[12:15], a[152:155], v[44:47]
  ds_read_b128 a[52:55], v5 offset:17408
  v_fma_mix_f32 v189, v144, v29, 0 op_sel:[1,0,0] op_sel_hi:[1,0,0]
  v_mfma_f32_16x16x32_bf16 v[80:83], a[12:15], a[156:159], v[80:83]
  buffer_load_dwordx4 v4, s[20:23], s70 offen offset:2048 lds
  v_mfma_f32_16x16x32_bf16 v[48:51], a[16:19], a[152:155], v[48:51]
  ds_read_b128 a[56:59], v5 offset:19456
  v_fma_mix_f32 v190, v145, v30, 0 op_sel:[0,0,0] op_sel_hi:[1,0,0]
  v_mfma_f32_16x16x32_bf16 v[84:87], a[16:19], a[156:159], v[84:87]
  ds_read_b128 a[60:63], v5 offset:21504
  v_fma_mix_f32 v191, v145, v31, 0 op_sel:[1,0,0] op_sel_hi:[1,0,0]
  v_mfma_f32_16x16x32_bf16 v[52:55], a[20:23], a[152:155], v[52:55]
  buffer_load_dwordx4 v4, s[20:23], s70 offen offset:3072 lds
  v_mfma_f32_16x16x32_bf16 v[88:91], a[20:23], a[156:159], v[88:91]
  ds_read_b128 a[64:67], v5 offset:23552
  s_mul_i32 s40, s33, 147456
  s_lshr_b32 s39, s29, 257
  v_mfma_f32_16x16x32_bf16 v[56:59], a[24:27], a[152:155], v[56:59]
  ds_read_b128 a[68:71], v5 offset:25600
  s_add_u32 m0, s72, 40960
  v_mfma_f32_16x16x32_bf16 v[92:95], a[24:27], a[156:159], v[92:95]
  buffer_load_dwordx4 v7, s[20:23], s70 offen lds
  v_mfma_f32_16x16x32_bf16 v[60:63], a[28:31], a[152:155], v[60:63]
  s_mul_i32 s39, s39, 9216
  s_add_u32 s45, s40, s39
  s_and_b32 s39, s29, 1
  v_mfma_f32_16x16x32_bf16 v[96:99], a[28:31], a[156:159], v[96:99]
  s_lshl_b32 s35, s39, 12
  s_add_u32 s41, s45, s35
  s_lshl_b32 s39, s39, 265
  v_mfma_f32_16x16x32_bf16 v[64:67], a[32:35], a[152:155], v[64:67]
  v_mfma_f32_16x16x32_bf16 v[100:103], a[32:35], a[156:159], v[100:103]
  s_waitcnt lgkmcnt(0)
  v_mfma_f32_16x16x32_bf16 v[32:35], a[36:39], a[160:163], v[32:35]
  s_add_u32 s45, s45, s39
  v_mov_b32_e64 v12, v4
  s_add_u32 s45, s45, 8192
  v_mfma_f32_16x16x32_bf16 v[36:39], a[40:43], a[160:163], v[36:39]
  v_add_u32 v13, 73728, v4
  v_lshrrev_b32 v14, 1, v4
  v_add_u32 v15, 73728, v14
  v_mfma_f32_16x16x32_bf16 v[68:71], a[36:39], a[164:167], v[68:71]
  s_nop 2
  v_mfma_f32_16x16x32_bf16 v[72:75], a[40:43], a[164:167], v[72:75]
  v_pk_mul_f32 v[32:33], v[32:33], v[160:161]
  v_pk_mul_f32 v[34:35], v[34:35], v[162:163]
  v_cvt_pk_bf16_f32 v116, v32, v33
  v_cvt_pk_bf16_f32 v117, v34, v35
  v_mfma_f32_16x16x32_bf16 v[40:43], a[44:47], a[160:163], v[40:43]
  v_pk_mul_f32 v[36:37], v[36:37], v[164:165]
  v_pk_mul_f32 v[38:39], v[38:39], v[166:167]
  v_cvt_pk_bf16_f32 v118, v36, v37
  v_cvt_pk_bf16_f32 v119, v38, v39
  v_mfma_f32_16x16x32_bf16 v[44:47], a[48:51], a[160:163], v[44:47]
  buffer_store_dwordx4 v[116:119], v12, s[52:55], s41 offen offset:0 sc0 sc1
  v_mfma_f32_16x16x32_bf16 v[76:79], a[44:47], a[164:167], v[76:79]
  v_pk_mul_f32 v[68:69], v[68:69], v[196:197]
  v_pk_mul_f32 v[70:71], v[70:71], v[198:199]
  v_cvt_pk_bf16_f32 v120, v68, v69
  v_cvt_pk_bf16_f32 v121, v70, v71
  v_mfma_f32_16x16x32_bf16 v[80:83], a[48:51], a[164:167], v[80:83]
  v_pk_mul_f32 v[72:73], v[72:73], v[200:201]
  v_pk_mul_f32 v[74:75], v[74:75], v[202:203]
  v_cvt_pk_bf16_f32 v122, v72, v73
  v_cvt_pk_bf16_f32 v123, v74, v75
  v_mfma_f32_16x16x32_bf16 v[48:51], a[52:55], a[160:163], v[48:51]
  buffer_store_dwordx4 v[120:123], v13, s[52:55], s41 offen offset:0 sc0 sc1
  v_mfma_f32_16x16x32_bf16 v[52:55], a[56:59], a[160:163], v[52:55]
  v_pk_mul_f32 v[40:41], v[40:41], v[168:169]
  v_pk_mul_f32 v[42:43], v[42:43], v[170:171]
  v_cvt_pk_bf16_f32 v124, v40, v41
  v_cvt_pk_bf16_f32 v125, v42, v43
  v_mfma_f32_16x16x32_bf16 v[84:87], a[52:55], a[164:167], v[84:87]
  v_pk_mul_f32 v[44:45], v[44:45], v[172:173]
  v_pk_mul_f32 v[46:47], v[46:47], v[174:175]
  v_cvt_pk_bf16_f32 v126, v44, v45
  v_cvt_pk_bf16_f32 v127, v46, v47
  v_mfma_f32_16x16x32_bf16 v[88:91], a[56:59], a[164:167], v[88:91]
  buffer_store_dwordx4 v[124:127], v12, s[52:55], s41 offen offset:1024 sc0 sc1
  v_mfma_f32_16x16x32_bf16 v[56:59], a[60:63], a[160:163], v[56:59]
  v_pk_mul_f32 v[76:77], v[76:77], v[204:205]
  v_pk_mul_f32 v[78:79], v[78:79], v[206:207]
  v_cvt_pk_bf16_f32 v128, v76, v77
  v_cvt_pk_bf16_f32 v129, v78, v79
  v_mfma_f32_16x16x32_bf16 v[60:63], a[64:67], a[160:163], v[60:63]
  v_pk_mul_f32 v[80:81], v[80:81], v[208:209]
  v_pk_mul_f32 v[82:83], v[82:83], v[210:211]
  v_cvt_pk_bf16_f32 v130, v80, v81
  v_cvt_pk_bf16_f32 v131, v82, v83
  v_mfma_f32_16x16x32_bf16 v[92:95], a[60:63], a[164:167], v[92:95]
  buffer_store_dwordx4 v[128:131], v13, s[52:55], s41 offen offset:1024 sc0 sc1
  v_mfma_f32_16x16x32_bf16 v[96:99], a[64:67], a[164:167], v[96:99]
  v_pk_mul_f32 v[48:49], v[48:49], v[176:177]
  v_pk_mul_f32 v[50:51], v[50:51], v[178:179]
  v_cvt_pk_bf16_f32 v132, v48, v49
  v_cvt_pk_bf16_f32 v133, v50, v51
  v_mfma_f32_16x16x32_bf16 v[64:67], a[68:71], a[160:163], v[64:67]
  v_pk_mul_f32 v[52:53], v[52:53], v[180:181]
  v_pk_mul_f32 v[54:55], v[54:55], v[182:183]
  v_cvt_pk_bf16_f32 v134, v52, v53
  v_cvt_pk_bf16_f32 v135, v54, v55
  v_mfma_f32_16x16x32_bf16 v[100:103], a[68:71], a[164:167], v[100:103]
  buffer_store_dwordx4 v[132:135], v12, s[52:55], s41 offen offset:2048 sc0 sc1
  v_pk_mul_f32 v[84:85], v[84:85], v[212:213]
  v_pk_mul_f32 v[86:87], v[86:87], v[214:215]
  v_cvt_pk_bf16_f32 v136, v84, v85
  v_cvt_pk_bf16_f32 v137, v86, v87
  v_pk_mul_f32 v[88:89], v[88:89], v[216:217]
  v_pk_mul_f32 v[90:91], v[90:91], v[218:219]
  v_cvt_pk_bf16_f32 v138, v88, v89
  v_cvt_pk_bf16_f32 v139, v90, v91
  buffer_store_dwordx4 v[136:139], v13, s[52:55], s41 offen offset:2048 sc0 sc1
  v_pk_mul_f32 v[56:57], v[56:57], v[184:185]
  v_pk_mul_f32 v[58:59], v[58:59], v[186:187]
  v_cvt_pk_bf16_f32 v140, v56, v57
  v_cvt_pk_bf16_f32 v141, v58, v59
  v_pk_mul_f32 v[60:61], v[60:61], v[188:189]
  v_pk_mul_f32 v[62:63], v[62:63], v[190:191]
  v_cvt_pk_bf16_f32 v142, v60, v61
  v_cvt_pk_bf16_f32 v143, v62, v63
  buffer_store_dwordx4 v[140:143], v12, s[52:55], s41 offen offset:3072 sc0 sc1
  v_pk_mul_f32 v[92:93], v[92:93], v[220:221]
  v_pk_mul_f32 v[94:95], v[94:95], v[222:223]
  v_cvt_pk_bf16_f32 v144, v92, v93
  v_cvt_pk_bf16_f32 v145, v94, v95
  v_pk_mul_f32 v[96:97], v[96:97], v[224:225]
  v_pk_mul_f32 v[98:99], v[98:99], v[226:227]
  v_cvt_pk_bf16_f32 v146, v96, v97
  v_cvt_pk_bf16_f32 v147, v98, v99
  buffer_store_dwordx4 v[144:147], v13, s[52:55], s41 offen offset:3072 sc0 sc1
  v_pk_mul_f32 v[64:65], v[64:65], v[192:193]
  v_pk_mul_f32 v[66:67], v[66:67], v[194:195]
  v_cvt_pk_bf16_f32 v148, v64, v65
  v_cvt_pk_bf16_f32 v149, v66, v67
  buffer_store_dwordx2 v[148:149], v14, s[52:55], s45 offen sc0 sc1
  v_pk_mul_f32 v[100:101], v[100:101], v[228:229]
  v_pk_mul_f32 v[102:103], v[102:103], v[230:231]
  v_cvt_pk_bf16_f32 v150, v100, v101
  v_cvt_pk_bf16_f32 v151, v102, v103
  buffer_store_dwordx2 v[150:151], v15, s[52:55], s45 offen sc0 sc1
  s_waitcnt vmcnt(20)
  s_barrier
  ds_read_b128 a[112:115], v237 offset:63488
  ds_read_b128 a[116:119], v237 offset:64512
  ds_read_b128 a[120:123], v240 offset:63488
  ds_read_b128 a[124:127], v240 offset:64512
  ds_read_b128 a[128:131], v243 offset:63488
  ds_read_b128 a[132:135], v243 offset:64512
  ds_read_b128 a[136:139], v246 offset:63488
  ds_read_b128 a[140:143], v246 offset:64512
  ds_read_b128 a[144:147], v6 offset:6144
  s_add_u32 s70, s67, 0
  s_add_u32 m0, s72, 55296
  s_getpc_b64 s[94:95]
  global_load_dword a248, v232, s[94:95]
  v_and_b32 v16, 3, v1
  v_cmp_eq_u32 vcc, s74, v16
  v_cndmask_b32 v19, -1, 0, vcc
  v_lshlrev_b32_e64 v16, 6, v16
  s_mul_i32 s35, s75, 18432
  s_add_u32 s45, s40, s35
  s_add_u32 s45, s45, 8192
  s_waitcnt lgkmcnt(0)
  v_mfma_f32_16x16x32_bf16 v[32:35], a[112:115], v[116:119], 0
  ds_read_b128 a[148:151], v238 offset:7168
  v_mfma_f32_16x16x32_bf16 v[36:39], a[112:115], v[120:123], 0
  buffer_load_dwordx4 v4, s[20:23], s70 offen offset:0 lds
  v_mfma_f32_16x16x32_bf16 v[40:43], a[116:119], v[116:119], 0
  ds_read_b128 a[152:155], v238 offset:8192
  v_mfma_f32_16x16x32_bf16 v[44:47], a[116:119], v[120:123], 0
  buffer_load_dwordx4 v4, s[20:23], s70 offen offset:1024 lds
  v_mfma_f32_16x16x32_bf16 v[48:51], a[120:123], v[116:119], 0
  ds_read_b128 a[156:159], v241 offset:7168
  v_mfma_f32_16x16x32_bf16 v[52:55], a[120:123], v[120:123], 0
  buffer_load_dwordx4 v4, s[20:23], s70 offen offset:2048 lds
  v_mfma_f32_16x16x32_bf16 v[56:59], a[124:127], v[116:119], 0
  ds_read_b128 a[160:163], v241 offset:8192
  v_mfma_f32_16x16x32_bf16 v[60:63], a[124:127], v[120:123], 0
  buffer_load_dwordx4 v4, s[20:23], s70 offen offset:3072 lds
  v_mfma_f32_16x16x32_bf16 v[64:67], a[128:131], v[116:119], 0
  ds_read_b128 a[164:167], v244 offset:7168
  s_add_u32 m0, s72, 59392
  v_mfma_f32_16x16x32_bf16 v[68:71], a[128:131], v[120:123], 0
  buffer_load_dwordx4 v7, s[20:23], s70 offen lds
  v_mfma_f32_16x16x32_bf16 v[72:75], a[132:135], v[116:119], 0
  ds_read_b128 a[168:171], v244 offset:8192
  s_add_u32 s70, s68, 0
  s_nop 0
  s_add_u32 m0, s69, 147456
  v_mfma_f32_16x16x32_bf16 v[76:79], a[132:135], v[120:123], 0
  buffer_load_dwordx4 v4, s[20:23], s70 offen offset:0 lds
  v_mfma_f32_16x16x32_bf16 v[80:83], a[136:139], v[116:119], 0
  ds_read_b128 a[172:175], v247 offset:7168
  v_mfma_f32_16x16x32_bf16 v[84:87], a[136:139], v[120:123], 0
  buffer_load_dwordx4 v4, s[20:23], s70 offen offset:1024 lds
  v_mfma_f32_16x16x32_bf16 v[88:91], a[140:143], v[116:119], 0
  ds_read_b128 a[176:179], v247 offset:8192
  v_mfma_f32_16x16x32_bf16 v[92:95], a[140:143], v[120:123], 0
  s_mov_b64 exec, 0xffff
  buffer_load_dwordx4 v4, s[20:23], s70 offen offset:2048 lds
  s_mov_b64 exec, -1
  v_mfma_f32_16x16x32_bf16 v[96:99], a[144:147], v[116:119], 0
  ds_read_b128 a[180:183], v6 offset:15360
  s_add_u32 s70, s67, 18432
  s_add_u32 m0, s72, 73728
  v_mfma_f32_16x16x32_bf16 v[100:103], a[144:147], v[120:123], 0
  buffer_load_dwordx4 v4, s[20:23], s70 offen offset:0 lds
  s_waitcnt lgkmcnt(0)
  v_mfma_f32_16x16x32_bf16 v[32:35], a[148:151], v[124:127], v[32:35]
  ds_read_b128 a[112:115], v236 offset:0
  v_mfma_f32_16x16x32_bf16 v[36:39], a[148:151], v[128:131], v[36:39]
  buffer_load_dwordx4 v4, s[20:23], s70 offen offset:1024 lds
  v_mfma_f32_16x16x32_bf16 v[40:43], a[152:155], v[124:127], v[40:43]
  ds_read_b128 a[116:119], v236 offset:1024
  v_mfma_f32_16x16x32_bf16 v[44:47], a[152:155], v[128:131], v[44:47]
  buffer_load_dwordx4 v4, s[20:23], s70 offen offset:2048 lds
  v_mfma_f32_16x16x32_bf16 v[48:51], a[156:159], v[124:127], v[48:51]
  ds_read_b128 a[120:123], v239 offset:0
  v_mfma_f32_16x16x32_bf16 v[52:55], a[156:159], v[128:131], v[52:55]
  buffer_load_dwordx4 v4, s[20:23], s70 offen offset:3072 lds
  v_mfma_f32_16x16x32_bf16 v[56:59], a[160:163], v[124:127], v[56:59]
  ds_read_b128 a[124:127], v239 offset:1024
  s_add_u32 m0, s72, 77824
  v_mfma_f32_16x16x32_bf16 v[60:63], a[160:163], v[128:131], v[60:63]
  buffer_load_dwordx4 v7, s[20:23], s70 offen lds
  v_mfma_f32_16x16x32_bf16 v[64:67], a[164:167], v[124:127], v[64:67]
  ds_read_b128 a[128:131], v242 offset:0
  v_mfma_f32_16x16x32_bf16 v[68:71], a[164:167], v[128:131], v[68:71]
  s_add_u32 s34, s74, 1
  s_and_b32 s34, s34, 3
  s_lshl2_add_u32 s34, s75, s34
  v_mfma_f32_16x16x32_bf16 v[72:75], a[168:171], v[124:127], v[72:75]
  ds_read_b128 a[132:135], v242 offset:1024
  v_mfma_f32_16x16x32_bf16 v[76:79], a[168:171], v[128:131], v[76:79]
  s_lshr_b32 s39, s34, 257
  s_mul_i32 s39, s39, 9216
  s_and_b32 s34, s34, 1
  v_mfma_f32_16x16x32_bf16 v[80:83], a[172:175], v[124:127], v[80:83]
  ds_read_b128 a[136:139], v245 offset:0
  v_mfma_f32_16x16x32_bf16 v[84:87], a[172:175], v[128:131], v[84:87]
  s_lshl_b32 s34, s34, 12
  s_add_u32 s34, s34, s39
  s_add_u32 s42, s40, s34
  v_mfma_f32_16x16x32_bf16 v[88:91], a[176:179], v[124:127], v[88:91]
  ds_read_b128 a[140:143], v245 offset:1024
  v_mfma_f32_16x16x32_bf16 v[92:95], a[176:179], v[128:131], v[92:95]
  s_add_u32 s34, s74, 2
  s_and_b32 s34, s34, 3
  s_lshl2_add_u32 s34, s75, s34
  v_mfma_f32_16x16x32_bf16 v[96:99], a[180:183], v[124:127], v[96:99]
  ds_read_b128 a[144:147], v4 offset:8192
  v_mfma_f32_16x16x32_bf16 v[100:103], a[180:183], v[128:131], v[100:103]
  s_lshr_b32 s39, s34, 257
  s_mul_i32 s39, s39, 9216
  s_and_b32 s34, s34, 1
  s_waitcnt vmcnt(14)
  buffer_store_dwordx4 v[252:255], v250, s[24:27], s47 offen sc0 sc1
  s_waitcnt lgkmcnt(0)
  v_mfma_f32_16x16x32_bf16 v[32:35], a[112:115], v[132:135], v[32:35]
  ds_read_b128 a[148:151], v236 offset:9216
  v_mfma_f32_16x16x32_bf16 v[36:39], a[112:115], v[136:139], v[36:39]
  s_lshl_b32 s34, s34, 268
  s_add_u32 s34, s34, s39
  s_add_u32 s43, s40, s34
  v_mfma_f32_16x16x32_bf16 v[40:43], a[116:119], v[132:135], v[40:43]
  ds_read_b128 a[152:155], v236 offset:10240
  v_mfma_f32_16x16x32_bf16 v[44:47], a[116:119], v[136:139], v[44:47]
  s_add_u32 s34, s74, 3
  s_and_b32 s34, s34, 3
  s_lshl2_add_u32 s34, s75, s34
  v_mfma_f32_16x16x32_bf16 v[48:51], a[120:123], v[132:135], v[48:51]
  ds_read_b128 a[156:159], v239 offset:9216
  v_mfma_f32_16x16x32_bf16 v[52:55], a[120:123], v[136:139], v[52:55]
  s_lshr_b32 s39, s34, 1
  s_mul_i32 s39, s39, 9216
  s_and_b32 s34, s34, 1
  v_mfma_f32_16x16x32_bf16 v[56:59], a[124:127], v[132:135], v[56:59]
  ds_read_b128 a[160:163], v239 offset:10240
  v_mfma_f32_16x16x32_bf16 v[60:63], a[124:127], v[136:139], v[60:63]
  s_lshl_b32 s34, s34, 12
  s_add_u32 s34, s34, s39
  s_add_u32 s44, s40, s34
  v_mfma_f32_16x16x32_bf16 v[64:67], a[128:131], v[132:135], v[64:67]
  ds_read_b128 a[164:167], v242 offset:9216
  v_mfma_f32_16x16x32_bf16 v[68:71], a[128:131], v[136:139], v[68:71]
  ds_read_b128 a[168:171], v242 offset:10240
  v_mfma_f32_16x16x32_bf16 v[72:75], a[132:135], v[132:135], v[72:75]
  ds_read_b128 a[172:175], v245 offset:9216
  v_mfma_f32_16x16x32_bf16 v[76:79], a[132:135], v[136:139], v[76:79]
  ds_read_b128 a[176:179], v245 offset:10240
  v_mfma_f32_16x16x32_bf16 v[80:83], a[136:139], v[132:135], v[80:83]
  ds_read_b128 a[180:183], v4 offset:17408
  v_mfma_f32_16x16x32_bf16 v[84:87], a[136:139], v[136:139], v[84:87]
  v_mfma_f32_16x16x32_bf16 v[88:91], a[140:143], v[132:135], v[88:91]
  v_mfma_f32_16x16x32_bf16 v[92:95], a[140:143], v[136:139], v[92:95]
  v_mfma_f32_16x16x32_bf16 v[96:99], a[144:147], v[132:135], v[96:99]
  v_mfma_f32_16x16x32_bf16 v[100:103], a[144:147], v[136:139], v[100:103]
  s_waitcnt lgkmcnt(0)
  v_mfma_f32_16x16x32_bf16 v[32:35], a[148:151], v[140:143], v[32:35]
  ds_read_b128 a[120:123], v239 offset:18432
  v_mfma_f32_16x16x32_bf16 v[36:39], a[148:151], v[144:147], v[36:39]
  ds_read_b128 a[124:127], v239 offset:19456
  v_mfma_f32_16x16x32_bf16 v[40:43], a[152:155], v[140:143], v[40:43]
  ds_read_b128 a[128:131], v242 offset:18432
  v_mfma_f32_16x16x32_bf16 v[44:47], a[152:155], v[144:147], v[44:47]
  ds_read_b128 a[132:135], v242 offset:19456
  v_mfma_f32_16x16x32_bf16 v[48:51], a[156:159], v[140:143], v[48:51]
  ds_read_b128 a[136:139], v245 offset:18432
  v_mfma_f32_16x16x32_bf16 v[52:55], a[156:159], v[144:147], v[52:55]
  ds_read_b128 a[140:143], v245 offset:19456
  v_mfma_f32_16x16x32_bf16 v[56:59], a[160:163], v[140:143], v[56:59]
  ds_read_b128 a[144:147], v4 offset:26624
  v_mfma_f32_16x16x32_bf16 v[60:63], a[160:163], v[144:147], v[60:63]
  v_mfma_f32_16x16x32_bf16 v[64:67], a[164:167], v[140:143], v[64:67]
  v_mfma_f32_16x16x32_bf16 v[68:71], a[164:167], v[144:147], v[68:71]
  v_mfma_f32_16x16x32_bf16 v[72:75], a[168:171], v[140:143], v[72:75]
  v_mfma_f32_16x16x32_bf16 v[76:79], a[168:171], v[144:147], v[76:79]
  v_mfma_f32_16x16x32_bf16 v[80:83], a[172:175], v[140:143], v[80:83]
  v_mfma_f32_16x16x32_bf16 v[84:87], a[172:175], v[144:147], v[84:87]
  v_mfma_f32_16x16x32_bf16 v[88:91], a[176:179], v[140:143], v[88:91]
  v_mfma_f32_16x16x32_bf16 v[92:95], a[176:179], v[144:147], v[92:95]
  v_mfma_f32_16x16x32_bf16 v[96:99], a[180:183], v[140:143], v[96:99]
  v_mfma_f32_16x16x32_bf16 v[100:103], a[180:183], v[144:147], v[100:103]
  buffer_load_dword v21, v16, s[24:27], s46 offen sc0 sc1
  s_mov_b32 s39, 0
  s_branch L_f5_chk
L_f5_spin:
  buffer_load_dword v21, v16, s[24:27], s46 offen sc0 sc1
L_f5_chk:
  s_waitcnt vmcnt(0)
  v_and_b32 v21, v21, v19
  v_cmp_eq_u32_e64 vcc, -1, v21
  s_cmp_eq_u64 vcc, 0
  s_cbranch_scc1 L_f5_go
  s_add_u32 s39, s39, 1
  s_cmp_lt_u32 s39, 0x40000
  s_cbranch_scc0 L_f5_go
  s_sleep 1
  s_branch L_f5_spin
L_f5_go:
  buffer_load_dwordx4 a[0:3], v12, s[52:55], s42 offen offset:0
  buffer_load_dwordx4 a[4:7], v13, s[52:55], s42 offen offset:0
  buffer_load_dwordx4 a[8:11], v12, s[52:55], s42 offen offset:1024
  buffer_load_dwordx4 a[12:15], v13, s[52:55], s42 offen offset:1024
  buffer_load_dwordx4 a[16:19], v12, s[52:55], s42 offen offset:2048
  buffer_load_dwordx4 a[20:23], v13, s[52:55], s42 offen offset:2048
  buffer_load_dwordx4 a[24:27], v12, s[52:55], s42 offen offset:3072
  buffer_load_dwordx4 a[28:31], v13, s[52:55], s42 offen offset:3072
  buffer_load_dwordx4 a[32:35], v12, s[52:55], s43 offen offset:0
  buffer_load_dwordx4 a[36:39], v13, s[52:55], s43 offen offset:0
  s_add_u32 s16, s10, 9437184
  s_addc_u32 s17, s11, 0
  s_mov_b32 s18, 2359296
  s_mov_b32 s19, 0x00020000
  s_nop 0
L_pg_22:
  s_cbranch_execz L_wr_3
  s_add_u32 s60, s10, 50331648
  s_addc_u32 s61, s11, 0
  s_mov_b32 s62, 9437184
  s_mov_b32 s63, 0x00020000
  s_mov_b32 s56, s84
  s_mov_b32 s57, s85
  s_mov_b32 s58, 2359296
  s_mov_b32 s59, 0x00020000
  s_mul_i32 s48, s33, 36864
  s_mul_i32 s39, s74, 288
  s_add_u32 s48, s48, s39
  s_lshl_b32 s39, s75, 6
  s_add_u32 s49, s48, s39
  s_mul_i32 s35, s33, 36864
  s_mul_i32 s34, s74, 9
  v_add_u32 v20, 18432, v12
  s_lshl_b32 s51, s28, 2
  s_add_u32 s51, s51, s74
  s_lshl_b32 s51, s51, 2
  s_add_u32 s51, s51, s12
  s_mul_i32 s51, s51, 36864
  v_mul_u32_u24 v26, 1152, v2
  v_lshl_add_u32 v26, v3, 3, v26
  v_add_u32 v27, 18432, v26
  v_cmp_eq_u32 vcc, s75, v3
  v_mov_b32 v31, 0x40000000
  v_cndmask_b32 v31, v31, 0, vcc
  v_add_u32 v28, v31, v26
  v_add_u32 v29, v31, v27
  v_add_u32 v30, v31, v12
  s_getpc_b64 s[94:95]
  global_load_dword a248, v232, s[94:95]
  s_waitcnt vmcnt(9)
  s_waitcnt lgkmcnt(0)
  v_mfma_f32_16x16x32_bf16 v[48:51], a[120:123], a[0:3], v[48:51]
  ds_read_b128 a[156:159], v239 offset:27648
  v_mfma_f32_16x16x32_bf16 v[52:55], a[120:123], a[4:7], v[52:55]
  ds_read_b128 a[160:163], v239 offset:28672
  v_mfma_f32_16x16x32_bf16 v[56:59], a[124:127], a[0:3], v[56:59]
  buffer_load_dwordx4 a[40:43], v12, s[52:55], s43 offen offset:1024
  v_mfma_f32_16x16x32_bf16 v[60:63], a[124:127], a[4:7], v[60:63]
  ds_read_b128 a[164:167], v242 offset:27648
  v_mfma_f32_16x16x32_bf16 v[64:67], a[128:131], a[0:3], v[64:67]
  ds_read_b128 a[168:171], v242 offset:28672
  v_mfma_f32_16x16x32_bf16 v[68:71], a[128:131], a[4:7], v[68:71]
  buffer_load_dwordx4 a[44:47], v13, s[52:55], s43 offen offset:1024
  v_mfma_f32_16x16x32_bf16 v[72:75], a[132:135], a[0:3], v[72:75]
  ds_read_b128 a[172:175], v245 offset:27648
  v_mfma_f32_16x16x32_bf16 v[76:79], a[132:135], a[4:7], v[76:79]
  ds_read_b128 a[176:179], v245 offset:28672
  v_mfma_f32_16x16x32_bf16 v[80:83], a[136:139], a[0:3], v[80:83]
  ds_read_b128 a[180:183], v4 offset:35840
  v_mfma_f32_16x16x32_bf16 v[84:87], a[136:139], a[4:7], v[84:87]
  v_mfma_f32_16x16x32_bf16 v[88:91], a[140:143], a[0:3], v[88:91]
  v_mfma_f32_16x16x32_bf16 v[92:95], a[140:143], a[4:7], v[92:95]
  v_mfma_f32_16x16x32_bf16 v[96:99], a[144:147], a[0:3], v[96:99]
  v_mfma_f32_16x16x32_bf16 v[100:103], a[144:147], a[4:7], v[100:103]
  s_waitcnt vmcnt(9)
  s_waitcnt lgkmcnt(0)
  v_mfma_f32_16x16x32_bf16 v[48:51], a[156:159], a[8:11], v[48:51]
  ds_read_b128 a[120:123], v240 offset:26624
  v_mfma_f32_16x16x32_bf16 v[52:55], a[156:159], a[12:15], v[52:55]
  ds_read_b128 a[124:127], v240 offset:27648
  v_mfma_f32_16x16x32_bf16 v[56:59], a[160:163], a[8:11], v[56:59]
  buffer_load_dwordx4 a[48:51], v12, s[52:55], s43 offen offset:2048
  v_mfma_f32_16x16x32_bf16 v[60:63], a[160:163], a[12:15], v[60:63]
  ds_read_b128 a[128:131], v243 offset:26624
  v_mfma_f32_16x16x32_bf16 v[64:67], a[164:167], a[8:11], v[64:67]
  ds_read_b128 a[132:135], v243 offset:27648
  v_mfma_f32_16x16x32_bf16 v[68:71], a[164:167], a[12:15], v[68:71]
  buffer_load_dwordx4 a[52:55], v13, s[52:55], s43 offen offset:2048
  v_mfma_f32_16x16x32_bf16 v[72:75], a[168:171], a[8:11], v[72:75]
  ds_read_b128 a[136:139], v246 offset:26624
  v_mfma_f32_16x16x32_bf16 v[76:79], a[168:171], a[12:15], v[76:79]
  ds_read_b128 a[140:143], v246 offset:27648
  v_mfma_f32_16x16x32_bf16 v[80:83], a[172:175], a[8:11], v[80:83]
  ds_read_b128 a[144:147], v5 offset:34816
  v_mfma_f32_16x16x32_bf16 v[84:87], a[172:175], a[12:15], v[84:87]
  v_mfma_f32_16x16x32_bf16 v[88:91], a[176:179], a[8:11], v[88:91]
  v_mfma_f32_16x16x32_bf16 v[92:95], a[176:179], a[12:15], v[92:95]
  v_mfma_f32_16x16x32_bf16 v[96:99], a[180:183], a[8:11], v[96:99]
  v_mfma_f32_16x16x32_bf16 v[100:103], a[180:183], a[12:15], v[100:103]
  s_waitcnt vmcnt(9)
  s_waitcnt lgkmcnt(0)
  v_mfma_f32_16x16x32_bf16 v[48:51], a[120:123], a[16:19], v[48:51]
  ds_read_b128 a[156:159], v240 offset:35840
  v_mfma_f32_16x16x32_bf16 v[52:55], a[120:123], a[20:23], v[52:55]
  ds_read_b128 a[160:163], v240 offset:36864
  v_mfma_f32_16x16x32_bf16 v[56:59], a[124:127], a[16:19], v[56:59]
  buffer_load_dwordx4 a[56:59], v12, s[52:55], s43 offen offset:3072
  v_mfma_f32_16x16x32_bf16 v[60:63], a[124:127], a[20:23], v[60:63]
  ds_read_b128 a[164:167], v243 offset:35840
  v_mfma_f32_16x16x32_bf16 v[64:67], a[128:131], a[16:19], v[64:67]
  ds_read_b128 a[168:171], v243 offset:36864
  v_mfma_f32_16x16x32_bf16 v[68:71], a[128:131], a[20:23], v[68:71]
  buffer_load_dwordx4 a[60:63], v13, s[52:55], s43 offen offset:3072
  v_mfma_f32_16x16x32_bf16 v[72:75], a[132:135], a[16:19], v[72:75]
  ds_read_b128 a[172:175], v246 offset:35840
  v_mfma_f32_16x16x32_bf16 v[76:79], a[132:135], a[20:23], v[76:79]
  ds_read_b128 a[176:179], v246 offset:36864
  v_mfma_f32_16x16x32_bf16 v[80:83], a[136:139], a[16:19], v[80:83]
  ds_read_b128 a[180:183], v5 offset:44032
  v_mfma_f32_16x16x32_bf16 v[84:87], a[136:139], a[20:23], v[84:87]
  v_mfma_f32_16x16x32_bf16 v[88:91], a[140:143], a[16:19], v[88:91]
  v_mfma_f32_16x16x32_bf16 v[92:95], a[140:143], a[20:23], v[92:95]
  v_mfma_f32_16x16x32_bf16 v[96:99], a[144:147], a[16:19], v[96:99]
  v_mfma_f32_16x16x32_bf16 v[100:103], a[144:147], a[20:23], v[100:103]
  s_barrier
  s_waitcnt vmcnt(9)
  s_waitcnt lgkmcnt(0)
  s_nop 0
  v_mfma_f32_16x16x32_bf16 v[48:51], a[156:159], a[24:27], v[48:51]
  ds_read_b128 a[120:123], v240 offset:45056
  v_mfma_f32_16x16x32_bf16 v[52:55], a[156:159], a[28:31], v[52:55]
  ds_read_b128 a[124:127], v240 offset:46080
  v_mfma_f32_16x16x32_bf16 v[56:59], a[160:163], a[24:27], v[56:59]
  buffer_load_dwordx4 a[64:67], v12, s[52:55], s44 offen offset:0
  v_mfma_f32_16x16x32_bf16 v[60:63], a[160:163], a[28:31], v[60:63]
  ds_read_b128 a[128:131], v243 offset:45056
  v_mfma_f32_16x16x32_bf16 v[64:67], a[164:167], a[24:27], v[64:67]
  ds_read_b128 a[132:135], v243 offset:46080
  v_mfma_f32_16x16x32_bf16 v[68:71], a[164:167], a[28:31], v[68:71]
  buffer_load_dwordx4 a[68:71], v13, s[52:55], s44 offen offset:0
  v_mfma_f32_16x16x32_bf16 v[72:75], a[168:171], a[24:27], v[72:75]
  ds_read_b128 a[136:139], v246 offset:45056
  v_mfma_f32_16x16x32_bf16 v[76:79], a[168:171], a[28:31], v[76:79]
  ds_read_b128 a[140:143], v246 offset:46080
  v_mfma_f32_16x16x32_bf16 v[80:83], a[172:175], a[24:27], v[80:83]
  ds_read_b128 a[144:147], v5 offset:53248
  v_mfma_f32_16x16x32_bf16 v[84:87], a[172:175], a[28:31], v[84:87]
  v_mfma_f32_16x16x32_bf16 v[88:91], a[176:179], a[24:27], v[88:91]
  v_mfma_f32_16x16x32_bf16 v[92:95], a[176:179], a[28:31], v[92:95]
  v_mfma_f32_16x16x32_bf16 v[96:99], a[180:183], a[24:27], v[96:99]
  v_mfma_f32_16x16x32_bf16 v[100:103], a[180:183], a[28:31], v[100:103]
  s_waitcnt vmcnt(9)
  s_waitcnt lgkmcnt(0)
  v_mfma_f32_16x16x32_bf16 v[48:51], a[120:123], a[32:35], v[48:51]
  ds_read_b128 a[156:159], v240 offset:54272
  v_mfma_f32_16x16x32_bf16 v[52:55], a[120:123], a[36:39], v[52:55]
  ds_read_b128 a[160:163], v240 offset:55296
  v_mfma_f32_16x16x32_bf16 v[56:59], a[124:127], a[32:35], v[56:59]
  buffer_load_dwordx4 a[72:75], v12, s[52:55], s44 offen offset:1024
  v_mfma_f32_16x16x32_bf16 v[60:63], a[124:127], a[36:39], v[60:63]
  ds_read_b128 a[164:167], v243 offset:54272
  v_mfma_f32_16x16x32_bf16 v[64:67], a[128:131], a[32:35], v[64:67]
  ds_read_b128 a[168:171], v243 offset:55296
  v_mfma_f32_16x16x32_bf16 v[68:71], a[128:131], a[36:39], v[68:71]
  buffer_load_dwordx4 a[76:79], v13, s[52:55], s44 offen offset:1024
  v_mfma_f32_16x16x32_bf16 v[72:75], a[132:135], a[32:35], v[72:75]
  ds_read_b128 a[172:175], v246 offset:54272
  v_mfma_f32_16x16x32_bf16 v[76:79], a[132:135], a[36:39], v[76:79]
  ds_read_b128 a[176:179], v246 offset:55296
  v_mfma_f32_16x16x32_bf16 v[80:83], a[136:139], a[32:35], v[80:83]
  ds_read_b128 a[180:183], v5 offset:62464
  v_mfma_f32_16x16x32_bf16 v[84:87], a[136:139], a[36:39], v[84:87]
  v_mfma_f32_16x16x32_bf16 v[88:91], a[140:143], a[32:35], v[88:91]
  v_mfma_f32_16x16x32_bf16 v[92:95], a[140:143], a[36:39], v[92:95]
  v_mfma_f32_16x16x32_bf16 v[96:99], a[144:147], a[32:35], v[96:99]
  v_mfma_f32_16x16x32_bf16 v[100:103], a[144:147], a[36:39], v[100:103]
  s_waitcnt vmcnt(8)
  s_waitcnt lgkmcnt(0)
  v_mfma_f32_16x16x32_bf16 v[48:51], a[156:159], a[40:43], v[48:51]
  ds_read_b128 a[120:123], v239 offset:36864
  v_mfma_f32_16x16x32_bf16 v[52:55], a[156:159], a[44:47], v[52:55]
  ds_read_b128 a[124:127], v239 offset:37888
  v_mfma_f32_16x16x32_bf16 v[56:59], a[160:163], a[40:43], v[56:59]
  buffer_load_dwordx4 a[80:83], v12, s[52:55], s44 offen offset:2048
  v_mfma_f32_16x16x32_bf16 v[60:63], a[160:163], a[44:47], v[60:63]
  ds_read_b128 a[128:131], v242 offset:36864
  v_mfma_f32_16x16x32_bf16 v[64:67], a[164:167], a[40:43], v[64:67]
  ds_read_b128 a[132:135], v242 offset:37888
  v_mfma_f32_16x16x32_bf16 v[68:71], a[164:167], a[44:47], v[68:71]
  buffer_load_dwordx4 a[84:87], v13, s[52:55], s44 offen offset:2048
  v_mfma_f32_16x16x32_bf16 v[72:75], a[168:171], a[40:43], v[72:75]
  ds_read_b128 a[136:139], v245 offset:36864
  v_mfma_f32_16x16x32_bf16 v[76:79], a[168:171], a[44:47], v[76:79]
  ds_read_b128 a[140:143], v245 offset:37888
  v_mfma_f32_16x16x32_bf16 v[80:83], a[172:175], a[40:43], v[80:83]
  s_add_u32 s70, s68, 9216
  v_mfma_f32_16x16x32_bf16 v[84:87], a[172:175], a[44:47], v[84:87]
  ds_read_b128 a[144:147], v4 offset:45056
  v_mfma_f32_16x16x32_bf16 v[88:91], a[176:179], a[40:43], v[88:91]
  v_mfma_f32_16x16x32_bf16 v[92:95], a[176:179], a[44:47], v[92:95]
  s_add_u32 m0, s69, 129024
  v_mfma_f32_16x16x32_bf16 v[96:99], a[180:183], a[40:43], v[96:99]
  v_mfma_f32_16x16x32_bf16 v[100:103], a[180:183], a[44:47], v[100:103]
  buffer_load_dwordx4 v4, s[20:23], s70 offen offset:0 lds
  s_waitcnt vmcnt(9)
  s_waitcnt lgkmcnt(0)
  v_mfma_f32_16x16x32_bf16 v[48:51], a[120:123], a[48:51], v[48:51]
  ds_read_b128 a[156:159], v239 offset:46080
  v_mfma_f32_16x16x32_bf16 v[52:55], a[120:123], a[52:55], v[52:55]
  ds_read_b128 a[160:163], v239 offset:47104
  v_mfma_f32_16x16x32_bf16 v[56:59], a[124:127], a[48:51], v[56:59]
  buffer_load_dwordx4 v4, s[20:23], s70 offen offset:1024 lds
  v_mfma_f32_16x16x32_bf16 v[60:63], a[124:127], a[52:55], v[60:63]
  ds_read_b128 a[164:167], v242 offset:46080
  v_mfma_f32_16x16x32_bf16 v[64:67], a[128:131], a[48:51], v[64:67]
  ds_read_b128 a[168:171], v242 offset:47104
  v_mfma_f32_16x16x32_bf16 v[68:71], a[128:131], a[52:55], v[68:71]
  s_mov_b64 exec, 0xffff
  buffer_load_dwordx4 v4, s[20:23], s70 offen offset:2048 lds
  s_mov_b64 exec, -1
  s_nop 0
  v_mfma_f32_16x16x32_bf16 v[72:75], a[132:135], a[48:51], v[72:75]
  ds_read_b128 a[172:175], v245 offset:46080
  v_mfma_f32_16x16x32_bf16 v[76:79], a[132:135], a[52:55], v[76:79]
  ds_read_b128 a[176:179], v245 offset:47104
  v_mfma_f32_16x16x32_bf16 v[80:83], a[136:139], a[48:51], v[80:83]
  buffer_load_dwordx4 a[88:91], v12, s[52:55], s44 offen offset:3072
  v_mfma_f32_16x16x32_bf16 v[84:87], a[136:139], a[52:55], v[84:87]
  ds_read_b128 a[180:183], v4 offset:54272
  v_mfma_f32_16x16x32_bf16 v[88:91], a[140:143], a[48:51], v[88:91]
  v_mfma_f32_16x16x32_bf16 v[92:95], a[140:143], a[52:55], v[92:95]
  buffer_load_dwordx4 a[92:95], v13, s[52:55], s44 offen offset:3072
  v_mfma_f32_16x16x32_bf16 v[96:99], a[144:147], a[48:51], v[96:99]
  v_mfma_f32_16x16x32_bf16 v[100:103], a[144:147], a[52:55], v[100:103]
  s_waitcnt vmcnt(11)
  s_waitcnt lgkmcnt(0)
  v_mfma_f32_16x16x32_bf16 v[48:51], a[156:159], a[56:59], v[48:51]
  ds_read_b128 a[120:123], v239 offset:55296
  v_mfma_f32_16x16x32_bf16 v[52:55], a[156:159], a[60:63], v[52:55]
  ds_read_b128 a[124:127], v239 offset:56320
  v_mfma_f32_16x16x32_bf16 v[56:59], a[160:163], a[56:59], v[56:59]
  buffer_load_dwordx2 a[96:97], v14, s[52:55], s45 offen offset:0
  buffer_load_dwordx2 a[98:99], v14, s[52:55], s45 offen offset:512
  v_mfma_f32_16x16x32_bf16 v[60:63], a[160:163], a[60:63], v[60:63]
  ds_read_b128 a[128:131], v242 offset:55296
  v_mfma_f32_16x16x32_bf16 v[64:67], a[164:167], a[56:59], v[64:67]
  ds_read_b128 a[132:135], v242 offset:56320
  v_mfma_f32_16x16x32_bf16 v[68:71], a[164:167], a[60:63], v[68:71]
  buffer_load_dwordx2 a[100:101], v15, s[52:55], s45 offen offset:0
  buffer_load_dwordx2 a[102:103], v15, s[52:55], s45 offen offset:512
  v_mfma_f32_16x16x32_bf16 v[72:75], a[168:171], a[56:59], v[72:75]
  ds_read_b128 a[136:139], v245 offset:55296
  v_mfma_f32_16x16x32_bf16 v[76:79], a[168:171], a[60:63], v[76:79]
  ds_read_b128 a[140:143], v245 offset:56320
  v_mfma_f32_16x16x32_bf16 v[80:83], a[172:175], a[56:59], v[80:83]
  ds_read_b128 a[144:147], v4 offset:63488
  v_mfma_f32_16x16x32_bf16 v[84:87], a[172:175], a[60:63], v[84:87]
  v_mfma_f32_16x16x32_bf16 v[88:91], a[176:179], a[56:59], v[88:91]
  v_mfma_f32_16x16x32_bf16 v[92:95], a[176:179], a[60:63], v[92:95]
  v_mfma_f32_16x16x32_bf16 v[96:99], a[180:183], a[56:59], v[96:99]
  v_mfma_f32_16x16x32_bf16 v[100:103], a[180:183], a[60:63], v[100:103]
  s_waitcnt vmcnt(13)
  s_waitcnt lgkmcnt(0)
  v_mfma_f32_16x16x32_bf16 v[48:51], a[120:123], a[64:67], v[48:51]
  ds_read_b128 a[156:159], v239 offset:64512
  v_mfma_f32_16x16x32_bf16 v[52:55], a[120:123], a[68:71], v[52:55]
  ds_read_b128 a[160:163], v240 offset:0
  v_mfma_f32_16x16x32_bf16 v[56:59], a[124:127], a[64:67], v[56:59]
  s_add_u32 s45, s45, 9216
  buffer_load_dwordx2 a[104:105], v14, s[52:55], s45 offen offset:0
  buffer_load_dwordx2 a[106:107], v14, s[52:55], s45 offen offset:512
  v_mfma_f32_16x16x32_bf16 v[60:63], a[124:127], a[68:71], v[60:63]
  ds_read_b128 a[164:167], v242 offset:64512
  v_mfma_f32_16x16x32_bf16 v[64:67], a[128:131], a[64:67], v[64:67]
  ds_read_b128 a[168:171], v243 offset:0
  v_mfma_f32_16x16x32_bf16 v[68:71], a[128:131], a[68:71], v[68:71]
  buffer_load_dwordx2 a[108:109], v15, s[52:55], s45 offen offset:0
  buffer_load_dwordx2 a[110:111], v15, s[52:55], s45 offen offset:512
  v_mfma_f32_16x16x32_bf16 v[72:75], a[132:135], a[64:67], v[72:75]
  ds_read_b128 a[172:175], v245 offset:64512
  v_mfma_f32_16x16x32_bf16 v[76:79], a[132:135], a[68:71], v[76:79]
  ds_read_b128 a[176:179], v246 offset:0
  v_mfma_f32_16x16x32_bf16 v[80:83], a[136:139], a[64:67], v[80:83]
  ds_read_b128 a[180:183], v5 offset:7168
  v_mfma_f32_16x16x32_bf16 v[84:87], a[136:139], a[68:71], v[84:87]
  v_mfma_f32_16x16x32_bf16 v[88:91], a[140:143], a[64:67], v[88:91]
  v_mfma_f32_16x16x32_bf16 v[92:95], a[140:143], a[68:71], v[92:95]
  v_mfma_f32_16x16x32_bf16 v[96:99], a[144:147], a[64:67], v[96:99]
  v_mfma_f32_16x16x32_bf16 v[100:103], a[144:147], a[68:71], v[100:103]
  s_waitcnt vmcnt(15)
  s_waitcnt lgkmcnt(0)
  v_mfma_f32_16x16x32_bf16 v[48:51], a[156:159], a[72:75], v[48:51]
  ds_read_b128 a[120:123], v240 offset:8192
  v_mfma_f32_16x16x32_bf16 v[52:55], a[156:159], a[76:79], v[52:55]
  ds_read_b128 a[124:127], v240 offset:9216
  v_mfma_f32_16x16x32_bf16 v[56:59], a[160:163], a[72:75], v[56:59]
  ds_read_b128 a[128:131], v243 offset:8192
  v_mfma_f32_16x16x32_bf16 v[60:63], a[160:163], a[76:79], v[60:63]
  ds_read_b128 a[132:135], v243 offset:9216
  v_mfma_f32_16x16x32_bf16 v[64:67], a[164:167], a[72:75], v[64:67]
  ds_read_b128 a[136:139], v246 offset:8192
  v_mfma_f32_16x16x32_bf16 v[68:71], a[164:167], a[76:79], v[68:71]
  ds_read_b128 a[140:143], v246 offset:9216
  v_mfma_f32_16x16x32_bf16 v[72:75], a[168:171], a[72:75], v[72:75]
  ds_read_b128 a[144:147], v5 offset:16384
  v_mfma_f32_16x16x32_bf16 v[76:79], a[168:171], a[76:79], v[76:79]
  v_mfma_f32_16x16x32_bf16 v[80:83], a[172:175], a[72:75], v[80:83]
  v_mfma_f32_16x16x32_bf16 v[84:87], a[172:175], a[76:79], v[84:87]
  v_mfma_f32_16x16x32_bf16 v[88:91], a[176:179], a[72:75], v[88:91]
  v_mfma_f32_16x16x32_bf16 v[92:95], a[176:179], a[76:79], v[92:95]
  v_mfma_f32_16x16x32_bf16 v[96:99], a[180:183], a[72:75], v[96:99]
  v_mfma_f32_16x16x32_bf16 v[100:103], a[180:183], a[76:79], v[100:103]
  s_waitcnt vmcnt(13)
  s_waitcnt lgkmcnt(0)
  v_mfma_f32_16x16x32_bf16 v[48:51], a[120:123], a[80:83], v[48:51]
  ds_read_b128 a[156:159], v240 offset:17408
  v_mfma_f32_16x16x32_bf16 v[52:55], a[120:123], a[84:87], v[52:55]
  ds_read_b128 a[160:163], v240 offset:18432
  v_mfma_f32_16x16x32_bf16 v[56:59], a[124:127], a[80:83], v[56:59]
  s_lshl_b32 s39, s75, 257
  s_add_u32 s39, s39, s34
  s_add_u32 s39, s39, 0
  s_lshr_b32 s50, s39, 1
  s_and_b32 s39, s39, 1
  s_lshr_b32 s38, 0x2814, s50
  s_lshl_b32 s50, s50, 10
  s_bitcmp1_b32 s38, 0
  s_cselect_b32 s38, 9, 3
  s_lshl_b32 s39, s39, s38
  s_add_u32 s50, s50, s39
  s_add_u32 s50, s50, s35
  s_lshr_b32 s38, s38, 3
  v_lshrrev_b32 v22, s38, v12
  s_add_u32 s39, s50, 18432
  buffer_load_dwordx2 v[104:105], v22, s[16:19], s50 offen
  buffer_load_dwordx2 v[106:107], v22, s[16:19], s39 offen
  v_mfma_f32_16x16x32_bf16 v[60:63], a[124:127], a[84:87], v[60:63]
  ds_read_b128 a[164:167], v243 offset:17408
  v_mfma_f32_16x16x32_bf16 v[64:67], a[128:131], a[80:83], v[64:67]
  ds_read_b128 a[168:171], v243 offset:18432
  v_mfma_f32_16x16x32_bf16 v[68:71], a[128:131], a[84:87], v[68:71]
  s_lshl_b32 s39, s75, 257
  s_add_u32 s39, s39, s34
  s_add_u32 s39, s39, 1
  s_lshr_b32 s50, s39, 1
  s_and_b32 s39, s39, 1
  s_lshr_b32 s38, 0x2814, s50
  s_lshl_b32 s50, s50, 10
  s_bitcmp1_b32 s38, 0
  s_cselect_b32 s38, 9, 3
  s_lshl_b32 s39, s39, s38
  s_add_u32 s50, s50, s39
  s_add_u32 s50, s50, s35
  s_lshr_b32 s38, s38, 3
  v_lshrrev_b32 v23, s38, v12
  s_add_u32 s39, s50, 18432
  buffer_load_dwordx2 v[108:109], v23, s[16:19], s50 offen
  buffer_load_dwordx2 v[110:111], v23, s[16:19], s39 offen
  v_mfma_f32_16x16x32_bf16 v[72:75], a[132:135], a[80:83], v[72:75]
  ds_read_b128 a[172:175], v246 offset:17408
  v_mfma_f32_16x16x32_bf16 v[76:79], a[132:135], a[84:87], v[76:79]
  ds_read_b128 a[176:179], v246 offset:18432
  v_mfma_f32_16x16x32_bf16 v[80:83], a[136:139], a[80:83], v[80:83]
  s_add_u32 s39, s34, 8
  s_lshr_b32 s50, s39, 257
  s_and_b32 s39, s39, 1
  s_lshr_b32 s38, 0x2814, s50
  s_lshl_b32 s50, s50, 10
  s_bitcmp1_b32 s38, 0
  s_cselect_b32 s38, 9, 3
  s_lshl_b32 s39, s39, s38
  s_add_u32 s50, s50, s39
  s_add_u32 s50, s50, s35
  s_lshr_b32 s38, s38, 3
  v_lshrrev_b32 v24, s38, v12
  s_add_u32 s39, s50, 18432
  buffer_load_dwordx2 v[112:113], v24, s[16:19], s50 offen
  buffer_load_dwordx2 v[114:115], v24, s[16:19], s39 offen
  v_mfma_f32_16x16x32_bf16 v[84:87], a[136:139], a[84:87], v[84:87]
  ds_read_b128 a[180:183], v5 offset:25600
  v_mfma_f32_16x16x32_bf16 v[88:91], a[140:143], a[80:83], v[88:91]
  v_mfma_f32_16x16x32_bf16 v[92:95], a[140:143], a[84:87], v[92:95]
  v_mfma_f32_16x16x32_bf16 v[96:99], a[144:147], a[80:83], v[96:99]
  v_mfma_f32_16x16x32_bf16 v[100:103], a[144:147], a[84:87], v[100:103]
  s_waitcnt vmcnt(14)
  s_waitcnt lgkmcnt(0)
  v_mfma_f32_16x16x32_bf16 v[48:51], a[156:159], a[88:91], v[48:51]
  ds_read_b128 a[120:123], v241 offset:16384
  v_mfma_f32_16x16x32_bf16 v[52:55], a[156:159], a[92:95], v[52:55]
  ds_read_b128 a[124:127], v241 offset:17408
  v_mfma_f32_16x16x32_bf16 v[56:59], a[160:163], a[88:91], v[56:59]
  ds_read_b128 a[128:131], v244 offset:16384
  v_mfma_f32_16x16x32_bf16 v[60:63], a[160:163], a[92:95], v[60:63]
  ds_read_b128 a[132:135], v244 offset:17408
  v_mfma_f32_16x16x32_bf16 v[64:67], a[164:167], a[88:91], v[64:67]
  ds_read_b128 a[136:139], v247 offset:16384
  v_mfma_f32_16x16x32_bf16 v[68:71], a[164:167], a[92:95], v[68:71]
  ds_read_b128 a[140:143], v247 offset:17408
  v_mfma_f32_16x16x32_bf16 v[72:75], a[168:171], a[88:91], v[72:75]
  ds_read_b128 a[144:147], v6 offset:24576
  v_mfma_f32_16x16x32_bf16 v[76:79], a[168:171], a[92:95], v[76:79]
  v_mfma_f32_16x16x32_bf16 v[80:83], a[172:175], a[88:91], v[80:83]
  v_mfma_f32_16x16x32_bf16 v[84:87], a[172:175], a[92:95], v[84:87]
  v_mfma_f32_16x16x32_bf16 v[88:91], a[176:179], a[88:91], v[88:91]
  v_mfma_f32_16x16x32_bf16 v[92:95], a[176:179], a[92:95], v[92:95]
  v_mfma_f32_16x16x32_bf16 v[96:99], a[180:183], a[88:91], v[96:99]
  v_mfma_f32_16x16x32_bf16 v[100:103], a[180:183], a[92:95], v[100:103]
  s_waitcnt vmcnt(16)
  s_barrier
  s_waitcnt vmcnt(10)
  s_waitcnt lgkmcnt(0)
  v_mfma_f32_16x16x32_bf16 v[48:51], a[120:123], a[96:99], v[48:51]
  ds_read_b128 a[156:159], v240 offset:63488
  v_mfma_f32_16x16x32_bf16 v[52:55], a[120:123], a[100:103], v[52:55]
  ds_read_b128 a[160:163], v240 offset:64512
  v_mfma_f32_16x16x32_bf16 v[56:59], a[124:127], a[96:99], v[56:59]
  ds_read_b128 a[164:167], v243 offset:63488
  v_mfma_f32_16x16x32_bf16 v[60:63], a[124:127], a[100:103], v[60:63]
  ds_read_b128 a[168:171], v243 offset:64512
  v_mfma_f32_16x16x32_bf16 v[64:67], a[128:131], a[96:99], v[64:67]
  ds_read_b128 a[172:175], v246 offset:63488
  v_mfma_f32_16x16x32_bf16 v[68:71], a[128:131], a[100:103], v[68:71]
  ds_read_b128 a[176:179], v246 offset:64512
  v_mfma_f32_16x16x32_bf16 v[72:75], a[132:135], a[96:99], v[72:75]
  ds_read_b128 a[180:183], v6 offset:6144
  v_mfma_f32_16x16x32_bf16 v[76:79], a[132:135], a[100:103], v[76:79]
  v_mfma_f32_16x16x32_bf16 v[80:83], a[136:139], a[96:99], v[80:83]
  v_mfma_f32_16x16x32_bf16 v[84:87], a[136:139], a[100:103], v[84:87]
  v_mfma_f32_16x16x32_bf16 v[88:91], a[140:143], a[96:99], v[88:91]
  v_mfma_f32_16x16x32_bf16 v[92:95], a[140:143], a[100:103], v[92:95]
  v_mfma_f32_16x16x32_bf16 v[96:99], a[144:147], a[96:99], v[96:99]
  v_mfma_f32_16x16x32_bf16 v[100:103], a[144:147], a[100:103], v[100:103]
  s_waitcnt vmcnt(6)
  s_waitcnt lgkmcnt(0)
  v_mfma_f32_16x16x32_bf16 v[48:51], a[156:159], a[104:107], v[48:51]
  ds_read_b128 a[184:187], v236 offset:18432
  v_mfma_f32_16x16x32_bf16 v[52:55], a[156:159], a[108:111], v[52:55]
  ds_read_b128 a[188:191], v236 offset:19456
  v_mfma_f32_16x16x32_bf16 v[56:59], a[160:163], a[104:107], v[56:59]
  ds_read_b128 a[192:195], v236 offset:27648
  v_mfma_f32_16x16x32_bf16 v[60:63], a[160:163], a[108:111], v[60:63]
  ds_read_b128 a[196:199], v236 offset:28672
  v_mfma_f32_16x16x32_bf16 v[64:67], a[164:167], a[104:107], v[64:67]
  ds_read_b128 a[200:203], v237 offset:26624
  v_mfma_f32_16x16x32_bf16 v[68:71], a[164:167], a[108:111], v[68:71]
  ds_read_b128 a[204:207], v237 offset:27648
  v_mfma_f32_16x16x32_bf16 v[72:75], a[168:171], a[104:107], v[72:75]
  v_mfma_f32_16x16x32_bf16 v[76:79], a[168:171], a[108:111], v[76:79]
  v_mfma_f32_16x16x32_bf16 v[80:83], a[172:175], a[104:107], v[80:83]
  v_mfma_f32_16x16x32_bf16 v[84:87], a[172:175], a[108:111], v[84:87]
  v_mfma_f32_16x16x32_bf16 v[88:91], a[176:179], a[104:107], v[88:91]
  v_mfma_f32_16x16x32_bf16 v[92:95], a[176:179], a[108:111], v[92:95]
  v_mfma_f32_16x16x32_bf16 v[96:99], a[180:183], a[104:107], v[96:99]
  v_mfma_f32_16x16x32_bf16 v[100:103], a[180:183], a[108:111], v[100:103]
  s_waitcnt lgkmcnt(4)
  v_mfma_f32_16x16x32_bf16 v[32:35], a[184:187], a[0:3], v[32:35]
  v_cvt_pk_bf16_f32 v160, v48, v49
  v_cvt_pk_bf16_f32 v161, v50, v51
  v_cvt_pk_bf16_f32 v162, v52, v53
  ds_read_b128 a[208:211], v237 offset:35840
  v_mfma_f32_16x16x32_bf16 v[36:39], a[184:187], a[4:7], v[36:39]
  v_cvt_pk_bf16_f32 v163, v54, v55
  s_lshl_b32 s39, s75, 1
  s_add_u32 s39, s39, 2
  s_and_b32 s39, s39, 7
  s_lshl_b32 s39, s39, 2
  s_add_u32 s39, s39, s75
  s_lshl_b32 s39, s39, 10
  s_add_u32 s39, s39, s51
  buffer_store_dwordx4 v[160:163], v12, s[60:63], s39 offen sc0 sc1
  ds_read_b128 a[212:215], v237 offset:36864
  v_mfma_f32_16x16x32_bf16 v[40:43], a[188:191], a[0:3], v[40:43]
  v_cvt_pk_bf16_f32 v164, v56, v57
  v_cvt_pk_bf16_f32 v165, v58, v59
  v_cvt_pk_bf16_f32 v166, v60, v61
  v_mfma_f32_16x16x32_bf16 v[44:47], a[188:191], a[4:7], v[44:47]
  v_cvt_pk_bf16_f32 v167, v62, v63
  s_lshl_b32 s39, s75, 1
  s_add_u32 s39, s39, 3
  s_and_b32 s39, s39, 7
  s_lshl_b32 s39, s39, 2
  s_add_u32 s39, s39, s75
  s_lshl_b32 s39, s39, 10
  s_add_u32 s39, s39, s51
  buffer_store_dwordx4 v[164:167], v12, s[60:63], s39 offen sc0 sc1
  s_waitcnt lgkmcnt(4)
  v_mfma_f32_16x16x32_bf16 v[32:35], a[192:195], a[8:11], v[32:35]
  v_cvt_pk_bf16_f32 v168, v64, v65
  v_cvt_pk_bf16_f32 v169, v66, v67
  v_cvt_pk_bf16_f32 v170, v68, v69
  ds_read_b128 a[184:187], v237 offset:45056
  v_mfma_f32_16x16x32_bf16 v[36:39], a[192:195], a[12:15], v[36:39]
  v_cvt_pk_bf16_f32 v171, v70, v71
  s_lshl_b32 s39, s75, 257
  s_add_u32 s39, s39, 4
  s_and_b32 s39, s39, 7
  s_lshl_b32 s39, s39, 2
  s_add_u32 s39, s39, s75
  s_lshl_b32 s39, s39, 10
  s_add_u32 s39, s39, s51
  buffer_store_dwordx4 v[168:171], v12, s[60:63], s39 offen sc0 sc1
  ds_read_b128 a[188:191], v237 offset:46080
  v_mfma_f32_16x16x32_bf16 v[40:43], a[196:199], a[8:11], v[40:43]
  v_cvt_pk_bf16_f32 v172, v72, v73
  v_cvt_pk_bf16_f32 v173, v74, v75
  v_cvt_pk_bf16_f32 v174, v76, v77
  v_mfma_f32_16x16x32_bf16 v[44:47], a[196:199], a[12:15], v[44:47]
  v_cvt_pk_bf16_f32 v175, v78, v79
  s_lshl_b32 s39, s75, 1
  s_add_u32 s39, s39, 5
  s_and_b32 s39, s39, 7
  s_lshl_b32 s39, s39, 2
  s_add_u32 s39, s39, s75
  s_lshl_b32 s39, s39, 10
  s_add_u32 s39, s39, s51
  buffer_store_dwordx4 v[172:175], v12, s[60:63], s39 offen sc0 sc1
  s_waitcnt lgkmcnt(4)
  v_mfma_f32_16x16x32_bf16 v[32:35], a[200:203], a[16:19], v[32:35]
  v_cvt_pk_bf16_f32 v176, v80, v81
  v_cvt_pk_bf16_f32 v177, v82, v83
  v_cvt_pk_bf16_f32 v178, v84, v85
  ds_read_b128 a[192:195], v237 offset:54272
  v_mfma_f32_16x16x32_bf16 v[36:39], a[200:203], a[20:23], v[36:39]
  v_cvt_pk_bf16_f32 v179, v86, v87
  s_lshl_b32 s39, s75, 257
  s_add_u32 s39, s39, 6
  s_and_b32 s39, s39, 7
  s_lshl_b32 s39, s39, 2
  s_add_u32 s39, s39, s75
  s_lshl_b32 s39, s39, 10
  s_add_u32 s39, s39, s51
  buffer_store_dwordx4 v[176:179], v12, s[60:63], s39 offen sc0 sc1
  ds_read_b128 a[196:199], v237 offset:55296
  v_mfma_f32_16x16x32_bf16 v[40:43], a[204:207], a[16:19], v[40:43]
  v_cvt_pk_bf16_f32 v180, v88, v89
  v_cvt_pk_bf16_f32 v181, v90, v91
  v_cvt_pk_bf16_f32 v182, v92, v93
  v_mfma_f32_16x16x32_bf16 v[44:47], a[204:207], a[20:23], v[44:47]
  v_cvt_pk_bf16_f32 v183, v94, v95
  s_lshl_b32 s39, s75, 257
  s_add_u32 s39, s39, 7
  s_and_b32 s39, s39, 7
  s_lshl_b32 s39, s39, 2
  s_add_u32 s39, s39, s75
  s_lshl_b32 s39, s39, 10
  s_add_u32 s39, s39, s51
  buffer_store_dwordx4 v[180:183], v12, s[60:63], s39 offen sc0 sc1
  s_waitcnt lgkmcnt(4)
  v_mfma_f32_16x16x32_bf16 v[32:35], a[208:211], a[24:27], v[32:35]
  v_cvt_pk_bf16_f32 v184, v96, v97
  v_cvt_pk_bf16_f32 v185, v98, v99
  v_cvt_pk_bf16_f32 v186, v100, v101
  ds_read_b128 a[200:203], v236 offset:36864
  v_mfma_f32_16x16x32_bf16 v[36:39], a[208:211], a[28:31], v[36:39]
  v_cvt_pk_bf16_f32 v187, v102, v103
  s_add_u32 s39, s75, 32
  s_lshl_b32 s39, s39, 10
  s_add_u32 s39, s39, s51
  buffer_store_dwordx4 v[184:187], v12, s[60:63], s39 offen sc0 sc1
  ds_read_b128 a[204:207], v236 offset:37888
  v_mfma_f32_16x16x32_bf16 v[40:43], a[212:215], a[24:27], v[40:43]
  v_mfma_f32_16x16x32_bf16 v[44:47], a[212:215], a[28:31], v[44:47]
  s_waitcnt lgkmcnt(4)
  v_mfma_f32_16x16x32_bf16 v[32:35], a[184:187], a[32:35], v[32:35]
  ds_read_b128 a[208:211], v236 offset:46080
  v_mfma_f32_16x16x32_bf16 v[36:39], a[184:187], a[36:39], v[36:39]
  ds_read_b128 a[212:215], v236 offset:47104
  v_mfma_f32_16x16x32_bf16 v[40:43], a[188:191], a[32:35], v[40:43]
  v_mfma_f32_16x16x32_bf16 v[44:47], a[188:191], a[36:39], v[44:47]
  s_waitcnt lgkmcnt(4)
  v_mfma_f32_16x16x32_bf16 v[32:35], a[192:195], a[40:43], v[32:35]
  ds_read_b128 a[184:187], v236 offset:55296
  v_mfma_f32_16x16x32_bf16 v[36:39], a[192:195], a[44:47], v[36:39]
  ds_read_b128 a[188:191], v236 offset:56320
  v_mfma_f32_16x16x32_bf16 v[40:43], a[196:199], a[40:43], v[40:43]
  v_mfma_f32_16x16x32_bf16 v[44:47], a[196:199], a[44:47], v[44:47]
  s_waitcnt lgkmcnt(4)
  v_mfma_f32_16x16x32_bf16 v[32:35], a[200:203], a[48:51], v[32:35]
  ds_read_b128 a[192:195], v236 offset:64512
  v_mfma_f32_16x16x32_bf16 v[36:39], a[200:203], a[52:55], v[36:39]
  ds_read_b128 a[196:199], v237 offset:0
  v_mfma_f32_16x16x32_bf16 v[40:43], a[204:207], a[48:51], v[40:43]
  v_mfma_f32_16x16x32_bf16 v[44:47], a[204:207], a[52:55], v[44:47]
  s_waitcnt lgkmcnt(4)
  v_mfma_f32_16x16x32_bf16 v[32:35], a[208:211], a[56:59], v[32:35]
  ds_read_b128 a[200:203], v237 offset:8192
  v_mfma_f32_16x16x32_bf16 v[36:39], a[208:211], a[60:63], v[36:39]
  ds_read_b128 a[204:207], v237 offset:9216
  v_mfma_f32_16x16x32_bf16 v[40:43], a[212:215], a[56:59], v[40:43]
  v_mfma_f32_16x16x32_bf16 v[44:47], a[212:215], a[60:63], v[44:47]
  s_waitcnt lgkmcnt(4)
  v_mfma_f32_16x16x32_bf16 v[32:35], a[184:187], a[64:67], v[32:35]
  ds_read_b128 a[208:211], v237 offset:17408
  v_mfma_f32_16x16x32_bf16 v[36:39], a[184:187], a[68:71], v[36:39]
  ds_read_b128 a[212:215], v237 offset:18432
  v_mfma_f32_16x16x32_bf16 v[40:43], a[188:191], a[64:67], v[40:43]
  s_nop 0
L_pg_23:
  s_cbranch_execz L_wr_3
  v_mfma_f32_16x16x32_bf16 v[44:47], a[188:191], a[68:71], v[44:47]
  s_waitcnt lgkmcnt(4)
  v_mfma_f32_16x16x32_bf16 v[32:35], a[192:195], a[72:75], v[32:35]
  ds_read_b128 a[184:187], v238 offset:16384
  v_mfma_f32_16x16x32_bf16 v[36:39], a[192:195], a[76:79], v[36:39]
  ds_read_b128 a[188:191], v238 offset:17408
  v_mfma_f32_16x16x32_bf16 v[40:43], a[196:199], a[72:75], v[40:43]
  v_mfma_f32_16x16x32_bf16 v[44:47], a[196:199], a[76:79], v[44:47]
  s_waitcnt lgkmcnt(4)
  v_mfma_f32_16x16x32_bf16 v[32:35], a[200:203], a[80:83], v[32:35]
  ds_read_b128 a[192:195], v237 offset:63488
  v_mfma_f32_16x16x32_bf16 v[36:39], a[200:203], a[84:87], v[36:39]
  ds_read_b128 a[196:199], v237 offset:64512
  v_mfma_f32_16x16x32_bf16 v[40:43], a[204:207], a[80:83], v[40:43]
  v_mfma_f32_16x16x32_bf16 v[44:47], a[204:207], a[84:87], v[44:47]
  s_waitcnt lgkmcnt(4)
  v_mfma_f32_16x16x32_bf16 v[32:35], a[208:211], a[88:91], v[32:35]
  v_mfma_f32_16x16x32_bf16 v[36:39], a[208:211], a[92:95], v[36:39]
  v_mfma_f32_16x16x32_bf16 v[40:43], a[212:215], a[88:91], v[40:43]
  v_mfma_f32_16x16x32_bf16 v[44:47], a[212:215], a[92:95], v[44:47]
  s_waitcnt lgkmcnt(2)
  v_mfma_f32_16x16x32_bf16 v[32:35], a[184:187], a[96:99], v[32:35]
  v_mfma_f32_16x16x32_bf16 v[36:39], a[184:187], a[100:103], v[36:39]
  v_mfma_f32_16x16x32_bf16 v[40:43], a[188:191], a[96:99], v[40:43]
  v_mfma_f32_16x16x32_bf16 v[44:47], a[188:191], a[100:103], v[44:47]
  s_waitcnt lgkmcnt(0)
  v_mfma_f32_16x16x32_bf16 v[32:35], a[192:195], a[104:107], v[32:35]
  v_mfma_f32_16x16x32_bf16 v[36:39], a[192:195], a[108:111], v[36:39]
  v_mfma_f32_16x16x32_bf16 v[40:43], a[196:199], a[104:107], v[40:43]
  v_mfma_f32_16x16x32_bf16 v[44:47], a[196:199], a[108:111], v[44:47]
  s_add_u32 s39, s75, 0
  s_and_b32 s39, s39, 3
  s_lshl_b32 s35, s75, 3
  s_add_u32 s39, s39, s35
  s_lshl_b32 s39, s39, 10
  s_add_u32 s64, s39, s51
  s_add_u32 s40, s64, 4096
  s_add_u32 s39, s75, 1
  s_and_b32 s39, s39, 3
  s_lshl_b32 s35, s75, 3
  s_add_u32 s39, s39, s35
  s_lshl_b32 s39, s39, 10
  s_add_u32 s65, s39, s51
  s_add_u32 s41, s65, 4096
  s_add_u32 s39, s75, 2
  s_and_b32 s39, s39, 3
  s_lshl_b32 s35, s75, 3
  s_add_u32 s39, s39, s35
  s_lshl_b32 s39, s39, 10
  s_add_u32 s66, s39, s51
  s_add_u32 s42, s66, 4096
  s_add_u32 s39, s75, 3
  s_and_b32 s39, s39, 3
  s_lshl_b32 s35, s75, 3
  s_add_u32 s39, s39, s35
  s_lshl_b32 s39, s39, 10
  s_add_u32 s67, s39, s51
  s_add_u32 s43, s67, 4096
  s_add_u32 s68, s51, 32768
  s_mov_b32 s39, 0
  s_sleep 6
  buffer_load_dwordx4 v[72:75], v30, s[60:63], s68 offen offset:0 sc0 sc1
  buffer_load_dwordx4 v[76:79], v30, s[60:63], s68 offen offset:1024 sc0 sc1
  buffer_load_dwordx4 v[80:83], v30, s[60:63], s68 offen offset:2048 sc0 sc1
  buffer_load_dwordx4 v[84:87], v30, s[60:63], s68 offen offset:3072 sc0 sc1
  s_branch L_p6_c1
L_p6_spin:
  buffer_load_dwordx4 v[72:75], v30, s[60:63], s68 offen offset:0 sc0 sc1
  buffer_load_dwordx4 v[76:79], v30, s[60:63], s68 offen offset:1024 sc0 sc1
  buffer_load_dwordx4 v[80:83], v30, s[60:63], s68 offen offset:2048 sc0 sc1
  buffer_load_dwordx4 v[84:87], v30, s[60:63], s68 offen offset:3072 sc0 sc1
L_p6_c1:
  s_waitcnt vmcnt(0)
  v_max3_u32 v21, v72, v73, v74
  v_max3_u32 v21, v21, v75, v76
  v_max3_u32 v21, v21, v77, v78
  v_max3_u32 v21, v21, v79, v80
  v_max3_u32 v21, v21, v81, v82
  v_max3_u32 v21, v21, v83, v84
  v_max3_u32 v21, v21, v85, v86
  v_max_u32 v21, v21, v87
  v_cmp_eq_u32 vcc, -1, v21
  s_cmp_eq_u64 vcc, 0
  s_cbranch_scc1 L_p6_spin2
  s_add_u32 s39, s39, 1
  s_cmp_lt_u32 s39, 0x4000
  s_cbranch_scc0 L_p6_spin2
  s_sleep 1
  s_branch L_p6_spin
L_p6_spin2:
  buffer_load_dwordx4 v[48:51], v12, s[60:63], s65 offen sc0 sc1
  buffer_load_dwordx4 v[52:55], v12, s[60:63], s41 offen sc0 sc1
  buffer_load_dwordx4 v[56:59], v12, s[60:63], s66 offen sc0 sc1
  buffer_load_dwordx4 v[60:63], v12, s[60:63], s42 offen sc0 sc1
  buffer_load_dwordx4 v[64:67], v12, s[60:63], s67 offen sc0 sc1
  buffer_load_dwordx4 v[68:71], v12, s[60:63], s43 offen sc0 sc1
  s_waitcnt vmcnt(0)
  s_nop 0
  v_max3_u32 v21, v48, v49, v50
  v_max3_u32 v21, v21, v51, v52
  v_max3_u32 v21, v21, v53, v54
  v_max3_u32 v21, v21, v55, v56
  v_max3_u32 v21, v21, v57, v58
  v_max3_u32 v21, v21, v59, v60
  v_max3_u32 v21, v21, v61, v62
  v_max3_u32 v21, v21, v63, v64
  v_max3_u32 v21, v21, v65, v66
  v_max3_u32 v21, v21, v67, v68
  v_max3_u32 v21, v21, v69, v70
  v_max_u32_e64 v21, v21, v71
  v_cmp_eq_u32 vcc, -1, v21
  s_cmp_eq_u64 vcc, 0
  s_cbranch_scc1 L_p6_go
  s_add_u32 s39, s39, 1
  s_cmp_lt_u32 s39, 0x4000
  s_cbranch_scc0 L_p6_go
  s_sleep 1
  s_branch L_p6_spin2
L_p6_go:
  v_lshlrev_b32 v88, 16, v72
  v_and_b32 v89, 0xffff0000, v72
  v_lshlrev_b32_e64 v90, 16, v73
  v_and_b32 v91, 0xffff0000, v73
  v_lshlrev_b32_e64 v92, 16, v74
  v_and_b32 v93, 0xffff0000, v74
  v_lshlrev_b32_e64 v94, 16, v75
  v_and_b32 v95, 0xffff0000, v75
  v_lshlrev_b32_e64 v116, 16, v48
  v_and_b32 v117, 0xffff0000, v48
  v_lshlrev_b32_e64 v118, 16, v49
  v_and_b32 v119, 0xffff0000, v49
  v_lshlrev_b32_e64 v120, 16, v50
  v_and_b32 v121, 0xffff0000, v50
  v_lshlrev_b32_e64 v122, 16, v51
  v_and_b32 v123, 0xffff0000, v51
  v_lshlrev_b32_e64 v124, 16, v52
  v_and_b32 v125, 0xffff0000, v52
  v_lshlrev_b32_e64 v126, 16, v53
  v_and_b32 v127, 0xffff0000, v53
  v_lshlrev_b32_e64 v128, 16, v54
  v_and_b32 v129, 0xffff0000, v54
  v_lshlrev_b32_e64 v130, 16, v55
  v_and_b32 v131, 0xffff0000, v55
  v_lshlrev_b32_e64 v132, 16, v76
  v_and_b32 v133, 0xffff0000, v76
  v_lshlrev_b32_e64 v134, 16, v77
  v_and_b32 v135, 0xffff0000, v77
  v_lshlrev_b32_e64 v136, 16, v78
  v_and_b32 v137, 0xffff0000, v78
  v_lshlrev_b32_e64 v138, 16, v79
  v_and_b32 v139, 0xffff0000, v79
  v_pk_add_f32 v[32:33], v[32:33], v[116:117]
  v_pk_add_f32 v[34:35], v[34:35], v[118:119]
  v_pk_add_f32 v[36:37], v[36:37], v[120:121]
  v_pk_add_f32 v[38:39], v[38:39], v[122:123]
  v_pk_add_f32 v[40:41], v[40:41], v[124:125]
  v_pk_add_f32 v[42:43], v[42:43], v[126:127]
  v_pk_add_f32 v[44:45], v[44:45], v[128:129]
  v_pk_add_f32 v[46:47], v[46:47], v[130:131]
  v_pk_add_f32 v[88:89], v[88:89], v[132:133]
  v_pk_add_f32 v[90:91], v[90:91], v[134:135]
  v_pk_add_f32 v[92:93], v[92:93], v[136:137]
  v_pk_add_f32 v[94:95], v[94:95], v[138:139]
  v_lshlrev_b32_e64 v116, 16, v56
  v_and_b32 v117, 0xffff0000, v56
  v_lshlrev_b32_e64 v118, 16, v57
  v_and_b32 v119, 0xffff0000, v57
  v_lshlrev_b32_e64 v120, 16, v58
  v_and_b32 v121, 0xffff0000, v58
  v_lshlrev_b32_e64 v122, 16, v59
  v_and_b32 v123, 0xffff0000, v59
  v_lshlrev_b32_e64 v124, 16, v60
  v_and_b32 v125, 0xffff0000, v60
  v_lshlrev_b32_e64 v126, 16, v61
  v_and_b32 v127, 0xffff0000, v61
  v_lshlrev_b32_e64 v128, 16, v62
  v_and_b32 v129, 0xffff0000, v62
  v_lshlrev_b32_e64 v130, 16, v63
  v_and_b32 v131, 0xffff0000, v63
  v_lshlrev_b32_e64 v132, 16, v80
  v_and_b32 v133, 0xffff0000, v80
  v_lshlrev_b32_e64 v134, 16, v81
  v_and_b32 v135, 0xffff0000, v81
  v_lshlrev_b32_e64 v136, 16, v82
  v_and_b32 v137, 0xffff0000, v82
  v_lshlrev_b32_e64 v138, 16, v83
  v_and_b32 v139, 0xffff0000, v83
  v_pk_add_f32 v[32:33], v[32:33], v[116:117]
  v_pk_add_f32 v[34:35], v[34:35], v[118:119]
  v_pk_add_f32 v[36:37], v[36:37], v[120:121]
  v_pk_add_f32 v[38:39], v[38:39], v[122:123]
  v_pk_add_f32 v[40:41], v[40:41], v[124:125]
  v_pk_add_f32 v[42:43], v[42:43], v[126:127]
  v_pk_add_f32 v[44:45], v[44:45], v[128:129]
  v_pk_add_f32 v[46:47], v[46:47], v[130:131]
  v_pk_add_f32 v[88:89], v[88:89], v[132:133]
  v_pk_add_f32 v[90:91], v[90:91], v[134:135]
  v_pk_add_f32 v[92:93], v[92:93], v[136:137]
  v_pk_add_f32 v[94:95], v[94:95], v[138:139]
  v_lshlrev_b32_e64 v116, 16, v64
  v_and_b32 v117, 0xffff0000, v64
  v_lshlrev_b32_e64 v118, 16, v65
  v_and_b32 v119, 0xffff0000, v65
  v_lshlrev_b32_e64 v120, 16, v66
  v_and_b32 v121, 0xffff0000, v66
  v_lshlrev_b32_e64 v122, 16, v67
  v_and_b32 v123, 0xffff0000, v67
  v_lshlrev_b32_e64 v124, 16, v68
  v_and_b32 v125, 0xffff0000, v68
  v_lshlrev_b32_e64 v126, 16, v69
  v_and_b32 v127, 0xffff0000, v69
  v_lshlrev_b32_e64 v128, 16, v70
  v_and_b32 v129, 0xffff0000, v70
  v_lshlrev_b32_e64 v130, 16, v71
  v_and_b32 v131, 0xffff0000, v71
  v_lshlrev_b32_e64 v132, 16, v84
  v_and_b32 v133, 0xffff0000, v84
  v_lshlrev_b32_e64 v134, 16, v85
  v_and_b32 v135, 0xffff0000, v85
  v_lshlrev_b32_e64 v136, 16, v86
  v_and_b32 v137, 0xffff0000, v86
  v_lshlrev_b32_e64 v138, 16, v87
  v_and_b32 v139, 0xffff0000, v87
  v_pk_add_f32 v[32:33], v[32:33], v[116:117]
  v_pk_add_f32 v[34:35], v[34:35], v[118:119]
  v_pk_add_f32 v[36:37], v[36:37], v[120:121]
  v_pk_add_f32 v[38:39], v[38:39], v[122:123]
  v_pk_add_f32 v[40:41], v[40:41], v[124:125]
  v_pk_add_f32 v[42:43], v[42:43], v[126:127]
  v_pk_add_f32 v[44:45], v[44:45], v[128:129]
  v_pk_add_f32 v[46:47], v[46:47], v[130:131]
  v_pk_add_f32 v[88:89], v[88:89], v[132:133]
  v_pk_add_f32 v[90:91], v[90:91], v[134:135]
  v_pk_add_f32 v[92:93], v[92:93], v[136:137]
  v_pk_add_f32 v[94:95], v[94:95], v[138:139]
  v_cvt_pk_bf16_f32 v48, v32, v33
  v_cvt_pk_bf16_f32 v49, v34, v35
  v_cvt_pk_bf16_f32 v50, v36, v37
  v_cvt_pk_bf16_f32 v51, v38, v39
  v_cvt_pk_bf16_f32 v52, v40, v41
  v_cvt_pk_bf16_f32 v53, v42, v43
  v_cvt_pk_bf16_f32 v54, v44, v45
  v_cvt_pk_bf16_f32 v55, v46, v47
  v_cvt_pk_bf16_f32 v56, v88, v89
  v_cvt_pk_bf16_f32 v57, v90, v91
  v_cvt_pk_bf16_f32 v58, v92, v93
  v_cvt_pk_bf16_f32 v59, v94, v95
  v_lshlrev_b32_e64 v116, 16, v48
  v_and_b32 v117, 0xffff0000, v48
  v_lshlrev_b32_e64 v118, 16, v49
  v_and_b32 v119, 0xffff0000, v49
  v_lshlrev_b32_e64 v120, 16, v50
  v_and_b32 v121, 0xffff0000, v50
  v_lshlrev_b32_e64 v122, 16, v51
  v_and_b32 v123, 0xffff0000, v51
  v_lshlrev_b32_e64 v124, 16, v52
  v_and_b32 v125, 0xffff0000, v52
  v_lshlrev_b32_e64 v126, 16, v53
  v_and_b32 v127, 0xffff0000, v53
  v_lshlrev_b32_e64 v128, 16, v54
  v_and_b32 v129, 0xffff0000, v54
  v_lshlrev_b32_e64 v130, 16, v55
  v_and_b32 v131, 0xffff0000, v55
  v_lshlrev_b32_e64 v132, 16, v56
  v_and_b32 v133, 0xffff0000, v56
  v_lshlrev_b32_e64 v134, 16, v57
  v_and_b32 v135, 0xffff0000, v57
  v_lshlrev_b32_e64 v136, 16, v58
  v_and_b32 v137, 0xffff0000, v58
  v_lshlrev_b32_e64 v138, 16, v59
  v_and_b32 v139, 0xffff0000, v59
  v_lshlrev_b32_e64 v160, 16, v104
  v_and_b32 v161, 0xffff0000, v104
  v_lshlrev_b32_e64 v162, 16, v105
  v_and_b32 v163, 0xffff0000, v105
  v_lshlrev_b32_e64 v164, 16, v106
  v_and_b32 v165, 0xffff0000, v106
  v_lshlrev_b32_e64 v166, 16, v107
  v_and_b32 v167, 0xffff0000, v107
  v_lshlrev_b32_e64 v168, 16, v108
  v_and_b32 v169, 0xffff0000, v108
  v_lshlrev_b32_e64 v170, 16, v109
  v_and_b32 v171, 0xffff0000, v109
  v_lshlrev_b32_e64 v172, 16, v110
  v_and_b32 v173, 0xffff0000, v110
  v_lshlrev_b32_e64 v174, 16, v111
  v_and_b32 v175, 0xffff0000, v111
  v_lshlrev_b32_e64 v176, 16, v112
  v_and_b32 v177, 0xffff0000, v112
  v_lshlrev_b32_e64 v178, 16, v113
  v_and_b32 v179, 0xffff0000, v113
  v_lshlrev_b32_e64 v180, 16, v114
  v_and_b32 v181, 0xffff0000, v114
  v_lshlrev_b32_e64 v182, 16, v115
  v_and_b32 v183, 0xffff0000, v115
  v_pk_add_f32 v[116:117], v[116:117], v[160:161]
  v_pk_add_f32 v[118:119], v[118:119], v[162:163]
  v_pk_add_f32 v[120:121], v[120:121], v[164:165]
  v_pk_add_f32 v[122:123], v[122:123], v[166:167]
  v_pk_add_f32 v[124:125], v[124:125], v[168:169]
  v_pk_add_f32 v[126:127], v[126:127], v[170:171]
  v_pk_add_f32 v[128:129], v[128:129], v[172:173]
  v_pk_add_f32 v[130:131], v[130:131], v[174:175]
  v_pk_add_f32 v[132:133], v[132:133], v[176:177]
  v_pk_add_f32 v[134:135], v[134:135], v[178:179]
  v_pk_add_f32 v[136:137], v[136:137], v[180:181]
  v_pk_add_f32 v[138:139], v[138:139], v[182:183]
  v_cvt_pk_bf16_f32 v48, v116, v117
  v_cvt_pk_bf16_f32 v49, v118, v119
  buffer_store_dwordx2 v[48:49], v26, s[56:59], s49 offen offset:0
  v_cvt_pk_bf16_f32 v50, v120, v121
  v_cvt_pk_bf16_f32 v51, v122, v123
  buffer_store_dwordx2 v[50:51], v27, s[56:59], s49 offen offset:0
  v_cvt_pk_bf16_f32 v52, v124, v125
  v_cvt_pk_bf16_f32 v53, v126, v127
  buffer_store_dwordx2 v[52:53], v26, s[56:59], s49 offen offset:32
  v_cvt_pk_bf16_f32 v54, v128, v129
  v_cvt_pk_bf16_f32 v55, v130, v131
  buffer_store_dwordx2 v[54:55], v27, s[56:59], s49 offen offset:32
  v_cvt_pk_bf16_f32 v56, v132, v133
  v_cvt_pk_bf16_f32 v57, v134, v135
  buffer_store_dwordx2 v[56:57], v28, s[56:59], s48 offen offset:256
  v_cvt_pk_bf16_f32 v58, v136, v137
  v_cvt_pk_bf16_f32 v59, v138, v139
  buffer_store_dwordx2 v[58:59], v29, s[56:59], s48 offen offset:256
  s_endpgm
L_p3_redo:
  buffer_load_dword v18, v17, s[96:99], s37 offen sc0 sc1
  s_waitcnt vmcnt(0)
  s_mov_b32 s40, 0
L_f2r_chk:
  v_cmp_ne_u32_e64 vcc, 2, v18
  s_cmp_eq_u64 vcc, 0
  s_cbranch_scc1 L_f2r_go
  s_add_u32 s40, s40, 1
  s_cmp_lt_u32 s40, 0x40000
  s_cbranch_scc0 L_f2r_go
  buffer_load_dword v18, v17, s[96:99], s37 offen sc0 sc1
  s_waitcnt vmcnt(0)
  s_branch L_f2r_chk
L_f2r_go:
  s_add_u32 s36, s70, 0
  buffer_load_dwordx4 a[0:3], v4, s[48:51], s36 offen offset:0 sc0 sc1
  buffer_load_dwordx4 a[4:7], v4, s[48:51], s36 offen offset:1024 sc0 sc1
  buffer_load_dwordx4 a[8:11], v4, s[48:51], s36 offen offset:2048 sc0 sc1
  buffer_load_dwordx4 a[12:15], v4, s[48:51], s36 offen offset:3072 sc0 sc1
  s_add_u32 s36, s70, 4096
  buffer_load_dwordx4 a[16:19], v4, s[48:51], s36 offen offset:0 sc0 sc1
  buffer_load_dwordx4 a[20:23], v4, s[48:51], s36 offen offset:1024 sc0 sc1
  buffer_load_dwordx4 a[24:27], v4, s[48:51], s36 offen offset:2048 sc0 sc1
  buffer_load_dwordx4 a[28:31], v4, s[48:51], s36 offen offset:3072 sc0 sc1
  s_add_u32 s36, s70, 8192
  buffer_load_dwordx4 a[32:35], v4, s[48:51], s36 offen offset:0 sc0 sc1
  buffer_load_dwordx4 a[36:39], v4, s[48:51], s36 offen offset:1024 sc0 sc1
  buffer_load_dwordx4 a[40:43], v4, s[48:51], s36 offen offset:2048 sc0 sc1
  buffer_load_dwordx4 a[44:47], v4, s[48:51], s36 offen offset:3072 sc0 sc1
  s_add_u32 s36, s70, 12288
  buffer_load_dwordx4 a[48:51], v4, s[48:51], s36 offen offset:0 sc0 sc1
  buffer_load_dwordx4 a[52:55], v4, s[48:51], s36 offen offset:1024 sc0 sc1
  buffer_load_dwordx4 a[56:59], v4, s[48:51], s36 offen offset:2048 sc0 sc1
  buffer_load_dwordx4 a[60:63], v4, s[48:51], s36 offen offset:3072 sc0 sc1
  s_add_u32 s36, s70, 16384
  buffer_load_dword a64, v16, s[48:51], s36 offen offset:0 sc0 sc1
  buffer_load_dword a65, v16, s[48:51], s36 offen offset:64 sc0 sc1
  buffer_load_dword a66, v16, s[48:51], s36 offen offset:128 sc0 sc1
  buffer_load_dword a67, v16, s[48:51], s36 offen offset:192 sc0 sc1
  buffer_load_dword a68, v16, s[48:51], s36 offen offset:1024 sc0 sc1
  buffer_load_dword a69, v16, s[48:51], s36 offen offset:1088 sc0 sc1
  buffer_load_dword a70, v16, s[48:51], s36 offen offset:1152 sc0 sc1
  buffer_load_dword a71, v16, s[48:51], s36 offen offset:1216 sc0 sc1
  s_waitcnt vmcnt(0)
  s_nop 0
  ds_read_b128 a[144:147], v4 offset:0
  ds_read_b128 a[148:151], v4 offset:1024
  ds_read_b128 a[152:155], v4 offset:2048
  ds_read_b128 a[156:159], v4 offset:4160
  ds_read_b128 a[160:163], v4 offset:5184
  s_waitcnt lgkmcnt(0)
  v_mfma_f32_16x16x32_bf16 v[32:35], a[144:147], a[0:3], 0
  v_mfma_f32_16x16x32_bf16 v[36:39], a[148:151], a[0:3], 0
  v_mfma_f32_16x16x32_bf16 v[40:43], a[152:155], a[0:3], 0
  v_mfma_f32_16x16x32_bf16 v[44:47], a[156:159], a[0:3], 0
  v_mfma_f32_16x16x32_bf16 v[48:51], a[160:163], a[0:3], 0
  s_nop 7
  ds_read_b128 a[144:147], v4 offset:37440
  ds_read_b128 a[148:151], v4 offset:38464
  ds_read_b128 a[152:155], v4 offset:39488
  ds_read_b128 a[156:159], v4 offset:41600
  ds_read_b128 a[160:163], v4 offset:42624
  s_waitcnt lgkmcnt(0)
  v_mfma_f32_16x16x32_bf16 v[32:35], a[144:147], a[4:7], v[32:35]
  v_mfma_f32_16x16x32_bf16 v[36:39], a[148:151], a[4:7], v[36:39]
  v_mfma_f32_16x16x32_bf16 v[40:43], a[152:155], a[4:7], v[40:43]
  v_mfma_f32_16x16x32_bf16 v[44:47], a[156:159], a[4:7], v[44:47]
  v_mfma_f32_16x16x32_bf16 v[48:51], a[160:163], a[4:7], v[48:51]
  s_nop 7
  ds_read_b128 a[144:147], v5 offset:17760
  ds_read_b128 a[148:151], v5 offset:18784
  ds_read_b128 a[152:155], v5 offset:19808
  ds_read_b128 a[156:159], v5 offset:21872
  ds_read_b128 a[160:163], v5 offset:22896
  s_waitcnt lgkmcnt(0)
  v_mfma_f32_16x16x32_bf16 v[32:35], a[144:147], a[8:11], v[32:35]
  v_mfma_f32_16x16x32_bf16 v[36:39], a[148:151], a[8:11], v[36:39]
  v_mfma_f32_16x16x32_bf16 v[40:43], a[152:155], a[8:11], v[40:43]
  v_mfma_f32_16x16x32_bf16 v[44:47], a[156:159], a[8:11], v[44:47]
  v_mfma_f32_16x16x32_bf16 v[48:51], a[160:163], a[8:11], v[48:51]
  s_nop 7
  ds_read_b128 a[144:147], v5 offset:54768
  ds_read_b128 a[148:151], v5 offset:55792
  ds_read_b128 a[152:155], v5 offset:56816
  ds_read_b128 a[156:159], v5 offset:58880
  ds_read_b128 a[160:163], v5 offset:59904
  s_waitcnt lgkmcnt(0)
  v_mfma_f32_16x16x32_bf16 v[32:35], a[144:147], a[12:15], v[32:35]
  v_mfma_f32_16x16x32_bf16 v[36:39], a[148:151], a[12:15], v[36:39]
  v_mfma_f32_16x16x32_bf16 v[40:43], a[152:155], a[12:15], v[40:43]
  v_mfma_f32_16x16x32_bf16 v[44:47], a[156:159], a[12:15], v[44:47]
  v_mfma_f32_16x16x32_bf16 v[48:51], a[160:163], a[12:15], v[48:51]
  s_nop 7
  ds_read_b128 a[144:147], v4 offset:6208
  ds_read_b128 a[148:151], v4 offset:8320
  ds_read_b128 a[152:155], v4 offset:9344
  ds_read_b128 a[156:159], v4 offset:10368
  ds_read_b128 a[160:163], v4 offset:12480
  s_waitcnt lgkmcnt(0)
  v_mfma_f32_16x16x32_bf16 v[32:35], a[144:147], a[16:19], v[32:35]
  v_mfma_f32_16x16x32_bf16 v[36:39], a[148:151], a[16:19], v[36:39]
  v_mfma_f32_16x16x32_bf16 v[40:43], a[152:155], a[16:19], v[40:43]
  v_mfma_f32_16x16x32_bf16 v[44:47], a[156:159], a[16:19], v[44:47]
  v_mfma_f32_16x16x32_bf16 v[48:51], a[160:163], a[16:19], v[48:51]
  s_nop 7
  ds_read_b128 a[144:147], v4 offset:43648
  ds_read_b128 a[148:151], v4 offset:45760
  ds_read_b128 a[152:155], v4 offset:46784
  ds_read_b128 a[156:159], v4 offset:47808
  ds_read_b128 a[160:163], v4 offset:49920
  s_waitcnt lgkmcnt(0)
  v_mfma_f32_16x16x32_bf16 v[32:35], a[144:147], a[20:23], v[32:35]
  v_mfma_f32_16x16x32_bf16 v[36:39], a[148:151], a[20:23], v[36:39]
  v_mfma_f32_16x16x32_bf16 v[40:43], a[152:155], a[20:23], v[40:43]
  v_mfma_f32_16x16x32_bf16 v[44:47], a[156:159], a[20:23], v[44:47]
  v_mfma_f32_16x16x32_bf16 v[48:51], a[160:163], a[20:23], v[48:51]
  s_nop 7
  ds_read_b128 a[144:147], v5 offset:23920
  ds_read_b128 a[148:151], v5 offset:25984
  ds_read_b128 a[152:155], v5 offset:27008
  ds_read_b128 a[156:159], v5 offset:28032
  ds_read_b128 a[160:163], v5 offset:30096
  s_waitcnt lgkmcnt(0)
  v_mfma_f32_16x16x32_bf16 v[32:35], a[144:147], a[24:27], v[32:35]
  v_mfma_f32_16x16x32_bf16 v[36:39], a[148:151], a[24:27], v[36:39]
  v_mfma_f32_16x16x32_bf16 v[40:43], a[152:155], a[24:27], v[40:43]
  v_mfma_f32_16x16x32_bf16 v[44:47], a[156:159], a[24:27], v[44:47]
  v_mfma_f32_16x16x32_bf16 v[48:51], a[160:163], a[24:27], v[48:51]
  s_nop 7
  ds_read_b128 a[144:147], v5 offset:60928
  ds_read_b128 a[148:151], v5 offset:62992
  ds_read_b128 a[152:155], v5 offset:64016
  ds_read_b128 a[156:159], v5 offset:65040
  ds_read_b128 a[160:163], v6 offset:1568
  s_waitcnt lgkmcnt(0)
  v_mfma_f32_16x16x32_bf16 v[32:35], a[144:147], a[28:31], v[32:35]
  v_mfma_f32_16x16x32_bf16 v[36:39], a[148:151], a[28:31], v[36:39]
  v_mfma_f32_16x16x32_bf16 v[40:43], a[152:155], a[28:31], v[40:43]
  v_mfma_f32_16x16x32_bf16 v[44:47], a[156:159], a[28:31], v[44:47]
  v_mfma_f32_16x16x32_bf16 v[48:51], a[160:163], a[28:31], v[48:51]
  s_nop 7
  ds_read_b128 a[144:147], v4 offset:13504
  ds_read_b128 a[148:151], v4 offset:14528
  ds_read_b128 a[152:155], v4 offset:16640
  ds_read_b128 a[156:159], v4 offset:17664
  ds_read_b128 a[160:163], v4 offset:18688
  s_waitcnt lgkmcnt(0)
  v_mfma_f32_16x16x32_bf16 v[32:35], a[144:147], a[32:35], v[32:35]
  v_mfma_f32_16x16x32_bf16 v[36:39], a[148:151], a[32:35], v[36:39]
  v_mfma_f32_16x16x32_bf16 v[40:43], a[152:155], a[32:35], v[40:43]
  v_mfma_f32_16x16x32_bf16 v[44:47], a[156:159], a[32:35], v[44:47]
  v_mfma_f32_16x16x32_bf16 v[48:51], a[160:163], a[32:35], v[48:51]
  s_nop 7
  ds_read_b128 a[144:147], v4 offset:50944
  ds_read_b128 a[148:151], v4 offset:51968
  ds_read_b128 a[152:155], v4 offset:54080
  ds_read_b128 a[156:159], v4 offset:55104
  ds_read_b128 a[160:163], v4 offset:56128
  s_waitcnt lgkmcnt(0)
  v_mfma_f32_16x16x32_bf16 v[32:35], a[144:147], a[36:39], v[32:35]
  v_mfma_f32_16x16x32_bf16 v[36:39], a[148:151], a[36:39], v[36:39]
  v_mfma_f32_16x16x32_bf16 v[40:43], a[152:155], a[36:39], v[40:43]
  v_mfma_f32_16x16x32_bf16 v[44:47], a[156:159], a[36:39], v[44:47]
  v_mfma_f32_16x16x32_bf16 v[48:51], a[160:163], a[36:39], v[48:51]
  s_nop 7
  ds_read_b128 a[144:147], v5 offset:31120
  ds_read_b128 a[148:151], v5 offset:32144
  ds_read_b128 a[152:155], v5 offset:34208
  ds_read_b128 a[156:159], v5 offset:35232
  ds_read_b128 a[160:163], v5 offset:36256
  s_waitcnt lgkmcnt(0)
  v_mfma_f32_16x16x32_bf16 v[32:35], a[144:147], a[40:43], v[32:35]
  v_mfma_f32_16x16x32_bf16 v[36:39], a[148:151], a[40:43], v[36:39]
  v_mfma_f32_16x16x32_bf16 v[40:43], a[152:155], a[40:43], v[40:43]
  v_mfma_f32_16x16x32_bf16 v[44:47], a[156:159], a[40:43], v[44:47]
  v_mfma_f32_16x16x32_bf16 v[48:51], a[160:163], a[40:43], v[48:51]
  s_nop 7
  ds_read_b128 a[144:147], v6 offset:2592
  ds_read_b128 a[148:151], v6 offset:3616
  ds_read_b128 a[152:155], v6 offset:5680
  ds_read_b128 a[156:159], v6 offset:6704
  ds_read_b128 a[160:163], v6 offset:7728
  s_waitcnt lgkmcnt(0)
  v_mfma_f32_16x16x32_bf16 v[32:35], a[144:147], a[44:47], v[32:35]
  v_mfma_f32_16x16x32_bf16 v[36:39], a[148:151], a[44:47], v[36:39]
  v_mfma_f32_16x16x32_bf16 v[40:43], a[152:155], a[44:47], v[40:43]
  v_mfma_f32_16x16x32_bf16 v[44:47], a[156:159], a[44:47], v[44:47]
  v_mfma_f32_16x16x32_bf16 v[48:51], a[160:163], a[44:47], v[48:51]
  s_nop 7
  ds_read_b128 a[144:147], v4 offset:20800
  ds_read_b128 a[148:151], v4 offset:21824
  ds_read_b128 a[152:155], v4 offset:22848
  ds_read_b128 a[156:159], v4 offset:24960
  ds_read_b128 a[160:163], v4 offset:25984
  s_waitcnt lgkmcnt(0)
  v_mfma_f32_16x16x32_bf16 v[32:35], a[144:147], a[48:51], v[32:35]
  v_mfma_f32_16x16x32_bf16 v[36:39], a[148:151], a[48:51], v[36:39]
  v_mfma_f32_16x16x32_bf16 v[40:43], a[152:155], a[48:51], v[40:43]
  v_mfma_f32_16x16x32_bf16 v[44:47], a[156:159], a[48:51], v[44:47]
  v_mfma_f32_16x16x32_bf16 v[48:51], a[160:163], a[48:51], v[48:51]
  s_nop 7
  ds_read_b128 a[144:147], v4 offset:58240
  ds_read_b128 a[148:151], v4 offset:59264
  ds_read_b128 a[152:155], v4 offset:60288
  ds_read_b128 a[156:159], v4 offset:62400
  ds_read_b128 a[160:163], v4 offset:63424
  s_waitcnt lgkmcnt(0)
  v_mfma_f32_16x16x32_bf16 v[32:35], a[144:147], a[52:55], v[32:35]
  v_mfma_f32_16x16x32_bf16 v[36:39], a[148:151], a[52:55], v[36:39]
  v_mfma_f32_16x16x32_bf16 v[40:43], a[152:155], a[52:55], v[40:43]
  v_mfma_f32_16x16x32_bf16 v[44:47], a[156:159], a[52:55], v[44:47]
  v_mfma_f32_16x16x32_bf16 v[48:51], a[160:163], a[52:55], v[48:51]
  s_nop 7
  ds_read_b128 a[144:147], v5 offset:38320
  ds_read_b128 a[148:151], v5 offset:39344
  ds_read_b128 a[152:155], v5 offset:40368
  ds_read_b128 a[156:159], v5 offset:42432
  ds_read_b128 a[160:163], v5 offset:43456
  s_waitcnt lgkmcnt(0)
  v_mfma_f32_16x16x32_bf16 v[32:35], a[144:147], a[56:59], v[32:35]
  v_mfma_f32_16x16x32_bf16 v[36:39], a[148:151], a[56:59], v[36:39]
  v_mfma_f32_16x16x32_bf16 v[40:43], a[152:155], a[56:59], v[40:43]
  v_mfma_f32_16x16x32_bf16 v[44:47], a[156:159], a[56:59], v[44:47]
  v_mfma_f32_16x16x32_bf16 v[48:51], a[160:163], a[56:59], v[48:51]
  s_nop 7
  ds_read_b128 a[144:147], v6 offset:9792
  ds_read_b128 a[148:151], v6 offset:10816
  ds_read_b128 a[152:155], v6 offset:11840
  ds_read_b128 a[156:159], v6 offset:13904
  ds_read_b128 a[160:163], v6 offset:14928
  s_waitcnt lgkmcnt(0)
  v_mfma_f32_16x16x32_bf16 v[32:35], a[144:147], a[60:63], v[32:35]
  v_mfma_f32_16x16x32_bf16 v[36:39], a[148:151], a[60:63], v[36:39]
  v_mfma_f32_16x16x32_bf16 v[40:43], a[152:155], a[60:63], v[40:43]
  v_mfma_f32_16x16x32_bf16 v[44:47], a[156:159], a[60:63], v[44:47]
  v_mfma_f32_16x16x32_bf16 v[48:51], a[160:163], a[60:63], v[48:51]
  s_nop 7
  ds_read_b128 a[144:147], v4 offset:29120
  ds_read_b128 a[148:151], v4 offset:30144
  ds_read_b128 a[152:155], v4 offset:31168
  ds_read_b128 a[156:159], v4 offset:33280
  ds_read_b128 a[160:163], v4 offset:34304
  s_waitcnt lgkmcnt(0)
  v_mfma_f32_16x16x32_bf16 v[32:35], a[144:147], a[64:67], v[32:35]
  v_mfma_f32_16x16x32_bf16 v[36:39], a[148:151], a[64:67], v[36:39]
  v_mfma_f32_16x16x32_bf16 v[40:43], a[152:155], a[64:67], v[40:43]
  v_mfma_f32_16x16x32_bf16 v[44:47], a[156:159], a[64:67], v[44:47]
  v_mfma_f32_16x16x32_bf16 v[48:51], a[160:163], a[64:67], v[48:51]
  s_nop 7
  ds_read_b128 a[144:147], v5 offset:1024
  ds_read_b128 a[148:151], v5 offset:2048
  ds_read_b128 a[152:155], v5 offset:3072
  ds_read_b128 a[156:159], v5 offset:5184
  ds_read_b128 a[160:163], v5 offset:6208
  s_waitcnt lgkmcnt(0)
  v_mfma_f32_16x16x32_bf16 v[32:35], a[144:147], a[68:71], v[32:35]
  v_mfma_f32_16x16x32_bf16 v[36:39], a[148:151], a[68:71], v[36:39]
  v_mfma_f32_16x16x32_bf16 v[40:43], a[152:155], a[68:71], v[40:43]
  v_mfma_f32_16x16x32_bf16 v[44:47], a[156:159], a[68:71], v[44:47]
  v_mfma_f32_16x16x32_bf16 v[48:51], a[160:163], a[68:71], v[48:51]
  s_nop 7
  s_nop 7
  s_branch L_p3_ok
L_k4_spin0:
  s_mov_b32 s38, 0
L_k4_spin:
  s_sleep 1
  buffer_load_dwordx4 v[240:243], v4, s[44:47], s68 offen offset:0 sc0 sc1
  buffer_load_dwordx4 v[244:247], v4, s[44:47], s68 offen offset:1024 sc0 sc1
  buffer_load_dwordx4 v[248:251], v4, s[44:47], s68 offen offset:2048 sc0 sc1
  buffer_load_dwordx4 v[252:255], v4, s[44:47], s68 offen offset:3072 sc0 sc1
  s_waitcnt vmcnt(0)
  v_add_f32 v240, v240, v244
  v_add_f32 v241, v241, v245
  v_add_f32 v242, v242, v246
  v_add_f32 v243, v243, v247
  v_add_f32 v248, v248, v252
  v_add_f32 v249, v249, v253
  v_add_f32 v250, v250, v254
  v_add_f32 v251, v251, v255
  v_add_f32 v240, v240, v248
  v_add_f32 v241, v241, v249
  v_add_f32 v242, v242, v250
  v_add_f32 v243, v243, v251
  s_nop 0
  v_add_f32_dpp v240, v240, v240 row_ror:8 row_mask:0xf bank_mask:0x3
  v_add_f32_dpp v241, v241, v241 row_ror:8 row_mask:0xf bank_mask:0x3
  v_add_f32_dpp v240, v242, v242 row_ror:8 row_mask:0xf bank_mask:0xc
  v_add_f32_dpp v241, v243, v243 row_ror:8 row_mask:0xf bank_mask:0xc
  s_nop 0
  v_add_f32_dpp v240, v240, v240 row_shr:4 row_mask:0xf bank_mask:0xa
  v_add_f32_dpp v241, v241, v241 row_shr:4 row_mask:0xf bank_mask:0xa
  v_cmp_u_f32_e64 vcc, v240, v241
  s_cmp_eq_u64 vcc, 0
  s_cbranch_scc1 L_k4_go
  s_add_u32 s38, s38, 1
  s_cmp_lt_u32 s38, 0x20000
  s_cbranch_scc1 L_k4_spin
  s_branch L_k4_go
L_k5r_0:
  ds_read_b32 v109, v108
  s_waitcnt lgkmcnt(0)
L_k5s_0:
  v_cmp_gt_u32 vcc, 2, v109
  s_cbranch_vccnz L_k5r_0
  s_branch L_k5g_0
L_k5r_1:
  ds_read_b32 v109, v108
  s_waitcnt lgkmcnt(0)
L_k5s_1:
  v_cmp_gt_u32 vcc, 3, v109
  s_cbranch_vccnz L_k5r_1
  s_cmp_eq_u32 s87, 0
  s_cbranch_scc0 L_f4s_2
L_f4g_2:
  s_branch L_k5g_1
L_k5r_2:
  ds_read_b32 v109, v108
  s_waitcnt lgkmcnt(0)
L_k5s_2:
  v_cmp_gt_u32 vcc, 4, v109
  s_cbranch_vccnz L_k5r_2
  s_branch L_k5g_2
L_k5r_3:
  ds_read_b32 v109, v108
  s_waitcnt lgkmcnt(0)
L_k5s_3:
  v_cmp_gt_u32 vcc, 5, v109
  s_cbranch_vccnz L_k5r_3
  s_cmp_eq_u32 s87, 0
  s_cbranch_scc0 L_f4s_3
L_f4g_3:
  s_branch L_k5g_3
L_k5r_4:
  ds_read_b32 v109, v108
  s_waitcnt lgkmcnt(0)
L_k5s_4:
  v_cmp_gt_u32 vcc, 6, v109
  s_cbranch_vccnz L_k5r_4
  s_branch L_k5g_4
L_k5r_5:
  ds_read_b32 v109, v108
  s_waitcnt lgkmcnt(0)
L_k5s_5:
  v_cmp_gt_u32 vcc, 7, v109
  s_cbranch_vccnz L_k5r_5
  s_cmp_eq_u32 s87, 0
  s_cbranch_scc0 L_f4s_4
L_f4g_4:
  s_branch L_k5g_5
L_k5r_6:
  ds_read_b32 v109, v108
  s_waitcnt lgkmcnt(0)
L_k5s_6:
  v_cmp_gt_u32 vcc, 8, v109
  s_cbranch_vccnz L_k5r_6
  s_branch L_k5g_6
L_k5r_7:
  ds_read_b32 v109, v108
  s_waitcnt lgkmcnt(0)
L_k5s_7:
  v_cmp_gt_u32 vcc, 9, v109
  s_cbranch_vccnz L_k5r_7
  s_cmp_eq_u32 s87, 0
  s_cbranch_scc0 L_f4s_5
L_f4g_5:
  s_branch L_k5g_7
L_k5r_8:
  ds_read_b32 v109, v108
  s_waitcnt lgkmcnt(0)
L_k5s_8:
  v_cmp_gt_u32 vcc, 10, v109
  s_cbranch_vccnz L_k5r_8
  s_branch L_k5g_8
L_k5r_9:
  ds_read_b32 v109, v108
  s_waitcnt lgkmcnt(0)
L_k5s_9:
  v_cmp_gt_u32 vcc, 11, v109
  s_cbranch_vccnz L_k5r_9
  s_cmp_eq_u32 s87, 0
  s_cbranch_scc0 L_f4s_6
L_f4g_6:
  s_branch L_k5g_9
L_k5r_10:
  ds_read_b32 v109, v108
  s_waitcnt lgkmcnt(0)
L_k5s_10:
  v_cmp_gt_u32 vcc, 12, v109
  s_cbranch_vccnz L_k5r_10
  s_branch L_k5g_10
L_k5r_11:
  ds_read_b32 v109, v108
  s_waitcnt lgkmcnt(0)
L_k5s_11:
  v_cmp_gt_u32 vcc, 13, v109
  s_cbranch_vccnz L_k5r_11
  s_cmp_eq_u32 s87, 0
  s_cbranch_scc0 L_f4s_7
L_f4g_7:
  s_branch L_k5g_11
L_k5r_12:
  ds_read_b32 v109, v108
  s_waitcnt lgkmcnt(0)
L_k5s_12:
  v_cmp_gt_u32 vcc, 14, v109
  s_cbranch_vccnz L_k5r_12
  s_branch L_k5g_12
L_k5r_13:
  ds_read_b32 v109, v108
  s_waitcnt lgkmcnt(0)
L_k5s_13:
  v_cmp_gt_u32 vcc, 15, v109
  s_cbranch_vccnz L_k5r_13
  s_cmp_eq_u32 s87, 0
  s_cbranch_scc0 L_f4s_8
L_f4g_8:
  s_branch L_k5g_13
L_k5r_14:
  ds_read_b32 v109, v108
  s_waitcnt lgkmcnt(0)
L_k5s_14:
  v_cmp_gt_u32 vcc, 16, v109
  s_cbranch_vccnz L_k5r_14
  s_branch L_k5g_14
L_k5r_15:
  ds_read_b32 v109, v108
  s_waitcnt lgkmcnt(0)
L_k5s_15:
  v_cmp_gt_u32 vcc, 17, v109
  s_cbranch_vccnz L_k5r_15
  s_cmp_eq_u32 s87, 0
  s_cbranch_scc0 L_f4s_9
L_f4g_9:
  s_branch L_k5g_15
L_k5r_16:
  ds_read_b32 v109, v108
  s_waitcnt lgkmcnt(0)
L_k5s_16:
  v_cmp_gt_u32 vcc, 18, v109
  s_cbranch_vccnz L_k5r_16
  s_branch L_k5g_16
L_k5r_17:
  ds_read_b32 v109, v108
  s_waitcnt lgkmcnt(0)
L_k5s_17:
  v_cmp_gt_u32 vcc, 19, v109
  s_cbranch_vccnz L_k5r_17
  s_cmp_eq_u32 s87, 0
  s_cbranch_scc0 L_f4s_10
L_f4g_10:
  s_branch L_k5g_17
L_k5r_18:
  ds_read_b32 v109, v108
  s_waitcnt lgkmcnt(0)
L_k5s_18:
  v_cmp_gt_u32 vcc, 20, v109
  s_cbranch_vccnz L_k5r_18
  s_branch L_k5g_18
L_k5r_19:
  ds_read_b32 v109, v108
  s_waitcnt lgkmcnt(0)
L_k5s_19:
  v_cmp_gt_u32 vcc, 21, v109
  s_cbranch_vccnz L_k5r_19
  s_cmp_eq_u32 s87, 0
  s_cbranch_scc0 L_f4s_11
L_f4g_11:
  s_branch L_k5g_19
L_k5r_20:
  ds_read_b32 v109, v108
  s_waitcnt lgkmcnt(0)
L_k5s_20:
  v_cmp_gt_u32 vcc, 22, v109
  s_cbranch_vccnz L_k5r_20
  s_branch L_k5g_20
L_k5r_21:
  ds_read_b32 v109, v108
  s_waitcnt lgkmcnt(0)
L_k5s_21:
  v_cmp_gt_u32 vcc, 23, v109
  s_cbranch_vccnz L_k5r_21
  s_cmp_eq_u32 s87, 0
  s_cbranch_scc0 L_f4s_12
L_f4g_12:
  s_branch L_k5g_21
L_k5r_22:
  ds_read_b32 v109, v108
  s_waitcnt lgkmcnt(0)
L_k5s_22:
  v_cmp_gt_u32 vcc, 24, v109
  s_cbranch_vccnz L_k5r_22
  s_branch L_k5g_22
L_k5r_23:
  ds_read_b32 v109, v108
  s_waitcnt lgkmcnt(0)
L_k5s_23:
  v_cmp_gt_u32 vcc, 25, v109
  s_cbranch_vccnz L_k5r_23
  s_cmp_eq_u32 s87, 0
  s_cbranch_scc0 L_f4s_13
L_f4g_13:
  s_branch L_k5g_23
L_k5r_24:
  ds_read_b32 v109, v108
  s_waitcnt lgkmcnt(0)
L_k5s_24:
  v_cmp_gt_u32 vcc, 26, v109
  s_cbranch_vccnz L_k5r_24
  s_branch L_k5g_24
L_k5r_25:
  ds_read_b32 v109, v108
  s_waitcnt lgkmcnt(0)
L_k5s_25:
  v_cmp_gt_u32 vcc, 27, v109
  s_cbranch_vccnz L_k5r_25
  s_cmp_eq_u32 s87, 0
  s_cbranch_scc0 L_f4s_14
L_f4g_14:
  s_branch L_k5g_25
L_k5r_26:
  ds_read_b32 v109, v108
  s_waitcnt lgkmcnt(0)
L_k5s_26:
  v_cmp_gt_u32 vcc, 28, v109
  s_cbranch_vccnz L_k5r_26
  s_branch L_k5g_26
L_f4s_0:
  s_mov_b32 s39, 0
  s_branch L_f4c_0
L_f4l_0:
  buffer_load_dword v249, v248, s[24:27], s36 offen sc0 sc1
  s_waitcnt vmcnt(0)
L_f4c_0:
  v_cmp_eq_u32 vcc, -1, v249
  s_and_b32 s87, vcc_lo, 0xfffe
  s_and_b32 s38, s87, s83
  s_cbranch_scc0 L_f4e_0
  s_add_u32 s39, s39, 1
  s_cmp_lt_u32 s39, 0x40000
  s_cbranch_scc1 L_f4l_0
L_f4e_0:
  s_lshl_b32 s83, s83, 1
  s_branch L_f4g_0
L_f4s_1:
  s_mov_b32 s39, 0
  s_branch L_f4c_1
L_f4l_1:
  buffer_load_dword v249, v248, s[24:27], s36 offen sc0 sc1
  s_waitcnt vmcnt(0)
L_f4c_1:
  v_cmp_eq_u32_e64 vcc, -1, v249
  s_and_b32 s87, vcc_lo, 0xfffe
  s_and_b32 s38, s87, s83
  s_cbranch_scc0 L_f4e_1
  s_add_u32 s39, s39, 1
  s_cmp_lt_u32 s39, 0x40000
  s_cbranch_scc1 L_f4l_1
L_f4e_1:
  s_lshl_b32 s83, s83, 1
  buffer_load_dword v249, v248, s[24:27], s36 offen sc0 sc1
  s_branch L_f4g_1
L_f4s_2:
  s_waitcnt vmcnt(16)
  s_mov_b32 s39, 0
  s_branch L_f4c_2
L_f4l_2:
  buffer_load_dword v249, v248, s[24:27], s36 offen sc0 sc1
  s_waitcnt vmcnt(0)
L_f4c_2:
  v_cmp_eq_u32_e64 vcc, -1, v249
  s_and_b32 s87, vcc_lo, 0xfffe
  s_and_b32 s38, s87, s83
  s_cbranch_scc0 L_f4e_2
  s_add_u32 s39, s39, 1
  s_cmp_lt_u32 s39, 0x40000
  s_cbranch_scc1 L_f4l_2
L_f4e_2:
  s_lshl_b32 s83, s83, 1
  buffer_load_dword v249, v248, s[24:27], s36 offen sc0 sc1
  s_branch L_f4g_2
L_f4s_3:
  s_waitcnt vmcnt(16)
  s_mov_b32 s39, 0
  s_branch L_f4c_3
L_f4l_3:
  buffer_load_dword v249, v248, s[24:27], s36 offen sc0 sc1
  s_waitcnt vmcnt(0)
L_f4c_3:
  v_cmp_eq_u32_e64 vcc, -1, v249
  s_and_b32 s87, vcc_lo, 0xfffe
  s_and_b32 s38, s87, s83
  s_cbranch_scc0 L_f4e_3
  s_add_u32 s39, s39, 1
  s_cmp_lt_u32 s39, 0x40000
  s_cbranch_scc1 L_f4l_3
L_f4e_3:
  s_lshl_b32 s83, s83, 1
  buffer_load_dword v249, v248, s[24:27], s36 offen sc0 sc1
  s_branch L_f4g_3
L_f4s_4:
  s_waitcnt vmcnt(17)
  s_mov_b32 s39, 0
  s_branch L_f4c_4
L_f4l_4:
  buffer_load_dword v249, v248, s[24:27], s36 offen sc0 sc1
  s_waitcnt vmcnt(0)
L_f4c_4:
  v_cmp_eq_u32_e64 vcc, -1, v249
  s_and_b32 s87, vcc_lo, 0xfffe
  s_and_b32 s38, s87, s83
  s_cbranch_scc0 L_f4e_4
  s_add_u32 s39, s39, 1
  s_cmp_lt_u32 s39, 0x40000
  s_cbranch_scc1 L_f4l_4
L_f4e_4:
  s_lshl_b32 s83, s83, 1
  buffer_load_dword v249, v248, s[24:27], s36 offen sc0 sc1
  s_branch L_f4g_4
L_f4s_5:
  s_waitcnt vmcnt(16)
  s_mov_b32 s39, 0
  s_branch L_f4c_5
L_f4l_5:
  buffer_load_dword v249, v248, s[24:27], s36 offen sc0 sc1
  s_waitcnt vmcnt(0)
L_f4c_5:
  v_cmp_eq_u32_e64 vcc, -1, v249
  s_and_b32 s87, vcc_lo, 0xfffe
  s_and_b32 s38, s87, s83
  s_cbranch_scc0 L_f4e_5
  s_add_u32 s39, s39, 1
  s_cmp_lt_u32 s39, 0x40000
  s_cbranch_scc1 L_f4l_5
L_f4e_5:
  s_lshl_b32 s83, s83, 1
  buffer_load_dword v249, v248, s[24:27], s36 offen sc0 sc1
  s_branch L_f4g_5
L_f4s_6:
  s_waitcnt vmcnt(17)
  s_mov_b32 s39, 0
  s_branch L_f4c_6
L_f4l_6:
  buffer_load_dword v249, v248, s[24:27], s36 offen sc0 sc1
  s_waitcnt vmcnt(0)
L_f4c_6:
  v_cmp_eq_u32_e64 vcc, -1, v249
  s_and_b32 s87, vcc_lo, 0xfffe
  s_and_b32 s38, s87, s83
  s_cbranch_scc0 L_f4e_6
  s_add_u32 s39, s39, 1
  s_cmp_lt_u32 s39, 0x40000
  s_cbranch_scc1 L_f4l_6
L_f4e_6:
  s_lshl_b32 s83, s83, 1
  buffer_load_dword v249, v248, s[24:27], s36 offen sc0 sc1
  s_branch L_f4g_6
L_f4s_7:
  s_waitcnt vmcnt(16)
  s_mov_b32 s39, 0
  s_branch L_f4c_7
L_f4l_7:
  buffer_load_dword v249, v248, s[24:27], s36 offen sc0 sc1
  s_waitcnt vmcnt(0)
L_f4c_7:
  v_cmp_eq_u32_e64 vcc, -1, v249
  s_and_b32 s87, vcc_lo, 0xfffe
  s_and_b32 s38, s87, s83
  s_cbranch_scc0 L_f4e_7
  s_add_u32 s39, s39, 1
  s_cmp_lt_u32 s39, 0x40000
  s_cbranch_scc1 L_f4l_7
L_f4e_7:
  s_lshl_b32 s83, s83, 1
  buffer_load_dword v249, v248, s[24:27], s36 offen sc0 sc1
  s_branch L_f4g_7
L_f4s_8:
  s_waitcnt vmcnt(17)
  s_mov_b32 s39, 0
  s_branch L_f4c_8
L_f4l_8:
  buffer_load_dword v249, v248, s[24:27], s36 offen sc0 sc1
  s_waitcnt vmcnt(0)
L_f4c_8:
  v_cmp_eq_u32_e64 vcc, -1, v249
  s_and_b32 s87, vcc_lo, 0xfffe
  s_and_b32 s38, s87, s83
  s_cbranch_scc0 L_f4e_8
  s_add_u32 s39, s39, 1
  s_cmp_lt_u32 s39, 0x40000
  s_cbranch_scc1 L_f4l_8
L_f4e_8:
  s_lshl_b32 s83, s83, 1
  buffer_load_dword v249, v248, s[24:27], s36 offen sc0 sc1
  s_branch L_f4g_8
L_f4s_9:
  s_waitcnt vmcnt(15)
  s_mov_b32 s39, 0
  s_branch L_f4c_9
L_f4l_9:
  buffer_load_dword v249, v248, s[24:27], s36 offen sc0 sc1
  s_waitcnt vmcnt(0)
L_f4c_9:
  v_cmp_eq_u32_e64 vcc, -1, v249
  s_and_b32 s87, vcc_lo, 0xfffe
  s_and_b32 s38, s87, s83
  s_cbranch_scc0 L_f4e_9
  s_add_u32 s39, s39, 1
  s_cmp_lt_u32 s39, 0x40000
  s_cbranch_scc1 L_f4l_9
L_f4e_9:
  s_lshl_b32 s83, s83, 1
  buffer_load_dword v249, v248, s[24:27], s36 offen sc0 sc1
  s_branch L_f4g_9
L_f4s_10:
  s_waitcnt vmcnt(17)
  s_mov_b32 s39, 0
  s_branch L_f4c_10
L_f4l_10:
  buffer_load_dword v249, v248, s[24:27], s36 offen sc0 sc1
  s_waitcnt vmcnt(0)
L_f4c_10:
  v_cmp_eq_u32_e64 vcc, -1, v249
  s_and_b32 s87, vcc_lo, 0xfffe
  s_and_b32 s38, s87, s83
  s_cbranch_scc0 L_f4e_10
  s_add_u32 s39, s39, 1
  s_cmp_lt_u32 s39, 0x40000
  s_cbranch_scc1 L_f4l_10
L_f4e_10:
  s_lshl_b32 s83, s83, 1
  buffer_load_dword v249, v248, s[24:27], s36 offen sc0 sc1
  s_branch L_f4g_10
L_f4s_11:
  s_waitcnt vmcnt(16)
  s_mov_b32 s39, 0
  s_branch L_f4c_11
L_f4l_11:
  buffer_load_dword v249, v248, s[24:27], s36 offen sc0 sc1
  s_waitcnt vmcnt(0)
L_f4c_11:
  v_cmp_eq_u32_e64 vcc, -1, v249
  s_and_b32 s87, vcc_lo, 0xfffe
  s_and_b32 s38, s87, s83
  s_cbranch_scc0 L_f4e_11
  s_add_u32 s39, s39, 1
  s_cmp_lt_u32 s39, 0x40000
  s_cbranch_scc1 L_f4l_11
L_f4e_11:
  s_lshl_b32 s83, s83, 1
  buffer_load_dword v249, v248, s[24:27], s36 offen sc0 sc1
  s_branch L_f4g_11
L_f4s_12:
  s_waitcnt vmcnt(17)
  s_mov_b32 s39, 0
  s_branch L_f4c_12
L_f4l_12:
  buffer_load_dword v249, v248, s[24:27], s36 offen sc0 sc1
  s_waitcnt vmcnt(0)
L_f4c_12:
  v_cmp_eq_u32_e64 vcc, -1, v249
  s_and_b32 s87, vcc_lo, 0xfffe
  s_and_b32 s38, s87, s83
  s_cbranch_scc0 L_f4e_12
  s_add_u32 s39, s39, 1
  s_cmp_lt_u32 s39, 0x40000
  s_cbranch_scc1 L_f4l_12
L_f4e_12:
  s_lshl_b32 s83, s83, 1
  buffer_load_dword v249, v248, s[24:27], s36 offen sc0 sc1
  s_branch L_f4g_12
L_f4s_13:
  s_waitcnt vmcnt(16)
  s_mov_b32 s39, 0
  s_branch L_f4c_13
L_f4l_13:
  buffer_load_dword v249, v248, s[24:27], s36 offen sc0 sc1
  s_waitcnt vmcnt(0)
L_f4c_13:
  v_cmp_eq_u32_e64 vcc, -1, v249
  s_and_b32 s87, vcc_lo, 0xfffe
  s_and_b32 s38, s87, s83
  s_cbranch_scc0 L_f4e_13
  s_add_u32 s39, s39, 1
  s_cmp_lt_u32 s39, 0x40000
  s_cbranch_scc1 L_f4l_13
L_f4e_13:
  s_lshl_b32 s83, s83, 1
  buffer_load_dword v249, v248, s[24:27], s36 offen sc0 sc1
  s_branch L_f4g_13
L_f4s_14:
  s_waitcnt vmcnt(17)
  s_mov_b32 s39, 0
  s_branch L_f4c_14
L_f4l_14:
  buffer_load_dword v249, v248, s[24:27], s36 offen sc0 sc1
  s_waitcnt vmcnt(0)
L_f4c_14:
  v_cmp_eq_u32_e64 vcc, -1, v249
  s_and_b32 s87, vcc_lo, 0xfffe
  s_and_b32 s38, s87, s83
  s_cbranch_scc0 L_f4e_14
  s_add_u32 s39, s39, 1
  s_cmp_lt_u32 s39, 0x40000
  s_cbranch_scc1 L_f4l_14
L_f4e_14:
  s_lshl_b32 s83, s83, 1
  s_branch L_f4g_14
L_k1_sre:
  s_mov_b32 s55, 0
L_k1_srl:
  buffer_load_dwordx2 v[212:213], v192, s[96:99], s52 offen offset:0 sc0 sc1
  buffer_load_dword v222, v194, s[96:99], s53 offen offset:0 sc0 sc1
  buffer_load_dwordx2 v[214:215], v192, s[96:99], s52 offen offset:2048 sc0 sc1
  buffer_load_dword v223, v194, s[96:99], s53 offen offset:1024 sc0 sc1
  buffer_load_dwordx2 v[216:217], v192, s[96:99], s54 offen offset:0 sc0 sc1
  buffer_load_dword v224, v194, s[96:99], s53 offen offset:2048 sc0 sc1
  buffer_load_dwordx2 v[218:219], v192, s[96:99], s54 offen offset:2048 sc0 sc1
  buffer_load_dword v225, v194, s[96:99], s53 offen offset:3072 sc0 sc1
  buffer_load_dwordx2 v[220:221], v193, s[96:99], s52 offen offset:0 sc0 sc1
  buffer_load_dword v226, v195, s[96:99], s53 offen offset:0 sc0 sc1
  s_waitcnt vmcnt(0)
  v_add_f32 v212, v212, v214
  v_add_f32 v213, v213, v215
  v_add_f32 v222, v222, v223
  v_add_f32 v216, v216, v218
  v_add_f32 v217, v217, v219
  v_add_f32 v224, v224, v225
  v_add_f32 v212, v212, v220
  v_add_f32 v213, v213, v221
  v_add_f32 v222, v222, v226
  v_add_f32 v212, v212, v216
  v_add_f32 v213, v213, v217
  v_add_f32 v222, v222, v224
  v_mov_b32 v214, v212
  v_mov_b32 v215, v213
  v_mov_b32 v223, v222
  s_nop 0
  v_permlane32_swap_b32 v212, v214
  v_permlane32_swap_b32 v213, v215
  v_permlane32_swap_b32 v222, v223
  s_nop 0
  v_add_f32 v212, v212, v214
  v_add_f32 v213, v213, v215
  v_add_f32 v222, v222, v223
  v_add_f32_e64 v214, v212, v213
  v_cmp_u_f32 vcc, v214, v222
  s_cmp_eq_u64 vcc, 0
  s_cbranch_scc1 L_k1_sok
  s_add_u32 s55, s55, 1
  s_cmp_lt_u32 s55, 0x20000
  s_cbranch_scc1 L_k1_srl
  s_branch L_k1_sok
L_k2_maxpass:
  v_mov_b32_e64 v25, 0
  v_mov_b32 v8, 0xff800000
  v_mov_b32_e64 v27, 0
  v_mov_b32 v9, 0xff800000
  v_mov_b32_e64 v13, v140
  v_mov_b32 v14, v141
  s_mov_b32 s34, 0
L_k2_maxloop:
  ds_read_b64_tr_b16 v[32:33], v13 offset:0
  ds_read_b64_tr_b16 v[34:35], v13 offset:16640
  ds_read_b64_tr_b16 v[40:41], v14 offset:0
  v_add_u32_e64 v13, 64, v13
  v_add_u32 v14, 64, v14
  s_waitcnt lgkmcnt(0)
  v_mfma_f32_32x32x16_bf16 v[72:87], v[32:35], v[16:19], 0
  v_mfma_f32_32x32x16_bf16 v[88:103], v[32:35], v[20:23], 0
  v_mfma_f32_32x32x8bf16_1k v[72:87], v[40:41], v[24:25], v[72:87]
  v_mfma_f32_32x32x8bf16_1k v[88:103], v[40:41], v[26:27], v[88:103]
  s_nop 7
  s_nop 7
  v_max3_f32 v8, v8, v72, v73
  v_max3_f32 v8, v8, v74, v75
  v_max3_f32 v8, v8, v76, v77
  v_max3_f32 v8, v8, v78, v79
  v_max3_f32 v8, v8, v80, v81
  v_max3_f32 v8, v8, v82, v83
  v_max3_f32 v8, v8, v84, v85
  v_max3_f32 v8, v8, v86, v87
  s_nop 7
  s_nop 0
  v_max3_f32 v9, v9, v88, v89
  v_max3_f32 v9, v9, v90, v91
  v_max3_f32 v9, v9, v92, v93
  v_max3_f32 v9, v9, v94, v95
  v_max3_f32 v9, v9, v96, v97
  v_max3_f32 v9, v9, v98, v99
  v_max3_f32 v9, v9, v100, v101
  v_max3_f32 v9, v9, v102, v103
  s_add_u32 s34, s34, 1
  s_cmp_lt_u32 s34, s30
  s_cbranch_scc1 L_k2_maxloop
  v_mov_b32 v13, v140
  v_mov_b32 v14, v141
  v_mov_b32 v15, v142
  ds_read_b64_tr_b16 v[32:33], v13 offset:0
  ds_read_b64_tr_b16 v[34:35], v13 offset:16640
  ds_read_b64_tr_b16 v[40:41], v14 offset:0
  ds_read_b64_tr_b16 v[36:37], v13 offset:64
  ds_read_b64_tr_b16 v[38:39], v13 offset:16704
  ds_read_b64_tr_b16 v[42:43], v14 offset:64
  ds_read_b128 v[48:51], v15 offset:0
  ds_read_b128 v[52:55], v15 offset:32
  v_mov_b32 v10, v8
  s_nop 1
  v_permlane32_swap_b32 v8, v10
  s_nop 1
  v_max_f32 v8, v8, v10
  v_sub_f32 v8, 0, v8
  v_cvt_pk_bf16_f32 v10, v8, v8
  v_lshlrev_b32 v10, 16, v10
  v_sub_f32 v11, v8, v10
  v_cvt_pk_bf16_f32 v10, v10, v11
  v_cndmask_b32 v25, 0, v10, s[68:69]
  v_mov_b32 v10, v9
  s_nop 1
  v_permlane32_swap_b32 v9, v10
  s_nop 1
  v_max_f32 v9, v9, v10
  v_sub_f32 v9, 0, v9
  v_cvt_pk_bf16_f32 v10, v9, v9
  v_lshlrev_b32 v10, 16, v10
  v_sub_f32 v11, v9, v10
  v_cvt_pk_bf16_f32 v10, v10, v11
  v_cndmask_b32 v27, 0, v10, s[68:69]
  v_mov_b32 v104, 0
  v_mov_b32 v105, 0
  v_mov_b32 v106, 0
  v_mov_b32 v107, 0
  v_mov_b32 v108, 0
  v_mov_b32 v109, 0
  v_mov_b32 v110, 0
  v_mov_b32 v111, 0
  v_mov_b32 v112, 0
  v_mov_b32 v113, 0
  v_mov_b32 v114, 0
  v_mov_b32 v115, 0
  v_mov_b32 v116, 0
  v_mov_b32 v117, 0
  v_mov_b32 v118, 0
  v_mov_b32 v119, 0
  v_mov_b32 v120, 0
  v_mov_b32 v121, 0
  v_mov_b32 v122, 0
  v_mov_b32 v123, 0
  v_mov_b32 v124, 0
  v_mov_b32 v125, 0
  v_mov_b32 v126, 0
  v_mov_b32 v127, 0
  v_mov_b32 v128, 0
  v_mov_b32 v129, 0
  v_mov_b32 v130, 0
  v_mov_b32 v131, 0
  v_mov_b32 v132, 0
  v_mov_b32 v133, 0
  v_mov_b32 v134, 0
  v_mov_b32 v135, 0
  v_mov_b32 v68, 0
  v_mov_b32 v60, 0
  v_mov_b32 v69, 0
  v_mov_b32 v61, 0
  v_mov_b32 v70, 0
  v_mov_b32 v62, 0
  v_mov_b32_e64 v71, 0
  v_mov_b32 v63, 0
  s_waitcnt lgkmcnt(5)
  v_mfma_f32_32x32x16_bf16 v[72:87], v[32:35], v[16:19], 0
  v_mfma_f32_32x32x8bf16_1k v[72:87], v[40:41], v[24:25], v[72:87]
  s_nop 15
  s_mov_b32 s34, 0
  s_branch L_k2_loop
L_k2_loop:
  v_mfma_f32_32x32x16_bf16 v[88:103], v[32:35], v[20:23], 0
  v_exp_f32 v72, v72
  v_exp_f32 v73, v73
  v_exp_f32 v74, v74
  v_exp_f32_e64 v75, v75
  v_cvt_pk_bf16_f32 v64, v72, v73
  v_cvt_pk_bf16_f32 v65, v74, v75
  v_mfma_f32_32x32x16_bf16 v[120:135], v[60:63], v[68:71], v[120:135]
  ds_read_b64_tr_b16 v[32:33], v13 offset:128
  v_exp_f32 v76, v76
  v_exp_f32 v77, v77
  v_exp_f32 v78, v78
  v_exp_f32 v79, v79
  v_cvt_pk_bf16_f32 v66, v76, v77
  v_cvt_pk_bf16_f32 v67, v78, v79
  v_mfma_f32_32x32x8bf16_1k v[88:103], v[40:41], v[26:27], v[88:103]
  s_waitcnt lgkmcnt(1)
  ds_read_b64_tr_b16 v[34:35], v13 offset:16768
  v_exp_f32 v80, v80
  v_exp_f32 v81, v81
  v_exp_f32 v82, v82
  v_exp_f32_e64 v83, v83
  v_cvt_pk_bf16_f32 v68, v80, v81
  v_cvt_pk_bf16_f32 v69, v82, v83
  v_mfma_f32_32x32x16_bf16 v[104:119], v[48:51], v[64:67], v[104:119]
  ds_read_b64_tr_b16 v[40:41], v14 offset:128
  v_exp_f32 v84, v84
  v_exp_f32 v85, v85
  v_exp_f32 v86, v86
  v_exp_f32 v87, v87
  v_cvt_pk_bf16_f32 v70, v84, v85
  v_cvt_pk_bf16_f32 v71, v86, v87
  v_mfma_f32_32x32x16_bf16 v[72:87], v[36:39], v[16:19], 0
  ds_read_b128 v[56:59], v15 offset:64
  v_exp_f32 v88, v88
  v_exp_f32 v89, v89
  v_exp_f32 v90, v90
  v_exp_f32 v91, v91
  v_cvt_pk_bf16_f32 v64, v88, v89
  v_cvt_pk_bf16_f32 v65, v90, v91
  v_mfma_f32_32x32x16_bf16 v[104:119], v[52:55], v[68:71], v[104:119]
  ds_read_b128 v[60:63], v15 offset:96
  v_exp_f32 v92, v92
  v_exp_f32 v93, v93
  v_exp_f32 v94, v94
  v_exp_f32 v95, v95
  v_cvt_pk_bf16_f32 v66, v92, v93
  v_cvt_pk_bf16_f32 v67, v94, v95
  v_mfma_f32_32x32x8bf16_1k v[72:87], v[42:43], v[24:25], v[72:87]
  v_exp_f32 v96, v96
  v_exp_f32 v97, v97
  v_exp_f32 v98, v98
  v_exp_f32 v99, v99
  v_cvt_pk_bf16_f32 v68, v96, v97
  v_cvt_pk_bf16_f32 v69, v98, v99
  v_mfma_f32_32x32x16_bf16 v[120:135], v[48:51], v[64:67], v[120:135]
  v_exp_f32 v100, v100
  v_exp_f32 v101, v101
  v_exp_f32 v102, v102
  v_exp_f32 v103, v103
  v_cvt_pk_bf16_f32 v70, v100, v101
  v_cvt_pk_bf16_f32 v71, v102, v103
  v_mfma_f32_32x32x16_bf16 v[88:103], v[36:39], v[20:23], 0
  v_exp_f32 v72, v72
  v_exp_f32 v73, v73
  v_exp_f32 v74, v74
  v_exp_f32 v75, v75
  v_cvt_pk_bf16_f32 v64, v72, v73
  v_cvt_pk_bf16_f32 v65, v74, v75
  v_mfma_f32_32x32x16_bf16 v[120:135], v[52:55], v[68:71], v[120:135]
  ds_read_b64_tr_b16 v[36:37], v13 offset:192
  v_exp_f32 v76, v76
  v_exp_f32 v77, v77
  v_exp_f32 v78, v78
  v_exp_f32 v79, v79
  v_cvt_pk_bf16_f32 v66, v76, v77
  v_cvt_pk_bf16_f32 v67, v78, v79
  v_mfma_f32_32x32x8bf16_1k v[88:103], v[42:43], v[26:27], v[88:103]
  s_waitcnt lgkmcnt(1)
  ds_read_b64_tr_b16 v[38:39], v13 offset:16832
  v_exp_f32 v80, v80
  v_exp_f32 v81, v81
  v_exp_f32 v82, v82
  v_exp_f32_e64 v83, v83
  v_cvt_pk_bf16_f32 v68, v80, v81
  v_cvt_pk_bf16_f32 v69, v82, v83
  v_mfma_f32_32x32x16_bf16 v[104:119], v[56:59], v[64:67], v[104:119]
  ds_read_b64_tr_b16 v[42:43], v14 offset:192
  v_exp_f32 v84, v84
  v_exp_f32 v85, v85
  v_exp_f32 v86, v86
  v_exp_f32 v87, v87
  v_cvt_pk_bf16_f32 v70, v84, v85
  v_cvt_pk_bf16_f32 v71, v86, v87
  v_mfma_f32_32x32x16_bf16 v[72:87], v[32:35], v[16:19], 0
  ds_read_b128 v[48:51], v15 offset:128
  v_exp_f32 v88, v88
  v_exp_f32 v89, v89
  v_exp_f32 v90, v90
  v_exp_f32 v91, v91
  v_cvt_pk_bf16_f32 v64, v88, v89
  v_cvt_pk_bf16_f32 v65, v90, v91
  v_mfma_f32_32x32x16_bf16 v[104:119], v[60:63], v[68:71], v[104:119]
  ds_read_b128 v[52:55], v15 offset:160
  v_exp_f32 v92, v92
  v_exp_f32 v93, v93
  v_exp_f32 v94, v94
  v_exp_f32 v95, v95
  v_cvt_pk_bf16_f32 v66, v92, v93
  v_cvt_pk_bf16_f32 v67, v94, v95
  v_mfma_f32_32x32x8bf16_1k v[72:87], v[40:41], v[24:25], v[72:87]
  v_exp_f32 v96, v96
  v_exp_f32 v97, v97
  v_exp_f32 v98, v98
  v_exp_f32 v99, v99
  v_cvt_pk_bf16_f32 v68, v96, v97
  v_cvt_pk_bf16_f32 v69, v98, v99
  v_mfma_f32_32x32x16_bf16 v[120:135], v[56:59], v[64:67], v[120:135]
  v_exp_f32 v100, v100
  v_exp_f32 v101, v101
  v_exp_f32 v102, v102
  v_exp_f32 v103, v103
  v_cvt_pk_bf16_f32 v70, v100, v101
  v_cvt_pk_bf16_f32 v71, v102, v103
  v_mfma_f32_32x32x16_bf16 v[88:103], v[32:35], v[20:23], 0
  v_exp_f32 v72, v72
  v_exp_f32 v73, v73
  v_exp_f32 v74, v74
  v_exp_f32 v75, v75
  v_cvt_pk_bf16_f32 v64, v72, v73
  v_cvt_pk_bf16_f32 v65, v74, v75
  v_mfma_f32_32x32x16_bf16 v[120:135], v[60:63], v[68:71], v[120:135]
  ds_read_b64_tr_b16 v[32:33], v13 offset:256
  v_exp_f32 v76, v76
  v_exp_f32 v77, v77
  v_exp_f32 v78, v78
  v_exp_f32 v79, v79
  v_cvt_pk_bf16_f32 v66, v76, v77
  v_cvt_pk_bf16_f32 v67, v78, v79
  v_mfma_f32_32x32x8bf16_1k v[88:103], v[40:41], v[26:27], v[88:103]
  s_waitcnt lgkmcnt(1)
  ds_read_b64_tr_b16 v[34:35], v13 offset:16896
  v_exp_f32 v80, v80
  v_exp_f32 v81, v81
  v_exp_f32 v82, v82
  v_exp_f32_e64 v83, v83
  v_cvt_pk_bf16_f32 v68, v80, v81
  v_cvt_pk_bf16_f32 v69, v82, v83
  v_mfma_f32_32x32x16_bf16 v[104:119], v[48:51], v[64:67], v[104:119]
  ds_read_b64_tr_b16 v[40:41], v14 offset:256
  v_exp_f32 v84, v84
  v_exp_f32 v85, v85
  v_exp_f32 v86, v86
  v_exp_f32 v87, v87
  v_cvt_pk_bf16_f32 v70, v84, v85
  v_cvt_pk_bf16_f32 v71, v86, v87
  v_mfma_f32_32x32x16_bf16 v[72:87], v[36:39], v[16:19], 0
  ds_read_b128 v[56:59], v15 offset:192
  v_exp_f32 v88, v88
  v_exp_f32 v89, v89
  v_exp_f32 v90, v90
  v_exp_f32 v91, v91
  v_cvt_pk_bf16_f32 v64, v88, v89
  v_cvt_pk_bf16_f32 v65, v90, v91
  v_mfma_f32_32x32x16_bf16 v[104:119], v[52:55], v[68:71], v[104:119]
  ds_read_b128 v[60:63], v15 offset:224
  v_exp_f32 v92, v92
  v_exp_f32 v93, v93
  v_exp_f32 v94, v94
  v_exp_f32 v95, v95
  v_cvt_pk_bf16_f32 v66, v92, v93
  v_cvt_pk_bf16_f32 v67, v94, v95
  v_mfma_f32_32x32x8bf16_1k v[72:87], v[42:43], v[24:25], v[72:87]
  v_exp_f32 v96, v96
  v_exp_f32 v97, v97
  v_exp_f32 v98, v98
  v_exp_f32 v99, v99
  v_cvt_pk_bf16_f32 v68, v96, v97
  v_cvt_pk_bf16_f32 v69, v98, v99
  v_mfma_f32_32x32x16_bf16 v[120:135], v[48:51], v[64:67], v[120:135]
  v_exp_f32 v100, v100
  v_exp_f32 v101, v101
  v_exp_f32 v102, v102
  v_exp_f32 v103, v103
  v_cvt_pk_bf16_f32 v70, v100, v101
  v_cvt_pk_bf16_f32 v71, v102, v103
  v_mfma_f32_32x32x16_bf16 v[88:103], v[36:39], v[20:23], 0
  v_exp_f32 v72, v72
  v_exp_f32 v73, v73
  v_exp_f32 v74, v74
  v_exp_f32 v75, v75
  v_cvt_pk_bf16_f32 v64, v72, v73
  v_cvt_pk_bf16_f32 v65, v74, v75
  v_mfma_f32_32x32x16_bf16 v[120:135], v[52:55], v[68:71], v[120:135]
  ds_read_b64_tr_b16 v[36:37], v13 offset:320
  v_exp_f32 v76, v76
  v_exp_f32 v77, v77
  v_exp_f32 v78, v78
  v_exp_f32 v79, v79
  v_cvt_pk_bf16_f32 v66, v76, v77
  v_cvt_pk_bf16_f32 v67, v78, v79
  v_mfma_f32_32x32x8bf16_1k v[88:103], v[42:43], v[26:27], v[88:103]
  s_waitcnt lgkmcnt(1)
  ds_read_b64_tr_b16 v[38:39], v13 offset:16960
  v_exp_f32 v80, v80
  v_exp_f32 v81, v81
  v_exp_f32 v82, v82
  v_exp_f32_e64 v83, v83
  v_cvt_pk_bf16_f32 v68, v80, v81
  v_cvt_pk_bf16_f32 v69, v82, v83
  v_mfma_f32_32x32x16_bf16 v[104:119], v[56:59], v[64:67], v[104:119]
  ds_read_b64_tr_b16 v[42:43], v14 offset:320
  v_exp_f32 v84, v84
  v_exp_f32 v85, v85
  v_exp_f32 v86, v86
  v_exp_f32 v87, v87
  v_cvt_pk_bf16_f32 v70, v84, v85
  v_cvt_pk_bf16_f32 v71, v86, v87
  v_mfma_f32_32x32x16_bf16 v[72:87], v[32:35], v[16:19], 0
  ds_read_b128 v[48:51], v15 offset:256
  v_exp_f32 v88, v88
  v_exp_f32 v89, v89
  v_exp_f32 v90, v90
  v_exp_f32 v91, v91
  v_cvt_pk_bf16_f32 v64, v88, v89
  v_cvt_pk_bf16_f32 v65, v90, v91
  v_mfma_f32_32x32x16_bf16 v[104:119], v[60:63], v[68:71], v[104:119]
  ds_read_b128 v[52:55], v15 offset:288
  v_exp_f32 v92, v92
  v_exp_f32 v93, v93
  v_exp_f32 v94, v94
  v_exp_f32 v95, v95
  v_cvt_pk_bf16_f32 v66, v92, v93
  v_cvt_pk_bf16_f32 v67, v94, v95
  v_mfma_f32_32x32x8bf16_1k v[72:87], v[40:41], v[24:25], v[72:87]
  v_add_u32 v13, 256, v13
  v_add_u32 v14, 256, v14
  v_add_u32 v15, 256, v15
  v_exp_f32 v96, v96
  v_exp_f32 v97, v97
  v_exp_f32 v98, v98
  v_exp_f32 v99, v99
  v_cvt_pk_bf16_f32 v68, v96, v97
  v_cvt_pk_bf16_f32 v69, v98, v99
  v_mfma_f32_32x32x16_bf16 v[120:135], v[56:59], v[64:67], v[120:135]
  s_add_u32 s34, s34, 1
  s_cmp_lt_u32 s34, 16
  v_exp_f32 v100, v100
  v_exp_f32 v101, v101
  v_exp_f32_e64 v102, v102
  v_exp_f32 v103, v103
  v_cvt_pk_bf16_f32 v70, v100, v101
  v_cvt_pk_bf16_f32 v71, v102, v103
  s_cbranch_scc1 L_k2_loop
  s_branch L_k2_lend
L_k2_slow:
  s_waitcnt vmcnt(0)
  s_mov_b32 m0, s32
  s_nop 0
  buffer_load_dwordx4 v235, s[16:19], s29 offen offset:0 lds
  buffer_load_dwordx4 v235, s[16:19], s45 offen offset:1024 lds
  buffer_load_dwordx4 v235, s[16:19], s46 offen offset:2048 lds
  buffer_load_dwordx4 v235, s[16:19], s47 offen offset:3072 lds
  s_mov_b32 m0, s37
  s_nop 0
  buffer_load_dwordx4 v235, s[16:19], s29 offen offset:64 lds
  buffer_load_dwordx4 v235, s[16:19], s45 offen offset:1088 lds
  buffer_load_dwordx4 v235, s[16:19], s46 offen offset:2112 lds
  buffer_load_dwordx4 v235, s[16:19], s47 offen offset:3136 lds
  s_mov_b32 m0, s38
  s_nop 0
  buffer_load_dwordx4 v235, s[16:19], s29 offen offset:128 lds
  buffer_load_dwordx4 v235, s[16:19], s45 offen offset:1152 lds
  buffer_load_dwordx4 v235, s[16:19], s46 offen offset:2176 lds
  buffer_load_dwordx4 v235, s[16:19], s47 offen offset:3200 lds
  s_mov_b32 m0, s39
  s_nop 0
  buffer_load_dwordx4 v235, s[16:19], s29 offen offset:192 lds
  buffer_load_dwordx4 v235, s[16:19], s45 offen offset:1216 lds
  buffer_load_dwordx4 v235, s[16:19], s46 offen offset:2240 lds
  buffer_load_dwordx4 v235, s[16:19], s47 offen offset:3264 lds
  s_mov_b32 m0, s40
  s_nop 0
  buffer_load_dwordx4 v235, s[16:19], s29 offen offset:256 lds
  buffer_load_dwordx4 v235, s[16:19], s45 offen offset:1280 lds
  buffer_load_dwordx4 v235, s[16:19], s46 offen offset:2304 lds
  buffer_load_dwordx4 v235, s[16:19], s47 offen offset:3328 lds
  s_mov_b32 m0, s41
  s_nop 0
  buffer_load_dwordx4 v235, s[16:19], s29 offen offset:320 lds
  buffer_load_dwordx4 v235, s[16:19], s45 offen offset:1344 lds
  buffer_load_dwordx4 v235, s[16:19], s46 offen offset:2368 lds
  buffer_load_dwordx4 v235, s[16:19], s47 offen offset:3392 lds
  s_mov_b32 m0, s42
  s_nop 0
  buffer_load_dwordx4 v235, s[16:19], s29 offen offset:384 lds
  buffer_load_dwordx4 v235, s[16:19], s45 offen offset:1408 lds
  buffer_load_dwordx4 v235, s[16:19], s46 offen offset:2432 lds
  buffer_load_dwordx4 v235, s[16:19], s47 offen offset:3456 lds
  s_mov_b32 m0, s43
  s_nop 0
  buffer_load_dwordx4 v235, s[16:19], s29 offen offset:448 lds
  buffer_load_dwordx4 v235, s[16:19], s45 offen offset:1472 lds
  buffer_load_dwordx4 v235, s[16:19], s46 offen offset:2496 lds
  buffer_load_dwordx4 v235, s[16:19], s47 offen offset:3520 lds
  s_mov_b32 m0, s44
  s_nop 0
  buffer_load_dwordx4 v235, s[16:19], s29 offen offset:512 lds
  buffer_load_dwordx4 v235, s[16:19], s45 offen offset:1536 lds
  buffer_load_dwordx4 v235, s[16:19], s46 offen offset:2560 lds
  buffer_load_dwordx4 v235, s[16:19], s47 offen offset:3584 lds
  s_waitcnt vmcnt(0)
  s_barrier
  s_cmp_lg_u32 s31, 0
  s_cbranch_scc1 L_k2_maxpass
L_k2_join:
  s_barrier
  s_add_u32 m0, s32, 0
  s_add_u32 s13, s52, 0
  buffer_load_dwordx4 v2, s[60:63], s13 offen offset:0 lds
  buffer_load_dwordx4 v2, s[60:63], s13 offen offset:1024 lds
  buffer_load_dwordx4 v2, s[60:63], s13 offen offset:2048 lds
  s_add_u32 m0, s37, 64
  s_add_u32 s13, s52, 3072
  s_add_u32 s34, s52, 145408
  buffer_load_dwordx4 v2, s[60:63], s13 offen offset:0 lds
  buffer_load_dwordx4 v2, s[60:63], s13 offen offset:1024 lds
  buffer_load_dwordx4 v2, s[60:63], s34 offen offset:2048 lds
  s_add_u32 m0, s38, 128
  s_add_u32 s13, s52, 148480
  buffer_load_dwordx4 v2, s[60:63], s13 offen offset:0 lds
  buffer_load_dwordx4 v2, s[60:63], s13 offen offset:1024 lds
  buffer_load_dwordx4 v2, s[60:63], s13 offen offset:2048 lds
  s_add_u32 m0, s39, 192
  s_add_u32 s13, s52, 151552
  s_add_u32 s34, s52, 293888
  buffer_load_dwordx4 v2, s[60:63], s13 offen offset:0 lds
  buffer_load_dwordx4 v2, s[60:63], s34 offen offset:1024 lds
  buffer_load_dwordx4 v2, s[60:63], s34 offen offset:2048 lds
  s_add_u32 m0, s40, 256
  s_add_u32 s13, s52, 296960
  buffer_load_dwordx4 v2, s[60:63], s13 offen offset:0 lds
  buffer_load_dwordx4 v2, s[60:63], s13 offen offset:1024 lds
  buffer_load_dwordx4 v2, s[60:63], s13 offen offset:2048 lds
  s_add_u32 m0, s41, 320
  s_add_u32 s13, s52, 442368
  buffer_load_dwordx4 v2, s[60:63], s13 offen offset:0 lds
  buffer_load_dwordx4 v2, s[60:63], s13 offen offset:1024 lds
  buffer_load_dwordx4 v2, s[60:63], s13 offen offset:2048 lds
  s_add_u32 m0, s42, 384
  s_add_u32 s13, s52, 445440
  buffer_load_dwordx4 v2, s[60:63], s13 offen offset:0 lds
  buffer_load_dwordx4 v2, s[60:63], s13 offen offset:1024 lds
  s_cmp_ge_u32 s12, 2
  s_cbranch_scc1 L_k2_now4b
  s_add_u32 m0, s43, 448
  s_add_u32 s13, s52, 589824
  buffer_load_dwordx4 v2, s[60:63], s13 offen offset:0 lds
  buffer_load_dwordx4 v2, s[60:63], s13 offen offset:1024 lds
  buffer_load_dwordx4 v2, s[60:63], s13 offen offset:2048 lds
  s_add_u32 m0, s44, 512
  s_add_u32 s13, s52, 592896
  buffer_load_dwordx4 v2, s[60:63], s13 offen offset:0 lds
  buffer_load_dwordx4 v2, s[60:63], s13 offen offset:1024 lds
L_k2_now4b:
  s_mov_b32 m0, s54
  s_nop 0
  buffer_load_dwordx4 v138, s[4:7], s53 offen offset:0 lds
  buffer_load_dwordx4 v139, s[4:7], s53 offen offset:1024 lds
  buffer_load_dwordx4 v31, s[4:7], s53 offen offset:2048 lds
  s_waitcnt vmcnt(0)
  s_barrier
  s_branch L_k2_done
L_kb_end:
  s_endpgm
  .fill 3072, 4, 0xbf800000
.section .rodata,"a"
.p2align 6
.amdhsa_kernel sequential_preLN__mha_block__mixer_gmlp__prompt_kernel
  .amdhsa_next_free_vgpr 508
  .amdhsa_next_free_sgpr 102
  .amdhsa_accum_offset 256
  .amdhsa_group_segment_fixed_size 0
  .amdhsa_kernarg_size 88
  .amdhsa_user_sgpr_count 2
  .amdhsa_user_sgpr_kernarg_segment_ptr 1
  .amdhsa_system_sgpr_workgroup_id_x 1
.end_amdhsa_kernel
```
